```python
import torch

def _softmax(x, axis=-1):
    return torch.softmax(x, dim=axis)
def _gelu(x):
    return torch.nn.functional.gelu(x, approximate="tanh")
def _silu(x):
    return torch.nn.functional.silu(x)
def _sigmoid(x):
    return torch.sigmoid(x)
def _layernorm(x, axis=-1, eps=1e-5):
    m = x.mean(dim=axis, keepdim=True)
    v = x.var(dim=axis, keepdim=True, unbiased=False)
    return (x - m) / torch.sqrt(v + eps)
def _scatter_add(tgt, idx, src, axis=0):
    return tgt.clone().index_add_(axis, idx, src)
def _segment_sum(src, seg, n):
    out = torch.zeros((n,) + src.shape[1:], dtype=src.dtype)
    return out.index_add_(0, seg, src)
def _pad(x, pw):
    flat = tuple(v for pair in reversed(pw) for v in pair)
    return torch.nn.functional.pad(x, flat)

kernel_name = 'interleave_layers__linear_kernel_hedgehog__dense_activation_squared_relu__prompt'

def setup_inputs():

    _w = (lambda a: (lambda t: t.to(torch.bfloat16) if t.is_floating_point() else t)(torch.as_tensor(a)))
    def _A_setup():
        B, S, D, H = 1, 2048, 576, 32
        Dh = D // H
        return {
            "x": _w((lambda *s: torch.randn(*s, dtype=torch.bfloat16) * 0.05)(B, S, D)),
            "wqkv": _w((lambda *s: torch.randn(*s, dtype=torch.bfloat16) * 0.2)(D, 3 * D)),
            "w_phi": _w((lambda *s: torch.randn(*s, dtype=torch.bfloat16) * 0.2)(H, Dh, Dh) * (Dh ** -0.5)),
            "wo": _w((lambda *s: torch.randn(*s, dtype=torch.bfloat16) * 0.1)(D, D)),
        }
    _A_in = _A_setup()

    def _B_setup():
        B, S, D, F = 1, 2048, 576, 4608
        return {
            "x": _w((lambda *s: torch.randn(*s, dtype=torch.bfloat16) * 0.05)(B, S, D)),
            "w1": _w((lambda *s: torch.randn(*s, dtype=torch.bfloat16) * 0.05)(D, F)),
            "b1": _w((lambda *s: torch.randn(*s, dtype=torch.bfloat16) * 0.2)(F)),
            "w2": _w((lambda *s: torch.randn(*s, dtype=torch.bfloat16) * 0.05)(F, D)),
            "b2": _w((lambda *s: torch.randn(*s, dtype=torch.bfloat16) * 1.6)(D)),
        }
    _B_in = _B_setup()

    return {
        "A_x": _A_in["x"],
        "A_wqkv": _A_in["wqkv"],
        "A_w_phi": _A_in["w_phi"],
        "A_wo": _A_in["wo"],
        "B_x": _B_in["x"],
        "B_w1": _B_in["w1"],
        "B_b1": _B_in["b1"],
        "B_w2": _B_in["w2"],
        "B_b2": _B_in["b2"],
    }

def reference(A_x, A_wqkv, A_w_phi, A_wo, B_x, B_w1, B_b1, B_w2, B_b2):
    def _A_ref(x, wqkv, w_phi, wo):
        B, S, D = x.shape
        H = 32; Dh = D // H
        qkv = (lambda x, *d: x.permute(*d))((x @ wqkv).reshape(B, S, 3, H, Dh), 2, 0, 3, 1, 4)
        q, k, v = qkv[0], qkv[1], qkv[2]
        pq = torch.einsum("bhsd,hdf->bhsf", q, w_phi)
        pk = torch.einsum("bhsd,hdf->bhsf", k, w_phi)
        phi_q = torch.concatenate([_softmax(pq, axis=-1), _softmax(-pq, axis=-1)], axis=-1)
        phi_k = torch.concatenate([_softmax(pk, axis=-1), _softmax(-pk, axis=-1)], axis=-1)
        kv = torch.einsum("bhsf,bhsd->bhfd", phi_k, v)
        z  = torch.einsum("bhsf->bhf", phi_k)
        num = torch.einsum("bhqf,bhfd->bhqd", phi_q, kv)
        den = torch.einsum("bhqf,bhf->bhq", phi_q, z)[..., None] + 1e-6
        o = num / den
        return (lambda x, *d: x.permute(*d))(o, 0, 2, 1, 3).reshape(B, S, D) @ wo

    def _B_ref(x, w1, b1, w2, b2):
        h = torch.einsum("bsd,df->bsf", x, w1) + b1
        zero = torch.zeros_like(h)
        r = torch.where(h > zero, h, zero)
        h = r * r
        out = torch.einsum("bsf,fd->bsd", h, w2) + b2
        return out

    x = A_x
    x = x + _A_ref(_layernorm(x, axis=-1), A_wqkv, A_w_phi, A_wo)
    x = x + _B_ref(_layernorm(x, axis=-1), B_w1, B_b1, B_w2, B_b2)
    x = x + _A_ref(_layernorm(x, axis=-1), A_wqkv, A_w_phi, A_wo)
    x = x + _B_ref(_layernorm(x, axis=-1), B_w1, B_b1, B_w2, B_b2)
    return x
```

```asm
; @launch kernel=prep_kernel grid=(556,1,1) block=(256,1,1) lds=49152
; @launch kernel=k1l0_kernel grid=(256,1,1) block=(512,1,1) lds=116736
; @launch kernel=k2l0_kernel grid=(256,1,1) block=(512,1,1) lds=147456
; @launch kernel=k3l0_kernel grid=(256,1,1) block=(512,1,1) lds=163840
; @launch kernel=k4l0_kernel grid=(256,1,1) block=(512,1,1) lds=163840
; @launch kernel=k1l1_kernel grid=(256,1,1) block=(512,1,1) lds=116736
; @launch kernel=k2l1_kernel grid=(256,1,1) block=(512,1,1) lds=147456
; @launch kernel=k3l1_kernel grid=(256,1,1) block=(512,1,1) lds=163840
; @launch kernel=k4l1_kernel grid=(256,1,1) block=(512,1,1) lds=163840
.amdgcn_target "amdgcn-amd-amdhsa--gfx950"
.text
.globl prep_kernel
.p2align 8
.type prep_kernel,@function
prep_kernel:
    s_load_dwordx2 s[4:5], s[0:1], 88
    s_load_dwordx2 s[6:7], s[0:1], 0
    s_load_dwordx2 s[8:9], s[0:1], 8
    s_load_dwordx2 s[10:11], s[0:1], 16
    s_load_dwordx2 s[12:13], s[0:1], 24
    s_load_dwordx2 s[14:15], s[0:1], 40
    s_load_dwordx2 s[16:17], s[0:1], 56
    v_and_b32 v1, 63, v0
    v_lshrrev_b32 v2, 6, v0
    s_nop 0
    v_readfirstlane_b32 s3, v2
    v_and_b32 v3, 15, v1
    v_lshrrev_b32 v4, 4, v1
    v_lshlrev_b32 v5, 4, v1
    v_lshrrev_b32 v6, 2, v3
    v_lshlrev_b32 v6, 3, v6
    v_and_b32 v7, 3, v3
    v_add_u32 v6, v6, v7
    s_waitcnt lgkmcnt(0)
    s_lshl_b32 s59, s3, 13
    v_add_u32 v14, s59, v5
    s_cmp_ge_u32 s2, 556
    s_nop 0
    s_cbranch_scc1 .End_prep_kernel_9
    s_cmp_ge_u32 s2, 556
    s_cbranch_scc1 .B2_prep_kernel_4
    s_cmp_ge_u32 s2, 412
    s_cbranch_scc1 .B_prep_kernel_3
    s_cmp_ge_u32 s2, 388
    s_cbranch_scc1 .A2_prep_kernel_2
    s_cmp_ge_u32 s2, 244
    s_cbranch_scc1 .A_prep_kernel_1
    s_cmp_ge_u32 s2, 208
    s_cbranch_scc1 .G_prep_kernel_8
    s_cmp_ge_u32 s2, 200
    s_cbranch_scc1 .F_prep_kernel_7
    s_cmp_ge_u32 s2, 168
    s_cbranch_scc1 .E_prep_kernel_6
    s_cmp_ge_u32 s2, 144
    s_cbranch_scc1 .C_prep_kernel_5
    s_and_b32 s32, s2, 7
    s_lshr_b32 s33, s2, 3
    s_mov_b32 s20, s8
    s_mov_b32 s21, s9
    s_and_b32 s21, s21, 0xffff
    s_mov_b32 s22, 0x1e6000
    s_mov_b32 s23, 0x20000
    s_mov_b32 s24, s4
    s_mov_b32 s25, s5
    s_and_b32 s25, s25, 0xffff
    s_mov_b32 s26, 0x1f8000
    s_mov_b32 s27, 0x20000
    s_mov_b32 s28, s10
    s_mov_b32 s29, s11
    s_and_b32 s29, s29, 0xffff
    s_mov_b32 s30, 0x5100
    s_mov_b32 s31, 0x20000
    s_add_u32 s36, s4, 0x200000
    s_addc_u32 s37, s5, 0
    s_and_b32 s37, s37, 0xffff
    s_mov_b32 s38, 0x1f800
    s_mov_b32 s39, 0x20000
    v_and_b32 v8, 31, v0
    v_lshrrev_b32 v9, 5, v0
    v_and_b32 v10, 1, v9
    v_lshrrev_b32 v11, 1, v9
    v_mul_u32_u24 v12, 3456, v8
    v_mul_u32_u24 v13, 1152, v10
    v_add_u32 v12, v12, v13
    v_mul_u32_u24 v13, 36, v11
    v_add_u32 v12, v12, v13
    v_mul_u32_u24 v14, 3456, v8
    v_add_u32 v14, v14, v13
    v_add_u32 v14, 2304, v14
    v_mul_u32_u24 v15, 1296, v11
    v_lshlrev_b32 v16, 8, v11
    v_lshl_add_u32 v16, v8, 1, v16
    v_add_u32 v16, 6144, v16
    v_cmp_eq_u32 vcc, 0, v10
    s_nop 0
    s_mov_b64 s[40:41], vcc
    s_not_b64 s[42:43], vcc
    s_mul_i32 s35, s32, 144
    s_mul_i32 s44, s33, 110592
    s_add_u32 s35, s35, s44
    s_add_u32 s45, s35, 0
    buffer_load_dwordx4 v[20:23], v12, s[20:23], s45 offen
    buffer_load_dwordx4 v[24:27], v12, s[20:23], s45 offen offset:16
    buffer_load_dword v28, v12, s[20:23], s45 offen offset:32
    buffer_load_dwordx4 v[90:93], v14, s[20:23], s45 offen
    buffer_load_dwordx4 v[94:97], v14, s[20:23], s45 offen offset:16
    buffer_load_dword v98, v14, s[20:23], s45 offen offset:32
    s_mul_i32 s34, s32, 2592
    v_lshlrev_b32 v100, 1, v0
    v_lshlrev_b32 v101, 2, v0
    buffer_load_ushort v102, v100, s[28:31], s34 offen offset:0
    buffer_load_ushort v103, v100, s[28:31], s34 offen offset:512
    buffer_load_ushort v104, v100, s[28:31], s34 offen offset:1024
    buffer_load_ushort v105, v100, s[28:31], s34 offen offset:1536
    buffer_load_ushort v106, v100, s[28:31], s34 offen offset:2048
    buffer_load_ushort v107, v100, s[28:31], s34 offen offset:2560
    s_waitcnt vmcnt(0)
    v_lshlrev_b32 v102, 16, v102
    ds_write_b32 v101, v102 offset:0
    v_lshlrev_b32 v103, 16, v103
    ds_write_b32 v101, v103 offset:1024
    v_lshlrev_b32 v104, 16, v104
    ds_write_b32 v101, v104 offset:2048
    v_lshlrev_b32 v105, 16, v105
    ds_write_b32 v101, v105 offset:3072
    v_lshlrev_b32 v106, 16, v106
    ds_write_b32 v101, v106 offset:4096
    v_lshlrev_b32 v107, 16, v107
    ds_write_b32 v101, v107 offset:5120
    s_waitcnt lgkmcnt(0)
    s_barrier
    s_waitcnt vmcnt(9)
    v_lshlrev_b32 v30, 16, v20
    v_and_b32 v31, 0xffff0000, v20
    v_lshlrev_b32 v32, 16, v21
    v_and_b32 v33, 0xffff0000, v21
    v_lshlrev_b32 v34, 16, v22
    v_and_b32 v35, 0xffff0000, v22
    v_lshlrev_b32 v36, 16, v23
    v_and_b32 v37, 0xffff0000, v23
    v_lshlrev_b32 v38, 16, v24
    v_and_b32 v39, 0xffff0000, v24
    v_lshlrev_b32 v40, 16, v25
    v_and_b32 v41, 0xffff0000, v25
    v_lshlrev_b32 v42, 16, v26
    v_and_b32 v43, 0xffff0000, v26
    v_lshlrev_b32 v44, 16, v27
    v_and_b32 v45, 0xffff0000, v27
    v_lshlrev_b32 v46, 16, v28
    v_and_b32 v47, 0xffff0000, v28
    v_mov_b32 v50, 0
    v_mov_b32 v51, 0
    v_mov_b32 v52, 0
    v_mov_b32 v53, 0
    v_mov_b32 v54, 0
    v_mov_b32 v55, 0
    v_mov_b32 v56, 0
    v_mov_b32 v57, 0
    v_mov_b32 v58, 0
    v_mov_b32 v59, 0
    v_mov_b32 v60, 0
    v_mov_b32 v61, 0
    v_mov_b32 v62, 0
    v_mov_b32 v63, 0
    v_mov_b32 v64, 0
    v_mov_b32 v65, 0
    v_mov_b32 v66, 0
    v_mov_b32 v67, 0
    ds_read_b64 v[70:71], v15 offset:0
    ds_read_b64 v[72:73], v15 offset:8
    ds_read_b64 v[74:75], v15 offset:16
    ds_read_b64 v[76:77], v15 offset:24
    ds_read_b64 v[78:79], v15 offset:32
    ds_read_b64 v[80:81], v15 offset:40
    ds_read_b64 v[82:83], v15 offset:48
    ds_read_b64 v[84:85], v15 offset:56
    ds_read_b64 v[86:87], v15 offset:64
    s_waitcnt lgkmcnt(8)
    v_fmac_f32 v50, v30, v70
    v_fmac_f32 v51, v30, v71
    s_waitcnt lgkmcnt(7)
    v_fmac_f32 v52, v30, v72
    v_fmac_f32 v53, v30, v73
    s_waitcnt lgkmcnt(6)
    v_fmac_f32 v54, v30, v74
    v_fmac_f32 v55, v30, v75
    s_waitcnt lgkmcnt(5)
    v_fmac_f32 v56, v30, v76
    v_fmac_f32 v57, v30, v77
    s_waitcnt lgkmcnt(4)
    v_fmac_f32 v58, v30, v78
    v_fmac_f32 v59, v30, v79
    s_waitcnt lgkmcnt(3)
    v_fmac_f32 v60, v30, v80
    v_fmac_f32 v61, v30, v81
    s_waitcnt lgkmcnt(2)
    v_fmac_f32 v62, v30, v82
    v_fmac_f32 v63, v30, v83
    s_waitcnt lgkmcnt(1)
    v_fmac_f32 v64, v30, v84
    v_fmac_f32 v65, v30, v85
    s_waitcnt lgkmcnt(0)
    v_fmac_f32 v66, v30, v86
    v_fmac_f32 v67, v30, v87
    ds_read_b64 v[70:71], v15 offset:72
    ds_read_b64 v[72:73], v15 offset:80
    ds_read_b64 v[74:75], v15 offset:88
    ds_read_b64 v[76:77], v15 offset:96
    ds_read_b64 v[78:79], v15 offset:104
    ds_read_b64 v[80:81], v15 offset:112
    ds_read_b64 v[82:83], v15 offset:120
    ds_read_b64 v[84:85], v15 offset:128
    ds_read_b64 v[86:87], v15 offset:136
    s_waitcnt lgkmcnt(8)
    v_fmac_f32 v50, v31, v70
    v_fmac_f32 v51, v31, v71
    s_waitcnt lgkmcnt(7)
    v_fmac_f32 v52, v31, v72
    v_fmac_f32 v53, v31, v73
    s_waitcnt lgkmcnt(6)
    v_fmac_f32 v54, v31, v74
    v_fmac_f32 v55, v31, v75
    s_waitcnt lgkmcnt(5)
    v_fmac_f32 v56, v31, v76
    v_fmac_f32 v57, v31, v77
    s_waitcnt lgkmcnt(4)
    v_fmac_f32 v58, v31, v78
    v_fmac_f32 v59, v31, v79
    s_waitcnt lgkmcnt(3)
    v_fmac_f32 v60, v31, v80
    v_fmac_f32 v61, v31, v81
    s_waitcnt lgkmcnt(2)
    v_fmac_f32 v62, v31, v82
    v_fmac_f32 v63, v31, v83
    s_waitcnt lgkmcnt(1)
    v_fmac_f32 v64, v31, v84
    v_fmac_f32 v65, v31, v85
    s_waitcnt lgkmcnt(0)
    v_fmac_f32 v66, v31, v86
    v_fmac_f32 v67, v31, v87
    ds_read_b64 v[70:71], v15 offset:144
    ds_read_b64 v[72:73], v15 offset:152
    ds_read_b64 v[74:75], v15 offset:160
    ds_read_b64 v[76:77], v15 offset:168
    ds_read_b64 v[78:79], v15 offset:176
    ds_read_b64 v[80:81], v15 offset:184
    ds_read_b64 v[82:83], v15 offset:192
    ds_read_b64 v[84:85], v15 offset:200
    ds_read_b64 v[86:87], v15 offset:208
    s_waitcnt lgkmcnt(8)
    v_fmac_f32 v50, v32, v70
    v_fmac_f32 v51, v32, v71
    s_waitcnt lgkmcnt(7)
    v_fmac_f32 v52, v32, v72
    v_fmac_f32 v53, v32, v73
    s_waitcnt lgkmcnt(6)
    v_fmac_f32 v54, v32, v74
    v_fmac_f32 v55, v32, v75
    s_waitcnt lgkmcnt(5)
    v_fmac_f32 v56, v32, v76
    v_fmac_f32 v57, v32, v77
    s_waitcnt lgkmcnt(4)
    v_fmac_f32 v58, v32, v78
    v_fmac_f32 v59, v32, v79
    s_waitcnt lgkmcnt(3)
    v_fmac_f32 v60, v32, v80
    v_fmac_f32 v61, v32, v81
    s_waitcnt lgkmcnt(2)
    v_fmac_f32 v62, v32, v82
    v_fmac_f32 v63, v32, v83
    s_waitcnt lgkmcnt(1)
    v_fmac_f32 v64, v32, v84
    v_fmac_f32 v65, v32, v85
    s_waitcnt lgkmcnt(0)
    v_fmac_f32 v66, v32, v86
    v_fmac_f32 v67, v32, v87
    ds_read_b64 v[70:71], v15 offset:216
    ds_read_b64 v[72:73], v15 offset:224
    ds_read_b64 v[74:75], v15 offset:232
    ds_read_b64 v[76:77], v15 offset:240
    ds_read_b64 v[78:79], v15 offset:248
    ds_read_b64 v[80:81], v15 offset:256
    ds_read_b64 v[82:83], v15 offset:264
    ds_read_b64 v[84:85], v15 offset:272
    ds_read_b64 v[86:87], v15 offset:280
    s_waitcnt lgkmcnt(8)
    v_fmac_f32 v50, v33, v70
    v_fmac_f32 v51, v33, v71
    s_waitcnt lgkmcnt(7)
    v_fmac_f32 v52, v33, v72
    v_fmac_f32 v53, v33, v73
    s_waitcnt lgkmcnt(6)
    v_fmac_f32 v54, v33, v74
    v_fmac_f32 v55, v33, v75
    s_waitcnt lgkmcnt(5)
    v_fmac_f32 v56, v33, v76
    v_fmac_f32 v57, v33, v77
    s_waitcnt lgkmcnt(4)
    v_fmac_f32 v58, v33, v78
    v_fmac_f32 v59, v33, v79
    s_waitcnt lgkmcnt(3)
    v_fmac_f32 v60, v33, v80
    v_fmac_f32 v61, v33, v81
    s_waitcnt lgkmcnt(2)
    v_fmac_f32 v62, v33, v82
    v_fmac_f32 v63, v33, v83
    s_waitcnt lgkmcnt(1)
    v_fmac_f32 v64, v33, v84
    v_fmac_f32 v65, v33, v85
    s_waitcnt lgkmcnt(0)
    v_fmac_f32 v66, v33, v86
    v_fmac_f32 v67, v33, v87
    ds_read_b64 v[70:71], v15 offset:288
    ds_read_b64 v[72:73], v15 offset:296
    ds_read_b64 v[74:75], v15 offset:304
    ds_read_b64 v[76:77], v15 offset:312
    ds_read_b64 v[78:79], v15 offset:320
    ds_read_b64 v[80:81], v15 offset:328
    ds_read_b64 v[82:83], v15 offset:336
    ds_read_b64 v[84:85], v15 offset:344
    ds_read_b64 v[86:87], v15 offset:352
    s_waitcnt lgkmcnt(8)
    v_fmac_f32 v50, v34, v70
    v_fmac_f32 v51, v34, v71
    s_waitcnt lgkmcnt(7)
    v_fmac_f32 v52, v34, v72
    v_fmac_f32 v53, v34, v73
    s_waitcnt lgkmcnt(6)
    v_fmac_f32 v54, v34, v74
    v_fmac_f32 v55, v34, v75
    s_waitcnt lgkmcnt(5)
    v_fmac_f32 v56, v34, v76
    v_fmac_f32 v57, v34, v77
    s_waitcnt lgkmcnt(4)
    v_fmac_f32 v58, v34, v78
    v_fmac_f32 v59, v34, v79
    s_waitcnt lgkmcnt(3)
    v_fmac_f32 v60, v34, v80
    v_fmac_f32 v61, v34, v81
    s_waitcnt lgkmcnt(2)
    v_fmac_f32 v62, v34, v82
    v_fmac_f32 v63, v34, v83
    s_waitcnt lgkmcnt(1)
    v_fmac_f32 v64, v34, v84
    v_fmac_f32 v65, v34, v85
    s_waitcnt lgkmcnt(0)
    v_fmac_f32 v66, v34, v86
    v_fmac_f32 v67, v34, v87
    ds_read_b64 v[70:71], v15 offset:360
    ds_read_b64 v[72:73], v15 offset:368
    ds_read_b64 v[74:75], v15 offset:376
    ds_read_b64 v[76:77], v15 offset:384
    ds_read_b64 v[78:79], v15 offset:392
    ds_read_b64 v[80:81], v15 offset:400
    ds_read_b64 v[82:83], v15 offset:408
    ds_read_b64 v[84:85], v15 offset:416
    ds_read_b64 v[86:87], v15 offset:424
    s_waitcnt lgkmcnt(8)
    v_fmac_f32 v50, v35, v70
    v_fmac_f32 v51, v35, v71
    s_waitcnt lgkmcnt(7)
    v_fmac_f32 v52, v35, v72
    v_fmac_f32 v53, v35, v73
    s_waitcnt lgkmcnt(6)
    v_fmac_f32 v54, v35, v74
    v_fmac_f32 v55, v35, v75
    s_waitcnt lgkmcnt(5)
    v_fmac_f32 v56, v35, v76
    v_fmac_f32 v57, v35, v77
    s_waitcnt lgkmcnt(4)
    v_fmac_f32 v58, v35, v78
    v_fmac_f32 v59, v35, v79
    s_waitcnt lgkmcnt(3)
    v_fmac_f32 v60, v35, v80
    v_fmac_f32 v61, v35, v81
    s_waitcnt lgkmcnt(2)
    v_fmac_f32 v62, v35, v82
    v_fmac_f32 v63, v35, v83
    s_waitcnt lgkmcnt(1)
    v_fmac_f32 v64, v35, v84
    v_fmac_f32 v65, v35, v85
    s_waitcnt lgkmcnt(0)
    v_fmac_f32 v66, v35, v86
    v_fmac_f32 v67, v35, v87
    ds_read_b64 v[70:71], v15 offset:432
    ds_read_b64 v[72:73], v15 offset:440
    ds_read_b64 v[74:75], v15 offset:448
    ds_read_b64 v[76:77], v15 offset:456
    ds_read_b64 v[78:79], v15 offset:464
    ds_read_b64 v[80:81], v15 offset:472
    ds_read_b64 v[82:83], v15 offset:480
    ds_read_b64 v[84:85], v15 offset:488
    ds_read_b64 v[86:87], v15 offset:496
    s_waitcnt lgkmcnt(8)
    v_fmac_f32 v50, v36, v70
    v_fmac_f32 v51, v36, v71
    s_waitcnt lgkmcnt(7)
    v_fmac_f32 v52, v36, v72
    v_fmac_f32 v53, v36, v73
    s_waitcnt lgkmcnt(6)
    v_fmac_f32 v54, v36, v74
    v_fmac_f32 v55, v36, v75
    s_waitcnt lgkmcnt(5)
    v_fmac_f32 v56, v36, v76
    v_fmac_f32 v57, v36, v77
    s_waitcnt lgkmcnt(4)
    v_fmac_f32 v58, v36, v78
    v_fmac_f32 v59, v36, v79
    s_waitcnt lgkmcnt(3)
    v_fmac_f32 v60, v36, v80
    v_fmac_f32 v61, v36, v81
    s_waitcnt lgkmcnt(2)
    v_fmac_f32 v62, v36, v82
    v_fmac_f32 v63, v36, v83
    s_waitcnt lgkmcnt(1)
    v_fmac_f32 v64, v36, v84
    v_fmac_f32 v65, v36, v85
    s_waitcnt lgkmcnt(0)
    v_fmac_f32 v66, v36, v86
    v_fmac_f32 v67, v36, v87
    ds_read_b64 v[70:71], v15 offset:504
    ds_read_b64 v[72:73], v15 offset:512
    ds_read_b64 v[74:75], v15 offset:520
    ds_read_b64 v[76:77], v15 offset:528
    ds_read_b64 v[78:79], v15 offset:536
    ds_read_b64 v[80:81], v15 offset:544
    ds_read_b64 v[82:83], v15 offset:552
    ds_read_b64 v[84:85], v15 offset:560
    ds_read_b64 v[86:87], v15 offset:568
    s_waitcnt lgkmcnt(8)
    v_fmac_f32 v50, v37, v70
    v_fmac_f32 v51, v37, v71
    s_waitcnt lgkmcnt(7)
    v_fmac_f32 v52, v37, v72
    v_fmac_f32 v53, v37, v73
    s_waitcnt lgkmcnt(6)
    v_fmac_f32 v54, v37, v74
    v_fmac_f32 v55, v37, v75
    s_waitcnt lgkmcnt(5)
    v_fmac_f32 v56, v37, v76
    v_fmac_f32 v57, v37, v77
    s_waitcnt lgkmcnt(4)
    v_fmac_f32 v58, v37, v78
    v_fmac_f32 v59, v37, v79
    s_waitcnt lgkmcnt(3)
    v_fmac_f32 v60, v37, v80
    v_fmac_f32 v61, v37, v81
    s_waitcnt lgkmcnt(2)
    v_fmac_f32 v62, v37, v82
    v_fmac_f32 v63, v37, v83
    s_waitcnt lgkmcnt(1)
    v_fmac_f32 v64, v37, v84
    v_fmac_f32 v65, v37, v85
    s_waitcnt lgkmcnt(0)
    v_fmac_f32 v66, v37, v86
    v_fmac_f32 v67, v37, v87
    ds_read_b64 v[70:71], v15 offset:576
    ds_read_b64 v[72:73], v15 offset:584
    ds_read_b64 v[74:75], v15 offset:592
    ds_read_b64 v[76:77], v15 offset:600
    ds_read_b64 v[78:79], v15 offset:608
    ds_read_b64 v[80:81], v15 offset:616
    ds_read_b64 v[82:83], v15 offset:624
    ds_read_b64 v[84:85], v15 offset:632
    ds_read_b64 v[86:87], v15 offset:640
    s_waitcnt lgkmcnt(8)
    v_fmac_f32 v50, v38, v70
    v_fmac_f32 v51, v38, v71
    s_waitcnt lgkmcnt(7)
    v_fmac_f32 v52, v38, v72
    v_fmac_f32 v53, v38, v73
    s_waitcnt lgkmcnt(6)
    v_fmac_f32 v54, v38, v74
    v_fmac_f32 v55, v38, v75
    s_waitcnt lgkmcnt(5)
    v_fmac_f32 v56, v38, v76
    v_fmac_f32 v57, v38, v77
    s_waitcnt lgkmcnt(4)
    v_fmac_f32 v58, v38, v78
    v_fmac_f32 v59, v38, v79
    s_waitcnt lgkmcnt(3)
    v_fmac_f32 v60, v38, v80
    v_fmac_f32 v61, v38, v81
    s_waitcnt lgkmcnt(2)
    v_fmac_f32 v62, v38, v82
    v_fmac_f32 v63, v38, v83
    s_waitcnt lgkmcnt(1)
    v_fmac_f32 v64, v38, v84
    v_fmac_f32 v65, v38, v85
    s_waitcnt lgkmcnt(0)
    v_fmac_f32 v66, v38, v86
    v_fmac_f32 v67, v38, v87
    ds_read_b64 v[70:71], v15 offset:648
    ds_read_b64 v[72:73], v15 offset:656
    ds_read_b64 v[74:75], v15 offset:664
    ds_read_b64 v[76:77], v15 offset:672
    ds_read_b64 v[78:79], v15 offset:680
    ds_read_b64 v[80:81], v15 offset:688
    ds_read_b64 v[82:83], v15 offset:696
    ds_read_b64 v[84:85], v15 offset:704
    ds_read_b64 v[86:87], v15 offset:712
    s_waitcnt lgkmcnt(8)
    v_fmac_f32 v50, v39, v70
    v_fmac_f32 v51, v39, v71
    s_waitcnt lgkmcnt(7)
    v_fmac_f32 v52, v39, v72
    v_fmac_f32 v53, v39, v73
    s_waitcnt lgkmcnt(6)
    v_fmac_f32 v54, v39, v74
    v_fmac_f32 v55, v39, v75
    s_waitcnt lgkmcnt(5)
    v_fmac_f32 v56, v39, v76
    v_fmac_f32 v57, v39, v77
    s_waitcnt lgkmcnt(4)
    v_fmac_f32 v58, v39, v78
    v_fmac_f32 v59, v39, v79
    s_waitcnt lgkmcnt(3)
    v_fmac_f32 v60, v39, v80
    v_fmac_f32 v61, v39, v81
    s_waitcnt lgkmcnt(2)
    v_fmac_f32 v62, v39, v82
    v_fmac_f32 v63, v39, v83
    s_waitcnt lgkmcnt(1)
    v_fmac_f32 v64, v39, v84
    v_fmac_f32 v65, v39, v85
    s_waitcnt lgkmcnt(0)
    v_fmac_f32 v66, v39, v86
    v_fmac_f32 v67, v39, v87
    ds_read_b64 v[70:71], v15 offset:720
    ds_read_b64 v[72:73], v15 offset:728
    ds_read_b64 v[74:75], v15 offset:736
    ds_read_b64 v[76:77], v15 offset:744
    ds_read_b64 v[78:79], v15 offset:752
    ds_read_b64 v[80:81], v15 offset:760
    ds_read_b64 v[82:83], v15 offset:768
    ds_read_b64 v[84:85], v15 offset:776
    ds_read_b64 v[86:87], v15 offset:784
    s_waitcnt lgkmcnt(8)
    v_fmac_f32 v50, v40, v70
    v_fmac_f32 v51, v40, v71
    s_waitcnt lgkmcnt(7)
    v_fmac_f32 v52, v40, v72
    v_fmac_f32 v53, v40, v73
    s_waitcnt lgkmcnt(6)
    v_fmac_f32 v54, v40, v74
    v_fmac_f32 v55, v40, v75
    s_waitcnt lgkmcnt(5)
    v_fmac_f32 v56, v40, v76
    v_fmac_f32 v57, v40, v77
    s_waitcnt lgkmcnt(4)
    v_fmac_f32 v58, v40, v78
    v_fmac_f32 v59, v40, v79
    s_waitcnt lgkmcnt(3)
    v_fmac_f32 v60, v40, v80
    v_fmac_f32 v61, v40, v81
    s_waitcnt lgkmcnt(2)
    v_fmac_f32 v62, v40, v82
    v_fmac_f32 v63, v40, v83
    s_waitcnt lgkmcnt(1)
    v_fmac_f32 v64, v40, v84
    v_fmac_f32 v65, v40, v85
    s_waitcnt lgkmcnt(0)
    v_fmac_f32 v66, v40, v86
    v_fmac_f32 v67, v40, v87
    ds_read_b64 v[70:71], v15 offset:792
    ds_read_b64 v[72:73], v15 offset:800
    ds_read_b64 v[74:75], v15 offset:808
    ds_read_b64 v[76:77], v15 offset:816
    ds_read_b64 v[78:79], v15 offset:824
    ds_read_b64 v[80:81], v15 offset:832
    ds_read_b64 v[82:83], v15 offset:840
    ds_read_b64 v[84:85], v15 offset:848
    ds_read_b64 v[86:87], v15 offset:856
    s_waitcnt lgkmcnt(8)
    v_fmac_f32 v50, v41, v70
    v_fmac_f32 v51, v41, v71
    s_waitcnt lgkmcnt(7)
    v_fmac_f32 v52, v41, v72
    v_fmac_f32 v53, v41, v73
    s_waitcnt lgkmcnt(6)
    v_fmac_f32 v54, v41, v74
    v_fmac_f32 v55, v41, v75
    s_waitcnt lgkmcnt(5)
    v_fmac_f32 v56, v41, v76
    v_fmac_f32 v57, v41, v77
    s_waitcnt lgkmcnt(4)
    v_fmac_f32 v58, v41, v78
    v_fmac_f32 v59, v41, v79
    s_waitcnt lgkmcnt(3)
    v_fmac_f32 v60, v41, v80
    v_fmac_f32 v61, v41, v81
    s_waitcnt lgkmcnt(2)
    v_fmac_f32 v62, v41, v82
    v_fmac_f32 v63, v41, v83
    s_waitcnt lgkmcnt(1)
    v_fmac_f32 v64, v41, v84
    v_fmac_f32 v65, v41, v85
    s_waitcnt lgkmcnt(0)
    v_fmac_f32 v66, v41, v86
    v_fmac_f32 v67, v41, v87
    ds_read_b64 v[70:71], v15 offset:864
    ds_read_b64 v[72:73], v15 offset:872
    ds_read_b64 v[74:75], v15 offset:880
    ds_read_b64 v[76:77], v15 offset:888
    ds_read_b64 v[78:79], v15 offset:896
    ds_read_b64 v[80:81], v15 offset:904
    ds_read_b64 v[82:83], v15 offset:912
    ds_read_b64 v[84:85], v15 offset:920
    ds_read_b64 v[86:87], v15 offset:928
    s_waitcnt lgkmcnt(8)
    v_fmac_f32 v50, v42, v70
    v_fmac_f32 v51, v42, v71
    s_waitcnt lgkmcnt(7)
    v_fmac_f32 v52, v42, v72
    v_fmac_f32 v53, v42, v73
    s_waitcnt lgkmcnt(6)
    v_fmac_f32 v54, v42, v74
    v_fmac_f32 v55, v42, v75
    s_waitcnt lgkmcnt(5)
    v_fmac_f32 v56, v42, v76
    v_fmac_f32 v57, v42, v77
    s_waitcnt lgkmcnt(4)
    v_fmac_f32 v58, v42, v78
    v_fmac_f32 v59, v42, v79
    s_waitcnt lgkmcnt(3)
    v_fmac_f32 v60, v42, v80
    v_fmac_f32 v61, v42, v81
    s_waitcnt lgkmcnt(2)
    v_fmac_f32 v62, v42, v82
    v_fmac_f32 v63, v42, v83
    s_waitcnt lgkmcnt(1)
    v_fmac_f32 v64, v42, v84
    v_fmac_f32 v65, v42, v85
    s_waitcnt lgkmcnt(0)
    v_fmac_f32 v66, v42, v86
    v_fmac_f32 v67, v42, v87
    ds_read_b64 v[70:71], v15 offset:936
    ds_read_b64 v[72:73], v15 offset:944
    ds_read_b64 v[74:75], v15 offset:952
    ds_read_b64 v[76:77], v15 offset:960
    ds_read_b64 v[78:79], v15 offset:968
    ds_read_b64 v[80:81], v15 offset:976
    ds_read_b64 v[82:83], v15 offset:984
    ds_read_b64 v[84:85], v15 offset:992
    ds_read_b64 v[86:87], v15 offset:1000
    s_waitcnt lgkmcnt(8)
    v_fmac_f32 v50, v43, v70
    v_fmac_f32 v51, v43, v71
    s_waitcnt lgkmcnt(7)
    v_fmac_f32 v52, v43, v72
    v_fmac_f32 v53, v43, v73
    s_waitcnt lgkmcnt(6)
    v_fmac_f32 v54, v43, v74
    v_fmac_f32 v55, v43, v75
    s_waitcnt lgkmcnt(5)
    v_fmac_f32 v56, v43, v76
    v_fmac_f32 v57, v43, v77
    s_waitcnt lgkmcnt(4)
    v_fmac_f32 v58, v43, v78
    v_fmac_f32 v59, v43, v79
    s_waitcnt lgkmcnt(3)
    v_fmac_f32 v60, v43, v80
    v_fmac_f32 v61, v43, v81
    s_waitcnt lgkmcnt(2)
    v_fmac_f32 v62, v43, v82
    v_fmac_f32 v63, v43, v83
    s_waitcnt lgkmcnt(1)
    v_fmac_f32 v64, v43, v84
    v_fmac_f32 v65, v43, v85
    s_waitcnt lgkmcnt(0)
    v_fmac_f32 v66, v43, v86
    v_fmac_f32 v67, v43, v87
    ds_read_b64 v[70:71], v15 offset:1008
    ds_read_b64 v[72:73], v15 offset:1016
    ds_read_b64 v[74:75], v15 offset:1024
    ds_read_b64 v[76:77], v15 offset:1032
    ds_read_b64 v[78:79], v15 offset:1040
    ds_read_b64 v[80:81], v15 offset:1048
    ds_read_b64 v[82:83], v15 offset:1056
    ds_read_b64 v[84:85], v15 offset:1064
    ds_read_b64 v[86:87], v15 offset:1072
    s_waitcnt lgkmcnt(8)
    v_fmac_f32 v50, v44, v70
    v_fmac_f32 v51, v44, v71
    s_waitcnt lgkmcnt(7)
    v_fmac_f32 v52, v44, v72
    v_fmac_f32 v53, v44, v73
    s_waitcnt lgkmcnt(6)
    v_fmac_f32 v54, v44, v74
    v_fmac_f32 v55, v44, v75
    s_waitcnt lgkmcnt(5)
    v_fmac_f32 v56, v44, v76
    v_fmac_f32 v57, v44, v77
    s_waitcnt lgkmcnt(4)
    v_fmac_f32 v58, v44, v78
    v_fmac_f32 v59, v44, v79
    s_waitcnt lgkmcnt(3)
    v_fmac_f32 v60, v44, v80
    v_fmac_f32 v61, v44, v81
    s_waitcnt lgkmcnt(2)
    v_fmac_f32 v62, v44, v82
    v_fmac_f32 v63, v44, v83
    s_waitcnt lgkmcnt(1)
    v_fmac_f32 v64, v44, v84
    v_fmac_f32 v65, v44, v85
    s_waitcnt lgkmcnt(0)
    v_fmac_f32 v66, v44, v86
    v_fmac_f32 v67, v44, v87
    ds_read_b64 v[70:71], v15 offset:1080
    ds_read_b64 v[72:73], v15 offset:1088
    ds_read_b64 v[74:75], v15 offset:1096
    ds_read_b64 v[76:77], v15 offset:1104
    ds_read_b64 v[78:79], v15 offset:1112
    ds_read_b64 v[80:81], v15 offset:1120
    ds_read_b64 v[82:83], v15 offset:1128
    ds_read_b64 v[84:85], v15 offset:1136
    ds_read_b64 v[86:87], v15 offset:1144
    s_waitcnt lgkmcnt(8)
    v_fmac_f32 v50, v45, v70
    v_fmac_f32 v51, v45, v71
    s_waitcnt lgkmcnt(7)
    v_fmac_f32 v52, v45, v72
    v_fmac_f32 v53, v45, v73
    s_waitcnt lgkmcnt(6)
    v_fmac_f32 v54, v45, v74
    v_fmac_f32 v55, v45, v75
    s_waitcnt lgkmcnt(5)
    v_fmac_f32 v56, v45, v76
    v_fmac_f32 v57, v45, v77
    s_waitcnt lgkmcnt(4)
    v_fmac_f32 v58, v45, v78
    v_fmac_f32 v59, v45, v79
    s_waitcnt lgkmcnt(3)
    v_fmac_f32 v60, v45, v80
    v_fmac_f32 v61, v45, v81
    s_waitcnt lgkmcnt(2)
    v_fmac_f32 v62, v45, v82
    v_fmac_f32 v63, v45, v83
    s_waitcnt lgkmcnt(1)
    v_fmac_f32 v64, v45, v84
    v_fmac_f32 v65, v45, v85
    s_waitcnt lgkmcnt(0)
    v_fmac_f32 v66, v45, v86
    v_fmac_f32 v67, v45, v87
    ds_read_b64 v[70:71], v15 offset:1152
    ds_read_b64 v[72:73], v15 offset:1160
    ds_read_b64 v[74:75], v15 offset:1168
    ds_read_b64 v[76:77], v15 offset:1176
    ds_read_b64 v[78:79], v15 offset:1184
    ds_read_b64 v[80:81], v15 offset:1192
    ds_read_b64 v[82:83], v15 offset:1200
    ds_read_b64 v[84:85], v15 offset:1208
    ds_read_b64 v[86:87], v15 offset:1216
    s_waitcnt lgkmcnt(8)
    v_fmac_f32 v50, v46, v70
    v_fmac_f32 v51, v46, v71
    s_waitcnt lgkmcnt(7)
    v_fmac_f32 v52, v46, v72
    v_fmac_f32 v53, v46, v73
    s_waitcnt lgkmcnt(6)
    v_fmac_f32 v54, v46, v74
    v_fmac_f32 v55, v46, v75
    s_waitcnt lgkmcnt(5)
    v_fmac_f32 v56, v46, v76
    v_fmac_f32 v57, v46, v77
    s_waitcnt lgkmcnt(4)
    v_fmac_f32 v58, v46, v78
    v_fmac_f32 v59, v46, v79
    s_waitcnt lgkmcnt(3)
    v_fmac_f32 v60, v46, v80
    v_fmac_f32 v61, v46, v81
    s_waitcnt lgkmcnt(2)
    v_fmac_f32 v62, v46, v82
    v_fmac_f32 v63, v46, v83
    s_waitcnt lgkmcnt(1)
    v_fmac_f32 v64, v46, v84
    v_fmac_f32 v65, v46, v85
    s_waitcnt lgkmcnt(0)
    v_fmac_f32 v66, v46, v86
    v_fmac_f32 v67, v46, v87
    ds_read_b64 v[70:71], v15 offset:1224
    ds_read_b64 v[72:73], v15 offset:1232
    ds_read_b64 v[74:75], v15 offset:1240
    ds_read_b64 v[76:77], v15 offset:1248
    ds_read_b64 v[78:79], v15 offset:1256
    ds_read_b64 v[80:81], v15 offset:1264
    ds_read_b64 v[82:83], v15 offset:1272
    ds_read_b64 v[84:85], v15 offset:1280
    ds_read_b64 v[86:87], v15 offset:1288
    s_waitcnt lgkmcnt(8)
    v_fmac_f32 v50, v47, v70
    v_fmac_f32 v51, v47, v71
    s_waitcnt lgkmcnt(7)
    v_fmac_f32 v52, v47, v72
    v_fmac_f32 v53, v47, v73
    s_waitcnt lgkmcnt(6)
    v_fmac_f32 v54, v47, v74
    v_fmac_f32 v55, v47, v75
    s_waitcnt lgkmcnt(5)
    v_fmac_f32 v56, v47, v76
    v_fmac_f32 v57, v47, v77
    s_waitcnt lgkmcnt(4)
    v_fmac_f32 v58, v47, v78
    v_fmac_f32 v59, v47, v79
    s_waitcnt lgkmcnt(3)
    v_fmac_f32 v60, v47, v80
    v_fmac_f32 v61, v47, v81
    s_waitcnt lgkmcnt(2)
    v_fmac_f32 v62, v47, v82
    v_fmac_f32 v63, v47, v83
    s_waitcnt lgkmcnt(1)
    v_fmac_f32 v64, v47, v84
    v_fmac_f32 v65, v47, v85
    s_waitcnt lgkmcnt(0)
    v_fmac_f32 v66, v47, v86
    v_fmac_f32 v67, v47, v87
    v_cvt_pk_bf16_f32 v20, v50, v51
    v_cvt_pk_bf16_f32 v21, v52, v53
    v_cvt_pk_bf16_f32 v22, v54, v55
    v_cvt_pk_bf16_f32 v23, v56, v57
    v_cvt_pk_bf16_f32 v24, v58, v59
    v_cvt_pk_bf16_f32 v25, v60, v61
    v_cvt_pk_bf16_f32 v26, v62, v63
    v_cvt_pk_bf16_f32 v27, v64, v65
    v_cvt_pk_bf16_f32 v28, v66, v67
    s_mov_b64 exec, s[40:41]
    ds_write_b16 v16, v20 offset:0
    ds_write_b16_d16_hi v16, v20 offset:64
    ds_write_b16 v16, v21 offset:128
    ds_write_b16_d16_hi v16, v21 offset:192
    ds_write_b16 v16, v22 offset:1024
    ds_write_b16_d16_hi v16, v22 offset:1088
    ds_write_b16 v16, v23 offset:1152
    ds_write_b16_d16_hi v16, v23 offset:1216
    ds_write_b16 v16, v24 offset:2048
    ds_write_b16_d16_hi v16, v24 offset:2112
    ds_write_b16 v16, v25 offset:2176
    ds_write_b16_d16_hi v16, v25 offset:2240
    ds_write_b16 v16, v26 offset:3072
    ds_write_b16_d16_hi v16, v26 offset:3136
    ds_write_b16 v16, v27 offset:3200
    ds_write_b16_d16_hi v16, v27 offset:3264
    ds_write_b16 v16, v28 offset:4096
    ds_write_b16_d16_hi v16, v28 offset:4160
    s_waitcnt vmcnt(0)
    ds_write_b16 v16, v90 offset:9344
    ds_write_b16_d16_hi v16, v90 offset:9408
    ds_write_b16 v16, v91 offset:10240
    ds_write_b16_d16_hi v16, v91 offset:10304
    ds_write_b16 v16, v92 offset:10368
    ds_write_b16_d16_hi v16, v92 offset:10432
    ds_write_b16 v16, v93 offset:11264
    ds_write_b16_d16_hi v16, v93 offset:11328
    ds_write_b16 v16, v94 offset:11392
    ds_write_b16_d16_hi v16, v94 offset:11456
    ds_write_b16 v16, v95 offset:12288
    ds_write_b16_d16_hi v16, v95 offset:12352
    ds_write_b16 v16, v96 offset:12416
    ds_write_b16_d16_hi v16, v96 offset:12480
    ds_write_b16 v16, v97 offset:13312
    ds_write_b16_d16_hi v16, v97 offset:13376
    ds_write_b16 v16, v98 offset:13440
    ds_write_b16_d16_hi v16, v98 offset:13504
    s_mov_b64 exec, s[42:43]
    ds_write_b16 v16, v20 offset:5120
    ds_write_b16_d16_hi v16, v20 offset:5184
    ds_write_b16 v16, v21 offset:5248
    ds_write_b16_d16_hi v16, v21 offset:5312
    ds_write_b16 v16, v22 offset:6144
    ds_write_b16_d16_hi v16, v22 offset:6208
    ds_write_b16 v16, v23 offset:6272
    ds_write_b16_d16_hi v16, v23 offset:6336
    ds_write_b16 v16, v24 offset:7168
    ds_write_b16_d16_hi v16, v24 offset:7232
    ds_write_b16 v16, v25 offset:7296
    ds_write_b16_d16_hi v16, v25 offset:7360
    ds_write_b16 v16, v26 offset:8192
    ds_write_b16_d16_hi v16, v26 offset:8256
    ds_write_b16 v16, v27 offset:8320
    ds_write_b16_d16_hi v16, v27 offset:8384
    ds_write_b16 v16, v28 offset:9216
    ds_write_b16_d16_hi v16, v28 offset:9280
    v_mov_b32 v70, 0
    ds_write_b16 v16, v70 offset:4224
    ds_write_b16 v16, v70 offset:4288
    s_mov_b64 exec, -1
    s_waitcnt lgkmcnt(0)
    s_barrier
    v_lshlrev_b32 v8, 6, v3
    v_lshl_add_u32 v8, v4, 4, v8
    s_lshl_b32 s46, s3, 10
    v_add_u32 v8, s46, v8
    v_add_u32 v8, 6144, v8
    s_mul_i32 s47, s32, 18
    s_add_u32 s47, s47, s33
    s_mul_i32 s47, s47, 14336
    s_add_u32 s47, s47, s46
    s_lshl_b32 s49, s33, 3
    s_add_u32 s49, s49, s32
    s_mul_i32 s49, s49, 896
    s_lshl_b32 s50, s3, 6
    s_add_u32 s49, s49, s50
    v_lshlrev_b32 v9, 2, v3
    v_mov_b32 v10, 0x7ff00000
    v_cmp_gt_u32 vcc, 16, v1
    s_nop 1
    v_cndmask_b32 v9, v10, v9, vcc
    ds_read_b128 v[20:23], v8 offset:0
    v_mov_b32 v40, 0
    s_waitcnt lgkmcnt(0)
    s_add_u32 s51, s47, 0
    buffer_store_dwordx4 v[20:23], v5, s[24:27], s51 offen
    v_lshlrev_b32 v41, 16, v20
    v_and_b32 v42, 0xffff0000, v20
    v_add_f32 v40, v40, v41
    v_add_f32 v40, v40, v42
    v_lshlrev_b32 v41, 16, v21
    v_and_b32 v42, 0xffff0000, v21
    v_add_f32 v40, v40, v41
    v_add_f32 v40, v40, v42
    v_lshlrev_b32 v41, 16, v22
    v_and_b32 v42, 0xffff0000, v22
    v_add_f32 v40, v40, v41
    v_add_f32 v40, v40, v42
    v_lshlrev_b32 v41, 16, v23
    v_and_b32 v42, 0xffff0000, v23
    v_add_f32 v40, v40, v41
    v_add_f32 v40, v40, v42
    v_mov_b32 v41, v40
    s_nop 1
    v_permlane16_swap_b32 v40, v41
    v_add_f32 v40, v40, v41
    v_mov_b32 v41, v40
    s_nop 1
    v_permlane32_swap_b32 v40, v41
    v_add_f32 v40, v40, v41
    s_add_u32 s51, s49, 0
    buffer_store_dword v40, v9, s[36:39], s51 offen
    ds_read_b128 v[20:23], v8 offset:4096
    v_mov_b32 v40, 0
    s_waitcnt lgkmcnt(0)
    s_add_u32 s51, s47, 4096
    buffer_store_dwordx4 v[20:23], v5, s[24:27], s51 offen
    v_lshlrev_b32 v41, 16, v20
    v_and_b32 v42, 0xffff0000, v20
    v_add_f32 v40, v40, v41
    v_add_f32 v40, v40, v42
    v_lshlrev_b32 v41, 16, v21
    v_and_b32 v42, 0xffff0000, v21
    v_add_f32 v40, v40, v41
    v_add_f32 v40, v40, v42
    v_lshlrev_b32 v41, 16, v22
    v_and_b32 v42, 0xffff0000, v22
    v_add_f32 v40, v40, v41
    v_add_f32 v40, v40, v42
    v_lshlrev_b32 v41, 16, v23
    v_and_b32 v42, 0xffff0000, v23
    v_add_f32 v40, v40, v41
    v_add_f32 v40, v40, v42
    v_mov_b32 v41, v40
    s_nop 1
    v_permlane16_swap_b32 v40, v41
    v_add_f32 v40, v40, v41
    v_mov_b32 v41, v40
    s_nop 1
    v_permlane32_swap_b32 v40, v41
    v_add_f32 v40, v40, v41
    s_add_u32 s51, s49, 256
    buffer_store_dword v40, v9, s[36:39], s51 offen
    ds_read_b128 v[20:23], v8 offset:8192
    v_mov_b32 v40, 0
    s_waitcnt lgkmcnt(0)
    s_add_u32 s51, s47, 8192
    buffer_store_dwordx4 v[20:23], v5, s[24:27], s51 offen
    v_lshlrev_b32 v41, 16, v20
    v_and_b32 v42, 0xffff0000, v20
    v_add_f32 v40, v40, v41
    v_add_f32 v40, v40, v42
    v_lshlrev_b32 v41, 16, v21
    v_and_b32 v42, 0xffff0000, v21
    v_add_f32 v40, v40, v41
    v_add_f32 v40, v40, v42
    v_lshlrev_b32 v41, 16, v22
    v_and_b32 v42, 0xffff0000, v22
    v_add_f32 v40, v40, v41
    v_add_f32 v40, v40, v42
    v_lshlrev_b32 v41, 16, v23
    v_and_b32 v42, 0xffff0000, v23
    v_add_f32 v40, v40, v41
    v_add_f32 v40, v40, v42
    v_mov_b32 v41, v40
    s_nop 1
    v_permlane16_swap_b32 v40, v41
    v_add_f32 v40, v40, v41
    v_mov_b32 v41, v40
    s_nop 1
    v_permlane32_swap_b32 v40, v41
    v_add_f32 v40, v40, v41
    s_add_u32 s51, s49, 512
    buffer_store_dword v40, v9, s[36:39], s51 offen
    s_cmp_ge_u32 s3, 2
    s_cbranch_scc1 .Dskip_prep_kernel_10
    ds_read_b128 v[20:23], v8 offset:12288
    v_mov_b32 v40, 0
    s_waitcnt lgkmcnt(0)
    s_add_u32 s51, s47, 12288
    buffer_store_dwordx4 v[20:23], v5, s[24:27], s51 offen
    v_lshlrev_b32 v41, 16, v20
    v_and_b32 v42, 0xffff0000, v20
    v_add_f32 v40, v40, v41
    v_add_f32 v40, v40, v42
    v_lshlrev_b32 v41, 16, v21
    v_and_b32 v42, 0xffff0000, v21
    v_add_f32 v40, v40, v41
    v_add_f32 v40, v40, v42
    v_lshlrev_b32 v41, 16, v22
    v_and_b32 v42, 0xffff0000, v22
    v_add_f32 v40, v40, v41
    v_add_f32 v40, v40, v42
    v_lshlrev_b32 v41, 16, v23
    v_and_b32 v42, 0xffff0000, v23
    v_add_f32 v40, v40, v41
    v_add_f32 v40, v40, v42
    v_mov_b32 v41, v40
    s_nop 1
    v_permlane16_swap_b32 v40, v41
    v_add_f32 v40, v40, v41
    v_mov_b32 v41, v40
    s_nop 1
    v_permlane32_swap_b32 v40, v41
    v_add_f32 v40, v40, v41
    s_add_u32 s51, s49, 768
    buffer_store_dword v40, v9, s[36:39], s51 offen
.Dskip_prep_kernel_10:
    s_branch .End_prep_kernel_9
.A_prep_kernel_1:
    s_mov_b32 s62, 0x05040100
    s_mov_b32 s63, 0x07060302
    s_sub_u32 s32, s2, 244
    s_lshl_b32 s32, s32, 2
    s_add_u32 s32, s32, s3
    s_mul_i32 s33, s32, 3641
    s_lshr_b32 s33, s33, 16
    s_mul_i32 s34, s33, 18
    s_sub_u32 s34, s32, s34
    s_mov_b32 s20, s14
    s_mov_b32 s21, s15
    s_and_b32 s21, s21, 0xffff
    s_mov_b32 s22, 0x510000
    s_mov_b32 s23, 0x20000
    s_add_u32 s24, s4, 0x800000
    s_addc_u32 s25, s5, 0
    s_and_b32 s25, s25, 0xffff
    s_mov_b32 s26, 0x510000
    s_mov_b32 s27, 0x20000
    v_mul_u32_u24 v8, 73728, v4
    v_lshl_add_u32 v8, v3, 4, v8
    s_mul_i32 s35, s34, 294912
    s_mul_i32 s36, s33, 288
    s_add_u32 s35, s35, s36
    s_add_u32 s37, s35, 0
    buffer_load_dwordx4 v[16:19], v8, s[20:23], s37 offen
    s_add_u32 s37, s35, 9216
    buffer_load_dwordx4 v[20:23], v8, s[20:23], s37 offen
    s_add_u32 s37, s35, 18432
    buffer_load_dwordx4 v[24:27], v8, s[20:23], s37 offen
    s_add_u32 s37, s35, 27648
    buffer_load_dwordx4 v[28:31], v8, s[20:23], s37 offen
    s_add_u32 s37, s35, 36864
    buffer_load_dwordx4 v[32:35], v8, s[20:23], s37 offen
    s_add_u32 s37, s35, 46080
    buffer_load_dwordx4 v[36:39], v8, s[20:23], s37 offen
    s_add_u32 s37, s35, 55296
    buffer_load_dwordx4 v[40:43], v8, s[20:23], s37 offen
    s_add_u32 s37, s35, 64512
    buffer_load_dwordx4 v[44:47], v8, s[20:23], s37 offen
    v_lshrrev_b32 v9, 2, v3
    v_lshlrev_b32 v9, 11, v9
    v_lshl_add_u32 v9, v4, 8, v9
    v_and_b32 v10, 3, v3
    v_lshl_add_u32 v9, v10, 6, v9
    v_add_u32 v9, s59, v9
    s_mul_i32 s38, s32, 9216
    s_waitcnt vmcnt(0)
    v_perm_b32 v48, v20, v16, s62
    v_perm_b32 v49, v28, v24, s62
    v_perm_b32 v50, v36, v32, s62
    v_perm_b32 v51, v44, v40, s62
    ds_write_b128 v9, v[48:51] offset:0
    v_perm_b32 v52, v20, v16, s63
    v_perm_b32 v53, v28, v24, s63
    v_perm_b32 v54, v36, v32, s63
    v_perm_b32 v55, v44, v40, s63
    ds_write_b128 v9, v[52:55] offset:16
    v_perm_b32 v56, v21, v17, s62
    v_perm_b32 v57, v29, v25, s62
    v_perm_b32 v58, v37, v33, s62
    v_perm_b32 v59, v45, v41, s62
    ds_write_b128 v9, v[56:59] offset:32
    v_perm_b32 v60, v21, v17, s63
    v_perm_b32 v61, v29, v25, s63
    v_perm_b32 v62, v37, v33, s63
    v_perm_b32 v63, v45, v41, s63
    ds_write_b128 v9, v[60:63] offset:48
    v_perm_b32 v48, v22, v18, s62
    v_perm_b32 v49, v30, v26, s62
    v_perm_b32 v50, v38, v34, s62
    v_perm_b32 v51, v46, v42, s62
    ds_write_b128 v9, v[48:51] offset:1024
    v_perm_b32 v52, v22, v18, s63
    v_perm_b32 v53, v30, v26, s63
    v_perm_b32 v54, v38, v34, s63
    v_perm_b32 v55, v46, v42, s63
    ds_write_b128 v9, v[52:55] offset:1040
    v_perm_b32 v56, v23, v19, s62
    v_perm_b32 v57, v31, v27, s62
    v_perm_b32 v58, v39, v35, s62
    v_perm_b32 v59, v47, v43, s62
    ds_write_b128 v9, v[56:59] offset:1056
    v_perm_b32 v60, v23, v19, s63
    v_perm_b32 v61, v31, v27, s63
    v_perm_b32 v62, v39, v35, s63
    v_perm_b32 v63, v47, v43, s63
    ds_write_b128 v9, v[60:63] offset:1072
    ds_read_b128 v[16:19], v14 offset:0
    ds_read_b128 v[20:23], v14 offset:1024
    ds_read_b128 v[24:27], v14 offset:2048
    ds_read_b128 v[28:31], v14 offset:3072
    ds_read_b128 v[32:35], v14 offset:4096
    ds_read_b128 v[36:39], v14 offset:5120
    ds_read_b128 v[40:43], v14 offset:6144
    ds_read_b128 v[44:47], v14 offset:7168
    s_waitcnt lgkmcnt(7)
    s_add_u32 s61, s38, 0
    buffer_store_dwordx4 v[16:19], v5, s[24:27], s61 offen
    s_waitcnt lgkmcnt(6)
    s_add_u32 s61, s38, 1024
    buffer_store_dwordx4 v[20:23], v5, s[24:27], s61 offen
    s_waitcnt lgkmcnt(5)
    s_add_u32 s61, s38, 2048
    buffer_store_dwordx4 v[24:27], v5, s[24:27], s61 offen
    s_waitcnt lgkmcnt(4)
    s_add_u32 s61, s38, 3072
    buffer_store_dwordx4 v[28:31], v5, s[24:27], s61 offen
    s_waitcnt lgkmcnt(3)
    s_add_u32 s61, s38, 4096
    buffer_store_dwordx4 v[32:35], v5, s[24:27], s61 offen
    s_waitcnt lgkmcnt(2)
    s_add_u32 s61, s38, 5120
    buffer_store_dwordx4 v[36:39], v5, s[24:27], s61 offen
    s_waitcnt lgkmcnt(1)
    s_add_u32 s61, s38, 6144
    buffer_store_dwordx4 v[40:43], v5, s[24:27], s61 offen
    s_waitcnt lgkmcnt(0)
    s_add_u32 s61, s38, 7168
    buffer_store_dwordx4 v[44:47], v5, s[24:27], s61 offen
    s_nop 1
    s_branch .End_prep_kernel_9
.A2_prep_kernel_2:
    s_mov_b32 s62, 0x05040100
    s_mov_b32 s63, 0x07060302
    s_sub_u32 s32, s2, 388
    s_lshl_b32 s32, s32, 2
    s_add_u32 s32, s32, s3
    s_mul_i32 s33, s32, 21846
    s_lshr_b32 s33, s33, 16
    s_mul_i32 s34, s33, 3
    s_sub_u32 s34, s32, s34
    s_mov_b32 s20, s14
    s_mov_b32 s21, s15
    s_and_b32 s21, s21, 0xffff
    s_mov_b32 s22, 0x510000
    s_mov_b32 s23, 0x20000
    s_add_u32 s24, s4, 0x800000
    s_addc_u32 s25, s5, 0
    s_and_b32 s25, s25, 0xffff
    s_mov_b32 s26, 0x510000
    s_mov_b32 s27, 0x20000
    v_lshrrev_b32 v8, 3, v1
    v_bfe_u32 v9, v1, 1, 2
    v_and_b32 v10, 1, v1
    v_mul_u32_u24 v11, 294912, v8
    v_mul_u32_u24 v12, 73728, v9
    v_add_u32 v11, v11, v12
    v_lshl_add_u32 v11, v10, 4, v11
    v_mov_b32 v13, 0x7ff00000
    v_cmp_gt_u32 vcc, 6, v8
    s_nop 1
    v_cndmask_b32 v11, v13, v11, vcc
    s_mul_i32 s35, s34, 1769472
    s_mul_i32 s36, s33, 288
    s_add_u32 s35, s35, s36
    s_add_u32 s35, s35, 256
    s_add_u32 s37, s35, 0
    buffer_load_dwordx4 v[16:19], v11, s[20:23], s37 offen
    s_add_u32 s37, s35, 9216
    buffer_load_dwordx4 v[20:23], v11, s[20:23], s37 offen
    s_add_u32 s37, s35, 18432
    buffer_load_dwordx4 v[24:27], v11, s[20:23], s37 offen
    s_add_u32 s37, s35, 27648
    buffer_load_dwordx4 v[28:31], v11, s[20:23], s37 offen
    s_add_u32 s37, s35, 36864
    buffer_load_dwordx4 v[32:35], v11, s[20:23], s37 offen
    s_add_u32 s37, s35, 46080
    buffer_load_dwordx4 v[36:39], v11, s[20:23], s37 offen
    s_add_u32 s37, s35, 55296
    buffer_load_dwordx4 v[40:43], v11, s[20:23], s37 offen
    s_add_u32 s37, s35, 64512
    buffer_load_dwordx4 v[44:47], v11, s[20:23], s37 offen
    v_mul_u32_u24 v12, 9216, v8
    v_lshl_add_u32 v12, v9, 8, v12
    v_lshl_add_u32 v12, v10, 7, v12
    v_cndmask_b32 v12, v13, v12, vcc
    s_mul_i32 s38, s33, 18
    s_mul_i32 s39, s34, 6
    s_add_u32 s38, s38, s39
    s_mul_i32 s38, s38, 9216
    s_add_u32 s38, s38, 8192
    s_waitcnt vmcnt(0)
    v_perm_b32 v48, v20, v16, s62
    v_perm_b32 v49, v28, v24, s62
    v_perm_b32 v50, v36, v32, s62
    v_perm_b32 v51, v44, v40, s62
    buffer_store_dwordx4 v[48:51], v12, s[24:27], s38 offen offset:0
    v_perm_b32 v52, v20, v16, s63
    v_perm_b32 v53, v28, v24, s63
    v_perm_b32 v54, v36, v32, s63
    v_perm_b32 v55, v44, v40, s63
    buffer_store_dwordx4 v[52:55], v12, s[24:27], s38 offen offset:16
    v_perm_b32 v56, v21, v17, s62
    v_perm_b32 v57, v29, v25, s62
    v_perm_b32 v58, v37, v33, s62
    v_perm_b32 v59, v45, v41, s62
    buffer_store_dwordx4 v[56:59], v12, s[24:27], s38 offen offset:32
    v_perm_b32 v60, v21, v17, s63
    v_perm_b32 v61, v29, v25, s63
    v_perm_b32 v62, v37, v33, s63
    v_perm_b32 v63, v45, v41, s63
    buffer_store_dwordx4 v[60:63], v12, s[24:27], s38 offen offset:48
    v_perm_b32 v48, v22, v18, s62
    v_perm_b32 v49, v30, v26, s62
    v_perm_b32 v50, v38, v34, s62
    v_perm_b32 v51, v46, v42, s62
    buffer_store_dwordx4 v[48:51], v12, s[24:27], s38 offen offset:64
    v_perm_b32 v52, v22, v18, s63
    v_perm_b32 v53, v30, v26, s63
    v_perm_b32 v54, v38, v34, s63
    v_perm_b32 v55, v46, v42, s63
    buffer_store_dwordx4 v[52:55], v12, s[24:27], s38 offen offset:80
    v_perm_b32 v56, v23, v19, s62
    v_perm_b32 v57, v31, v27, s62
    v_perm_b32 v58, v39, v35, s62
    v_perm_b32 v59, v47, v43, s62
    buffer_store_dwordx4 v[56:59], v12, s[24:27], s38 offen offset:96
    v_perm_b32 v60, v23, v19, s63
    v_perm_b32 v61, v31, v27, s63
    v_perm_b32 v62, v39, v35, s63
    v_perm_b32 v63, v47, v43, s63
    buffer_store_dwordx4 v[60:63], v12, s[24:27], s38 offen offset:112
    s_nop 1
    s_branch .End_prep_kernel_9
.B_prep_kernel_3:
    s_mov_b32 s62, 0x05040100
    s_mov_b32 s63, 0x07060302
    s_sub_u32 s32, s2, 412
    s_lshl_b32 s32, s32, 2
    s_add_u32 s32, s32, s3
    s_mul_i32 s33, s32, 911
    s_lshr_b32 s33, s33, 16
    s_mul_i32 s34, s33, 72
    s_sub_u32 s34, s32, s34
    s_mov_b32 s20, s16
    s_mov_b32 s21, s17
    s_and_b32 s21, s21, 0xffff
    s_mov_b32 s22, 0x510000
    s_mov_b32 s23, 0x20000
    s_add_u32 s24, s4, 0x1000000
    s_addc_u32 s25, s5, 0
    s_and_b32 s25, s25, 0xffff
    s_mov_b32 s26, 0x5a0000
    s_mov_b32 s27, 0x20000
    v_bfe_u32 v8, v1, 3, 1
    v_and_b32 v9, 7, v1
    v_mul_u32_u24 v10, 9216, v4
    v_mul_u32_u24 v11, 36864, v8
    v_add_u32 v10, v10, v11
    v_lshl_add_u32 v10, v9, 4, v10
    s_mul_i32 s35, s34, 73728
    s_mul_i32 s36, s33, 144
    s_add_u32 s35, s35, s36
    v_mov_b32 v13, 0x7ff00000
    v_cmp_eq_u32 s[40:41], 0, v9
    s_nop 1
    v_cndmask_b32 v15, v13, v10, s[40:41]
    s_add_u32 s37, s35, 0
    buffer_load_dwordx4 v[16:19], v10, s[20:23], s37 offen
    buffer_load_dwordx4 v[64:67], v15, s[20:23], s37 offen offset:128
    s_add_u32 s37, s35, 1152
    buffer_load_dwordx4 v[20:23], v10, s[20:23], s37 offen
    buffer_load_dwordx4 v[68:71], v15, s[20:23], s37 offen offset:128
    s_add_u32 s37, s35, 2304
    buffer_load_dwordx4 v[24:27], v10, s[20:23], s37 offen
    buffer_load_dwordx4 v[72:75], v15, s[20:23], s37 offen offset:128
    s_add_u32 s37, s35, 3456
    buffer_load_dwordx4 v[28:31], v10, s[20:23], s37 offen
    buffer_load_dwordx4 v[76:79], v15, s[20:23], s37 offen offset:128
    s_add_u32 s37, s35, 4608
    buffer_load_dwordx4 v[32:35], v10, s[20:23], s37 offen
    buffer_load_dwordx4 v[80:83], v15, s[20:23], s37 offen offset:128
    s_add_u32 s37, s35, 5760
    buffer_load_dwordx4 v[36:39], v10, s[20:23], s37 offen
    buffer_load_dwordx4 v[84:87], v15, s[20:23], s37 offen offset:128
    s_add_u32 s37, s35, 6912
    buffer_load_dwordx4 v[40:43], v10, s[20:23], s37 offen
    buffer_load_dwordx4 v[88:91], v15, s[20:23], s37 offen offset:128
    s_add_u32 s37, s35, 8064
    buffer_load_dwordx4 v[44:47], v10, s[20:23], s37 offen
    buffer_load_dwordx4 v[92:95], v15, s[20:23], s37 offen offset:128
    v_mul_u32_u24 v15, 5120, v8
    v_lshl_add_u32 v15, v4, 8, v15
    v_cndmask_b32 v15, v13, v15, s[40:41]
    v_lshlrev_b32 v12, 12, v8
    v_bfe_u32 v13, v1, 2, 1
    v_lshl_add_u32 v12, v13, 11, v12
    v_lshl_add_u32 v12, v4, 8, v12
    v_and_b32 v13, 3, v1
    v_lshl_add_u32 v12, v13, 6, v12
    v_add_u32 v12, s59, v12
    s_mul_i32 s38, s32, 10240
    s_waitcnt vmcnt(0)
    s_add_u32 s39, s38, 4096
    v_perm_b32 v48, v68, v64, s62
    v_perm_b32 v49, v76, v72, s62
    v_perm_b32 v50, v84, v80, s62
    v_perm_b32 v51, v92, v88, s62
    buffer_store_dwordx4 v[48:51], v15, s[24:27], s39 offen offset:0
    v_perm_b32 v52, v68, v64, s63
    v_perm_b32 v53, v76, v72, s63
    v_perm_b32 v54, v84, v80, s63
    v_perm_b32 v55, v92, v88, s63
    buffer_store_dwordx4 v[52:55], v15, s[24:27], s39 offen offset:16
    v_perm_b32 v56, v69, v65, s62
    v_perm_b32 v57, v77, v73, s62
    v_perm_b32 v58, v85, v81, s62
    v_perm_b32 v59, v93, v89, s62
    buffer_store_dwordx4 v[56:59], v15, s[24:27], s39 offen offset:32
    v_perm_b32 v60, v69, v65, s63
    v_perm_b32 v61, v77, v73, s63
    v_perm_b32 v62, v85, v81, s63
    v_perm_b32 v63, v93, v89, s63
    buffer_store_dwordx4 v[60:63], v15, s[24:27], s39 offen offset:48
    v_perm_b32 v48, v70, v66, s62
    v_perm_b32 v49, v78, v74, s62
    v_perm_b32 v50, v86, v82, s62
    v_perm_b32 v51, v94, v90, s62
    buffer_store_dwordx4 v[48:51], v15, s[24:27], s39 offen offset:64
    v_perm_b32 v52, v70, v66, s63
    v_perm_b32 v53, v78, v74, s63
    v_perm_b32 v54, v86, v82, s63
    v_perm_b32 v55, v94, v90, s63
    buffer_store_dwordx4 v[52:55], v15, s[24:27], s39 offen offset:80
    v_perm_b32 v56, v71, v67, s62
    v_perm_b32 v57, v79, v75, s62
    v_perm_b32 v58, v87, v83, s62
    v_perm_b32 v59, v95, v91, s62
    buffer_store_dwordx4 v[56:59], v15, s[24:27], s39 offen offset:96
    v_perm_b32 v60, v71, v67, s63
    v_perm_b32 v61, v79, v75, s63
    v_perm_b32 v62, v87, v83, s63
    v_perm_b32 v63, v95, v91, s63
    buffer_store_dwordx4 v[60:63], v15, s[24:27], s39 offen offset:112
    v_perm_b32 v48, v20, v16, s62
    v_perm_b32 v49, v28, v24, s62
    v_perm_b32 v50, v36, v32, s62
    v_perm_b32 v51, v44, v40, s62
    ds_write_b128 v12, v[48:51] offset:0
    v_perm_b32 v52, v20, v16, s63
    v_perm_b32 v53, v28, v24, s63
    v_perm_b32 v54, v36, v32, s63
    v_perm_b32 v55, v44, v40, s63
    ds_write_b128 v12, v[52:55] offset:16
    v_perm_b32 v56, v21, v17, s62
    v_perm_b32 v57, v29, v25, s62
    v_perm_b32 v58, v37, v33, s62
    v_perm_b32 v59, v45, v41, s62
    ds_write_b128 v12, v[56:59] offset:32
    v_perm_b32 v60, v21, v17, s63
    v_perm_b32 v61, v29, v25, s63
    v_perm_b32 v62, v37, v33, s63
    v_perm_b32 v63, v45, v41, s63
    ds_write_b128 v12, v[60:63] offset:48
    v_perm_b32 v48, v22, v18, s62
    v_perm_b32 v49, v30, v26, s62
    v_perm_b32 v50, v38, v34, s62
    v_perm_b32 v51, v46, v42, s62
    ds_write_b128 v12, v[48:51] offset:1024
    v_perm_b32 v52, v22, v18, s63
    v_perm_b32 v53, v30, v26, s63
    v_perm_b32 v54, v38, v34, s63
    v_perm_b32 v55, v46, v42, s63
    ds_write_b128 v12, v[52:55] offset:1040
    v_perm_b32 v56, v23, v19, s62
    v_perm_b32 v57, v31, v27, s62
    v_perm_b32 v58, v39, v35, s62
    v_perm_b32 v59, v47, v43, s62
    ds_write_b128 v12, v[56:59] offset:1056
    v_perm_b32 v60, v23, v19, s63
    v_perm_b32 v61, v31, v27, s63
    v_perm_b32 v62, v39, v35, s63
    v_perm_b32 v63, v47, v43, s63
    ds_write_b128 v12, v[60:63] offset:1072
    ds_read_b128 v[16:19], v14 offset:0
    ds_read_b128 v[20:23], v14 offset:1024
    ds_read_b128 v[24:27], v14 offset:2048
    ds_read_b128 v[28:31], v14 offset:3072
    ds_read_b128 v[32:35], v14 offset:4096
    ds_read_b128 v[36:39], v14 offset:5120
    ds_read_b128 v[40:43], v14 offset:6144
    ds_read_b128 v[44:47], v14 offset:7168
    s_waitcnt lgkmcnt(7)
    s_add_u32 s61, s38, 0
    buffer_store_dwordx4 v[16:19], v5, s[24:27], s61 offen
    s_waitcnt lgkmcnt(6)
    s_add_u32 s61, s38, 1024
    buffer_store_dwordx4 v[20:23], v5, s[24:27], s61 offen
    s_waitcnt lgkmcnt(5)
    s_add_u32 s61, s38, 2048
    buffer_store_dwordx4 v[24:27], v5, s[24:27], s61 offen
    s_waitcnt lgkmcnt(4)
    s_add_u32 s61, s38, 3072
    buffer_store_dwordx4 v[28:31], v5, s[24:27], s61 offen
    s_waitcnt lgkmcnt(3)
    s_add_u32 s61, s38, 5120
    buffer_store_dwordx4 v[32:35], v5, s[24:27], s61 offen
    s_waitcnt lgkmcnt(2)
    s_add_u32 s61, s38, 6144
    buffer_store_dwordx4 v[36:39], v5, s[24:27], s61 offen
    s_waitcnt lgkmcnt(1)
    s_add_u32 s61, s38, 7168
    buffer_store_dwordx4 v[40:43], v5, s[24:27], s61 offen
    s_waitcnt lgkmcnt(0)
    s_add_u32 s61, s38, 8192
    buffer_store_dwordx4 v[44:47], v5, s[24:27], s61 offen
    s_nop 1
    s_branch .End_prep_kernel_9
.B2_prep_kernel_4:
    s_mov_b32 s62, 0x05040100
    s_mov_b32 s63, 0x07060302
    s_sub_u32 s32, s2, 556
    s_lshl_b32 s32, s32, 2
    s_add_u32 s32, s32, s3
    s_mul_i32 s33, s32, 7282
    s_lshr_b32 s33, s33, 16
    s_mul_i32 s34, s33, 9
    s_sub_u32 s34, s32, s34
    s_mov_b32 s20, s16
    s_mov_b32 s21, s17
    s_and_b32 s21, s21, 0xffff
    s_mov_b32 s22, 0x510000
    s_mov_b32 s23, 0x20000
    s_add_u32 s24, s4, 0x1000000
    s_addc_u32 s25, s5, 0
    s_and_b32 s25, s25, 0xffff
    s_mov_b32 s26, 0x5a0000
    s_mov_b32 s27, 0x20000
    v_mul_u32_u24 v10, 9216, v1
    s_mul_i32 s35, s34, 589824
    s_mul_i32 s36, s33, 144
    s_add_u32 s35, s35, s36
    s_add_u32 s35, s35, 128
    s_add_u32 s37, s35, 0
    buffer_load_dwordx4 v[16:19], v10, s[20:23], s37 offen
    s_add_u32 s37, s35, 1152
    buffer_load_dwordx4 v[20:23], v10, s[20:23], s37 offen
    s_add_u32 s37, s35, 2304
    buffer_load_dwordx4 v[24:27], v10, s[20:23], s37 offen
    s_add_u32 s37, s35, 3456
    buffer_load_dwordx4 v[28:31], v10, s[20:23], s37 offen
    s_add_u32 s37, s35, 4608
    buffer_load_dwordx4 v[32:35], v10, s[20:23], s37 offen
    s_add_u32 s37, s35, 5760
    buffer_load_dwordx4 v[36:39], v10, s[20:23], s37 offen
    s_add_u32 s37, s35, 6912
    buffer_load_dwordx4 v[40:43], v10, s[20:23], s37 offen
    s_add_u32 s37, s35, 8064
    buffer_load_dwordx4 v[44:47], v10, s[20:23], s37 offen
    v_lshrrev_b32 v11, 2, v1
    v_mul_u32_u24 v12, 5120, v11
    v_and_b32 v13, 3, v1
    v_lshl_add_u32 v12, v13, 8, v12
    s_mul_i32 s38, s33, 144
    s_lshl_b32 s39, s34, 4
    s_add_u32 s38, s38, s39
    s_mul_i32 s38, s38, 5120
    s_add_u32 s38, s38, 4096
    s_waitcnt vmcnt(0)
    v_perm_b32 v48, v20, v16, s62
    v_perm_b32 v49, v28, v24, s62
    v_perm_b32 v50, v36, v32, s62
    v_perm_b32 v51, v44, v40, s62
    buffer_store_dwordx4 v[48:51], v12, s[24:27], s38 offen offset:0
    v_perm_b32 v52, v20, v16, s63
    v_perm_b32 v53, v28, v24, s63
    v_perm_b32 v54, v36, v32, s63
    v_perm_b32 v55, v44, v40, s63
    buffer_store_dwordx4 v[52:55], v12, s[24:27], s38 offen offset:16
    v_perm_b32 v56, v21, v17, s62
    v_perm_b32 v57, v29, v25, s62
    v_perm_b32 v58, v37, v33, s62
    v_perm_b32 v59, v45, v41, s62
    buffer_store_dwordx4 v[56:59], v12, s[24:27], s38 offen offset:32
    v_perm_b32 v60, v21, v17, s63
    v_perm_b32 v61, v29, v25, s63
    v_perm_b32 v62, v37, v33, s63
    v_perm_b32 v63, v45, v41, s63
    buffer_store_dwordx4 v[60:63], v12, s[24:27], s38 offen offset:48
    v_perm_b32 v48, v22, v18, s62
    v_perm_b32 v49, v30, v26, s62
    v_perm_b32 v50, v38, v34, s62
    v_perm_b32 v51, v46, v42, s62
    buffer_store_dwordx4 v[48:51], v12, s[24:27], s38 offen offset:64
    v_perm_b32 v52, v22, v18, s63
    v_perm_b32 v53, v30, v26, s63
    v_perm_b32 v54, v38, v34, s63
    v_perm_b32 v55, v46, v42, s63
    buffer_store_dwordx4 v[52:55], v12, s[24:27], s38 offen offset:80
    v_perm_b32 v56, v23, v19, s62
    v_perm_b32 v57, v31, v27, s62
    v_perm_b32 v58, v39, v35, s62
    v_perm_b32 v59, v47, v43, s62
    buffer_store_dwordx4 v[56:59], v12, s[24:27], s38 offen offset:96
    v_perm_b32 v60, v23, v19, s63
    v_perm_b32 v61, v31, v27, s63
    v_perm_b32 v62, v39, v35, s63
    v_perm_b32 v63, v47, v43, s63
    buffer_store_dwordx4 v[60:63], v12, s[24:27], s38 offen offset:112
    s_nop 1
    s_branch .End_prep_kernel_9
.G_prep_kernel_8:
    s_sub_u32 s32, s2, 208
    s_mov_b32 s20, s14
    s_mov_b32 s21, s15
    s_and_b32 s21, s21, 0xffff
    s_mov_b32 s22, 0x510000
    s_mov_b32 s23, 0x20000
    s_add_u32 s28, s4, 0x240000
    s_addc_u32 s29, s5, 0
    s_and_b32 s29, s29, 0xffff
    s_mov_b32 s30, 0x4800
    s_mov_b32 s31, 0x20000
    v_and_b32 v8, 15, v0
    v_lshrrev_b32 v9, 4, v0
    v_mul_u32_u24 v10, 331776, v9
    v_lshl_add_u32 v10, v8, 4, v10
    s_lshl_b32 s33, s32, 8
    v_mov_b32 v16, 0
    v_mov_b32 v17, 0
    v_mov_b32 v18, 0
    v_mov_b32 v19, 0
    v_mov_b32 v20, 0
    v_mov_b32 v21, 0
    v_mov_b32 v22, 0
    v_mov_b32 v23, 0
    s_add_u32 s34, s33, 0
    buffer_load_dwordx4 v[32:35], v10, s[20:23], s34 offen
    s_add_u32 s34, s33, 9216
    buffer_load_dwordx4 v[36:39], v10, s[20:23], s34 offen
    s_add_u32 s34, s33, 18432
    buffer_load_dwordx4 v[40:43], v10, s[20:23], s34 offen
    s_add_u32 s34, s33, 27648
    buffer_load_dwordx4 v[44:47], v10, s[20:23], s34 offen
    s_add_u32 s34, s33, 36864
    buffer_load_dwordx4 v[48:51], v10, s[20:23], s34 offen
    s_add_u32 s34, s33, 46080
    buffer_load_dwordx4 v[52:55], v10, s[20:23], s34 offen
    s_add_u32 s34, s33, 55296
    buffer_load_dwordx4 v[56:59], v10, s[20:23], s34 offen
    s_add_u32 s34, s33, 64512
    buffer_load_dwordx4 v[60:63], v10, s[20:23], s34 offen
    s_add_u32 s34, s33, 73728
    buffer_load_dwordx4 v[64:67], v10, s[20:23], s34 offen
    s_add_u32 s34, s33, 82944
    buffer_load_dwordx4 v[68:71], v10, s[20:23], s34 offen
    s_add_u32 s34, s33, 92160
    buffer_load_dwordx4 v[72:75], v10, s[20:23], s34 offen
    s_add_u32 s34, s33, 101376
    buffer_load_dwordx4 v[76:79], v10, s[20:23], s34 offen
    s_waitcnt vmcnt(11)
    v_lshlrev_b32 v24, 16, v32
    v_and_b32 v25, 0xffff0000, v32
    v_add_f32 v16, v16, v24
    v_add_f32 v17, v17, v25
    v_lshlrev_b32 v24, 16, v33
    v_and_b32 v25, 0xffff0000, v33
    v_add_f32 v18, v18, v24
    v_add_f32 v19, v19, v25
    v_lshlrev_b32 v24, 16, v34
    v_and_b32 v25, 0xffff0000, v34
    v_add_f32 v20, v20, v24
    v_add_f32 v21, v21, v25
    v_lshlrev_b32 v24, 16, v35
    v_and_b32 v25, 0xffff0000, v35
    v_add_f32 v22, v22, v24
    v_add_f32 v23, v23, v25
    s_waitcnt vmcnt(10)
    v_lshlrev_b32 v24, 16, v36
    v_and_b32 v25, 0xffff0000, v36
    v_add_f32 v16, v16, v24
    v_add_f32 v17, v17, v25
    v_lshlrev_b32 v24, 16, v37
    v_and_b32 v25, 0xffff0000, v37
    v_add_f32 v18, v18, v24
    v_add_f32 v19, v19, v25
    v_lshlrev_b32 v24, 16, v38
    v_and_b32 v25, 0xffff0000, v38
    v_add_f32 v20, v20, v24
    v_add_f32 v21, v21, v25
    v_lshlrev_b32 v24, 16, v39
    v_and_b32 v25, 0xffff0000, v39
    v_add_f32 v22, v22, v24
    v_add_f32 v23, v23, v25
    s_waitcnt vmcnt(9)
    v_lshlrev_b32 v24, 16, v40
    v_and_b32 v25, 0xffff0000, v40
    v_add_f32 v16, v16, v24
    v_add_f32 v17, v17, v25
    v_lshlrev_b32 v24, 16, v41
    v_and_b32 v25, 0xffff0000, v41
    v_add_f32 v18, v18, v24
    v_add_f32 v19, v19, v25
    v_lshlrev_b32 v24, 16, v42
    v_and_b32 v25, 0xffff0000, v42
    v_add_f32 v20, v20, v24
    v_add_f32 v21, v21, v25
    v_lshlrev_b32 v24, 16, v43
    v_and_b32 v25, 0xffff0000, v43
    v_add_f32 v22, v22, v24
    v_add_f32 v23, v23, v25
    s_waitcnt vmcnt(8)
    v_lshlrev_b32 v24, 16, v44
    v_and_b32 v25, 0xffff0000, v44
    v_add_f32 v16, v16, v24
    v_add_f32 v17, v17, v25
    v_lshlrev_b32 v24, 16, v45
    v_and_b32 v25, 0xffff0000, v45
    v_add_f32 v18, v18, v24
    v_add_f32 v19, v19, v25
    v_lshlrev_b32 v24, 16, v46
    v_and_b32 v25, 0xffff0000, v46
    v_add_f32 v20, v20, v24
    v_add_f32 v21, v21, v25
    v_lshlrev_b32 v24, 16, v47
    v_and_b32 v25, 0xffff0000, v47
    v_add_f32 v22, v22, v24
    v_add_f32 v23, v23, v25
    s_waitcnt vmcnt(7)
    v_lshlrev_b32 v24, 16, v48
    v_and_b32 v25, 0xffff0000, v48
    v_add_f32 v16, v16, v24
    v_add_f32 v17, v17, v25
    v_lshlrev_b32 v24, 16, v49
    v_and_b32 v25, 0xffff0000, v49
    v_add_f32 v18, v18, v24
    v_add_f32 v19, v19, v25
    v_lshlrev_b32 v24, 16, v50
    v_and_b32 v25, 0xffff0000, v50
    v_add_f32 v20, v20, v24
    v_add_f32 v21, v21, v25
    v_lshlrev_b32 v24, 16, v51
    v_and_b32 v25, 0xffff0000, v51
    v_add_f32 v22, v22, v24
    v_add_f32 v23, v23, v25
    s_waitcnt vmcnt(6)
    v_lshlrev_b32 v24, 16, v52
    v_and_b32 v25, 0xffff0000, v52
    v_add_f32 v16, v16, v24
    v_add_f32 v17, v17, v25
    v_lshlrev_b32 v24, 16, v53
    v_and_b32 v25, 0xffff0000, v53
    v_add_f32 v18, v18, v24
    v_add_f32 v19, v19, v25
    v_lshlrev_b32 v24, 16, v54
    v_and_b32 v25, 0xffff0000, v54
    v_add_f32 v20, v20, v24
    v_add_f32 v21, v21, v25
    v_lshlrev_b32 v24, 16, v55
    v_and_b32 v25, 0xffff0000, v55
    v_add_f32 v22, v22, v24
    v_add_f32 v23, v23, v25
    s_waitcnt vmcnt(5)
    v_lshlrev_b32 v24, 16, v56
    v_and_b32 v25, 0xffff0000, v56
    v_add_f32 v16, v16, v24
    v_add_f32 v17, v17, v25
    v_lshlrev_b32 v24, 16, v57
    v_and_b32 v25, 0xffff0000, v57
    v_add_f32 v18, v18, v24
    v_add_f32 v19, v19, v25
    v_lshlrev_b32 v24, 16, v58
    v_and_b32 v25, 0xffff0000, v58
    v_add_f32 v20, v20, v24
    v_add_f32 v21, v21, v25
    v_lshlrev_b32 v24, 16, v59
    v_and_b32 v25, 0xffff0000, v59
    v_add_f32 v22, v22, v24
    v_add_f32 v23, v23, v25
    s_waitcnt vmcnt(4)
    v_lshlrev_b32 v24, 16, v60
    v_and_b32 v25, 0xffff0000, v60
    v_add_f32 v16, v16, v24
    v_add_f32 v17, v17, v25
    v_lshlrev_b32 v24, 16, v61
    v_and_b32 v25, 0xffff0000, v61
    v_add_f32 v18, v18, v24
    v_add_f32 v19, v19, v25
    v_lshlrev_b32 v24, 16, v62
    v_and_b32 v25, 0xffff0000, v62
    v_add_f32 v20, v20, v24
    v_add_f32 v21, v21, v25
    v_lshlrev_b32 v24, 16, v63
    v_and_b32 v25, 0xffff0000, v63
    v_add_f32 v22, v22, v24
    v_add_f32 v23, v23, v25
    s_waitcnt vmcnt(3)
    v_lshlrev_b32 v24, 16, v64
    v_and_b32 v25, 0xffff0000, v64
    v_add_f32 v16, v16, v24
    v_add_f32 v17, v17, v25
    v_lshlrev_b32 v24, 16, v65
    v_and_b32 v25, 0xffff0000, v65
    v_add_f32 v18, v18, v24
    v_add_f32 v19, v19, v25
    v_lshlrev_b32 v24, 16, v66
    v_and_b32 v25, 0xffff0000, v66
    v_add_f32 v20, v20, v24
    v_add_f32 v21, v21, v25
    v_lshlrev_b32 v24, 16, v67
    v_and_b32 v25, 0xffff0000, v67
    v_add_f32 v22, v22, v24
    v_add_f32 v23, v23, v25
    s_waitcnt vmcnt(2)
    v_lshlrev_b32 v24, 16, v68
    v_and_b32 v25, 0xffff0000, v68
    v_add_f32 v16, v16, v24
    v_add_f32 v17, v17, v25
    v_lshlrev_b32 v24, 16, v69
    v_and_b32 v25, 0xffff0000, v69
    v_add_f32 v18, v18, v24
    v_add_f32 v19, v19, v25
    v_lshlrev_b32 v24, 16, v70
    v_and_b32 v25, 0xffff0000, v70
    v_add_f32 v20, v20, v24
    v_add_f32 v21, v21, v25
    v_lshlrev_b32 v24, 16, v71
    v_and_b32 v25, 0xffff0000, v71
    v_add_f32 v22, v22, v24
    v_add_f32 v23, v23, v25
    s_waitcnt vmcnt(1)
    v_lshlrev_b32 v24, 16, v72
    v_and_b32 v25, 0xffff0000, v72
    v_add_f32 v16, v16, v24
    v_add_f32 v17, v17, v25
    v_lshlrev_b32 v24, 16, v73
    v_and_b32 v25, 0xffff0000, v73
    v_add_f32 v18, v18, v24
    v_add_f32 v19, v19, v25
    v_lshlrev_b32 v24, 16, v74
    v_and_b32 v25, 0xffff0000, v74
    v_add_f32 v20, v20, v24
    v_add_f32 v21, v21, v25
    v_lshlrev_b32 v24, 16, v75
    v_and_b32 v25, 0xffff0000, v75
    v_add_f32 v22, v22, v24
    v_add_f32 v23, v23, v25
    s_waitcnt vmcnt(0)
    v_lshlrev_b32 v24, 16, v76
    v_and_b32 v25, 0xffff0000, v76
    v_add_f32 v16, v16, v24
    v_add_f32 v17, v17, v25
    v_lshlrev_b32 v24, 16, v77
    v_and_b32 v25, 0xffff0000, v77
    v_add_f32 v18, v18, v24
    v_add_f32 v19, v19, v25
    v_lshlrev_b32 v24, 16, v78
    v_and_b32 v25, 0xffff0000, v78
    v_add_f32 v20, v20, v24
    v_add_f32 v21, v21, v25
    v_lshlrev_b32 v24, 16, v79
    v_and_b32 v25, 0xffff0000, v79
    v_add_f32 v22, v22, v24
    v_add_f32 v23, v23, v25
    s_add_u32 s34, s33, 110592
    buffer_load_dwordx4 v[32:35], v10, s[20:23], s34 offen
    s_add_u32 s34, s33, 119808
    buffer_load_dwordx4 v[36:39], v10, s[20:23], s34 offen
    s_add_u32 s34, s33, 129024
    buffer_load_dwordx4 v[40:43], v10, s[20:23], s34 offen
    s_add_u32 s34, s33, 138240
    buffer_load_dwordx4 v[44:47], v10, s[20:23], s34 offen
    s_add_u32 s34, s33, 147456
    buffer_load_dwordx4 v[48:51], v10, s[20:23], s34 offen
    s_add_u32 s34, s33, 156672
    buffer_load_dwordx4 v[52:55], v10, s[20:23], s34 offen
    s_add_u32 s34, s33, 165888
    buffer_load_dwordx4 v[56:59], v10, s[20:23], s34 offen
    s_add_u32 s34, s33, 175104
    buffer_load_dwordx4 v[60:63], v10, s[20:23], s34 offen
    s_add_u32 s34, s33, 184320
    buffer_load_dwordx4 v[64:67], v10, s[20:23], s34 offen
    s_add_u32 s34, s33, 193536
    buffer_load_dwordx4 v[68:71], v10, s[20:23], s34 offen
    s_add_u32 s34, s33, 202752
    buffer_load_dwordx4 v[72:75], v10, s[20:23], s34 offen
    s_add_u32 s34, s33, 211968
    buffer_load_dwordx4 v[76:79], v10, s[20:23], s34 offen
    s_waitcnt vmcnt(11)
    v_lshlrev_b32 v24, 16, v32
    v_and_b32 v25, 0xffff0000, v32
    v_add_f32 v16, v16, v24
    v_add_f32 v17, v17, v25
    v_lshlrev_b32 v24, 16, v33
    v_and_b32 v25, 0xffff0000, v33
    v_add_f32 v18, v18, v24
    v_add_f32 v19, v19, v25
    v_lshlrev_b32 v24, 16, v34
    v_and_b32 v25, 0xffff0000, v34
    v_add_f32 v20, v20, v24
    v_add_f32 v21, v21, v25
    v_lshlrev_b32 v24, 16, v35
    v_and_b32 v25, 0xffff0000, v35
    v_add_f32 v22, v22, v24
    v_add_f32 v23, v23, v25
    s_waitcnt vmcnt(10)
    v_lshlrev_b32 v24, 16, v36
    v_and_b32 v25, 0xffff0000, v36
    v_add_f32 v16, v16, v24
    v_add_f32 v17, v17, v25
    v_lshlrev_b32 v24, 16, v37
    v_and_b32 v25, 0xffff0000, v37
    v_add_f32 v18, v18, v24
    v_add_f32 v19, v19, v25
    v_lshlrev_b32 v24, 16, v38
    v_and_b32 v25, 0xffff0000, v38
    v_add_f32 v20, v20, v24
    v_add_f32 v21, v21, v25
    v_lshlrev_b32 v24, 16, v39
    v_and_b32 v25, 0xffff0000, v39
    v_add_f32 v22, v22, v24
    v_add_f32 v23, v23, v25
    s_waitcnt vmcnt(9)
    v_lshlrev_b32 v24, 16, v40
    v_and_b32 v25, 0xffff0000, v40
    v_add_f32 v16, v16, v24
    v_add_f32 v17, v17, v25
    v_lshlrev_b32 v24, 16, v41
    v_and_b32 v25, 0xffff0000, v41
    v_add_f32 v18, v18, v24
    v_add_f32 v19, v19, v25
    v_lshlrev_b32 v24, 16, v42
    v_and_b32 v25, 0xffff0000, v42
    v_add_f32 v20, v20, v24
    v_add_f32 v21, v21, v25
    v_lshlrev_b32 v24, 16, v43
    v_and_b32 v25, 0xffff0000, v43
    v_add_f32 v22, v22, v24
    v_add_f32 v23, v23, v25
    s_waitcnt vmcnt(8)
    v_lshlrev_b32 v24, 16, v44
    v_and_b32 v25, 0xffff0000, v44
    v_add_f32 v16, v16, v24
    v_add_f32 v17, v17, v25
    v_lshlrev_b32 v24, 16, v45
    v_and_b32 v25, 0xffff0000, v45
    v_add_f32 v18, v18, v24
    v_add_f32 v19, v19, v25
    v_lshlrev_b32 v24, 16, v46
    v_and_b32 v25, 0xffff0000, v46
    v_add_f32 v20, v20, v24
    v_add_f32 v21, v21, v25
    v_lshlrev_b32 v24, 16, v47
    v_and_b32 v25, 0xffff0000, v47
    v_add_f32 v22, v22, v24
    v_add_f32 v23, v23, v25
    s_waitcnt vmcnt(7)
    v_lshlrev_b32 v24, 16, v48
    v_and_b32 v25, 0xffff0000, v48
    v_add_f32 v16, v16, v24
    v_add_f32 v17, v17, v25
    v_lshlrev_b32 v24, 16, v49
    v_and_b32 v25, 0xffff0000, v49
    v_add_f32 v18, v18, v24
    v_add_f32 v19, v19, v25
    v_lshlrev_b32 v24, 16, v50
    v_and_b32 v25, 0xffff0000, v50
    v_add_f32 v20, v20, v24
    v_add_f32 v21, v21, v25
    v_lshlrev_b32 v24, 16, v51
    v_and_b32 v25, 0xffff0000, v51
    v_add_f32 v22, v22, v24
    v_add_f32 v23, v23, v25
    s_waitcnt vmcnt(6)
    v_lshlrev_b32 v24, 16, v52
    v_and_b32 v25, 0xffff0000, v52
    v_add_f32 v16, v16, v24
    v_add_f32 v17, v17, v25
    v_lshlrev_b32 v24, 16, v53
    v_and_b32 v25, 0xffff0000, v53
    v_add_f32 v18, v18, v24
    v_add_f32 v19, v19, v25
    v_lshlrev_b32 v24, 16, v54
    v_and_b32 v25, 0xffff0000, v54
    v_add_f32 v20, v20, v24
    v_add_f32 v21, v21, v25
    v_lshlrev_b32 v24, 16, v55
    v_and_b32 v25, 0xffff0000, v55
    v_add_f32 v22, v22, v24
    v_add_f32 v23, v23, v25
    s_waitcnt vmcnt(5)
    v_lshlrev_b32 v24, 16, v56
    v_and_b32 v25, 0xffff0000, v56
    v_add_f32 v16, v16, v24
    v_add_f32 v17, v17, v25
    v_lshlrev_b32 v24, 16, v57
    v_and_b32 v25, 0xffff0000, v57
    v_add_f32 v18, v18, v24
    v_add_f32 v19, v19, v25
    v_lshlrev_b32 v24, 16, v58
    v_and_b32 v25, 0xffff0000, v58
    v_add_f32 v20, v20, v24
    v_add_f32 v21, v21, v25
    v_lshlrev_b32 v24, 16, v59
    v_and_b32 v25, 0xffff0000, v59
    v_add_f32 v22, v22, v24
    v_add_f32 v23, v23, v25
    s_waitcnt vmcnt(4)
    v_lshlrev_b32 v24, 16, v60
    v_and_b32 v25, 0xffff0000, v60
    v_add_f32 v16, v16, v24
    v_add_f32 v17, v17, v25
    v_lshlrev_b32 v24, 16, v61
    v_and_b32 v25, 0xffff0000, v61
    v_add_f32 v18, v18, v24
    v_add_f32 v19, v19, v25
    v_lshlrev_b32 v24, 16, v62
    v_and_b32 v25, 0xffff0000, v62
    v_add_f32 v20, v20, v24
    v_add_f32 v21, v21, v25
    v_lshlrev_b32 v24, 16, v63
    v_and_b32 v25, 0xffff0000, v63
    v_add_f32 v22, v22, v24
    v_add_f32 v23, v23, v25
    s_waitcnt vmcnt(3)
    v_lshlrev_b32 v24, 16, v64
    v_and_b32 v25, 0xffff0000, v64
    v_add_f32 v16, v16, v24
    v_add_f32 v17, v17, v25
    v_lshlrev_b32 v24, 16, v65
    v_and_b32 v25, 0xffff0000, v65
    v_add_f32 v18, v18, v24
    v_add_f32 v19, v19, v25
    v_lshlrev_b32 v24, 16, v66
    v_and_b32 v25, 0xffff0000, v66
    v_add_f32 v20, v20, v24
    v_add_f32 v21, v21, v25
    v_lshlrev_b32 v24, 16, v67
    v_and_b32 v25, 0xffff0000, v67
    v_add_f32 v22, v22, v24
    v_add_f32 v23, v23, v25
    s_waitcnt vmcnt(2)
    v_lshlrev_b32 v24, 16, v68
    v_and_b32 v25, 0xffff0000, v68
    v_add_f32 v16, v16, v24
    v_add_f32 v17, v17, v25
    v_lshlrev_b32 v24, 16, v69
    v_and_b32 v25, 0xffff0000, v69
    v_add_f32 v18, v18, v24
    v_add_f32 v19, v19, v25
    v_lshlrev_b32 v24, 16, v70
    v_and_b32 v25, 0xffff0000, v70
    v_add_f32 v20, v20, v24
    v_add_f32 v21, v21, v25
    v_lshlrev_b32 v24, 16, v71
    v_and_b32 v25, 0xffff0000, v71
    v_add_f32 v22, v22, v24
    v_add_f32 v23, v23, v25
    s_waitcnt vmcnt(1)
    v_lshlrev_b32 v24, 16, v72
    v_and_b32 v25, 0xffff0000, v72
    v_add_f32 v16, v16, v24
    v_add_f32 v17, v17, v25
    v_lshlrev_b32 v24, 16, v73
    v_and_b32 v25, 0xffff0000, v73
    v_add_f32 v18, v18, v24
    v_add_f32 v19, v19, v25
    v_lshlrev_b32 v24, 16, v74
    v_and_b32 v25, 0xffff0000, v74
    v_add_f32 v20, v20, v24
    v_add_f32 v21, v21, v25
    v_lshlrev_b32 v24, 16, v75
    v_and_b32 v25, 0xffff0000, v75
    v_add_f32 v22, v22, v24
    v_add_f32 v23, v23, v25
    s_waitcnt vmcnt(0)
    v_lshlrev_b32 v24, 16, v76
    v_and_b32 v25, 0xffff0000, v76
    v_add_f32 v16, v16, v24
    v_add_f32 v17, v17, v25
    v_lshlrev_b32 v24, 16, v77
    v_and_b32 v25, 0xffff0000, v77
    v_add_f32 v18, v18, v24
    v_add_f32 v19, v19, v25
    v_lshlrev_b32 v24, 16, v78
    v_and_b32 v25, 0xffff0000, v78
    v_add_f32 v20, v20, v24
    v_add_f32 v21, v21, v25
    v_lshlrev_b32 v24, 16, v79
    v_and_b32 v25, 0xffff0000, v79
    v_add_f32 v22, v22, v24
    v_add_f32 v23, v23, v25
    s_add_u32 s34, s33, 221184
    buffer_load_dwordx4 v[32:35], v10, s[20:23], s34 offen
    s_add_u32 s34, s33, 230400
    buffer_load_dwordx4 v[36:39], v10, s[20:23], s34 offen
    s_add_u32 s34, s33, 239616
    buffer_load_dwordx4 v[40:43], v10, s[20:23], s34 offen
    s_add_u32 s34, s33, 248832
    buffer_load_dwordx4 v[44:47], v10, s[20:23], s34 offen
    s_add_u32 s34, s33, 258048
    buffer_load_dwordx4 v[48:51], v10, s[20:23], s34 offen
    s_add_u32 s34, s33, 267264
    buffer_load_dwordx4 v[52:55], v10, s[20:23], s34 offen
    s_add_u32 s34, s33, 276480
    buffer_load_dwordx4 v[56:59], v10, s[20:23], s34 offen
    s_add_u32 s34, s33, 285696
    buffer_load_dwordx4 v[60:63], v10, s[20:23], s34 offen
    s_add_u32 s34, s33, 294912
    buffer_load_dwordx4 v[64:67], v10, s[20:23], s34 offen
    s_add_u32 s34, s33, 304128
    buffer_load_dwordx4 v[68:71], v10, s[20:23], s34 offen
    s_add_u32 s34, s33, 313344
    buffer_load_dwordx4 v[72:75], v10, s[20:23], s34 offen
    s_add_u32 s34, s33, 322560
    buffer_load_dwordx4 v[76:79], v10, s[20:23], s34 offen
    s_waitcnt vmcnt(11)
    v_lshlrev_b32 v24, 16, v32
    v_and_b32 v25, 0xffff0000, v32
    v_add_f32 v16, v16, v24
    v_add_f32 v17, v17, v25
    v_lshlrev_b32 v24, 16, v33
    v_and_b32 v25, 0xffff0000, v33
    v_add_f32 v18, v18, v24
    v_add_f32 v19, v19, v25
    v_lshlrev_b32 v24, 16, v34
    v_and_b32 v25, 0xffff0000, v34
    v_add_f32 v20, v20, v24
    v_add_f32 v21, v21, v25
    v_lshlrev_b32 v24, 16, v35
    v_and_b32 v25, 0xffff0000, v35
    v_add_f32 v22, v22, v24
    v_add_f32 v23, v23, v25
    s_waitcnt vmcnt(10)
    v_lshlrev_b32 v24, 16, v36
    v_and_b32 v25, 0xffff0000, v36
    v_add_f32 v16, v16, v24
    v_add_f32 v17, v17, v25
    v_lshlrev_b32 v24, 16, v37
    v_and_b32 v25, 0xffff0000, v37
    v_add_f32 v18, v18, v24
    v_add_f32 v19, v19, v25
    v_lshlrev_b32 v24, 16, v38
    v_and_b32 v25, 0xffff0000, v38
    v_add_f32 v20, v20, v24
    v_add_f32 v21, v21, v25
    v_lshlrev_b32 v24, 16, v39
    v_and_b32 v25, 0xffff0000, v39
    v_add_f32 v22, v22, v24
    v_add_f32 v23, v23, v25
    s_waitcnt vmcnt(9)
    v_lshlrev_b32 v24, 16, v40
    v_and_b32 v25, 0xffff0000, v40
    v_add_f32 v16, v16, v24
    v_add_f32 v17, v17, v25
    v_lshlrev_b32 v24, 16, v41
    v_and_b32 v25, 0xffff0000, v41
    v_add_f32 v18, v18, v24
    v_add_f32 v19, v19, v25
    v_lshlrev_b32 v24, 16, v42
    v_and_b32 v25, 0xffff0000, v42
    v_add_f32 v20, v20, v24
    v_add_f32 v21, v21, v25
    v_lshlrev_b32 v24, 16, v43
    v_and_b32 v25, 0xffff0000, v43
    v_add_f32 v22, v22, v24
    v_add_f32 v23, v23, v25
    s_waitcnt vmcnt(8)
    v_lshlrev_b32 v24, 16, v44
    v_and_b32 v25, 0xffff0000, v44
    v_add_f32 v16, v16, v24
    v_add_f32 v17, v17, v25
    v_lshlrev_b32 v24, 16, v45
    v_and_b32 v25, 0xffff0000, v45
    v_add_f32 v18, v18, v24
    v_add_f32 v19, v19, v25
    v_lshlrev_b32 v24, 16, v46
    v_and_b32 v25, 0xffff0000, v46
    v_add_f32 v20, v20, v24
    v_add_f32 v21, v21, v25
    v_lshlrev_b32 v24, 16, v47
    v_and_b32 v25, 0xffff0000, v47
    v_add_f32 v22, v22, v24
    v_add_f32 v23, v23, v25
    s_waitcnt vmcnt(7)
    v_lshlrev_b32 v24, 16, v48
    v_and_b32 v25, 0xffff0000, v48
    v_add_f32 v16, v16, v24
    v_add_f32 v17, v17, v25
    v_lshlrev_b32 v24, 16, v49
    v_and_b32 v25, 0xffff0000, v49
    v_add_f32 v18, v18, v24
    v_add_f32 v19, v19, v25
    v_lshlrev_b32 v24, 16, v50
    v_and_b32 v25, 0xffff0000, v50
    v_add_f32 v20, v20, v24
    v_add_f32 v21, v21, v25
    v_lshlrev_b32 v24, 16, v51
    v_and_b32 v25, 0xffff0000, v51
    v_add_f32 v22, v22, v24
    v_add_f32 v23, v23, v25
    s_waitcnt vmcnt(6)
    v_lshlrev_b32 v24, 16, v52
    v_and_b32 v25, 0xffff0000, v52
    v_add_f32 v16, v16, v24
    v_add_f32 v17, v17, v25
    v_lshlrev_b32 v24, 16, v53
    v_and_b32 v25, 0xffff0000, v53
    v_add_f32 v18, v18, v24
    v_add_f32 v19, v19, v25
    v_lshlrev_b32 v24, 16, v54
    v_and_b32 v25, 0xffff0000, v54
    v_add_f32 v20, v20, v24
    v_add_f32 v21, v21, v25
    v_lshlrev_b32 v24, 16, v55
    v_and_b32 v25, 0xffff0000, v55
    v_add_f32 v22, v22, v24
    v_add_f32 v23, v23, v25
    s_waitcnt vmcnt(5)
    v_lshlrev_b32 v24, 16, v56
    v_and_b32 v25, 0xffff0000, v56
    v_add_f32 v16, v16, v24
    v_add_f32 v17, v17, v25
    v_lshlrev_b32 v24, 16, v57
    v_and_b32 v25, 0xffff0000, v57
    v_add_f32 v18, v18, v24
    v_add_f32 v19, v19, v25
    v_lshlrev_b32 v24, 16, v58
    v_and_b32 v25, 0xffff0000, v58
    v_add_f32 v20, v20, v24
    v_add_f32 v21, v21, v25
    v_lshlrev_b32 v24, 16, v59
    v_and_b32 v25, 0xffff0000, v59
    v_add_f32 v22, v22, v24
    v_add_f32 v23, v23, v25
    s_waitcnt vmcnt(4)
    v_lshlrev_b32 v24, 16, v60
    v_and_b32 v25, 0xffff0000, v60
    v_add_f32 v16, v16, v24
    v_add_f32 v17, v17, v25
    v_lshlrev_b32 v24, 16, v61
    v_and_b32 v25, 0xffff0000, v61
    v_add_f32 v18, v18, v24
    v_add_f32 v19, v19, v25
    v_lshlrev_b32 v24, 16, v62
    v_and_b32 v25, 0xffff0000, v62
    v_add_f32 v20, v20, v24
    v_add_f32 v21, v21, v25
    v_lshlrev_b32 v24, 16, v63
    v_and_b32 v25, 0xffff0000, v63
    v_add_f32 v22, v22, v24
    v_add_f32 v23, v23, v25
    s_waitcnt vmcnt(3)
    v_lshlrev_b32 v24, 16, v64
    v_and_b32 v25, 0xffff0000, v64
    v_add_f32 v16, v16, v24
    v_add_f32 v17, v17, v25
    v_lshlrev_b32 v24, 16, v65
    v_and_b32 v25, 0xffff0000, v65
    v_add_f32 v18, v18, v24
    v_add_f32 v19, v19, v25
    v_lshlrev_b32 v24, 16, v66
    v_and_b32 v25, 0xffff0000, v66
    v_add_f32 v20, v20, v24
    v_add_f32 v21, v21, v25
    v_lshlrev_b32 v24, 16, v67
    v_and_b32 v25, 0xffff0000, v67
    v_add_f32 v22, v22, v24
    v_add_f32 v23, v23, v25
    s_waitcnt vmcnt(2)
    v_lshlrev_b32 v24, 16, v68
    v_and_b32 v25, 0xffff0000, v68
    v_add_f32 v16, v16, v24
    v_add_f32 v17, v17, v25
    v_lshlrev_b32 v24, 16, v69
    v_and_b32 v25, 0xffff0000, v69
    v_add_f32 v18, v18, v24
    v_add_f32 v19, v19, v25
    v_lshlrev_b32 v24, 16, v70
    v_and_b32 v25, 0xffff0000, v70
    v_add_f32 v20, v20, v24
    v_add_f32 v21, v21, v25
    v_lshlrev_b32 v24, 16, v71
    v_and_b32 v25, 0xffff0000, v71
    v_add_f32 v22, v22, v24
    v_add_f32 v23, v23, v25
    s_waitcnt vmcnt(1)
    v_lshlrev_b32 v24, 16, v72
    v_and_b32 v25, 0xffff0000, v72
    v_add_f32 v16, v16, v24
    v_add_f32 v17, v17, v25
    v_lshlrev_b32 v24, 16, v73
    v_and_b32 v25, 0xffff0000, v73
    v_add_f32 v18, v18, v24
    v_add_f32 v19, v19, v25
    v_lshlrev_b32 v24, 16, v74
    v_and_b32 v25, 0xffff0000, v74
    v_add_f32 v20, v20, v24
    v_add_f32 v21, v21, v25
    v_lshlrev_b32 v24, 16, v75
    v_and_b32 v25, 0xffff0000, v75
    v_add_f32 v22, v22, v24
    v_add_f32 v23, v23, v25
    s_waitcnt vmcnt(0)
    v_lshlrev_b32 v24, 16, v76
    v_and_b32 v25, 0xffff0000, v76
    v_add_f32 v16, v16, v24
    v_add_f32 v17, v17, v25
    v_lshlrev_b32 v24, 16, v77
    v_and_b32 v25, 0xffff0000, v77
    v_add_f32 v18, v18, v24
    v_add_f32 v19, v19, v25
    v_lshlrev_b32 v24, 16, v78
    v_and_b32 v25, 0xffff0000, v78
    v_add_f32 v20, v20, v24
    v_add_f32 v21, v21, v25
    v_lshlrev_b32 v24, 16, v79
    v_and_b32 v25, 0xffff0000, v79
    v_add_f32 v22, v22, v24
    v_add_f32 v23, v23, v25
    v_lshlrev_b32 v11, 9, v9
    v_lshl_add_u32 v11, v8, 5, v11
    ds_write_b128 v11, v[16:19]
    ds_write_b128 v11, v[20:23] offset:16
    s_waitcnt lgkmcnt(0)
    s_barrier
    v_lshlrev_b32 v12, 2, v0
    ds_read_b32 v32, v12 offset:0
    ds_read_b32 v33, v12 offset:512
    ds_read_b32 v34, v12 offset:1024
    ds_read_b32 v35, v12 offset:1536
    ds_read_b32 v36, v12 offset:2048
    ds_read_b32 v37, v12 offset:2560
    ds_read_b32 v38, v12 offset:3072
    ds_read_b32 v39, v12 offset:3584
    ds_read_b32 v40, v12 offset:4096
    ds_read_b32 v41, v12 offset:4608
    ds_read_b32 v42, v12 offset:5120
    ds_read_b32 v43, v12 offset:5632
    ds_read_b32 v44, v12 offset:6144
    ds_read_b32 v45, v12 offset:6656
    ds_read_b32 v46, v12 offset:7168
    ds_read_b32 v47, v12 offset:7680
    s_waitcnt lgkmcnt(0)
    v_add_f32 v32, v32, v33
    v_add_f32 v32, v32, v34
    v_add_f32 v32, v32, v35
    v_add_f32 v32, v32, v36
    v_add_f32 v32, v32, v37
    v_add_f32 v32, v32, v38
    v_add_f32 v32, v32, v39
    v_add_f32 v32, v32, v40
    v_add_f32 v32, v32, v41
    v_add_f32 v32, v32, v42
    v_add_f32 v32, v32, v43
    v_add_f32 v32, v32, v44
    v_add_f32 v32, v32, v45
    v_add_f32 v32, v32, v46
    v_add_f32 v32, v32, v47
    v_mov_b32 v13, 0x7ff00000
    v_cmp_gt_u32 vcc, 128, v0
    s_nop 1
    v_cndmask_b32 v12, v13, v12, vcc
    s_lshl_b32 s35, s32, 9
    buffer_store_dword v32, v12, s[28:31], s35 offen
    s_branch .End_prep_kernel_9
.C_prep_kernel_5:
    s_mov_b32 s62, 0x05040100
    s_mov_b32 s63, 0x07060302
    s_sub_u32 s32, s2, 144
    s_lshl_b32 s32, s32, 2
    s_add_u32 s32, s32, s3
    s_mul_i32 s33, s32, 21846
    s_lshr_b32 s33, s33, 16
    s_mul_i32 s34, s33, 3
    s_sub_u32 s34, s32, s34
    s_lshr_b32 s35, s33, 3
    s_and_b32 s36, s33, 7
    s_mov_b32 s20, s12
    s_mov_b32 s21, s13
    s_and_b32 s21, s21, 0xffff
    s_mov_b32 s22, 0xa2000
    s_mov_b32 s23, 0x20000
    s_add_u32 s24, s4, 0x400000
    s_addc_u32 s25, s5, 0
    s_and_b32 s25, s25, 0xffff
    s_mov_b32 s26, 0xd8000
    s_mov_b32 s27, 0x20000
    v_mul_u32_u24 v10, 4608, v4
    v_lshl_add_u32 v8, v3, 4, v10
    v_lshlrev_b32 v9, 4, v3
    v_mov_b32 v13, 0x7ff00000
    v_cmp_eq_u32 vcc, 0, v4
    s_nop 1
    v_cndmask_b32 v9, v13, v9, vcc
    v_cmp_gt_u32 s[40:41], 2, v3
    s_nop 1
    v_cndmask_b32 v11, v13, v8, s[40:41]
    v_cndmask_b32 v12, v13, v9, s[40:41]
    s_mul_i32 s37, s36, 82944
    s_mul_i32 s38, s35, 288
    s_add_u32 s37, s37, s38
    s_cmp_eq_u32 s34, 1
    s_cbranch_scc1 .Cks1_prep_kernel_12
    s_cmp_eq_u32 s34, 2
    s_cbranch_scc1 .Cks2_prep_kernel_13
.Cks0_prep_kernel_11:
    s_add_u32 s39, s37, 0
    buffer_load_dwordx4 v[16:19], v8, s[20:23], s39 offen
    buffer_load_dwordx4 v[64:67], v11, s[20:23], s39 offen offset:256
    s_add_u32 s39, s37, 1152
    buffer_load_dwordx4 v[20:23], v8, s[20:23], s39 offen
    buffer_load_dwordx4 v[68:71], v11, s[20:23], s39 offen offset:256
    s_add_u32 s39, s37, 2304
    buffer_load_dwordx4 v[24:27], v8, s[20:23], s39 offen
    buffer_load_dwordx4 v[72:75], v11, s[20:23], s39 offen offset:256
    s_add_u32 s39, s37, 3456
    buffer_load_dwordx4 v[28:31], v8, s[20:23], s39 offen
    buffer_load_dwordx4 v[76:79], v11, s[20:23], s39 offen offset:256
    s_add_u32 s39, s37, 18432
    buffer_load_dwordx4 v[32:35], v9, s[20:23], s39 offen
    buffer_load_dwordx4 v[80:83], v12, s[20:23], s39 offen offset:256
    s_add_u32 s39, s37, 19584
    buffer_load_dwordx4 v[36:39], v9, s[20:23], s39 offen
    buffer_load_dwordx4 v[84:87], v12, s[20:23], s39 offen offset:256
    s_add_u32 s39, s37, 20736
    buffer_load_dwordx4 v[40:43], v8, s[20:23], s39 offen
    buffer_load_dwordx4 v[88:91], v11, s[20:23], s39 offen offset:256
    s_add_u32 s39, s37, 21888
    buffer_load_dwordx4 v[44:47], v8, s[20:23], s39 offen
    buffer_load_dwordx4 v[92:95], v11, s[20:23], s39 offen offset:256
    s_branch .Cst_prep_kernel_14
.Cks1_prep_kernel_12:
    s_add_u32 s39, s37, 23040
    buffer_load_dwordx4 v[16:19], v8, s[20:23], s39 offen
    buffer_load_dwordx4 v[64:67], v11, s[20:23], s39 offen offset:256
    s_add_u32 s39, s37, 24192
    buffer_load_dwordx4 v[20:23], v8, s[20:23], s39 offen
    buffer_load_dwordx4 v[68:71], v11, s[20:23], s39 offen offset:256
    s_add_u32 s39, s37, 39168
    buffer_load_dwordx4 v[24:27], v9, s[20:23], s39 offen
    buffer_load_dwordx4 v[72:75], v12, s[20:23], s39 offen offset:256
    s_add_u32 s39, s37, 40320
    buffer_load_dwordx4 v[28:31], v9, s[20:23], s39 offen
    buffer_load_dwordx4 v[76:79], v12, s[20:23], s39 offen offset:256
    s_add_u32 s39, s37, 41472
    buffer_load_dwordx4 v[32:35], v8, s[20:23], s39 offen
    buffer_load_dwordx4 v[80:83], v11, s[20:23], s39 offen offset:256
    s_add_u32 s39, s37, 42624
    buffer_load_dwordx4 v[36:39], v8, s[20:23], s39 offen
    buffer_load_dwordx4 v[84:87], v11, s[20:23], s39 offen offset:256
    s_add_u32 s39, s37, 43776
    buffer_load_dwordx4 v[40:43], v8, s[20:23], s39 offen
    buffer_load_dwordx4 v[88:91], v11, s[20:23], s39 offen offset:256
    s_add_u32 s39, s37, 44928
    buffer_load_dwordx4 v[44:47], v8, s[20:23], s39 offen
    buffer_load_dwordx4 v[92:95], v11, s[20:23], s39 offen offset:256
    s_branch .Cst_prep_kernel_14
.Cks2_prep_kernel_13:
    s_add_u32 s39, s37, 59904
    buffer_load_dwordx4 v[16:19], v9, s[20:23], s39 offen
    buffer_load_dwordx4 v[64:67], v12, s[20:23], s39 offen offset:256
    s_add_u32 s39, s37, 61056
    buffer_load_dwordx4 v[20:23], v9, s[20:23], s39 offen
    buffer_load_dwordx4 v[68:71], v12, s[20:23], s39 offen offset:256
    s_add_u32 s39, s37, 62208
    buffer_load_dwordx4 v[24:27], v8, s[20:23], s39 offen
    buffer_load_dwordx4 v[72:75], v11, s[20:23], s39 offen offset:256
    s_add_u32 s39, s37, 63360
    buffer_load_dwordx4 v[28:31], v8, s[20:23], s39 offen
    buffer_load_dwordx4 v[76:79], v11, s[20:23], s39 offen offset:256
    s_add_u32 s39, s37, 64512
    buffer_load_dwordx4 v[32:35], v8, s[20:23], s39 offen
    buffer_load_dwordx4 v[80:83], v11, s[20:23], s39 offen offset:256
    s_add_u32 s39, s37, 65664
    buffer_load_dwordx4 v[36:39], v8, s[20:23], s39 offen
    buffer_load_dwordx4 v[84:87], v11, s[20:23], s39 offen offset:256
    s_add_u32 s39, s37, 80640
    buffer_load_dwordx4 v[40:43], v9, s[20:23], s39 offen
    buffer_load_dwordx4 v[88:91], v12, s[20:23], s39 offen offset:256
    s_add_u32 s39, s37, 81792
    buffer_load_dwordx4 v[44:47], v9, s[20:23], s39 offen
    buffer_load_dwordx4 v[92:95], v12, s[20:23], s39 offen offset:256
.Cst_prep_kernel_14:
    v_lshrrev_b32 v9, 2, v3
    v_lshlrev_b32 v9, 11, v9
    v_lshl_add_u32 v9, v4, 8, v9
    v_and_b32 v10, 3, v3
    v_lshl_add_u32 v9, v10, 6, v9
    v_lshlrev_b32 v10, 8, v4
    v_lshl_add_u32 v10, v3, 7, v10
    v_cndmask_b32 v10, v13, v10, s[40:41]
    s_mul_i32 s38, s32, 9216
    s_add_u32 s39, s38, 8192
    v_add_u32 v9, s59, v9
    s_waitcnt vmcnt(0)
    v_perm_b32 v48, v68, v64, s62
    v_perm_b32 v49, v76, v72, s62
    v_perm_b32 v50, v84, v80, s62
    v_perm_b32 v51, v92, v88, s62
    buffer_store_dwordx4 v[48:51], v10, s[24:27], s39 offen offset:0
    v_perm_b32 v52, v68, v64, s63
    v_perm_b32 v53, v76, v72, s63
    v_perm_b32 v54, v84, v80, s63
    v_perm_b32 v55, v92, v88, s63
    buffer_store_dwordx4 v[52:55], v10, s[24:27], s39 offen offset:16
    v_perm_b32 v56, v69, v65, s62
    v_perm_b32 v57, v77, v73, s62
    v_perm_b32 v58, v85, v81, s62
    v_perm_b32 v59, v93, v89, s62
    buffer_store_dwordx4 v[56:59], v10, s[24:27], s39 offen offset:32
    v_perm_b32 v60, v69, v65, s63
    v_perm_b32 v61, v77, v73, s63
    v_perm_b32 v62, v85, v81, s63
    v_perm_b32 v63, v93, v89, s63
    buffer_store_dwordx4 v[60:63], v10, s[24:27], s39 offen offset:48
    v_perm_b32 v48, v70, v66, s62
    v_perm_b32 v49, v78, v74, s62
    v_perm_b32 v50, v86, v82, s62
    v_perm_b32 v51, v94, v90, s62
    buffer_store_dwordx4 v[48:51], v10, s[24:27], s39 offen offset:64
    v_perm_b32 v52, v70, v66, s63
    v_perm_b32 v53, v78, v74, s63
    v_perm_b32 v54, v86, v82, s63
    v_perm_b32 v55, v94, v90, s63
    buffer_store_dwordx4 v[52:55], v10, s[24:27], s39 offen offset:80
    v_perm_b32 v56, v71, v67, s62
    v_perm_b32 v57, v79, v75, s62
    v_perm_b32 v58, v87, v83, s62
    v_perm_b32 v59, v95, v91, s62
    buffer_store_dwordx4 v[56:59], v10, s[24:27], s39 offen offset:96
    v_perm_b32 v60, v71, v67, s63
    v_perm_b32 v61, v79, v75, s63
    v_perm_b32 v62, v87, v83, s63
    v_perm_b32 v63, v95, v91, s63
    buffer_store_dwordx4 v[60:63], v10, s[24:27], s39 offen offset:112
    v_perm_b32 v48, v20, v16, s62
    v_perm_b32 v49, v28, v24, s62
    v_perm_b32 v50, v36, v32, s62
    v_perm_b32 v51, v44, v40, s62
    ds_write_b128 v9, v[48:51] offset:0
    v_perm_b32 v52, v20, v16, s63
    v_perm_b32 v53, v28, v24, s63
    v_perm_b32 v54, v36, v32, s63
    v_perm_b32 v55, v44, v40, s63
    ds_write_b128 v9, v[52:55] offset:16
    v_perm_b32 v56, v21, v17, s62
    v_perm_b32 v57, v29, v25, s62
    v_perm_b32 v58, v37, v33, s62
    v_perm_b32 v59, v45, v41, s62
    ds_write_b128 v9, v[56:59] offset:32
    v_perm_b32 v60, v21, v17, s63
    v_perm_b32 v61, v29, v25, s63
    v_perm_b32 v62, v37, v33, s63
    v_perm_b32 v63, v45, v41, s63
    ds_write_b128 v9, v[60:63] offset:48
    v_perm_b32 v48, v22, v18, s62
    v_perm_b32 v49, v30, v26, s62
    v_perm_b32 v50, v38, v34, s62
    v_perm_b32 v51, v46, v42, s62
    ds_write_b128 v9, v[48:51] offset:1024
    v_perm_b32 v52, v22, v18, s63
    v_perm_b32 v53, v30, v26, s63
    v_perm_b32 v54, v38, v34, s63
    v_perm_b32 v55, v46, v42, s63
    ds_write_b128 v9, v[52:55] offset:1040
    v_perm_b32 v56, v23, v19, s62
    v_perm_b32 v57, v31, v27, s62
    v_perm_b32 v58, v39, v35, s62
    v_perm_b32 v59, v47, v43, s62
    ds_write_b128 v9, v[56:59] offset:1056
    v_perm_b32 v60, v23, v19, s63
    v_perm_b32 v61, v31, v27, s63
    v_perm_b32 v62, v39, v35, s63
    v_perm_b32 v63, v47, v43, s63
    ds_write_b128 v9, v[60:63] offset:1072
    ds_read_b128 v[16:19], v14 offset:0
    ds_read_b128 v[20:23], v14 offset:1024
    ds_read_b128 v[24:27], v14 offset:2048
    ds_read_b128 v[28:31], v14 offset:3072
    ds_read_b128 v[32:35], v14 offset:4096
    ds_read_b128 v[36:39], v14 offset:5120
    ds_read_b128 v[40:43], v14 offset:6144
    ds_read_b128 v[44:47], v14 offset:7168
    s_waitcnt lgkmcnt(7)
    s_add_u32 s61, s38, 0
    buffer_store_dwordx4 v[16:19], v5, s[24:27], s61 offen
    s_waitcnt lgkmcnt(6)
    s_add_u32 s61, s38, 1024
    buffer_store_dwordx4 v[20:23], v5, s[24:27], s61 offen
    s_waitcnt lgkmcnt(5)
    s_add_u32 s61, s38, 2048
    buffer_store_dwordx4 v[24:27], v5, s[24:27], s61 offen
    s_waitcnt lgkmcnt(4)
    s_add_u32 s61, s38, 3072
    buffer_store_dwordx4 v[28:31], v5, s[24:27], s61 offen
    s_waitcnt lgkmcnt(3)
    s_add_u32 s61, s38, 4096
    buffer_store_dwordx4 v[32:35], v5, s[24:27], s61 offen
    s_waitcnt lgkmcnt(2)
    s_add_u32 s61, s38, 5120
    buffer_store_dwordx4 v[36:39], v5, s[24:27], s61 offen
    s_waitcnt lgkmcnt(1)
    s_add_u32 s61, s38, 6144
    buffer_store_dwordx4 v[40:43], v5, s[24:27], s61 offen
    s_waitcnt lgkmcnt(0)
    s_add_u32 s61, s38, 7168
    buffer_store_dwordx4 v[44:47], v5, s[24:27], s61 offen
    s_nop 1
    s_branch .End_prep_kernel_9
.E_prep_kernel_6:
    s_sub_u32 s32, s2, 168
    s_lshl_b32 s32, s32, 2
    s_add_u32 s32, s32, s3
    s_mov_b32 s20, s6
    s_mov_b32 s21, s7
    s_and_b32 s21, s21, 0xffff
    s_mov_b32 s22, 0x240000
    s_mov_b32 s23, 0x20000
    s_add_u32 s24, s4, 0x1800000
    s_addc_u32 s25, s5, 0
    s_and_b32 s25, s25, 0xffff
    s_mov_b32 s26, 0x240000
    s_mov_b32 s27, 0x20000
    s_add_u32 s28, s4, 0x2200000
    s_addc_u32 s29, s5, 0
    s_and_b32 s29, s29, 0xffff
    s_mov_b32 s30, 0x40000
    s_mov_b32 s31, 0x20000
    v_mul_u32_u24 v8, 1152, v3
    v_lshl_add_u32 v8, v4, 4, v8
    s_mul_i32 s33, s32, 18432
    s_mul_i32 s34, s32, 18432
    buffer_load_dwordx4 v[16:19], v8, s[20:23], s33 offen offset:0
    buffer_load_dwordx4 v[20:23], v8, s[20:23], s33 offen offset:64
    buffer_load_dwordx4 v[24:27], v8, s[20:23], s33 offen offset:128
    buffer_load_dwordx4 v[28:31], v8, s[20:23], s33 offen offset:192
    buffer_load_dwordx4 v[32:35], v8, s[20:23], s33 offen offset:256
    buffer_load_dwordx4 v[36:39], v8, s[20:23], s33 offen offset:320
    buffer_load_dwordx4 v[40:43], v8, s[20:23], s33 offen offset:384
    buffer_load_dwordx4 v[44:47], v8, s[20:23], s33 offen offset:448
    buffer_load_dwordx4 v[48:51], v8, s[20:23], s33 offen offset:512
    buffer_load_dwordx4 v[52:55], v8, s[20:23], s33 offen offset:576
    buffer_load_dwordx4 v[56:59], v8, s[20:23], s33 offen offset:640
    buffer_load_dwordx4 v[60:63], v8, s[20:23], s33 offen offset:704
    buffer_load_dwordx4 v[64:67], v8, s[20:23], s33 offen offset:768
    buffer_load_dwordx4 v[68:71], v8, s[20:23], s33 offen offset:832
    buffer_load_dwordx4 v[72:75], v8, s[20:23], s33 offen offset:896
    buffer_load_dwordx4 v[76:79], v8, s[20:23], s33 offen offset:960
    buffer_load_dwordx4 v[80:83], v8, s[20:23], s33 offen offset:1024
    buffer_load_dwordx4 v[84:87], v8, s[20:23], s33 offen offset:1088
    v_mov_b32 v9, 0
    s_waitcnt vmcnt(17)
    s_add_u32 s35, s34, 0
    buffer_store_dwordx4 v[16:19], v5, s[24:27], s35 offen
    v_lshlrev_b32 v10, 16, v16
    v_and_b32 v11, 0xffff0000, v16
    v_add_f32 v9, v9, v10
    v_add_f32 v9, v9, v11
    v_lshlrev_b32 v10, 16, v17
    v_and_b32 v11, 0xffff0000, v17
    v_add_f32 v9, v9, v10
    v_add_f32 v9, v9, v11
    v_lshlrev_b32 v10, 16, v18
    v_and_b32 v11, 0xffff0000, v18
    v_add_f32 v9, v9, v10
    v_add_f32 v9, v9, v11
    v_lshlrev_b32 v10, 16, v19
    v_and_b32 v11, 0xffff0000, v19
    v_add_f32 v9, v9, v10
    v_add_f32 v9, v9, v11
    s_waitcnt vmcnt(17)
    s_add_u32 s35, s34, 1024
    buffer_store_dwordx4 v[20:23], v5, s[24:27], s35 offen
    v_lshlrev_b32 v10, 16, v20
    v_and_b32 v11, 0xffff0000, v20
    v_add_f32 v9, v9, v10
    v_add_f32 v9, v9, v11
    v_lshlrev_b32 v10, 16, v21
    v_and_b32 v11, 0xffff0000, v21
    v_add_f32 v9, v9, v10
    v_add_f32 v9, v9, v11
    v_lshlrev_b32 v10, 16, v22
    v_and_b32 v11, 0xffff0000, v22
    v_add_f32 v9, v9, v10
    v_add_f32 v9, v9, v11
    v_lshlrev_b32 v10, 16, v23
    v_and_b32 v11, 0xffff0000, v23
    v_add_f32 v9, v9, v10
    v_add_f32 v9, v9, v11
    s_waitcnt vmcnt(17)
    s_add_u32 s35, s34, 2048
    buffer_store_dwordx4 v[24:27], v5, s[24:27], s35 offen
    v_lshlrev_b32 v10, 16, v24
    v_and_b32 v11, 0xffff0000, v24
    v_add_f32 v9, v9, v10
    v_add_f32 v9, v9, v11
    v_lshlrev_b32 v10, 16, v25
    v_and_b32 v11, 0xffff0000, v25
    v_add_f32 v9, v9, v10
    v_add_f32 v9, v9, v11
    v_lshlrev_b32 v10, 16, v26
    v_and_b32 v11, 0xffff0000, v26
    v_add_f32 v9, v9, v10
    v_add_f32 v9, v9, v11
    v_lshlrev_b32 v10, 16, v27
    v_and_b32 v11, 0xffff0000, v27
    v_add_f32 v9, v9, v10
    v_add_f32 v9, v9, v11
    s_waitcnt vmcnt(17)
    s_add_u32 s35, s34, 3072
    buffer_store_dwordx4 v[28:31], v5, s[24:27], s35 offen
    v_lshlrev_b32 v10, 16, v28
    v_and_b32 v11, 0xffff0000, v28
    v_add_f32 v9, v9, v10
    v_add_f32 v9, v9, v11
    v_lshlrev_b32 v10, 16, v29
    v_and_b32 v11, 0xffff0000, v29
    v_add_f32 v9, v9, v10
    v_add_f32 v9, v9, v11
    v_lshlrev_b32 v10, 16, v30
    v_and_b32 v11, 0xffff0000, v30
    v_add_f32 v9, v9, v10
    v_add_f32 v9, v9, v11
    v_lshlrev_b32 v10, 16, v31
    v_and_b32 v11, 0xffff0000, v31
    v_add_f32 v9, v9, v10
    v_add_f32 v9, v9, v11
    s_waitcnt vmcnt(17)
    s_add_u32 s35, s34, 4096
    buffer_store_dwordx4 v[32:35], v5, s[24:27], s35 offen
    v_lshlrev_b32 v10, 16, v32
    v_and_b32 v11, 0xffff0000, v32
    v_add_f32 v9, v9, v10
    v_add_f32 v9, v9, v11
    v_lshlrev_b32 v10, 16, v33
    v_and_b32 v11, 0xffff0000, v33
    v_add_f32 v9, v9, v10
    v_add_f32 v9, v9, v11
    v_lshlrev_b32 v10, 16, v34
    v_and_b32 v11, 0xffff0000, v34
    v_add_f32 v9, v9, v10
    v_add_f32 v9, v9, v11
    v_lshlrev_b32 v10, 16, v35
    v_and_b32 v11, 0xffff0000, v35
    v_add_f32 v9, v9, v10
    v_add_f32 v9, v9, v11
    s_waitcnt vmcnt(17)
    s_add_u32 s35, s34, 5120
    buffer_store_dwordx4 v[36:39], v5, s[24:27], s35 offen
    v_lshlrev_b32 v10, 16, v36
    v_and_b32 v11, 0xffff0000, v36
    v_add_f32 v9, v9, v10
    v_add_f32 v9, v9, v11
    v_lshlrev_b32 v10, 16, v37
    v_and_b32 v11, 0xffff0000, v37
    v_add_f32 v9, v9, v10
    v_add_f32 v9, v9, v11
    v_lshlrev_b32 v10, 16, v38
    v_and_b32 v11, 0xffff0000, v38
    v_add_f32 v9, v9, v10
    v_add_f32 v9, v9, v11
    v_lshlrev_b32 v10, 16, v39
    v_and_b32 v11, 0xffff0000, v39
    v_add_f32 v9, v9, v10
    v_add_f32 v9, v9, v11
    s_waitcnt vmcnt(17)
    s_add_u32 s35, s34, 6144
    buffer_store_dwordx4 v[40:43], v5, s[24:27], s35 offen
    v_lshlrev_b32 v10, 16, v40
    v_and_b32 v11, 0xffff0000, v40
    v_add_f32 v9, v9, v10
    v_add_f32 v9, v9, v11
    v_lshlrev_b32 v10, 16, v41
    v_and_b32 v11, 0xffff0000, v41
    v_add_f32 v9, v9, v10
    v_add_f32 v9, v9, v11
    v_lshlrev_b32 v10, 16, v42
    v_and_b32 v11, 0xffff0000, v42
    v_add_f32 v9, v9, v10
    v_add_f32 v9, v9, v11
    v_lshlrev_b32 v10, 16, v43
    v_and_b32 v11, 0xffff0000, v43
    v_add_f32 v9, v9, v10
    v_add_f32 v9, v9, v11
    s_waitcnt vmcnt(17)
    s_add_u32 s35, s34, 7168
    buffer_store_dwordx4 v[44:47], v5, s[24:27], s35 offen
    v_lshlrev_b32 v10, 16, v44
    v_and_b32 v11, 0xffff0000, v44
    v_add_f32 v9, v9, v10
    v_add_f32 v9, v9, v11
    v_lshlrev_b32 v10, 16, v45
    v_and_b32 v11, 0xffff0000, v45
    v_add_f32 v9, v9, v10
    v_add_f32 v9, v9, v11
    v_lshlrev_b32 v10, 16, v46
    v_and_b32 v11, 0xffff0000, v46
    v_add_f32 v9, v9, v10
    v_add_f32 v9, v9, v11
    v_lshlrev_b32 v10, 16, v47
    v_and_b32 v11, 0xffff0000, v47
    v_add_f32 v9, v9, v10
    v_add_f32 v9, v9, v11
    s_waitcnt vmcnt(17)
    s_add_u32 s35, s34, 8192
    buffer_store_dwordx4 v[48:51], v5, s[24:27], s35 offen
    v_lshlrev_b32 v10, 16, v48
    v_and_b32 v11, 0xffff0000, v48
    v_add_f32 v9, v9, v10
    v_add_f32 v9, v9, v11
    v_lshlrev_b32 v10, 16, v49
    v_and_b32 v11, 0xffff0000, v49
    v_add_f32 v9, v9, v10
    v_add_f32 v9, v9, v11
    v_lshlrev_b32 v10, 16, v50
    v_and_b32 v11, 0xffff0000, v50
    v_add_f32 v9, v9, v10
    v_add_f32 v9, v9, v11
    v_lshlrev_b32 v10, 16, v51
    v_and_b32 v11, 0xffff0000, v51
    v_add_f32 v9, v9, v10
    v_add_f32 v9, v9, v11
    s_waitcnt vmcnt(17)
    s_add_u32 s35, s34, 9216
    buffer_store_dwordx4 v[52:55], v5, s[24:27], s35 offen
    v_lshlrev_b32 v10, 16, v52
    v_and_b32 v11, 0xffff0000, v52
    v_add_f32 v9, v9, v10
    v_add_f32 v9, v9, v11
    v_lshlrev_b32 v10, 16, v53
    v_and_b32 v11, 0xffff0000, v53
    v_add_f32 v9, v9, v10
    v_add_f32 v9, v9, v11
    v_lshlrev_b32 v10, 16, v54
    v_and_b32 v11, 0xffff0000, v54
    v_add_f32 v9, v9, v10
    v_add_f32 v9, v9, v11
    v_lshlrev_b32 v10, 16, v55
    v_and_b32 v11, 0xffff0000, v55
    v_add_f32 v9, v9, v10
    v_add_f32 v9, v9, v11
    s_waitcnt vmcnt(17)
    s_add_u32 s35, s34, 10240
    buffer_store_dwordx4 v[56:59], v5, s[24:27], s35 offen
    v_lshlrev_b32 v10, 16, v56
    v_and_b32 v11, 0xffff0000, v56
    v_add_f32 v9, v9, v10
    v_add_f32 v9, v9, v11
    v_lshlrev_b32 v10, 16, v57
    v_and_b32 v11, 0xffff0000, v57
    v_add_f32 v9, v9, v10
    v_add_f32 v9, v9, v11
    v_lshlrev_b32 v10, 16, v58
    v_and_b32 v11, 0xffff0000, v58
    v_add_f32 v9, v9, v10
    v_add_f32 v9, v9, v11
    v_lshlrev_b32 v10, 16, v59
    v_and_b32 v11, 0xffff0000, v59
    v_add_f32 v9, v9, v10
    v_add_f32 v9, v9, v11
    s_waitcnt vmcnt(17)
    s_add_u32 s35, s34, 11264
    buffer_store_dwordx4 v[60:63], v5, s[24:27], s35 offen
    v_lshlrev_b32 v10, 16, v60
    v_and_b32 v11, 0xffff0000, v60
    v_add_f32 v9, v9, v10
    v_add_f32 v9, v9, v11
    v_lshlrev_b32 v10, 16, v61
    v_and_b32 v11, 0xffff0000, v61
    v_add_f32 v9, v9, v10
    v_add_f32 v9, v9, v11
    v_lshlrev_b32 v10, 16, v62
    v_and_b32 v11, 0xffff0000, v62
    v_add_f32 v9, v9, v10
    v_add_f32 v9, v9, v11
    v_lshlrev_b32 v10, 16, v63
    v_and_b32 v11, 0xffff0000, v63
    v_add_f32 v9, v9, v10
    v_add_f32 v9, v9, v11
    s_waitcnt vmcnt(17)
    s_add_u32 s35, s34, 12288
    buffer_store_dwordx4 v[64:67], v5, s[24:27], s35 offen
    v_lshlrev_b32 v10, 16, v64
    v_and_b32 v11, 0xffff0000, v64
    v_add_f32 v9, v9, v10
    v_add_f32 v9, v9, v11
    v_lshlrev_b32 v10, 16, v65
    v_and_b32 v11, 0xffff0000, v65
    v_add_f32 v9, v9, v10
    v_add_f32 v9, v9, v11
    v_lshlrev_b32 v10, 16, v66
    v_and_b32 v11, 0xffff0000, v66
    v_add_f32 v9, v9, v10
    v_add_f32 v9, v9, v11
    v_lshlrev_b32 v10, 16, v67
    v_and_b32 v11, 0xffff0000, v67
    v_add_f32 v9, v9, v10
    v_add_f32 v9, v9, v11
    s_waitcnt vmcnt(17)
    s_add_u32 s35, s34, 13312
    buffer_store_dwordx4 v[68:71], v5, s[24:27], s35 offen
    v_lshlrev_b32 v10, 16, v68
    v_and_b32 v11, 0xffff0000, v68
    v_add_f32 v9, v9, v10
    v_add_f32 v9, v9, v11
    v_lshlrev_b32 v10, 16, v69
    v_and_b32 v11, 0xffff0000, v69
    v_add_f32 v9, v9, v10
    v_add_f32 v9, v9, v11
    v_lshlrev_b32 v10, 16, v70
    v_and_b32 v11, 0xffff0000, v70
    v_add_f32 v9, v9, v10
    v_add_f32 v9, v9, v11
    v_lshlrev_b32 v10, 16, v71
    v_and_b32 v11, 0xffff0000, v71
    v_add_f32 v9, v9, v10
    v_add_f32 v9, v9, v11
    s_waitcnt vmcnt(17)
    s_add_u32 s35, s34, 14336
    buffer_store_dwordx4 v[72:75], v5, s[24:27], s35 offen
    v_lshlrev_b32 v10, 16, v72
    v_and_b32 v11, 0xffff0000, v72
    v_add_f32 v9, v9, v10
    v_add_f32 v9, v9, v11
    v_lshlrev_b32 v10, 16, v73
    v_and_b32 v11, 0xffff0000, v73
    v_add_f32 v9, v9, v10
    v_add_f32 v9, v9, v11
    v_lshlrev_b32 v10, 16, v74
    v_and_b32 v11, 0xffff0000, v74
    v_add_f32 v9, v9, v10
    v_add_f32 v9, v9, v11
    v_lshlrev_b32 v10, 16, v75
    v_and_b32 v11, 0xffff0000, v75
    v_add_f32 v9, v9, v10
    v_add_f32 v9, v9, v11
    s_waitcnt vmcnt(17)
    s_add_u32 s35, s34, 15360
    buffer_store_dwordx4 v[76:79], v5, s[24:27], s35 offen
    v_lshlrev_b32 v10, 16, v76
    v_and_b32 v11, 0xffff0000, v76
    v_add_f32 v9, v9, v10
    v_add_f32 v9, v9, v11
    v_lshlrev_b32 v10, 16, v77
    v_and_b32 v11, 0xffff0000, v77
    v_add_f32 v9, v9, v10
    v_add_f32 v9, v9, v11
    v_lshlrev_b32 v10, 16, v78
    v_and_b32 v11, 0xffff0000, v78
    v_add_f32 v9, v9, v10
    v_add_f32 v9, v9, v11
    v_lshlrev_b32 v10, 16, v79
    v_and_b32 v11, 0xffff0000, v79
    v_add_f32 v9, v9, v10
    v_add_f32 v9, v9, v11
    s_waitcnt vmcnt(17)
    s_add_u32 s35, s34, 16384
    buffer_store_dwordx4 v[80:83], v5, s[24:27], s35 offen
    v_lshlrev_b32 v10, 16, v80
    v_and_b32 v11, 0xffff0000, v80
    v_add_f32 v9, v9, v10
    v_add_f32 v9, v9, v11
    v_lshlrev_b32 v10, 16, v81
    v_and_b32 v11, 0xffff0000, v81
    v_add_f32 v9, v9, v10
    v_add_f32 v9, v9, v11
    v_lshlrev_b32 v10, 16, v82
    v_and_b32 v11, 0xffff0000, v82
    v_add_f32 v9, v9, v10
    v_add_f32 v9, v9, v11
    v_lshlrev_b32 v10, 16, v83
    v_and_b32 v11, 0xffff0000, v83
    v_add_f32 v9, v9, v10
    v_add_f32 v9, v9, v11
    s_waitcnt vmcnt(17)
    s_add_u32 s35, s34, 17408
    buffer_store_dwordx4 v[84:87], v5, s[24:27], s35 offen
    v_lshlrev_b32 v10, 16, v84
    v_and_b32 v11, 0xffff0000, v84
    v_add_f32 v9, v9, v10
    v_add_f32 v9, v9, v11
    v_lshlrev_b32 v10, 16, v85
    v_and_b32 v11, 0xffff0000, v85
    v_add_f32 v9, v9, v10
    v_add_f32 v9, v9, v11
    v_lshlrev_b32 v10, 16, v86
    v_and_b32 v11, 0xffff0000, v86
    v_add_f32 v9, v9, v10
    v_add_f32 v9, v9, v11
    v_lshlrev_b32 v10, 16, v87
    v_and_b32 v11, 0xffff0000, v87
    v_add_f32 v9, v9, v10
    v_add_f32 v9, v9, v11
    v_mov_b32 v10, v9
    s_nop 1
    v_permlane16_swap_b32 v9, v10
    v_add_f32 v9, v9, v10
    v_mov_b32 v10, v9
    s_nop 1
    v_permlane32_swap_b32 v9, v10
    v_add_f32 v9, v9, v10
    v_mul_f32 v9, 0x3ae38e39, v9
    v_mov_b32 v12, 0
    v_lshlrev_b32 v10, 16, v16
    v_and_b32 v11, 0xffff0000, v16
    v_sub_f32 v10, v10, v9
    v_sub_f32 v11, v11, v9
    v_fmac_f32 v12, v10, v10
    v_fmac_f32 v12, v11, v11
    v_lshlrev_b32 v10, 16, v17
    v_and_b32 v11, 0xffff0000, v17
    v_sub_f32 v10, v10, v9
    v_sub_f32 v11, v11, v9
    v_fmac_f32 v12, v10, v10
    v_fmac_f32 v12, v11, v11
    v_lshlrev_b32 v10, 16, v18
    v_and_b32 v11, 0xffff0000, v18
    v_sub_f32 v10, v10, v9
    v_sub_f32 v11, v11, v9
    v_fmac_f32 v12, v10, v10
    v_fmac_f32 v12, v11, v11
    v_lshlrev_b32 v10, 16, v19
    v_and_b32 v11, 0xffff0000, v19
    v_sub_f32 v10, v10, v9
    v_sub_f32 v11, v11, v9
    v_fmac_f32 v12, v10, v10
    v_fmac_f32 v12, v11, v11
    v_lshlrev_b32 v10, 16, v20
    v_and_b32 v11, 0xffff0000, v20
    v_sub_f32 v10, v10, v9
    v_sub_f32 v11, v11, v9
    v_fmac_f32 v12, v10, v10
    v_fmac_f32 v12, v11, v11
    v_lshlrev_b32 v10, 16, v21
    v_and_b32 v11, 0xffff0000, v21
    v_sub_f32 v10, v10, v9
    v_sub_f32 v11, v11, v9
    v_fmac_f32 v12, v10, v10
    v_fmac_f32 v12, v11, v11
    v_lshlrev_b32 v10, 16, v22
    v_and_b32 v11, 0xffff0000, v22
    v_sub_f32 v10, v10, v9
    v_sub_f32 v11, v11, v9
    v_fmac_f32 v12, v10, v10
    v_fmac_f32 v12, v11, v11
    v_lshlrev_b32 v10, 16, v23
    v_and_b32 v11, 0xffff0000, v23
    v_sub_f32 v10, v10, v9
    v_sub_f32 v11, v11, v9
    v_fmac_f32 v12, v10, v10
    v_fmac_f32 v12, v11, v11
    v_lshlrev_b32 v10, 16, v24
    v_and_b32 v11, 0xffff0000, v24
    v_sub_f32 v10, v10, v9
    v_sub_f32 v11, v11, v9
    v_fmac_f32 v12, v10, v10
    v_fmac_f32 v12, v11, v11
    v_lshlrev_b32 v10, 16, v25
    v_and_b32 v11, 0xffff0000, v25
    v_sub_f32 v10, v10, v9
    v_sub_f32 v11, v11, v9
    v_fmac_f32 v12, v10, v10
    v_fmac_f32 v12, v11, v11
    v_lshlrev_b32 v10, 16, v26
    v_and_b32 v11, 0xffff0000, v26
    v_sub_f32 v10, v10, v9
    v_sub_f32 v11, v11, v9
    v_fmac_f32 v12, v10, v10
    v_fmac_f32 v12, v11, v11
    v_lshlrev_b32 v10, 16, v27
    v_and_b32 v11, 0xffff0000, v27
    v_sub_f32 v10, v10, v9
    v_sub_f32 v11, v11, v9
    v_fmac_f32 v12, v10, v10
    v_fmac_f32 v12, v11, v11
    v_lshlrev_b32 v10, 16, v28
    v_and_b32 v11, 0xffff0000, v28
    v_sub_f32 v10, v10, v9
    v_sub_f32 v11, v11, v9
    v_fmac_f32 v12, v10, v10
    v_fmac_f32 v12, v11, v11
    v_lshlrev_b32 v10, 16, v29
    v_and_b32 v11, 0xffff0000, v29
    v_sub_f32 v10, v10, v9
    v_sub_f32 v11, v11, v9
    v_fmac_f32 v12, v10, v10
    v_fmac_f32 v12, v11, v11
    v_lshlrev_b32 v10, 16, v30
    v_and_b32 v11, 0xffff0000, v30
    v_sub_f32 v10, v10, v9
    v_sub_f32 v11, v11, v9
    v_fmac_f32 v12, v10, v10
    v_fmac_f32 v12, v11, v11
    v_lshlrev_b32 v10, 16, v31
    v_and_b32 v11, 0xffff0000, v31
    v_sub_f32 v10, v10, v9
    v_sub_f32 v11, v11, v9
    v_fmac_f32 v12, v10, v10
    v_fmac_f32 v12, v11, v11
    v_lshlrev_b32 v10, 16, v32
    v_and_b32 v11, 0xffff0000, v32
    v_sub_f32 v10, v10, v9
    v_sub_f32 v11, v11, v9
    v_fmac_f32 v12, v10, v10
    v_fmac_f32 v12, v11, v11
    v_lshlrev_b32 v10, 16, v33
    v_and_b32 v11, 0xffff0000, v33
    v_sub_f32 v10, v10, v9
    v_sub_f32 v11, v11, v9
    v_fmac_f32 v12, v10, v10
    v_fmac_f32 v12, v11, v11
    v_lshlrev_b32 v10, 16, v34
    v_and_b32 v11, 0xffff0000, v34
    v_sub_f32 v10, v10, v9
    v_sub_f32 v11, v11, v9
    v_fmac_f32 v12, v10, v10
    v_fmac_f32 v12, v11, v11
    v_lshlrev_b32 v10, 16, v35
    v_and_b32 v11, 0xffff0000, v35
    v_sub_f32 v10, v10, v9
    v_sub_f32 v11, v11, v9
    v_fmac_f32 v12, v10, v10
    v_fmac_f32 v12, v11, v11
    v_lshlrev_b32 v10, 16, v36
    v_and_b32 v11, 0xffff0000, v36
    v_sub_f32 v10, v10, v9
    v_sub_f32 v11, v11, v9
    v_fmac_f32 v12, v10, v10
    v_fmac_f32 v12, v11, v11
    v_lshlrev_b32 v10, 16, v37
    v_and_b32 v11, 0xffff0000, v37
    v_sub_f32 v10, v10, v9
    v_sub_f32 v11, v11, v9
    v_fmac_f32 v12, v10, v10
    v_fmac_f32 v12, v11, v11
    v_lshlrev_b32 v10, 16, v38
    v_and_b32 v11, 0xffff0000, v38
    v_sub_f32 v10, v10, v9
    v_sub_f32 v11, v11, v9
    v_fmac_f32 v12, v10, v10
    v_fmac_f32 v12, v11, v11
    v_lshlrev_b32 v10, 16, v39
    v_and_b32 v11, 0xffff0000, v39
    v_sub_f32 v10, v10, v9
    v_sub_f32 v11, v11, v9
    v_fmac_f32 v12, v10, v10
    v_fmac_f32 v12, v11, v11
    v_lshlrev_b32 v10, 16, v40
    v_and_b32 v11, 0xffff0000, v40
    v_sub_f32 v10, v10, v9
    v_sub_f32 v11, v11, v9
    v_fmac_f32 v12, v10, v10
    v_fmac_f32 v12, v11, v11
    v_lshlrev_b32 v10, 16, v41
    v_and_b32 v11, 0xffff0000, v41
    v_sub_f32 v10, v10, v9
    v_sub_f32 v11, v11, v9
    v_fmac_f32 v12, v10, v10
    v_fmac_f32 v12, v11, v11
    v_lshlrev_b32 v10, 16, v42
    v_and_b32 v11, 0xffff0000, v42
    v_sub_f32 v10, v10, v9
    v_sub_f32 v11, v11, v9
    v_fmac_f32 v12, v10, v10
    v_fmac_f32 v12, v11, v11
    v_lshlrev_b32 v10, 16, v43
    v_and_b32 v11, 0xffff0000, v43
    v_sub_f32 v10, v10, v9
    v_sub_f32 v11, v11, v9
    v_fmac_f32 v12, v10, v10
    v_fmac_f32 v12, v11, v11
    v_lshlrev_b32 v10, 16, v44
    v_and_b32 v11, 0xffff0000, v44
    v_sub_f32 v10, v10, v9
    v_sub_f32 v11, v11, v9
    v_fmac_f32 v12, v10, v10
    v_fmac_f32 v12, v11, v11
    v_lshlrev_b32 v10, 16, v45
    v_and_b32 v11, 0xffff0000, v45
    v_sub_f32 v10, v10, v9
    v_sub_f32 v11, v11, v9
    v_fmac_f32 v12, v10, v10
    v_fmac_f32 v12, v11, v11
    v_lshlrev_b32 v10, 16, v46
    v_and_b32 v11, 0xffff0000, v46
    v_sub_f32 v10, v10, v9
    v_sub_f32 v11, v11, v9
    v_fmac_f32 v12, v10, v10
    v_fmac_f32 v12, v11, v11
    v_lshlrev_b32 v10, 16, v47
    v_and_b32 v11, 0xffff0000, v47
    v_sub_f32 v10, v10, v9
    v_sub_f32 v11, v11, v9
    v_fmac_f32 v12, v10, v10
    v_fmac_f32 v12, v11, v11
    v_lshlrev_b32 v10, 16, v48
    v_and_b32 v11, 0xffff0000, v48
    v_sub_f32 v10, v10, v9
    v_sub_f32 v11, v11, v9
    v_fmac_f32 v12, v10, v10
    v_fmac_f32 v12, v11, v11
    v_lshlrev_b32 v10, 16, v49
    v_and_b32 v11, 0xffff0000, v49
    v_sub_f32 v10, v10, v9
    v_sub_f32 v11, v11, v9
    v_fmac_f32 v12, v10, v10
    v_fmac_f32 v12, v11, v11
    v_lshlrev_b32 v10, 16, v50
    v_and_b32 v11, 0xffff0000, v50
    v_sub_f32 v10, v10, v9
    v_sub_f32 v11, v11, v9
    v_fmac_f32 v12, v10, v10
    v_fmac_f32 v12, v11, v11
    v_lshlrev_b32 v10, 16, v51
    v_and_b32 v11, 0xffff0000, v51
    v_sub_f32 v10, v10, v9
    v_sub_f32 v11, v11, v9
    v_fmac_f32 v12, v10, v10
    v_fmac_f32 v12, v11, v11
    v_lshlrev_b32 v10, 16, v52
    v_and_b32 v11, 0xffff0000, v52
    v_sub_f32 v10, v10, v9
    v_sub_f32 v11, v11, v9
    v_fmac_f32 v12, v10, v10
    v_fmac_f32 v12, v11, v11
    v_lshlrev_b32 v10, 16, v53
    v_and_b32 v11, 0xffff0000, v53
    v_sub_f32 v10, v10, v9
    v_sub_f32 v11, v11, v9
    v_fmac_f32 v12, v10, v10
    v_fmac_f32 v12, v11, v11
    v_lshlrev_b32 v10, 16, v54
    v_and_b32 v11, 0xffff0000, v54
    v_sub_f32 v10, v10, v9
    v_sub_f32 v11, v11, v9
    v_fmac_f32 v12, v10, v10
    v_fmac_f32 v12, v11, v11
    v_lshlrev_b32 v10, 16, v55
    v_and_b32 v11, 0xffff0000, v55
    v_sub_f32 v10, v10, v9
    v_sub_f32 v11, v11, v9
    v_fmac_f32 v12, v10, v10
    v_fmac_f32 v12, v11, v11
    v_lshlrev_b32 v10, 16, v56
    v_and_b32 v11, 0xffff0000, v56
    v_sub_f32 v10, v10, v9
    v_sub_f32 v11, v11, v9
    v_fmac_f32 v12, v10, v10
    v_fmac_f32 v12, v11, v11
    v_lshlrev_b32 v10, 16, v57
    v_and_b32 v11, 0xffff0000, v57
    v_sub_f32 v10, v10, v9
    v_sub_f32 v11, v11, v9
    v_fmac_f32 v12, v10, v10
    v_fmac_f32 v12, v11, v11
    v_lshlrev_b32 v10, 16, v58
    v_and_b32 v11, 0xffff0000, v58
    v_sub_f32 v10, v10, v9
    v_sub_f32 v11, v11, v9
    v_fmac_f32 v12, v10, v10
    v_fmac_f32 v12, v11, v11
    v_lshlrev_b32 v10, 16, v59
    v_and_b32 v11, 0xffff0000, v59
    v_sub_f32 v10, v10, v9
    v_sub_f32 v11, v11, v9
    v_fmac_f32 v12, v10, v10
    v_fmac_f32 v12, v11, v11
    v_lshlrev_b32 v10, 16, v60
    v_and_b32 v11, 0xffff0000, v60
    v_sub_f32 v10, v10, v9
    v_sub_f32 v11, v11, v9
    v_fmac_f32 v12, v10, v10
    v_fmac_f32 v12, v11, v11
    v_lshlrev_b32 v10, 16, v61
    v_and_b32 v11, 0xffff0000, v61
    v_sub_f32 v10, v10, v9
    v_sub_f32 v11, v11, v9
    v_fmac_f32 v12, v10, v10
    v_fmac_f32 v12, v11, v11
    v_lshlrev_b32 v10, 16, v62
    v_and_b32 v11, 0xffff0000, v62
    v_sub_f32 v10, v10, v9
    v_sub_f32 v11, v11, v9
    v_fmac_f32 v12, v10, v10
    v_fmac_f32 v12, v11, v11
    v_lshlrev_b32 v10, 16, v63
    v_and_b32 v11, 0xffff0000, v63
    v_sub_f32 v10, v10, v9
    v_sub_f32 v11, v11, v9
    v_fmac_f32 v12, v10, v10
    v_fmac_f32 v12, v11, v11
    v_lshlrev_b32 v10, 16, v64
    v_and_b32 v11, 0xffff0000, v64
    v_sub_f32 v10, v10, v9
    v_sub_f32 v11, v11, v9
    v_fmac_f32 v12, v10, v10
    v_fmac_f32 v12, v11, v11
    v_lshlrev_b32 v10, 16, v65
    v_and_b32 v11, 0xffff0000, v65
    v_sub_f32 v10, v10, v9
    v_sub_f32 v11, v11, v9
    v_fmac_f32 v12, v10, v10
    v_fmac_f32 v12, v11, v11
    v_lshlrev_b32 v10, 16, v66
    v_and_b32 v11, 0xffff0000, v66
    v_sub_f32 v10, v10, v9
    v_sub_f32 v11, v11, v9
    v_fmac_f32 v12, v10, v10
    v_fmac_f32 v12, v11, v11
    v_lshlrev_b32 v10, 16, v67
    v_and_b32 v11, 0xffff0000, v67
    v_sub_f32 v10, v10, v9
    v_sub_f32 v11, v11, v9
    v_fmac_f32 v12, v10, v10
    v_fmac_f32 v12, v11, v11
    v_lshlrev_b32 v10, 16, v68
    v_and_b32 v11, 0xffff0000, v68
    v_sub_f32 v10, v10, v9
    v_sub_f32 v11, v11, v9
    v_fmac_f32 v12, v10, v10
    v_fmac_f32 v12, v11, v11
    v_lshlrev_b32 v10, 16, v69
    v_and_b32 v11, 0xffff0000, v69
    v_sub_f32 v10, v10, v9
    v_sub_f32 v11, v11, v9
    v_fmac_f32 v12, v10, v10
    v_fmac_f32 v12, v11, v11
    v_lshlrev_b32 v10, 16, v70
    v_and_b32 v11, 0xffff0000, v70
    v_sub_f32 v10, v10, v9
    v_sub_f32 v11, v11, v9
    v_fmac_f32 v12, v10, v10
    v_fmac_f32 v12, v11, v11
    v_lshlrev_b32 v10, 16, v71
    v_and_b32 v11, 0xffff0000, v71
    v_sub_f32 v10, v10, v9
    v_sub_f32 v11, v11, v9
    v_fmac_f32 v12, v10, v10
    v_fmac_f32 v12, v11, v11
    v_lshlrev_b32 v10, 16, v72
    v_and_b32 v11, 0xffff0000, v72
    v_sub_f32 v10, v10, v9
    v_sub_f32 v11, v11, v9
    v_fmac_f32 v12, v10, v10
    v_fmac_f32 v12, v11, v11
    v_lshlrev_b32 v10, 16, v73
    v_and_b32 v11, 0xffff0000, v73
    v_sub_f32 v10, v10, v9
    v_sub_f32 v11, v11, v9
    v_fmac_f32 v12, v10, v10
    v_fmac_f32 v12, v11, v11
    v_lshlrev_b32 v10, 16, v74
    v_and_b32 v11, 0xffff0000, v74
    v_sub_f32 v10, v10, v9
    v_sub_f32 v11, v11, v9
    v_fmac_f32 v12, v10, v10
    v_fmac_f32 v12, v11, v11
    v_lshlrev_b32 v10, 16, v75
    v_and_b32 v11, 0xffff0000, v75
    v_sub_f32 v10, v10, v9
    v_sub_f32 v11, v11, v9
    v_fmac_f32 v12, v10, v10
    v_fmac_f32 v12, v11, v11
    v_lshlrev_b32 v10, 16, v76
    v_and_b32 v11, 0xffff0000, v76
    v_sub_f32 v10, v10, v9
    v_sub_f32 v11, v11, v9
    v_fmac_f32 v12, v10, v10
    v_fmac_f32 v12, v11, v11
    v_lshlrev_b32 v10, 16, v77
    v_and_b32 v11, 0xffff0000, v77
    v_sub_f32 v10, v10, v9
    v_sub_f32 v11, v11, v9
    v_fmac_f32 v12, v10, v10
    v_fmac_f32 v12, v11, v11
    v_lshlrev_b32 v10, 16, v78
    v_and_b32 v11, 0xffff0000, v78
    v_sub_f32 v10, v10, v9
    v_sub_f32 v11, v11, v9
    v_fmac_f32 v12, v10, v10
    v_fmac_f32 v12, v11, v11
    v_lshlrev_b32 v10, 16, v79
    v_and_b32 v11, 0xffff0000, v79
    v_sub_f32 v10, v10, v9
    v_sub_f32 v11, v11, v9
    v_fmac_f32 v12, v10, v10
    v_fmac_f32 v12, v11, v11
    v_lshlrev_b32 v10, 16, v80
    v_and_b32 v11, 0xffff0000, v80
    v_sub_f32 v10, v10, v9
    v_sub_f32 v11, v11, v9
    v_fmac_f32 v12, v10, v10
    v_fmac_f32 v12, v11, v11
    v_lshlrev_b32 v10, 16, v81
    v_and_b32 v11, 0xffff0000, v81
    v_sub_f32 v10, v10, v9
    v_sub_f32 v11, v11, v9
    v_fmac_f32 v12, v10, v10
    v_fmac_f32 v12, v11, v11
    v_lshlrev_b32 v10, 16, v82
    v_and_b32 v11, 0xffff0000, v82
    v_sub_f32 v10, v10, v9
    v_sub_f32 v11, v11, v9
    v_fmac_f32 v12, v10, v10
    v_fmac_f32 v12, v11, v11
    v_lshlrev_b32 v10, 16, v83
    v_and_b32 v11, 0xffff0000, v83
    v_sub_f32 v10, v10, v9
    v_sub_f32 v11, v11, v9
    v_fmac_f32 v12, v10, v10
    v_fmac_f32 v12, v11, v11
    v_lshlrev_b32 v10, 16, v84
    v_and_b32 v11, 0xffff0000, v84
    v_sub_f32 v10, v10, v9
    v_sub_f32 v11, v11, v9
    v_fmac_f32 v12, v10, v10
    v_fmac_f32 v12, v11, v11
    v_lshlrev_b32 v10, 16, v85
    v_and_b32 v11, 0xffff0000, v85
    v_sub_f32 v10, v10, v9
    v_sub_f32 v11, v11, v9
    v_fmac_f32 v12, v10, v10
    v_fmac_f32 v12, v11, v11
    v_lshlrev_b32 v10, 16, v86
    v_and_b32 v11, 0xffff0000, v86
    v_sub_f32 v10, v10, v9
    v_sub_f32 v11, v11, v9
    v_fmac_f32 v12, v10, v10
    v_fmac_f32 v12, v11, v11
    v_lshlrev_b32 v10, 16, v87
    v_and_b32 v11, 0xffff0000, v87
    v_sub_f32 v10, v10, v9
    v_sub_f32 v11, v11, v9
    v_fmac_f32 v12, v10, v10
    v_fmac_f32 v12, v11, v11
    v_mov_b32 v10, v12
    s_nop 1
    v_permlane16_swap_b32 v12, v10
    v_add_f32 v12, v12, v10
    v_mov_b32 v10, v12
    s_nop 1
    v_permlane32_swap_b32 v12, v10
    v_add_f32 v12, v12, v10
    v_mov_b32 v10, v9
    v_mov_b32 v11, v12
    v_lshlrev_b32 v13, 3, v3
    v_mov_b32 v14, 0x7ff00000
    v_cmp_gt_u32 vcc, 16, v1
    s_nop 1
    v_cndmask_b32 v13, v14, v13, vcc
    s_lshl_b32 s36, s32, 11
    buffer_store_dwordx2 v[10:11], v13, s[28:31], s36 offen
    s_branch .End_prep_kernel_9
.F_prep_kernel_7:
    s_sub_u32 s32, s2, 200
    s_lshl_b32 s32, s32, 2
    s_add_u32 s32, s32, s3
    s_add_u32 s24, s4, 0x2300000
    s_addc_u32 s25, s5, 0
    s_and_b32 s25, s25, 0xffff
    s_mov_b32 s26, 0x80000
    s_mov_b32 s27, 0x20000
    s_lshl_b32 s33, s32, 14
    v_mov_b32 v8, 0
    v_mov_b32 v9, 0
    v_mov_b32 v10, 0
    v_mov_b32 v11, 0
    s_add_u32 s34, s33, 0
    buffer_store_dwordx4 v[8:11], v5, s[24:27], s34 offen
    s_add_u32 s34, s33, 1024
    buffer_store_dwordx4 v[8:11], v5, s[24:27], s34 offen
    s_add_u32 s34, s33, 2048
    buffer_store_dwordx4 v[8:11], v5, s[24:27], s34 offen
    s_add_u32 s34, s33, 3072
    buffer_store_dwordx4 v[8:11], v5, s[24:27], s34 offen
    s_add_u32 s34, s33, 4096
    buffer_store_dwordx4 v[8:11], v5, s[24:27], s34 offen
    s_add_u32 s34, s33, 5120
    buffer_store_dwordx4 v[8:11], v5, s[24:27], s34 offen
    s_add_u32 s34, s33, 6144
    buffer_store_dwordx4 v[8:11], v5, s[24:27], s34 offen
    s_add_u32 s34, s33, 7168
    buffer_store_dwordx4 v[8:11], v5, s[24:27], s34 offen
    s_add_u32 s34, s33, 8192
    buffer_store_dwordx4 v[8:11], v5, s[24:27], s34 offen
    s_add_u32 s34, s33, 9216
    buffer_store_dwordx4 v[8:11], v5, s[24:27], s34 offen
    s_add_u32 s34, s33, 10240
    buffer_store_dwordx4 v[8:11], v5, s[24:27], s34 offen
    s_add_u32 s34, s33, 11264
    buffer_store_dwordx4 v[8:11], v5, s[24:27], s34 offen
    s_add_u32 s34, s33, 12288
    buffer_store_dwordx4 v[8:11], v5, s[24:27], s34 offen
    s_add_u32 s34, s33, 13312
    buffer_store_dwordx4 v[8:11], v5, s[24:27], s34 offen
    s_add_u32 s34, s33, 14336
    buffer_store_dwordx4 v[8:11], v5, s[24:27], s34 offen
    s_add_u32 s34, s33, 15360
    buffer_store_dwordx4 v[8:11], v5, s[24:27], s34 offen
    s_nop 1
.End_prep_kernel_9:
    s_endpgm
.globl k1l0_kernel
.p2align 8
.type k1l0_kernel,@function
k1l0_kernel:
    s_cmp_ge_u32 s2, 256
    s_cbranch_scc1 .End_k1l0_kernel_1
    s_load_dwordx2 s[4:5], s[0:1], 88
    v_and_b32 v1, 63, v0
    v_lshrrev_b32 v2, 6, v0
    s_nop 0
    v_readfirstlane_b32 s3, v2
    v_and_b32 v3, 15, v1
    v_lshrrev_b32 v4, 4, v1
    v_lshlrev_b32 v5, 4, v1
    s_lshr_b32 s34, s2, 3
    s_and_b32 s32, s2, 1
    s_lshl_b32 s32, s32, 2
    s_and_b32 s35, s34, 3
    s_add_u32 s32, s32, s35
    s_bfe_u32 s33, s2, 0x20001
    s_lshl_b32 s33, s33, 3
    s_lshr_b32 s34, s34, 2
    s_add_u32 s33, s33, s34
    s_and_b32 s51, s3, 3
    s_lshl_b32 s34, s33, 2
    s_add_u32 s34, s34, s51
    s_waitcnt lgkmcnt(0)
    s_mov_b32 s8, s4
    s_mov_b32 s9, s5
    s_and_b32 s9, s9, 0xffff
    s_mov_b32 s10, 0x1f8000
    s_mov_b32 s11, 0x20000
    s_add_u32 s12, s4, 0x1800000
    s_addc_u32 s13, s5, 0
    s_and_b32 s13, s13, 0xffff
    s_mov_b32 s14, 0x240000
    s_mov_b32 s15, 0x20000
    s_add_u32 s16, s4, 0x2200000
    s_addc_u32 s17, s5, 0
    s_and_b32 s17, s17, 0xffff
    s_mov_b32 s18, 0x40000
    s_mov_b32 s19, 0x20000
    s_add_u32 s20, s4, 0x200000
    s_addc_u32 s21, s5, 0
    s_and_b32 s21, s21, 0xffff
    s_mov_b32 s22, 0x1f800
    s_mov_b32 s23, 0x20000
    s_add_u32 s24, s4, 0x2400000
    s_addc_u32 s25, s5, 0
    s_and_b32 s25, s25, 0xffff
    s_mov_b32 s26, 0x480000
    s_mov_b32 s27, 0x20000
    s_add_u32 s28, s4, 0x2300000
    s_addc_u32 s29, s5, 0
    s_and_b32 s29, s29, 0xffff
    s_mov_b32 s30, 0x28000
    s_mov_b32 s31, 0x20000
    v_add_u32 v2, 0x10000, v5
    v_add_u32 v15, 0x20000, v5
    s_mul_i32 s37, s34, 18432
    s_lshl_b32 s39, s3, 10
    s_mul_i32 s40, s32, 258048
    s_add_u32 s41, s40, s39
    s_min_u32 s42, s39, 3072
    v_lshlrev_b32 v6, 2, v0
    s_mul_i32 s35, s32, 896
    v_lshlrev_b32 v7, 3, v3
    s_lshl_b32 s36, s34, 11
    s_cmp_ge_u32 s3, 4
    s_cbranch_scc1 .kv_k1l0_kernel_2
    s_add_u32 s38, s37, 0
    buffer_load_dwordx4 v[16:19], v5, s[12:15], s38 offen
    s_add_u32 s38, s37, 1024
    buffer_load_dwordx4 v[20:23], v5, s[12:15], s38 offen
    s_add_u32 m0, s39, 0
    s_add_u32 s43, s41, 0
    buffer_load_dwordx4 v5, s[8:11], s43 offen lds
    s_add_u32 m0, s39, 8192
    s_add_u32 s43, s41, 8192
    buffer_load_dwordx4 v5, s[8:11], s43 offen lds
    s_add_u32 m0, s39, 16384
    s_add_u32 s43, s41, 16384
    buffer_load_dwordx4 v5, s[8:11], s43 offen lds
    s_add_u32 m0, s42, 24576
    s_add_u32 s43, s40, s42
    s_add_u32 s43, s43, 24576
    buffer_load_dwordx4 v5, s[8:11], s43 offen lds
    s_add_u32 s38, s37, 2048
    buffer_load_dwordx4 v[24:27], v5, s[12:15], s38 offen
    s_add_u32 s38, s37, 3072
    buffer_load_dwordx4 v[28:31], v5, s[12:15], s38 offen
    s_add_u32 m0, s39, 28672
    s_add_u32 s43, s41, 28672
    buffer_load_dwordx4 v5, s[8:11], s43 offen lds
    s_add_u32 m0, s39, 36864
    s_add_u32 s43, s41, 36864
    buffer_load_dwordx4 v5, s[8:11], s43 offen lds
    s_add_u32 m0, s39, 45056
    s_add_u32 s43, s41, 45056
    buffer_load_dwordx4 v5, s[8:11], s43 offen lds
    s_add_u32 m0, s42, 53248
    s_add_u32 s43, s40, s42
    s_add_u32 s43, s43, 53248
    buffer_load_dwordx4 v5, s[8:11], s43 offen lds
    s_waitcnt vmcnt(6)
    s_barrier
    s_add_u32 m0, s39, 57344
    s_add_u32 s43, s41, 57344
    buffer_load_dwordx4 v5, s[8:11], s43 offen lds
    s_add_u32 m0, s39, 65536
    s_add_u32 s43, s41, 65536
    buffer_load_dwordx4 v5, s[8:11], s43 offen lds
    s_add_u32 m0, s39, 73728
    s_add_u32 s43, s41, 73728
    buffer_load_dwordx4 v5, s[8:11], s43 offen lds
    s_add_u32 m0, s42, 81920
    s_add_u32 s43, s40, s42
    s_add_u32 s43, s43, 81920
    buffer_load_dwordx4 v5, s[8:11], s43 offen lds
    ds_read_b128 v[124:127], v5 offset:0
    ds_read_b128 v[128:131], v5 offset:1024
    ds_read_b128 v[132:135], v5 offset:2048
    ds_read_b128 v[136:139], v5 offset:3072
    ds_read_b128 v[140:143], v5 offset:4096
    ds_read_b128 v[160:163], v5 offset:14336
    ds_read_b128 v[164:167], v5 offset:15360
    ds_read_b128 v[168:171], v5 offset:16384
    ds_read_b128 v[172:175], v5 offset:17408
    ds_read_b128 v[176:179], v5 offset:18432
    s_waitcnt lgkmcnt(9)
    v_mfma_f32_16x16x32_bf16 v[88:91], v[124:127], v[16:19], 0
    s_waitcnt lgkmcnt(8)
    v_mfma_f32_16x16x32_bf16 v[92:95], v[128:131], v[16:19], 0
    s_waitcnt lgkmcnt(7)
    v_mfma_f32_16x16x32_bf16 v[96:99], v[132:135], v[16:19], 0
    s_waitcnt lgkmcnt(6)
    v_mfma_f32_16x16x32_bf16 v[100:103], v[136:139], v[16:19], 0
    s_waitcnt lgkmcnt(5)
    v_mfma_f32_16x16x32_bf16 v[104:107], v[140:143], v[16:19], 0
    s_add_u32 s38, s37, 4096
    buffer_load_dwordx4 v[32:35], v5, s[12:15], s38 offen
    s_waitcnt lgkmcnt(4)
    v_mfma_f32_16x16x32_bf16 v[88:91], v[160:163], v[20:23], v[88:91]
    s_waitcnt lgkmcnt(3)
    v_mfma_f32_16x16x32_bf16 v[92:95], v[164:167], v[20:23], v[92:95]
    s_waitcnt lgkmcnt(2)
    v_mfma_f32_16x16x32_bf16 v[96:99], v[168:171], v[20:23], v[96:99]
    s_waitcnt lgkmcnt(1)
    v_mfma_f32_16x16x32_bf16 v[100:103], v[172:175], v[20:23], v[100:103]
    s_waitcnt lgkmcnt(0)
    v_mfma_f32_16x16x32_bf16 v[104:107], v[176:179], v[20:23], v[104:107]
    s_add_u32 s38, s37, 5120
    buffer_load_dwordx4 v[36:39], v5, s[12:15], s38 offen
    s_waitcnt vmcnt(6)
    s_barrier
    s_add_u32 m0, s39, 86016
    s_add_u32 s43, s41, 86016
    buffer_load_dwordx4 v5, s[8:11], s43 offen lds
    s_add_u32 m0, s39, 94208
    s_add_u32 s43, s41, 94208
    buffer_load_dwordx4 v5, s[8:11], s43 offen lds
    s_add_u32 m0, s39, 102400
    s_add_u32 s43, s41, 102400
    buffer_load_dwordx4 v5, s[8:11], s43 offen lds
    s_add_u32 m0, s42, 110592
    s_add_u32 s43, s40, s42
    s_add_u32 s43, s43, 110592
    buffer_load_dwordx4 v5, s[8:11], s43 offen lds
    ds_read_b128 v[124:127], v5 offset:28672
    ds_read_b128 v[128:131], v5 offset:29696
    ds_read_b128 v[132:135], v5 offset:30720
    ds_read_b128 v[136:139], v5 offset:31744
    ds_read_b128 v[140:143], v5 offset:32768
    ds_read_b128 v[160:163], v5 offset:43008
    ds_read_b128 v[164:167], v5 offset:44032
    ds_read_b128 v[168:171], v5 offset:45056
    ds_read_b128 v[172:175], v5 offset:46080
    ds_read_b128 v[176:179], v5 offset:47104
    s_waitcnt lgkmcnt(9)
    v_mfma_f32_16x16x32_bf16 v[88:91], v[124:127], v[24:27], v[88:91]
    s_waitcnt lgkmcnt(8)
    v_mfma_f32_16x16x32_bf16 v[92:95], v[128:131], v[24:27], v[92:95]
    s_waitcnt lgkmcnt(7)
    v_mfma_f32_16x16x32_bf16 v[96:99], v[132:135], v[24:27], v[96:99]
    s_waitcnt lgkmcnt(6)
    v_mfma_f32_16x16x32_bf16 v[100:103], v[136:139], v[24:27], v[100:103]
    s_waitcnt lgkmcnt(5)
    v_mfma_f32_16x16x32_bf16 v[104:107], v[140:143], v[24:27], v[104:107]
    s_add_u32 s38, s37, 6144
    buffer_load_dwordx4 v[40:43], v5, s[12:15], s38 offen
    s_waitcnt lgkmcnt(4)
    v_mfma_f32_16x16x32_bf16 v[88:91], v[160:163], v[28:31], v[88:91]
    s_waitcnt lgkmcnt(3)
    v_mfma_f32_16x16x32_bf16 v[92:95], v[164:167], v[28:31], v[92:95]
    s_waitcnt lgkmcnt(2)
    v_mfma_f32_16x16x32_bf16 v[96:99], v[168:171], v[28:31], v[96:99]
    s_waitcnt lgkmcnt(1)
    v_mfma_f32_16x16x32_bf16 v[100:103], v[172:175], v[28:31], v[100:103]
    s_waitcnt lgkmcnt(0)
    v_mfma_f32_16x16x32_bf16 v[104:107], v[176:179], v[28:31], v[104:107]
    s_add_u32 s38, s37, 7168
    buffer_load_dwordx4 v[44:47], v5, s[12:15], s38 offen
    s_waitcnt vmcnt(8)
    s_barrier
    s_add_u32 m0, s39, 0
    s_add_u32 s43, s41, 114688
    buffer_load_dwordx4 v5, s[8:11], s43 offen lds
    s_add_u32 m0, s39, 8192
    s_add_u32 s43, s41, 122880
    buffer_load_dwordx4 v5, s[8:11], s43 offen lds
    s_add_u32 m0, s39, 16384
    s_add_u32 s43, s41, 131072
    buffer_load_dwordx4 v5, s[8:11], s43 offen lds
    s_add_u32 m0, s42, 24576
    s_add_u32 s43, s40, s42
    s_add_u32 s43, s43, 139264
    buffer_load_dwordx4 v5, s[8:11], s43 offen lds
    ds_read_b128 v[124:127], v5 offset:57344
    ds_read_b128 v[128:131], v5 offset:58368
    ds_read_b128 v[132:135], v5 offset:59392
    ds_read_b128 v[136:139], v5 offset:60416
    ds_read_b128 v[140:143], v5 offset:61440
    s_waitcnt vmcnt(11)
    ds_read_b128 v[160:163], v2 offset:6144
    ds_read_b128 v[164:167], v2 offset:7168
    ds_read_b128 v[168:171], v2 offset:8192
    ds_read_b128 v[172:175], v2 offset:9216
    ds_read_b128 v[176:179], v2 offset:10240
    s_waitcnt lgkmcnt(9)
    v_mfma_f32_16x16x32_bf16 v[88:91], v[124:127], v[32:35], v[88:91]
    s_waitcnt lgkmcnt(8)
    v_mfma_f32_16x16x32_bf16 v[92:95], v[128:131], v[32:35], v[92:95]
    s_waitcnt lgkmcnt(7)
    v_mfma_f32_16x16x32_bf16 v[96:99], v[132:135], v[32:35], v[96:99]
    s_waitcnt lgkmcnt(6)
    v_mfma_f32_16x16x32_bf16 v[100:103], v[136:139], v[32:35], v[100:103]
    s_waitcnt lgkmcnt(5)
    v_mfma_f32_16x16x32_bf16 v[104:107], v[140:143], v[32:35], v[104:107]
    s_add_u32 s38, s37, 8192
    buffer_load_dwordx4 v[48:51], v5, s[12:15], s38 offen
    s_waitcnt vmcnt(11)
    s_waitcnt lgkmcnt(4)
    v_mfma_f32_16x16x32_bf16 v[88:91], v[160:163], v[36:39], v[88:91]
    s_waitcnt lgkmcnt(3)
    v_mfma_f32_16x16x32_bf16 v[92:95], v[164:167], v[36:39], v[92:95]
    s_waitcnt lgkmcnt(2)
    v_mfma_f32_16x16x32_bf16 v[96:99], v[168:171], v[36:39], v[96:99]
    s_waitcnt lgkmcnt(1)
    v_mfma_f32_16x16x32_bf16 v[100:103], v[172:175], v[36:39], v[100:103]
    s_waitcnt lgkmcnt(0)
    v_mfma_f32_16x16x32_bf16 v[104:107], v[176:179], v[36:39], v[104:107]
    s_add_u32 s38, s37, 9216
    buffer_load_dwordx4 v[52:55], v5, s[12:15], s38 offen
    s_waitcnt vmcnt(8)
    s_barrier
    s_add_u32 m0, s39, 28672
    s_add_u32 s43, s41, 143360
    buffer_load_dwordx4 v5, s[8:11], s43 offen lds
    s_add_u32 m0, s39, 36864
    s_add_u32 s43, s41, 151552
    buffer_load_dwordx4 v5, s[8:11], s43 offen lds
    s_add_u32 m0, s39, 45056
    s_add_u32 s43, s41, 159744
    buffer_load_dwordx4 v5, s[8:11], s43 offen lds
    s_add_u32 m0, s42, 53248
    s_add_u32 s43, s40, s42
    s_add_u32 s43, s43, 167936
    buffer_load_dwordx4 v5, s[8:11], s43 offen lds
    ds_read_b128 v[124:127], v2 offset:20480
    ds_read_b128 v[128:131], v2 offset:21504
    ds_read_b128 v[132:135], v2 offset:22528
    ds_read_b128 v[136:139], v2 offset:23552
    ds_read_b128 v[140:143], v2 offset:24576
    s_waitcnt vmcnt(11)
    ds_read_b128 v[160:163], v2 offset:34816
    ds_read_b128 v[164:167], v2 offset:35840
    ds_read_b128 v[168:171], v2 offset:36864
    ds_read_b128 v[172:175], v2 offset:37888
    ds_read_b128 v[176:179], v2 offset:38912
    s_waitcnt lgkmcnt(9)
    v_mfma_f32_16x16x32_bf16 v[88:91], v[124:127], v[40:43], v[88:91]
    s_waitcnt lgkmcnt(8)
    v_mfma_f32_16x16x32_bf16 v[92:95], v[128:131], v[40:43], v[92:95]
    s_waitcnt lgkmcnt(7)
    v_mfma_f32_16x16x32_bf16 v[96:99], v[132:135], v[40:43], v[96:99]
    s_waitcnt lgkmcnt(6)
    v_mfma_f32_16x16x32_bf16 v[100:103], v[136:139], v[40:43], v[100:103]
    s_waitcnt lgkmcnt(5)
    v_mfma_f32_16x16x32_bf16 v[104:107], v[140:143], v[40:43], v[104:107]
    s_add_u32 s38, s37, 10240
    buffer_load_dwordx4 v[56:59], v5, s[12:15], s38 offen
    s_waitcnt vmcnt(11)
    s_waitcnt lgkmcnt(4)
    v_mfma_f32_16x16x32_bf16 v[88:91], v[160:163], v[44:47], v[88:91]
    s_waitcnt lgkmcnt(3)
    v_mfma_f32_16x16x32_bf16 v[92:95], v[164:167], v[44:47], v[92:95]
    s_waitcnt lgkmcnt(2)
    v_mfma_f32_16x16x32_bf16 v[96:99], v[168:171], v[44:47], v[96:99]
    s_waitcnt lgkmcnt(1)
    v_mfma_f32_16x16x32_bf16 v[100:103], v[172:175], v[44:47], v[100:103]
    s_waitcnt lgkmcnt(0)
    v_mfma_f32_16x16x32_bf16 v[104:107], v[176:179], v[44:47], v[104:107]
    s_add_u32 s38, s37, 11264
    buffer_load_dwordx4 v[60:63], v5, s[12:15], s38 offen
    s_waitcnt vmcnt(8)
    s_barrier
    s_add_u32 m0, s39, 57344
    s_add_u32 s43, s41, 172032
    buffer_load_dwordx4 v5, s[8:11], s43 offen lds
    s_add_u32 m0, s39, 65536
    s_add_u32 s43, s41, 180224
    buffer_load_dwordx4 v5, s[8:11], s43 offen lds
    s_add_u32 m0, s39, 73728
    s_add_u32 s43, s41, 188416
    buffer_load_dwordx4 v5, s[8:11], s43 offen lds
    s_add_u32 m0, s42, 81920
    s_add_u32 s43, s40, s42
    s_add_u32 s43, s43, 196608
    buffer_load_dwordx4 v5, s[8:11], s43 offen lds
    ds_read_b128 v[124:127], v5 offset:0
    ds_read_b128 v[128:131], v5 offset:1024
    ds_read_b128 v[132:135], v5 offset:2048
    ds_read_b128 v[136:139], v5 offset:3072
    ds_read_b128 v[140:143], v5 offset:4096
    s_waitcnt vmcnt(11)
    ds_read_b128 v[160:163], v5 offset:14336
    ds_read_b128 v[164:167], v5 offset:15360
    ds_read_b128 v[168:171], v5 offset:16384
    ds_read_b128 v[172:175], v5 offset:17408
    ds_read_b128 v[176:179], v5 offset:18432
    s_waitcnt lgkmcnt(9)
    v_mfma_f32_16x16x32_bf16 v[88:91], v[124:127], v[48:51], v[88:91]
    s_waitcnt lgkmcnt(8)
    v_mfma_f32_16x16x32_bf16 v[92:95], v[128:131], v[48:51], v[92:95]
    s_waitcnt lgkmcnt(7)
    v_mfma_f32_16x16x32_bf16 v[96:99], v[132:135], v[48:51], v[96:99]
    s_waitcnt lgkmcnt(6)
    v_mfma_f32_16x16x32_bf16 v[100:103], v[136:139], v[48:51], v[100:103]
    s_waitcnt lgkmcnt(5)
    v_mfma_f32_16x16x32_bf16 v[104:107], v[140:143], v[48:51], v[104:107]
    s_add_u32 s38, s37, 12288
    buffer_load_dwordx4 v[64:67], v5, s[12:15], s38 offen
    s_waitcnt vmcnt(11)
    s_waitcnt lgkmcnt(4)
    v_mfma_f32_16x16x32_bf16 v[88:91], v[160:163], v[52:55], v[88:91]
    s_waitcnt lgkmcnt(3)
    v_mfma_f32_16x16x32_bf16 v[92:95], v[164:167], v[52:55], v[92:95]
    s_waitcnt lgkmcnt(2)
    v_mfma_f32_16x16x32_bf16 v[96:99], v[168:171], v[52:55], v[96:99]
    s_waitcnt lgkmcnt(1)
    v_mfma_f32_16x16x32_bf16 v[100:103], v[172:175], v[52:55], v[100:103]
    s_waitcnt lgkmcnt(0)
    v_mfma_f32_16x16x32_bf16 v[104:107], v[176:179], v[52:55], v[104:107]
    s_add_u32 s38, s37, 13312
    buffer_load_dwordx4 v[68:71], v5, s[12:15], s38 offen
    s_waitcnt vmcnt(8)
    s_barrier
    s_add_u32 m0, s39, 86016
    s_add_u32 s43, s41, 200704
    buffer_load_dwordx4 v5, s[8:11], s43 offen lds
    s_add_u32 m0, s39, 94208
    s_add_u32 s43, s41, 208896
    buffer_load_dwordx4 v5, s[8:11], s43 offen lds
    s_add_u32 m0, s39, 102400
    s_add_u32 s43, s41, 217088
    buffer_load_dwordx4 v5, s[8:11], s43 offen lds
    s_add_u32 m0, s42, 110592
    s_add_u32 s43, s40, s42
    s_add_u32 s43, s43, 225280
    buffer_load_dwordx4 v5, s[8:11], s43 offen lds
    ds_read_b128 v[124:127], v5 offset:28672
    ds_read_b128 v[128:131], v5 offset:29696
    ds_read_b128 v[132:135], v5 offset:30720
    ds_read_b128 v[136:139], v5 offset:31744
    ds_read_b128 v[140:143], v5 offset:32768
    s_waitcnt vmcnt(11)
    ds_read_b128 v[160:163], v5 offset:43008
    ds_read_b128 v[164:167], v5 offset:44032
    ds_read_b128 v[168:171], v5 offset:45056
    ds_read_b128 v[172:175], v5 offset:46080
    ds_read_b128 v[176:179], v5 offset:47104
    s_waitcnt lgkmcnt(9)
    v_mfma_f32_16x16x32_bf16 v[88:91], v[124:127], v[56:59], v[88:91]
    s_waitcnt lgkmcnt(8)
    v_mfma_f32_16x16x32_bf16 v[92:95], v[128:131], v[56:59], v[92:95]
    s_waitcnt lgkmcnt(7)
    v_mfma_f32_16x16x32_bf16 v[96:99], v[132:135], v[56:59], v[96:99]
    s_waitcnt lgkmcnt(6)
    v_mfma_f32_16x16x32_bf16 v[100:103], v[136:139], v[56:59], v[100:103]
    s_waitcnt lgkmcnt(5)
    v_mfma_f32_16x16x32_bf16 v[104:107], v[140:143], v[56:59], v[104:107]
    s_add_u32 s38, s37, 14336
    buffer_load_dwordx4 v[72:75], v5, s[12:15], s38 offen
    s_waitcnt vmcnt(11)
    s_waitcnt lgkmcnt(4)
    v_mfma_f32_16x16x32_bf16 v[88:91], v[160:163], v[60:63], v[88:91]
    s_waitcnt lgkmcnt(3)
    v_mfma_f32_16x16x32_bf16 v[92:95], v[164:167], v[60:63], v[92:95]
    s_waitcnt lgkmcnt(2)
    v_mfma_f32_16x16x32_bf16 v[96:99], v[168:171], v[60:63], v[96:99]
    s_waitcnt lgkmcnt(1)
    v_mfma_f32_16x16x32_bf16 v[100:103], v[172:175], v[60:63], v[100:103]
    s_waitcnt lgkmcnt(0)
    v_mfma_f32_16x16x32_bf16 v[104:107], v[176:179], v[60:63], v[104:107]
    s_add_u32 s38, s37, 15360
    buffer_load_dwordx4 v[76:79], v5, s[12:15], s38 offen
    s_waitcnt vmcnt(8)
    s_barrier
    s_add_u32 m0, s39, 0
    s_add_u32 s43, s41, 229376
    buffer_load_dwordx4 v5, s[8:11], s43 offen lds
    s_add_u32 m0, s39, 8192
    s_add_u32 s43, s41, 237568
    buffer_load_dwordx4 v5, s[8:11], s43 offen lds
    s_add_u32 m0, s39, 16384
    s_add_u32 s43, s41, 245760
    buffer_load_dwordx4 v5, s[8:11], s43 offen lds
    s_add_u32 m0, s42, 24576
    s_add_u32 s43, s40, s42
    s_add_u32 s43, s43, 253952
    buffer_load_dwordx4 v5, s[8:11], s43 offen lds
    ds_read_b128 v[124:127], v5 offset:57344
    ds_read_b128 v[128:131], v5 offset:58368
    ds_read_b128 v[132:135], v5 offset:59392
    ds_read_b128 v[136:139], v5 offset:60416
    ds_read_b128 v[140:143], v5 offset:61440
    s_waitcnt vmcnt(11)
    ds_read_b128 v[160:163], v2 offset:6144
    ds_read_b128 v[164:167], v2 offset:7168
    ds_read_b128 v[168:171], v2 offset:8192
    ds_read_b128 v[172:175], v2 offset:9216
    ds_read_b128 v[176:179], v2 offset:10240
    s_waitcnt lgkmcnt(9)
    v_mfma_f32_16x16x32_bf16 v[88:91], v[124:127], v[64:67], v[88:91]
    s_waitcnt lgkmcnt(8)
    v_mfma_f32_16x16x32_bf16 v[92:95], v[128:131], v[64:67], v[92:95]
    s_waitcnt lgkmcnt(7)
    v_mfma_f32_16x16x32_bf16 v[96:99], v[132:135], v[64:67], v[96:99]
    s_waitcnt lgkmcnt(6)
    v_mfma_f32_16x16x32_bf16 v[100:103], v[136:139], v[64:67], v[100:103]
    s_waitcnt lgkmcnt(5)
    v_mfma_f32_16x16x32_bf16 v[104:107], v[140:143], v[64:67], v[104:107]
    s_add_u32 s38, s37, 16384
    buffer_load_dwordx4 v[80:83], v5, s[12:15], s38 offen
    s_waitcnt vmcnt(11)
    s_waitcnt lgkmcnt(4)
    v_mfma_f32_16x16x32_bf16 v[88:91], v[160:163], v[68:71], v[88:91]
    s_waitcnt lgkmcnt(3)
    v_mfma_f32_16x16x32_bf16 v[92:95], v[164:167], v[68:71], v[92:95]
    s_waitcnt lgkmcnt(2)
    v_mfma_f32_16x16x32_bf16 v[96:99], v[168:171], v[68:71], v[96:99]
    s_waitcnt lgkmcnt(1)
    v_mfma_f32_16x16x32_bf16 v[100:103], v[172:175], v[68:71], v[100:103]
    s_waitcnt lgkmcnt(0)
    v_mfma_f32_16x16x32_bf16 v[104:107], v[176:179], v[68:71], v[104:107]
    s_add_u32 s38, s37, 17408
    buffer_load_dwordx4 v[84:87], v5, s[12:15], s38 offen
    s_waitcnt vmcnt(8)
    s_barrier
    ds_read_b128 v[124:127], v2 offset:20480
    ds_read_b128 v[128:131], v2 offset:21504
    ds_read_b128 v[132:135], v2 offset:22528
    ds_read_b128 v[136:139], v2 offset:23552
    ds_read_b128 v[140:143], v2 offset:24576
    s_waitcnt vmcnt(7)
    ds_read_b128 v[160:163], v2 offset:34816
    ds_read_b128 v[164:167], v2 offset:35840
    ds_read_b128 v[168:171], v2 offset:36864
    ds_read_b128 v[172:175], v2 offset:37888
    ds_read_b128 v[176:179], v2 offset:38912
    s_waitcnt lgkmcnt(9)
    v_mfma_f32_16x16x32_bf16 v[88:91], v[124:127], v[72:75], v[88:91]
    s_waitcnt lgkmcnt(8)
    v_mfma_f32_16x16x32_bf16 v[92:95], v[128:131], v[72:75], v[92:95]
    s_waitcnt lgkmcnt(7)
    v_mfma_f32_16x16x32_bf16 v[96:99], v[132:135], v[72:75], v[96:99]
    s_waitcnt lgkmcnt(6)
    v_mfma_f32_16x16x32_bf16 v[100:103], v[136:139], v[72:75], v[100:103]
    s_waitcnt lgkmcnt(5)
    v_mfma_f32_16x16x32_bf16 v[104:107], v[140:143], v[72:75], v[104:107]
    s_add_u32 s44, s35, 0
    buffer_load_dword v204, v6, s[20:23], s44 offen
    s_add_u32 s44, s35, 7168
    buffer_load_dword v205, v6, s[20:23], s44 offen
    s_add_u32 s44, s35, 14336
    buffer_load_dword v206, v6, s[20:23], s44 offen
    s_add_u32 s44, s35, 21504
    buffer_load_dword v207, v6, s[20:23], s44 offen
    s_add_u32 s44, s35, 28672
    buffer_load_dword v208, v6, s[20:23], s44 offen
    s_add_u32 s44, s35, 35840
    buffer_load_dword v209, v6, s[20:23], s44 offen
    s_add_u32 s44, s35, 43008
    buffer_load_dword v210, v6, s[20:23], s44 offen
    s_add_u32 s44, s35, 50176
    buffer_load_dword v211, v6, s[20:23], s44 offen
    s_add_u32 s44, s35, 57344
    buffer_load_dword v212, v6, s[20:23], s44 offen
    s_add_u32 s44, s35, 64512
    buffer_load_dword v213, v6, s[20:23], s44 offen
    s_add_u32 s44, s35, 71680
    buffer_load_dword v214, v6, s[20:23], s44 offen
    s_add_u32 s44, s35, 78848
    buffer_load_dword v215, v6, s[20:23], s44 offen
    s_add_u32 s44, s35, 86016
    buffer_load_dword v216, v6, s[20:23], s44 offen
    s_add_u32 s44, s35, 93184
    buffer_load_dword v217, v6, s[20:23], s44 offen
    s_add_u32 s44, s35, 100352
    buffer_load_dword v218, v6, s[20:23], s44 offen
    s_add_u32 s44, s35, 107520
    buffer_load_dword v219, v6, s[20:23], s44 offen
    s_add_u32 s44, s35, 114688
    buffer_load_dword v220, v6, s[20:23], s44 offen
    s_add_u32 s44, s35, 121856
    buffer_load_dword v221, v6, s[20:23], s44 offen
    buffer_load_dwordx2 v[196:197], v7, s[16:19], s36 offen
    s_waitcnt vmcnt(25)
    s_waitcnt lgkmcnt(4)
    v_mfma_f32_16x16x32_bf16 v[88:91], v[160:163], v[76:79], v[88:91]
    s_waitcnt lgkmcnt(3)
    v_mfma_f32_16x16x32_bf16 v[92:95], v[164:167], v[76:79], v[92:95]
    s_waitcnt lgkmcnt(2)
    v_mfma_f32_16x16x32_bf16 v[96:99], v[168:171], v[76:79], v[96:99]
    s_waitcnt lgkmcnt(1)
    v_mfma_f32_16x16x32_bf16 v[100:103], v[172:175], v[76:79], v[100:103]
    s_waitcnt lgkmcnt(0)
    v_mfma_f32_16x16x32_bf16 v[104:107], v[176:179], v[76:79], v[104:107]
    s_waitcnt vmcnt(21)
    s_barrier
    ds_read_b128 v[124:127], v5 offset:0
    ds_read_b128 v[128:131], v5 offset:1024
    ds_read_b128 v[132:135], v5 offset:2048
    ds_read_b128 v[136:139], v5 offset:3072
    ds_read_b128 v[140:143], v5 offset:4096
    s_waitcnt vmcnt(20)
    ds_read_b128 v[160:163], v5 offset:14336
    ds_read_b128 v[164:167], v5 offset:15360
    ds_read_b128 v[168:171], v5 offset:16384
    ds_read_b128 v[172:175], v5 offset:17408
    ds_read_b128 v[176:179], v5 offset:18432
    s_waitcnt lgkmcnt(9)
    v_mfma_f32_16x16x32_bf16 v[88:91], v[124:127], v[80:83], v[88:91]
    s_waitcnt lgkmcnt(8)
    v_mfma_f32_16x16x32_bf16 v[92:95], v[128:131], v[80:83], v[92:95]
    s_waitcnt lgkmcnt(7)
    v_mfma_f32_16x16x32_bf16 v[96:99], v[132:135], v[80:83], v[96:99]
    s_waitcnt lgkmcnt(6)
    v_mfma_f32_16x16x32_bf16 v[100:103], v[136:139], v[80:83], v[100:103]
    s_waitcnt lgkmcnt(5)
    v_mfma_f32_16x16x32_bf16 v[104:107], v[140:143], v[80:83], v[104:107]
    s_waitcnt vmcnt(19)
    s_waitcnt lgkmcnt(4)
    v_mfma_f32_16x16x32_bf16 v[88:91], v[160:163], v[84:87], v[88:91]
    s_waitcnt lgkmcnt(3)
    v_mfma_f32_16x16x32_bf16 v[92:95], v[164:167], v[84:87], v[92:95]
    s_waitcnt lgkmcnt(2)
    v_mfma_f32_16x16x32_bf16 v[96:99], v[168:171], v[84:87], v[96:99]
    s_waitcnt lgkmcnt(1)
    v_mfma_f32_16x16x32_bf16 v[100:103], v[172:175], v[84:87], v[100:103]
    s_waitcnt lgkmcnt(0)
    v_mfma_f32_16x16x32_bf16 v[104:107], v[176:179], v[84:87], v[104:107]
    s_waitcnt vmcnt(0)
    v_add_f32 v204, v204, v205
    v_add_f32 v204, v204, v206
    v_add_f32 v204, v204, v207
    v_add_f32 v204, v204, v208
    v_add_f32 v204, v204, v209
    v_add_f32 v204, v204, v210
    v_add_f32 v204, v204, v211
    v_add_f32 v204, v204, v212
    v_add_f32 v204, v204, v213
    v_add_f32 v204, v204, v214
    v_add_f32 v204, v204, v215
    v_add_f32 v204, v204, v216
    v_add_f32 v204, v204, v217
    v_add_f32 v204, v204, v218
    v_add_f32 v204, v204, v219
    v_add_f32 v204, v204, v220
    v_add_f32 v204, v204, v221
    v_add_u32 v6, 114688, v6
    ds_write_b32 v6, v204
    v_and_b32 v12, 1, v4
    v_cmp_eq_u32 vcc, 1, v12
    v_mov_b32 v12, 0x42200000
    v_mov_b32 v13, 0x42000000
    v_cndmask_b32 v12, v12, v13, vcc
    v_mov_b32 v8, v196
    v_mov_b32 v11, v197
    v_mul_f32 v11, 0x3ae38e39, v11
    v_cvt_pk_bf16_f32 v10, v8, v11
    v_lshlrev_b32 v8, 16, v10
    v_and_b32 v11, 0xffff0000, v10
    v_add_f32 v11, 0x3727c5ac, v11
    v_cvt_pk_bf16_f32 v10, v11, v11
    v_lshlrev_b32 v11, 16, v10
    v_sqrt_f32 v11, v11
    s_nop 0
    v_cvt_pk_bf16_f32 v10, v11, v11
    v_lshlrev_b32 v11, 16, v10
    v_rcp_f32 v9, v11
    s_waitcnt lgkmcnt(0)
    s_barrier
    v_lshlrev_b32 v6, 4, v4
    v_add_u32 v6, 114688, v6
    ds_read_b128 v[124:127], v6 offset:0
    ds_read_b128 v[128:131], v6 offset:64
    ds_read_b128 v[132:135], v6 offset:128
    ds_read_b128 v[136:139], v6 offset:192
    ds_read_b128 v[140:143], v6 offset:256
    s_waitcnt lgkmcnt(4)
    v_fma_f32 v88, -v8, v124, v88
    v_mul_f32 v88, v88, v9
    v_fma_f32 v89, -v8, v125, v89
    v_mul_f32 v89, v89, v9
    v_fma_f32 v90, -v8, v126, v90
    v_mul_f32 v90, v90, v9
    v_fma_f32 v91, -v8, v127, v91
    v_mul_f32 v91, v91, v9
    s_waitcnt lgkmcnt(3)
    v_fma_f32 v92, -v8, v128, v92
    v_mul_f32 v92, v92, v9
    v_fma_f32 v93, -v8, v129, v93
    v_mul_f32 v93, v93, v9
    v_fma_f32 v94, -v8, v130, v94
    v_mul_f32 v94, v94, v9
    v_fma_f32 v95, -v8, v131, v95
    v_mul_f32 v95, v95, v9
    s_waitcnt lgkmcnt(2)
    v_fma_f32 v96, -v8, v132, v96
    v_mul_f32 v96, v96, v9
    v_fma_f32 v97, -v8, v133, v97
    v_mul_f32 v97, v97, v9
    v_fma_f32 v98, -v8, v134, v98
    v_mul_f32 v98, v98, v9
    v_fma_f32 v99, -v8, v135, v99
    v_mul_f32 v99, v99, v9
    s_waitcnt lgkmcnt(1)
    v_fma_f32 v100, -v8, v136, v100
    v_mul_f32 v100, v100, v9
    v_fma_f32 v101, -v8, v137, v101
    v_mul_f32 v101, v101, v9
    v_fma_f32 v102, -v8, v138, v102
    v_mul_f32 v102, v102, v9
    v_fma_f32 v103, -v8, v139, v103
    v_mul_f32 v103, v103, v9
    s_waitcnt lgkmcnt(0)
    v_fma_f32 v104, -v8, v140, v104
    v_mul_f32 v104, v104, v9
    v_fma_f32 v105, -v8, v141, v105
    v_mul_f32 v105, v105, v9
    v_cvt_pk_bf16_f32 v10, v88, v89
    v_lshlrev_b32 v88, 16, v10
    v_and_b32 v89, 0xffff0000, v10
    v_cvt_pk_bf16_f32 v10, v90, v91
    v_lshlrev_b32 v90, 16, v10
    v_and_b32 v91, 0xffff0000, v10
    v_cvt_pk_bf16_f32 v10, v92, v93
    v_lshlrev_b32 v92, 16, v10
    v_and_b32 v93, 0xffff0000, v10
    v_cvt_pk_bf16_f32 v10, v94, v95
    v_lshlrev_b32 v94, 16, v10
    v_and_b32 v95, 0xffff0000, v10
    v_cvt_pk_bf16_f32 v10, v96, v97
    v_lshlrev_b32 v96, 16, v10
    v_and_b32 v97, 0xffff0000, v10
    v_cvt_pk_bf16_f32 v10, v98, v99
    v_lshlrev_b32 v98, 16, v10
    v_and_b32 v99, 0xffff0000, v10
    v_cvt_pk_bf16_f32 v10, v100, v101
    v_lshlrev_b32 v100, 16, v10
    v_and_b32 v101, 0xffff0000, v10
    v_cvt_pk_bf16_f32 v10, v102, v103
    v_lshlrev_b32 v102, 16, v10
    v_and_b32 v103, 0xffff0000, v10
    v_cvt_pk_bf16_f32 v10, v104, v105
    v_lshlrev_b32 v104, 16, v10
    v_and_b32 v105, 0xffff0000, v10
    v_max3_f32 v58, v88, v89, v90
    v_min3_f32 v59, v88, v89, v90
    v_max3_f32 v58, v58, v91, v92
    v_min3_f32 v59, v59, v91, v92
    v_max3_f32 v58, v58, v93, v94
    v_min3_f32 v59, v59, v93, v94
    v_max3_f32 v58, v58, v95, v96
    v_min3_f32 v59, v59, v95, v96
    v_max3_f32 v58, v58, v97, v98
    v_min3_f32 v59, v59, v97, v98
    v_max3_f32 v58, v58, v99, v100
    v_min3_f32 v59, v59, v99, v100
    v_max3_f32 v58, v58, v101, v102
    v_min3_f32 v59, v59, v101, v102
    v_max3_f32 v58, v58, v103, v104
    v_min3_f32 v59, v59, v103, v104
    v_max_f32 v58, v58, v105
    v_min_f32 v59, v59, v105
    v_mov_b32 v62, 0x3fb8aa3b
    v_sub_f32 v40, v88, v58
    v_mul_f32 v40, v40, v62
    v_sub_f32 v41, v89, v58
    v_mul_f32 v41, v41, v62
    v_sub_f32 v42, v90, v58
    v_mul_f32 v42, v42, v62
    v_sub_f32 v43, v91, v58
    v_mul_f32 v43, v43, v62
    v_sub_f32 v44, v92, v58
    v_mul_f32 v44, v44, v62
    v_sub_f32 v45, v93, v58
    v_mul_f32 v45, v45, v62
    v_sub_f32 v46, v94, v58
    v_mul_f32 v46, v46, v62
    v_sub_f32 v47, v95, v58
    v_mul_f32 v47, v47, v62
    v_sub_f32 v48, v96, v58
    v_mul_f32 v48, v48, v62
    v_sub_f32 v49, v97, v58
    v_mul_f32 v49, v49, v62
    v_sub_f32 v50, v98, v58
    v_mul_f32 v50, v50, v62
    v_sub_f32 v51, v99, v58
    v_mul_f32 v51, v51, v62
    v_sub_f32 v52, v100, v58
    v_mul_f32 v52, v52, v62
    v_sub_f32 v53, v101, v58
    v_mul_f32 v53, v53, v62
    v_sub_f32 v54, v102, v58
    v_mul_f32 v54, v54, v62
    v_sub_f32 v55, v103, v58
    v_mul_f32 v55, v55, v62
    v_sub_f32 v56, v104, v58
    v_mul_f32 v56, v56, v62
    v_sub_f32 v57, v105, v58
    v_mul_f32 v57, v57, v62
    v_exp_f32 v40, v40
    v_exp_f32 v41, v41
    v_exp_f32 v42, v42
    v_exp_f32 v43, v43
    v_exp_f32 v44, v44
    v_exp_f32 v45, v45
    v_exp_f32 v46, v46
    v_exp_f32 v47, v47
    v_exp_f32 v48, v48
    v_exp_f32 v49, v49
    v_exp_f32 v50, v50
    v_exp_f32 v51, v51
    v_exp_f32 v52, v52
    v_exp_f32 v53, v53
    v_exp_f32 v54, v54
    v_exp_f32 v55, v55
    v_exp_f32 v56, v56
    v_exp_f32 v57, v57
    v_add_f32 v60, v40, v41
    v_add_f32 v60, v60, v42
    v_add_f32 v60, v60, v43
    v_add_f32 v60, v60, v44
    v_add_f32 v60, v60, v45
    v_add_f32 v60, v60, v46
    v_add_f32 v60, v60, v47
    v_add_f32 v60, v60, v48
    v_add_f32 v60, v60, v49
    v_add_f32 v60, v60, v50
    v_add_f32 v60, v60, v51
    v_add_f32 v60, v60, v52
    v_add_f32 v60, v60, v53
    v_add_f32 v60, v60, v54
    v_add_f32 v60, v60, v55
    v_add_f32 v60, v60, v56
    v_add_f32 v60, v60, v57
    v_rcp_f32 v61, v60
    s_nop 0
    v_mul_f32 v40, v40, v61
    v_mul_f32 v41, v41, v61
    v_mul_f32 v42, v42, v61
    v_mul_f32 v43, v43, v61
    v_mul_f32 v44, v44, v61
    v_mul_f32 v45, v45, v61
    v_mul_f32 v46, v46, v61
    v_mul_f32 v47, v47, v61
    v_mul_f32 v48, v48, v61
    v_mul_f32 v49, v49, v61
    v_mul_f32 v50, v50, v61
    v_mul_f32 v51, v51, v61
    v_mul_f32 v52, v52, v61
    v_mul_f32 v53, v53, v61
    v_mul_f32 v54, v54, v61
    v_mul_f32 v55, v55, v61
    v_mul_f32 v56, v56, v61
    v_mul_f32 v57, v57, v61
    v_cvt_pk_bf16_f32 v16, v40, v41
    v_cvt_pk_bf16_f32 v17, v42, v43
    v_cvt_pk_bf16_f32 v18, v44, v45
    v_cvt_pk_bf16_f32 v19, v46, v47
    v_cvt_pk_bf16_f32 v20, v48, v49
    v_cvt_pk_bf16_f32 v21, v50, v51
    v_cvt_pk_bf16_f32 v22, v52, v53
    v_cvt_pk_bf16_f32 v23, v54, v55
    v_cvt_pk_bf16_f32 v24, v56, v57
    v_sub_f32 v40, v59, v88
    v_mul_f32 v40, v40, v62
    v_sub_f32 v41, v59, v89
    v_mul_f32 v41, v41, v62
    v_sub_f32 v42, v59, v90
    v_mul_f32 v42, v42, v62
    v_sub_f32 v43, v59, v91
    v_mul_f32 v43, v43, v62
    v_sub_f32 v44, v59, v92
    v_mul_f32 v44, v44, v62
    v_sub_f32 v45, v59, v93
    v_mul_f32 v45, v45, v62
    v_sub_f32 v46, v59, v94
    v_mul_f32 v46, v46, v62
    v_sub_f32 v47, v59, v95
    v_mul_f32 v47, v47, v62
    v_sub_f32 v48, v59, v96
    v_mul_f32 v48, v48, v62
    v_sub_f32 v49, v59, v97
    v_mul_f32 v49, v49, v62
    v_sub_f32 v50, v59, v98
    v_mul_f32 v50, v50, v62
    v_sub_f32 v51, v59, v99
    v_mul_f32 v51, v51, v62
    v_sub_f32 v52, v59, v100
    v_mul_f32 v52, v52, v62
    v_sub_f32 v53, v59, v101
    v_mul_f32 v53, v53, v62
    v_sub_f32 v54, v59, v102
    v_mul_f32 v54, v54, v62
    v_sub_f32 v55, v59, v103
    v_mul_f32 v55, v55, v62
    v_sub_f32 v56, v59, v104
    v_mul_f32 v56, v56, v62
    v_sub_f32 v57, v59, v105
    v_mul_f32 v57, v57, v62
    v_exp_f32 v40, v40
    v_exp_f32 v41, v41
    v_exp_f32 v42, v42
    v_exp_f32 v43, v43
    v_exp_f32 v44, v44
    v_exp_f32 v45, v45
    v_exp_f32 v46, v46
    v_exp_f32 v47, v47
    v_exp_f32 v48, v48
    v_exp_f32 v49, v49
    v_exp_f32 v50, v50
    v_exp_f32 v51, v51
    v_exp_f32 v52, v52
    v_exp_f32 v53, v53
    v_exp_f32 v54, v54
    v_exp_f32 v55, v55
    v_exp_f32 v56, v56
    v_exp_f32 v57, v57
    v_add_f32 v60, v40, v41
    v_add_f32 v60, v60, v42
    v_add_f32 v60, v60, v43
    v_add_f32 v60, v60, v44
    v_add_f32 v60, v60, v45
    v_add_f32 v60, v60, v46
    v_add_f32 v60, v60, v47
    v_add_f32 v60, v60, v48
    v_add_f32 v60, v60, v49
    v_add_f32 v60, v60, v50
    v_add_f32 v60, v60, v51
    v_add_f32 v60, v60, v52
    v_add_f32 v60, v60, v53
    v_add_f32 v60, v60, v54
    v_add_f32 v60, v60, v55
    v_add_f32 v60, v60, v56
    v_add_f32 v60, v60, v57
    v_rcp_f32 v61, v60
    s_nop 0
    v_mul_f32 v40, v40, v61
    v_mul_f32 v41, v41, v61
    v_mul_f32 v42, v42, v61
    v_mul_f32 v43, v43, v61
    v_mul_f32 v44, v44, v61
    v_mul_f32 v45, v45, v61
    v_mul_f32 v46, v46, v61
    v_mul_f32 v47, v47, v61
    v_mul_f32 v48, v48, v61
    v_mul_f32 v49, v49, v61
    v_mul_f32 v50, v50, v61
    v_mul_f32 v51, v51, v61
    v_mul_f32 v52, v52, v61
    v_mul_f32 v53, v53, v61
    v_mul_f32 v54, v54, v61
    v_mul_f32 v55, v55, v61
    v_mul_f32 v56, v56, v61
    v_mul_f32 v57, v57, v61
    v_cvt_pk_bf16_f32 v25, v40, v41
    v_cvt_pk_bf16_f32 v26, v42, v43
    v_cvt_pk_bf16_f32 v27, v44, v45
    v_cvt_pk_bf16_f32 v28, v46, v47
    v_cvt_pk_bf16_f32 v29, v48, v49
    v_cvt_pk_bf16_f32 v30, v50, v51
    v_cvt_pk_bf16_f32 v31, v52, v53
    v_cvt_pk_bf16_f32 v32, v54, v55
    v_cvt_pk_bf16_f32 v33, v56, v57
    v_lshlrev_b32 v6, 10, v4
    v_lshl_add_u32 v6, v3, 4, v6
    v_lshlrev_b32 v7, 7, v4
    v_lshl_add_u32 v7, v3, 3, v7
    s_lshl_b32 s43, s34, 5
    s_lshl_b32 s44, s32, 2
    s_add_u32 s43, s43, s44
    s_lshl_b32 s44, s43, 7
    s_add_u32 s44, s44, 4194304
    s_lshl_b32 s43, s43, 10
    buffer_store_dwordx4 v[16:19], v6, s[24:27], s43 offen offset:0 sc1
    buffer_store_dwordx4 v[20:23], v6, s[24:27], s43 offen offset:256 sc1
    buffer_store_dwordx4 v[24:27], v6, s[24:27], s43 offen offset:512 sc1
    buffer_store_dwordx4 v[28:31], v6, s[24:27], s43 offen offset:768 sc1
    buffer_store_dwordx2 v[32:33], v7, s[24:27], s44 offen sc1
    s_barrier
    v_mul_u32_u24 v6, 144, v3
    v_lshl_add_u32 v6, v4, 4, v6
    s_mul_i32 s45, s3, 11520
    v_add_u32 v6, s45, v6
    ds_read_b128 v[64:67], v6 offset:6912
    ds_read_b128 v[68:71], v6 offset:6976
    ds_read_b128 v[72:75], v6 offset:9216
    ds_read_b128 v[76:79], v6 offset:9280
    ds_read_b128 v[80:83], v6 offset:0
    ds_read_b128 v[84:87], v6 offset:64
    ds_read_b128 v[88:91], v6 offset:2304
    ds_read_b128 v[92:95], v6 offset:2368
    ds_read_b128 v[96:99], v6 offset:4608
    ds_read_b128 v[100:103], v6 offset:4672
    v_mov_b32 v10, 0
    v_mov_b32 v11, 0x3f803f80
    v_cmp_eq_u32 vcc, 2, v3
    s_nop 1
    v_cndmask_b32 v10, v10, v11, vcc
    v_cmp_gt_u32 s[46:47], 2, v3
    v_cmp_gt_u32 s[48:49], 4, v3
    v_mov_b32 v11, 0
    s_waitcnt lgkmcnt(0)
    v_cndmask_b32 v72, v10, v72, s[46:47]
    v_cndmask_b32 v96, v11, v96, s[48:49]
    v_cndmask_b32 v73, v10, v73, s[46:47]
    v_cndmask_b32 v97, v11, v97, s[48:49]
    v_cndmask_b32 v74, v10, v74, s[46:47]
    v_cndmask_b32 v98, v11, v98, s[48:49]
    v_cndmask_b32 v75, v10, v75, s[46:47]
    v_cndmask_b32 v99, v11, v99, s[48:49]
    v_cndmask_b32 v76, v10, v76, s[46:47]
    v_cndmask_b32 v100, v11, v100, s[48:49]
    v_cndmask_b32 v77, v10, v77, s[46:47]
    v_cndmask_b32 v101, v11, v101, s[48:49]
    v_cndmask_b32 v78, v10, v78, s[46:47]
    v_cndmask_b32 v102, v11, v102, s[48:49]
    v_cndmask_b32 v79, v10, v79, s[46:47]
    v_cndmask_b32 v103, v11, v103, s[48:49]
    v_mfma_f32_16x16x32_bf16 v[104:107], v[64:67], v[80:83], 0
    v_mfma_f32_16x16x32_bf16 v[108:111], v[64:67], v[88:91], 0
    v_mfma_f32_16x16x32_bf16 v[112:115], v[64:67], v[96:99], 0
    v_mfma_f32_16x16x32_bf16 v[116:119], v[72:75], v[80:83], 0
    v_mfma_f32_16x16x32_bf16 v[120:123], v[72:75], v[88:91], 0
    v_mfma_f32_16x16x32_bf16 v[124:127], v[72:75], v[96:99], 0
    v_mfma_f32_16x16x32_bf16 v[104:107], v[68:71], v[84:87], v[104:107]
    v_mfma_f32_16x16x32_bf16 v[108:111], v[68:71], v[92:95], v[108:111]
    v_mfma_f32_16x16x32_bf16 v[112:115], v[68:71], v[100:103], v[112:115]
    v_mfma_f32_16x16x32_bf16 v[116:119], v[76:79], v[84:87], v[116:119]
    v_mfma_f32_16x16x32_bf16 v[120:123], v[76:79], v[92:95], v[120:123]
    v_mfma_f32_16x16x32_bf16 v[124:127], v[76:79], v[100:103], v[124:127]
    s_lshl_b32 s50, s32, 2
    s_add_u32 s50, s50, s3
    s_mul_i32 s50, s50, 5120
    v_lshlrev_b32 v6, 10, v4
    v_lshl_add_u32 v6, v3, 2, v6
    v_mov_b32 v12, 0x7ff00000
    v_cndmask_b32 v7, v12, v6, s[48:49]
    v_lshlrev_b32 v13, 2, v3
    v_add_u32 v13, 4096, v13
    v_cmp_eq_u32 vcc, 0, v4
    s_nop 1
    v_cndmask_b32 v13, v12, v13, vcc
    v_cndmask_b32 v14, v12, v13, s[48:49]
    buffer_atomic_add_f32 v104, v6, s[28:31], s50 offen offset:0
    buffer_atomic_add_f32 v105, v6, s[28:31], s50 offen offset:256
    buffer_atomic_add_f32 v106, v6, s[28:31], s50 offen offset:512
    buffer_atomic_add_f32 v107, v6, s[28:31], s50 offen offset:768
    buffer_atomic_add_f32 v108, v6, s[28:31], s50 offen offset:64
    buffer_atomic_add_f32 v109, v6, s[28:31], s50 offen offset:320
    buffer_atomic_add_f32 v110, v6, s[28:31], s50 offen offset:576
    buffer_atomic_add_f32 v111, v6, s[28:31], s50 offen offset:832
    buffer_atomic_add_f32 v112, v7, s[28:31], s50 offen offset:128
    buffer_atomic_add_f32 v113, v7, s[28:31], s50 offen offset:384
    buffer_atomic_add_f32 v114, v7, s[28:31], s50 offen offset:640
    buffer_atomic_add_f32 v115, v7, s[28:31], s50 offen offset:896
    buffer_atomic_add_f32 v116, v13, s[28:31], s50 offen offset:0
    buffer_atomic_add_f32 v117, v13, s[28:31], s50 offen offset:256
    buffer_atomic_add_f32 v118, v13, s[28:31], s50 offen offset:512
    buffer_atomic_add_f32 v120, v13, s[28:31], s50 offen offset:64
    buffer_atomic_add_f32 v121, v13, s[28:31], s50 offen offset:320
    buffer_atomic_add_f32 v122, v13, s[28:31], s50 offen offset:576
    buffer_atomic_add_f32 v124, v14, s[28:31], s50 offen offset:128
    buffer_atomic_add_f32 v125, v14, s[28:31], s50 offen offset:384
    buffer_atomic_add_f32 v126, v14, s[28:31], s50 offen offset:640
    s_branch .maindone_k1l0_kernel_3
.kv_k1l0_kernel_2:
    s_add_u32 s38, s37, 0
    buffer_load_dwordx4 v[16:19], v5, s[12:15], s38 offen
    s_add_u32 s38, s37, 1024
    buffer_load_dwordx4 v[20:23], v5, s[12:15], s38 offen
    s_add_u32 m0, s39, 0
    s_add_u32 s43, s41, 0
    buffer_load_dwordx4 v5, s[8:11], s43 offen lds
    s_add_u32 m0, s39, 8192
    s_add_u32 s43, s41, 8192
    buffer_load_dwordx4 v5, s[8:11], s43 offen lds
    s_add_u32 m0, s39, 16384
    s_add_u32 s43, s41, 16384
    buffer_load_dwordx4 v5, s[8:11], s43 offen lds
    s_add_u32 m0, s42, 24576
    s_add_u32 s43, s40, s42
    s_add_u32 s43, s43, 24576
    buffer_load_dwordx4 v5, s[8:11], s43 offen lds
    s_add_u32 s38, s37, 2048
    buffer_load_dwordx4 v[24:27], v5, s[12:15], s38 offen
    s_add_u32 s38, s37, 3072
    buffer_load_dwordx4 v[28:31], v5, s[12:15], s38 offen
    s_add_u32 m0, s39, 28672
    s_add_u32 s43, s41, 28672
    buffer_load_dwordx4 v5, s[8:11], s43 offen lds
    s_add_u32 m0, s39, 36864
    s_add_u32 s43, s41, 36864
    buffer_load_dwordx4 v5, s[8:11], s43 offen lds
    s_add_u32 m0, s39, 45056
    s_add_u32 s43, s41, 45056
    buffer_load_dwordx4 v5, s[8:11], s43 offen lds
    s_add_u32 m0, s42, 53248
    s_add_u32 s43, s40, s42
    s_add_u32 s43, s43, 53248
    buffer_load_dwordx4 v5, s[8:11], s43 offen lds
    s_waitcnt vmcnt(6)
    s_barrier
    s_add_u32 m0, s39, 57344
    s_add_u32 s43, s41, 57344
    buffer_load_dwordx4 v5, s[8:11], s43 offen lds
    s_add_u32 m0, s39, 65536
    s_add_u32 s43, s41, 65536
    buffer_load_dwordx4 v5, s[8:11], s43 offen lds
    s_add_u32 m0, s39, 73728
    s_add_u32 s43, s41, 73728
    buffer_load_dwordx4 v5, s[8:11], s43 offen lds
    s_add_u32 m0, s42, 81920
    s_add_u32 s43, s40, s42
    s_add_u32 s43, s43, 81920
    buffer_load_dwordx4 v5, s[8:11], s43 offen lds
    ds_read_b128 v[124:127], v5 offset:5120
    ds_read_b128 v[128:131], v5 offset:6144
    ds_read_b128 v[132:135], v5 offset:7168
    ds_read_b128 v[136:139], v5 offset:8192
    ds_read_b128 v[140:143], v5 offset:9216
    ds_read_b128 v[144:147], v5 offset:10240
    ds_read_b128 v[148:151], v5 offset:11264
    ds_read_b128 v[152:155], v5 offset:12288
    ds_read_b128 v[156:159], v5 offset:13312
    ds_read_b128 v[160:163], v5 offset:19456
    ds_read_b128 v[164:167], v5 offset:20480
    ds_read_b128 v[168:171], v5 offset:21504
    ds_read_b128 v[172:175], v5 offset:22528
    ds_read_b128 v[176:179], v5 offset:23552
    ds_read_b128 v[180:183], v5 offset:24576
    ds_read_b128 v[184:187], v5 offset:25600
    ds_read_b128 v[188:191], v5 offset:26624
    ds_read_b128 v[192:195], v5 offset:27648
    s_waitcnt lgkmcnt(15)
    v_mfma_f32_16x16x32_bf16 v[88:91], v[124:127], v[16:19], 0
    s_waitcnt lgkmcnt(15)
    v_mfma_f32_16x16x32_bf16 v[92:95], v[128:131], v[16:19], 0
    s_waitcnt lgkmcnt(15)
    v_mfma_f32_16x16x32_bf16 v[96:99], v[132:135], v[16:19], 0
    s_waitcnt lgkmcnt(14)
    v_mfma_f32_16x16x32_bf16 v[100:103], v[136:139], v[16:19], 0
    s_waitcnt lgkmcnt(13)
    v_mfma_f32_16x16x32_bf16 v[104:107], v[140:143], v[16:19], 0
    s_waitcnt lgkmcnt(12)
    v_mfma_f32_16x16x32_bf16 v[108:111], v[144:147], v[16:19], 0
    s_waitcnt lgkmcnt(11)
    v_mfma_f32_16x16x32_bf16 v[112:115], v[148:151], v[16:19], 0
    s_waitcnt lgkmcnt(10)
    v_mfma_f32_16x16x32_bf16 v[116:119], v[152:155], v[16:19], 0
    s_waitcnt lgkmcnt(9)
    v_mfma_f32_16x16x32_bf16 v[120:123], v[156:159], v[16:19], 0
    s_add_u32 s38, s37, 4096
    buffer_load_dwordx4 v[32:35], v5, s[12:15], s38 offen
    s_waitcnt lgkmcnt(8)
    v_mfma_f32_16x16x32_bf16 v[88:91], v[160:163], v[20:23], v[88:91]
    s_waitcnt lgkmcnt(7)
    v_mfma_f32_16x16x32_bf16 v[92:95], v[164:167], v[20:23], v[92:95]
    s_waitcnt lgkmcnt(6)
    v_mfma_f32_16x16x32_bf16 v[96:99], v[168:171], v[20:23], v[96:99]
    s_waitcnt lgkmcnt(5)
    v_mfma_f32_16x16x32_bf16 v[100:103], v[172:175], v[20:23], v[100:103]
    s_waitcnt lgkmcnt(4)
    v_mfma_f32_16x16x32_bf16 v[104:107], v[176:179], v[20:23], v[104:107]
    s_waitcnt lgkmcnt(3)
    v_mfma_f32_16x16x32_bf16 v[108:111], v[180:183], v[20:23], v[108:111]
    s_waitcnt lgkmcnt(2)
    v_mfma_f32_16x16x32_bf16 v[112:115], v[184:187], v[20:23], v[112:115]
    s_waitcnt lgkmcnt(1)
    v_mfma_f32_16x16x32_bf16 v[116:119], v[188:191], v[20:23], v[116:119]
    s_waitcnt lgkmcnt(0)
    v_mfma_f32_16x16x32_bf16 v[120:123], v[192:195], v[20:23], v[120:123]
    s_add_u32 s38, s37, 5120
    buffer_load_dwordx4 v[36:39], v5, s[12:15], s38 offen
    s_waitcnt vmcnt(6)
    s_barrier
    s_add_u32 m0, s39, 86016
    s_add_u32 s43, s41, 86016
    buffer_load_dwordx4 v5, s[8:11], s43 offen lds
    s_add_u32 m0, s39, 94208
    s_add_u32 s43, s41, 94208
    buffer_load_dwordx4 v5, s[8:11], s43 offen lds
    s_add_u32 m0, s39, 102400
    s_add_u32 s43, s41, 102400
    buffer_load_dwordx4 v5, s[8:11], s43 offen lds
    s_add_u32 m0, s42, 110592
    s_add_u32 s43, s40, s42
    s_add_u32 s43, s43, 110592
    buffer_load_dwordx4 v5, s[8:11], s43 offen lds
    ds_read_b128 v[124:127], v5 offset:33792
    ds_read_b128 v[128:131], v5 offset:34816
    ds_read_b128 v[132:135], v5 offset:35840
    ds_read_b128 v[136:139], v5 offset:36864
    ds_read_b128 v[140:143], v5 offset:37888
    ds_read_b128 v[144:147], v5 offset:38912
    ds_read_b128 v[148:151], v5 offset:39936
    ds_read_b128 v[152:155], v5 offset:40960
    ds_read_b128 v[156:159], v5 offset:41984
    ds_read_b128 v[160:163], v5 offset:48128
    ds_read_b128 v[164:167], v5 offset:49152
    ds_read_b128 v[168:171], v5 offset:50176
    ds_read_b128 v[172:175], v5 offset:51200
    ds_read_b128 v[176:179], v5 offset:52224
    ds_read_b128 v[180:183], v5 offset:53248
    ds_read_b128 v[184:187], v5 offset:54272
    ds_read_b128 v[188:191], v5 offset:55296
    ds_read_b128 v[192:195], v5 offset:56320
    s_waitcnt lgkmcnt(15)
    v_mfma_f32_16x16x32_bf16 v[88:91], v[124:127], v[24:27], v[88:91]
    s_waitcnt lgkmcnt(15)
    v_mfma_f32_16x16x32_bf16 v[92:95], v[128:131], v[24:27], v[92:95]
    s_waitcnt lgkmcnt(15)
    v_mfma_f32_16x16x32_bf16 v[96:99], v[132:135], v[24:27], v[96:99]
    s_waitcnt lgkmcnt(14)
    v_mfma_f32_16x16x32_bf16 v[100:103], v[136:139], v[24:27], v[100:103]
    s_waitcnt lgkmcnt(13)
    v_mfma_f32_16x16x32_bf16 v[104:107], v[140:143], v[24:27], v[104:107]
    s_waitcnt lgkmcnt(12)
    v_mfma_f32_16x16x32_bf16 v[108:111], v[144:147], v[24:27], v[108:111]
    s_waitcnt lgkmcnt(11)
    v_mfma_f32_16x16x32_bf16 v[112:115], v[148:151], v[24:27], v[112:115]
    s_waitcnt lgkmcnt(10)
    v_mfma_f32_16x16x32_bf16 v[116:119], v[152:155], v[24:27], v[116:119]
    s_waitcnt lgkmcnt(9)
    v_mfma_f32_16x16x32_bf16 v[120:123], v[156:159], v[24:27], v[120:123]
    s_add_u32 s38, s37, 6144
    buffer_load_dwordx4 v[40:43], v5, s[12:15], s38 offen
    s_waitcnt lgkmcnt(8)
    v_mfma_f32_16x16x32_bf16 v[88:91], v[160:163], v[28:31], v[88:91]
    s_waitcnt lgkmcnt(7)
    v_mfma_f32_16x16x32_bf16 v[92:95], v[164:167], v[28:31], v[92:95]
    s_waitcnt lgkmcnt(6)
    v_mfma_f32_16x16x32_bf16 v[96:99], v[168:171], v[28:31], v[96:99]
    s_waitcnt lgkmcnt(5)
    v_mfma_f32_16x16x32_bf16 v[100:103], v[172:175], v[28:31], v[100:103]
    s_waitcnt lgkmcnt(4)
    v_mfma_f32_16x16x32_bf16 v[104:107], v[176:179], v[28:31], v[104:107]
    s_waitcnt lgkmcnt(3)
    v_mfma_f32_16x16x32_bf16 v[108:111], v[180:183], v[28:31], v[108:111]
    s_waitcnt lgkmcnt(2)
    v_mfma_f32_16x16x32_bf16 v[112:115], v[184:187], v[28:31], v[112:115]
    s_waitcnt lgkmcnt(1)
    v_mfma_f32_16x16x32_bf16 v[116:119], v[188:191], v[28:31], v[116:119]
    s_waitcnt lgkmcnt(0)
    v_mfma_f32_16x16x32_bf16 v[120:123], v[192:195], v[28:31], v[120:123]
    s_add_u32 s38, s37, 7168
    buffer_load_dwordx4 v[44:47], v5, s[12:15], s38 offen
    s_waitcnt vmcnt(8)
    s_barrier
    s_add_u32 m0, s39, 0
    s_add_u32 s43, s41, 114688
    buffer_load_dwordx4 v5, s[8:11], s43 offen lds
    s_add_u32 m0, s39, 8192
    s_add_u32 s43, s41, 122880
    buffer_load_dwordx4 v5, s[8:11], s43 offen lds
    s_add_u32 m0, s39, 16384
    s_add_u32 s43, s41, 131072
    buffer_load_dwordx4 v5, s[8:11], s43 offen lds
    s_add_u32 m0, s42, 24576
    s_add_u32 s43, s40, s42
    s_add_u32 s43, s43, 139264
    buffer_load_dwordx4 v5, s[8:11], s43 offen lds
    ds_read_b128 v[124:127], v5 offset:62464
    ds_read_b128 v[128:131], v5 offset:63488
    ds_read_b128 v[132:135], v5 offset:64512
    ds_read_b128 v[136:139], v2 offset:0
    ds_read_b128 v[140:143], v2 offset:1024
    ds_read_b128 v[144:147], v2 offset:2048
    ds_read_b128 v[148:151], v2 offset:3072
    ds_read_b128 v[152:155], v2 offset:4096
    ds_read_b128 v[156:159], v2 offset:5120
    s_waitcnt vmcnt(11)
    ds_read_b128 v[160:163], v2 offset:11264
    ds_read_b128 v[164:167], v2 offset:12288
    ds_read_b128 v[168:171], v2 offset:13312
    ds_read_b128 v[172:175], v2 offset:14336
    ds_read_b128 v[176:179], v2 offset:15360
    ds_read_b128 v[180:183], v2 offset:16384
    ds_read_b128 v[184:187], v2 offset:17408
    ds_read_b128 v[188:191], v2 offset:18432
    ds_read_b128 v[192:195], v2 offset:19456
    s_waitcnt lgkmcnt(15)
    v_mfma_f32_16x16x32_bf16 v[88:91], v[124:127], v[32:35], v[88:91]
    s_waitcnt lgkmcnt(15)
    v_mfma_f32_16x16x32_bf16 v[92:95], v[128:131], v[32:35], v[92:95]
    s_waitcnt lgkmcnt(15)
    v_mfma_f32_16x16x32_bf16 v[96:99], v[132:135], v[32:35], v[96:99]
    s_waitcnt lgkmcnt(14)
    v_mfma_f32_16x16x32_bf16 v[100:103], v[136:139], v[32:35], v[100:103]
    s_waitcnt lgkmcnt(13)
    v_mfma_f32_16x16x32_bf16 v[104:107], v[140:143], v[32:35], v[104:107]
    s_waitcnt lgkmcnt(12)
    v_mfma_f32_16x16x32_bf16 v[108:111], v[144:147], v[32:35], v[108:111]
    s_waitcnt lgkmcnt(11)
    v_mfma_f32_16x16x32_bf16 v[112:115], v[148:151], v[32:35], v[112:115]
    s_waitcnt lgkmcnt(10)
    v_mfma_f32_16x16x32_bf16 v[116:119], v[152:155], v[32:35], v[116:119]
    s_waitcnt lgkmcnt(9)
    v_mfma_f32_16x16x32_bf16 v[120:123], v[156:159], v[32:35], v[120:123]
    s_add_u32 s38, s37, 8192
    buffer_load_dwordx4 v[48:51], v5, s[12:15], s38 offen
    s_waitcnt vmcnt(11)
    s_waitcnt lgkmcnt(8)
    v_mfma_f32_16x16x32_bf16 v[88:91], v[160:163], v[36:39], v[88:91]
    s_waitcnt lgkmcnt(7)
    v_mfma_f32_16x16x32_bf16 v[92:95], v[164:167], v[36:39], v[92:95]
    s_waitcnt lgkmcnt(6)
    v_mfma_f32_16x16x32_bf16 v[96:99], v[168:171], v[36:39], v[96:99]
    s_waitcnt lgkmcnt(5)
    v_mfma_f32_16x16x32_bf16 v[100:103], v[172:175], v[36:39], v[100:103]
    s_waitcnt lgkmcnt(4)
    v_mfma_f32_16x16x32_bf16 v[104:107], v[176:179], v[36:39], v[104:107]
    s_waitcnt lgkmcnt(3)
    v_mfma_f32_16x16x32_bf16 v[108:111], v[180:183], v[36:39], v[108:111]
    s_waitcnt lgkmcnt(2)
    v_mfma_f32_16x16x32_bf16 v[112:115], v[184:187], v[36:39], v[112:115]
    s_waitcnt lgkmcnt(1)
    v_mfma_f32_16x16x32_bf16 v[116:119], v[188:191], v[36:39], v[116:119]
    s_waitcnt lgkmcnt(0)
    v_mfma_f32_16x16x32_bf16 v[120:123], v[192:195], v[36:39], v[120:123]
    s_add_u32 s38, s37, 9216
    buffer_load_dwordx4 v[52:55], v5, s[12:15], s38 offen
    s_waitcnt vmcnt(8)
    s_barrier
    s_add_u32 m0, s39, 28672
    s_add_u32 s43, s41, 143360
    buffer_load_dwordx4 v5, s[8:11], s43 offen lds
    s_add_u32 m0, s39, 36864
    s_add_u32 s43, s41, 151552
    buffer_load_dwordx4 v5, s[8:11], s43 offen lds
    s_add_u32 m0, s39, 45056
    s_add_u32 s43, s41, 159744
    buffer_load_dwordx4 v5, s[8:11], s43 offen lds
    s_add_u32 m0, s42, 53248
    s_add_u32 s43, s40, s42
    s_add_u32 s43, s43, 167936
    buffer_load_dwordx4 v5, s[8:11], s43 offen lds
    ds_read_b128 v[124:127], v2 offset:25600
    ds_read_b128 v[128:131], v2 offset:26624
    ds_read_b128 v[132:135], v2 offset:27648
    ds_read_b128 v[136:139], v2 offset:28672
    ds_read_b128 v[140:143], v2 offset:29696
    ds_read_b128 v[144:147], v2 offset:30720
    ds_read_b128 v[148:151], v2 offset:31744
    ds_read_b128 v[152:155], v2 offset:32768
    ds_read_b128 v[156:159], v2 offset:33792
    s_waitcnt vmcnt(11)
    ds_read_b128 v[160:163], v2 offset:39936
    ds_read_b128 v[164:167], v2 offset:40960
    ds_read_b128 v[168:171], v2 offset:41984
    ds_read_b128 v[172:175], v2 offset:43008
    ds_read_b128 v[176:179], v2 offset:44032
    ds_read_b128 v[180:183], v2 offset:45056
    ds_read_b128 v[184:187], v2 offset:46080
    ds_read_b128 v[188:191], v2 offset:47104
    ds_read_b128 v[192:195], v2 offset:48128
    s_waitcnt lgkmcnt(15)
    v_mfma_f32_16x16x32_bf16 v[88:91], v[124:127], v[40:43], v[88:91]
    s_waitcnt lgkmcnt(15)
    v_mfma_f32_16x16x32_bf16 v[92:95], v[128:131], v[40:43], v[92:95]
    s_waitcnt lgkmcnt(15)
    v_mfma_f32_16x16x32_bf16 v[96:99], v[132:135], v[40:43], v[96:99]
    s_waitcnt lgkmcnt(14)
    v_mfma_f32_16x16x32_bf16 v[100:103], v[136:139], v[40:43], v[100:103]
    s_waitcnt lgkmcnt(13)
    v_mfma_f32_16x16x32_bf16 v[104:107], v[140:143], v[40:43], v[104:107]
    s_waitcnt lgkmcnt(12)
    v_mfma_f32_16x16x32_bf16 v[108:111], v[144:147], v[40:43], v[108:111]
    s_waitcnt lgkmcnt(11)
    v_mfma_f32_16x16x32_bf16 v[112:115], v[148:151], v[40:43], v[112:115]
    s_waitcnt lgkmcnt(10)
    v_mfma_f32_16x16x32_bf16 v[116:119], v[152:155], v[40:43], v[116:119]
    s_waitcnt lgkmcnt(9)
    v_mfma_f32_16x16x32_bf16 v[120:123], v[156:159], v[40:43], v[120:123]
    s_add_u32 s38, s37, 10240
    buffer_load_dwordx4 v[56:59], v5, s[12:15], s38 offen
    s_waitcnt vmcnt(11)
    s_waitcnt lgkmcnt(8)
    v_mfma_f32_16x16x32_bf16 v[88:91], v[160:163], v[44:47], v[88:91]
    s_waitcnt lgkmcnt(7)
    v_mfma_f32_16x16x32_bf16 v[92:95], v[164:167], v[44:47], v[92:95]
    s_waitcnt lgkmcnt(6)
    v_mfma_f32_16x16x32_bf16 v[96:99], v[168:171], v[44:47], v[96:99]
    s_waitcnt lgkmcnt(5)
    v_mfma_f32_16x16x32_bf16 v[100:103], v[172:175], v[44:47], v[100:103]
    s_waitcnt lgkmcnt(4)
    v_mfma_f32_16x16x32_bf16 v[104:107], v[176:179], v[44:47], v[104:107]
    s_waitcnt lgkmcnt(3)
    v_mfma_f32_16x16x32_bf16 v[108:111], v[180:183], v[44:47], v[108:111]
    s_waitcnt lgkmcnt(2)
    v_mfma_f32_16x16x32_bf16 v[112:115], v[184:187], v[44:47], v[112:115]
    s_waitcnt lgkmcnt(1)
    v_mfma_f32_16x16x32_bf16 v[116:119], v[188:191], v[44:47], v[116:119]
    s_waitcnt lgkmcnt(0)
    v_mfma_f32_16x16x32_bf16 v[120:123], v[192:195], v[44:47], v[120:123]
    s_add_u32 s38, s37, 11264
    buffer_load_dwordx4 v[60:63], v5, s[12:15], s38 offen
    s_waitcnt vmcnt(8)
    s_barrier
    s_add_u32 m0, s39, 57344
    s_add_u32 s43, s41, 172032
    buffer_load_dwordx4 v5, s[8:11], s43 offen lds
    s_add_u32 m0, s39, 65536
    s_add_u32 s43, s41, 180224
    buffer_load_dwordx4 v5, s[8:11], s43 offen lds
    s_add_u32 m0, s39, 73728
    s_add_u32 s43, s41, 188416
    buffer_load_dwordx4 v5, s[8:11], s43 offen lds
    s_add_u32 m0, s42, 81920
    s_add_u32 s43, s40, s42
    s_add_u32 s43, s43, 196608
    buffer_load_dwordx4 v5, s[8:11], s43 offen lds
    ds_read_b128 v[124:127], v5 offset:5120
    ds_read_b128 v[128:131], v5 offset:6144
    ds_read_b128 v[132:135], v5 offset:7168
    ds_read_b128 v[136:139], v5 offset:8192
    ds_read_b128 v[140:143], v5 offset:9216
    ds_read_b128 v[144:147], v5 offset:10240
    ds_read_b128 v[148:151], v5 offset:11264
    ds_read_b128 v[152:155], v5 offset:12288
    ds_read_b128 v[156:159], v5 offset:13312
    s_waitcnt vmcnt(11)
    ds_read_b128 v[160:163], v5 offset:19456
    ds_read_b128 v[164:167], v5 offset:20480
    ds_read_b128 v[168:171], v5 offset:21504
    ds_read_b128 v[172:175], v5 offset:22528
    ds_read_b128 v[176:179], v5 offset:23552
    ds_read_b128 v[180:183], v5 offset:24576
    ds_read_b128 v[184:187], v5 offset:25600
    ds_read_b128 v[188:191], v5 offset:26624
    ds_read_b128 v[192:195], v5 offset:27648
    s_waitcnt lgkmcnt(15)
    v_mfma_f32_16x16x32_bf16 v[88:91], v[124:127], v[48:51], v[88:91]
    s_waitcnt lgkmcnt(15)
    v_mfma_f32_16x16x32_bf16 v[92:95], v[128:131], v[48:51], v[92:95]
    s_waitcnt lgkmcnt(15)
    v_mfma_f32_16x16x32_bf16 v[96:99], v[132:135], v[48:51], v[96:99]
    s_waitcnt lgkmcnt(14)
    v_mfma_f32_16x16x32_bf16 v[100:103], v[136:139], v[48:51], v[100:103]
    s_waitcnt lgkmcnt(13)
    v_mfma_f32_16x16x32_bf16 v[104:107], v[140:143], v[48:51], v[104:107]
    s_waitcnt lgkmcnt(12)
    v_mfma_f32_16x16x32_bf16 v[108:111], v[144:147], v[48:51], v[108:111]
    s_waitcnt lgkmcnt(11)
    v_mfma_f32_16x16x32_bf16 v[112:115], v[148:151], v[48:51], v[112:115]
    s_waitcnt lgkmcnt(10)
    v_mfma_f32_16x16x32_bf16 v[116:119], v[152:155], v[48:51], v[116:119]
    s_waitcnt lgkmcnt(9)
    v_mfma_f32_16x16x32_bf16 v[120:123], v[156:159], v[48:51], v[120:123]
    s_add_u32 s38, s37, 12288
    buffer_load_dwordx4 v[64:67], v5, s[12:15], s38 offen
    s_waitcnt vmcnt(11)
    s_waitcnt lgkmcnt(8)
    v_mfma_f32_16x16x32_bf16 v[88:91], v[160:163], v[52:55], v[88:91]
    s_waitcnt lgkmcnt(7)
    v_mfma_f32_16x16x32_bf16 v[92:95], v[164:167], v[52:55], v[92:95]
    s_waitcnt lgkmcnt(6)
    v_mfma_f32_16x16x32_bf16 v[96:99], v[168:171], v[52:55], v[96:99]
    s_waitcnt lgkmcnt(5)
    v_mfma_f32_16x16x32_bf16 v[100:103], v[172:175], v[52:55], v[100:103]
    s_waitcnt lgkmcnt(4)
    v_mfma_f32_16x16x32_bf16 v[104:107], v[176:179], v[52:55], v[104:107]
    s_waitcnt lgkmcnt(3)
    v_mfma_f32_16x16x32_bf16 v[108:111], v[180:183], v[52:55], v[108:111]
    s_waitcnt lgkmcnt(2)
    v_mfma_f32_16x16x32_bf16 v[112:115], v[184:187], v[52:55], v[112:115]
    s_waitcnt lgkmcnt(1)
    v_mfma_f32_16x16x32_bf16 v[116:119], v[188:191], v[52:55], v[116:119]
    s_waitcnt lgkmcnt(0)
    v_mfma_f32_16x16x32_bf16 v[120:123], v[192:195], v[52:55], v[120:123]
    s_add_u32 s38, s37, 13312
    buffer_load_dwordx4 v[68:71], v5, s[12:15], s38 offen
    s_waitcnt vmcnt(8)
    s_barrier
    s_add_u32 m0, s39, 86016
    s_add_u32 s43, s41, 200704
    buffer_load_dwordx4 v5, s[8:11], s43 offen lds
    s_add_u32 m0, s39, 94208
    s_add_u32 s43, s41, 208896
    buffer_load_dwordx4 v5, s[8:11], s43 offen lds
    s_add_u32 m0, s39, 102400
    s_add_u32 s43, s41, 217088
    buffer_load_dwordx4 v5, s[8:11], s43 offen lds
    s_add_u32 m0, s42, 110592
    s_add_u32 s43, s40, s42
    s_add_u32 s43, s43, 225280
    buffer_load_dwordx4 v5, s[8:11], s43 offen lds
    ds_read_b128 v[124:127], v5 offset:33792
    ds_read_b128 v[128:131], v5 offset:34816
    ds_read_b128 v[132:135], v5 offset:35840
    ds_read_b128 v[136:139], v5 offset:36864
    ds_read_b128 v[140:143], v5 offset:37888
    ds_read_b128 v[144:147], v5 offset:38912
    ds_read_b128 v[148:151], v5 offset:39936
    ds_read_b128 v[152:155], v5 offset:40960
    ds_read_b128 v[156:159], v5 offset:41984
    s_waitcnt vmcnt(11)
    ds_read_b128 v[160:163], v5 offset:48128
    ds_read_b128 v[164:167], v5 offset:49152
    ds_read_b128 v[168:171], v5 offset:50176
    ds_read_b128 v[172:175], v5 offset:51200
    ds_read_b128 v[176:179], v5 offset:52224
    ds_read_b128 v[180:183], v5 offset:53248
    ds_read_b128 v[184:187], v5 offset:54272
    ds_read_b128 v[188:191], v5 offset:55296
    ds_read_b128 v[192:195], v5 offset:56320
    s_waitcnt lgkmcnt(15)
    v_mfma_f32_16x16x32_bf16 v[88:91], v[124:127], v[56:59], v[88:91]
    s_waitcnt lgkmcnt(15)
    v_mfma_f32_16x16x32_bf16 v[92:95], v[128:131], v[56:59], v[92:95]
    s_waitcnt lgkmcnt(15)
    v_mfma_f32_16x16x32_bf16 v[96:99], v[132:135], v[56:59], v[96:99]
    s_waitcnt lgkmcnt(14)
    v_mfma_f32_16x16x32_bf16 v[100:103], v[136:139], v[56:59], v[100:103]
    s_waitcnt lgkmcnt(13)
    v_mfma_f32_16x16x32_bf16 v[104:107], v[140:143], v[56:59], v[104:107]
    s_waitcnt lgkmcnt(12)
    v_mfma_f32_16x16x32_bf16 v[108:111], v[144:147], v[56:59], v[108:111]
    s_waitcnt lgkmcnt(11)
    v_mfma_f32_16x16x32_bf16 v[112:115], v[148:151], v[56:59], v[112:115]
    s_waitcnt lgkmcnt(10)
    v_mfma_f32_16x16x32_bf16 v[116:119], v[152:155], v[56:59], v[116:119]
    s_waitcnt lgkmcnt(9)
    v_mfma_f32_16x16x32_bf16 v[120:123], v[156:159], v[56:59], v[120:123]
    s_add_u32 s38, s37, 14336
    buffer_load_dwordx4 v[72:75], v5, s[12:15], s38 offen
    s_waitcnt vmcnt(11)
    s_waitcnt lgkmcnt(8)
    v_mfma_f32_16x16x32_bf16 v[88:91], v[160:163], v[60:63], v[88:91]
    s_waitcnt lgkmcnt(7)
    v_mfma_f32_16x16x32_bf16 v[92:95], v[164:167], v[60:63], v[92:95]
    s_waitcnt lgkmcnt(6)
    v_mfma_f32_16x16x32_bf16 v[96:99], v[168:171], v[60:63], v[96:99]
    s_waitcnt lgkmcnt(5)
    v_mfma_f32_16x16x32_bf16 v[100:103], v[172:175], v[60:63], v[100:103]
    s_waitcnt lgkmcnt(4)
    v_mfma_f32_16x16x32_bf16 v[104:107], v[176:179], v[60:63], v[104:107]
    s_waitcnt lgkmcnt(3)
    v_mfma_f32_16x16x32_bf16 v[108:111], v[180:183], v[60:63], v[108:111]
    s_waitcnt lgkmcnt(2)
    v_mfma_f32_16x16x32_bf16 v[112:115], v[184:187], v[60:63], v[112:115]
    s_waitcnt lgkmcnt(1)
    v_mfma_f32_16x16x32_bf16 v[116:119], v[188:191], v[60:63], v[116:119]
    s_waitcnt lgkmcnt(0)
    v_mfma_f32_16x16x32_bf16 v[120:123], v[192:195], v[60:63], v[120:123]
    s_add_u32 s38, s37, 15360
    buffer_load_dwordx4 v[76:79], v5, s[12:15], s38 offen
    s_waitcnt vmcnt(8)
    s_barrier
    s_add_u32 m0, s39, 0
    s_add_u32 s43, s41, 229376
    buffer_load_dwordx4 v5, s[8:11], s43 offen lds
    s_add_u32 m0, s39, 8192
    s_add_u32 s43, s41, 237568
    buffer_load_dwordx4 v5, s[8:11], s43 offen lds
    s_add_u32 m0, s39, 16384
    s_add_u32 s43, s41, 245760
    buffer_load_dwordx4 v5, s[8:11], s43 offen lds
    s_add_u32 m0, s42, 24576
    s_add_u32 s43, s40, s42
    s_add_u32 s43, s43, 253952
    buffer_load_dwordx4 v5, s[8:11], s43 offen lds
    ds_read_b128 v[124:127], v5 offset:62464
    ds_read_b128 v[128:131], v5 offset:63488
    ds_read_b128 v[132:135], v5 offset:64512
    ds_read_b128 v[136:139], v2 offset:0
    ds_read_b128 v[140:143], v2 offset:1024
    ds_read_b128 v[144:147], v2 offset:2048
    ds_read_b128 v[148:151], v2 offset:3072
    ds_read_b128 v[152:155], v2 offset:4096
    ds_read_b128 v[156:159], v2 offset:5120
    s_waitcnt vmcnt(11)
    ds_read_b128 v[160:163], v2 offset:11264
    ds_read_b128 v[164:167], v2 offset:12288
    ds_read_b128 v[168:171], v2 offset:13312
    ds_read_b128 v[172:175], v2 offset:14336
    ds_read_b128 v[176:179], v2 offset:15360
    ds_read_b128 v[180:183], v2 offset:16384
    ds_read_b128 v[184:187], v2 offset:17408
    ds_read_b128 v[188:191], v2 offset:18432
    ds_read_b128 v[192:195], v2 offset:19456
    s_waitcnt lgkmcnt(15)
    v_mfma_f32_16x16x32_bf16 v[88:91], v[124:127], v[64:67], v[88:91]
    s_waitcnt lgkmcnt(15)
    v_mfma_f32_16x16x32_bf16 v[92:95], v[128:131], v[64:67], v[92:95]
    s_waitcnt lgkmcnt(15)
    v_mfma_f32_16x16x32_bf16 v[96:99], v[132:135], v[64:67], v[96:99]
    s_waitcnt lgkmcnt(14)
    v_mfma_f32_16x16x32_bf16 v[100:103], v[136:139], v[64:67], v[100:103]
    s_waitcnt lgkmcnt(13)
    v_mfma_f32_16x16x32_bf16 v[104:107], v[140:143], v[64:67], v[104:107]
    s_waitcnt lgkmcnt(12)
    v_mfma_f32_16x16x32_bf16 v[108:111], v[144:147], v[64:67], v[108:111]
    s_waitcnt lgkmcnt(11)
    v_mfma_f32_16x16x32_bf16 v[112:115], v[148:151], v[64:67], v[112:115]
    s_waitcnt lgkmcnt(10)
    v_mfma_f32_16x16x32_bf16 v[116:119], v[152:155], v[64:67], v[116:119]
    s_waitcnt lgkmcnt(9)
    v_mfma_f32_16x16x32_bf16 v[120:123], v[156:159], v[64:67], v[120:123]
    s_add_u32 s38, s37, 16384
    buffer_load_dwordx4 v[80:83], v5, s[12:15], s38 offen
    s_waitcnt vmcnt(11)
    s_waitcnt lgkmcnt(8)
    v_mfma_f32_16x16x32_bf16 v[88:91], v[160:163], v[68:71], v[88:91]
    s_waitcnt lgkmcnt(7)
    v_mfma_f32_16x16x32_bf16 v[92:95], v[164:167], v[68:71], v[92:95]
    s_waitcnt lgkmcnt(6)
    v_mfma_f32_16x16x32_bf16 v[96:99], v[168:171], v[68:71], v[96:99]
    s_waitcnt lgkmcnt(5)
    v_mfma_f32_16x16x32_bf16 v[100:103], v[172:175], v[68:71], v[100:103]
    s_waitcnt lgkmcnt(4)
    v_mfma_f32_16x16x32_bf16 v[104:107], v[176:179], v[68:71], v[104:107]
    s_waitcnt lgkmcnt(3)
    v_mfma_f32_16x16x32_bf16 v[108:111], v[180:183], v[68:71], v[108:111]
    s_waitcnt lgkmcnt(2)
    v_mfma_f32_16x16x32_bf16 v[112:115], v[184:187], v[68:71], v[112:115]
    s_waitcnt lgkmcnt(1)
    v_mfma_f32_16x16x32_bf16 v[116:119], v[188:191], v[68:71], v[116:119]
    s_waitcnt lgkmcnt(0)
    v_mfma_f32_16x16x32_bf16 v[120:123], v[192:195], v[68:71], v[120:123]
    s_add_u32 s38, s37, 17408
    buffer_load_dwordx4 v[84:87], v5, s[12:15], s38 offen
    s_waitcnt vmcnt(8)
    s_barrier
    ds_read_b128 v[124:127], v2 offset:25600
    ds_read_b128 v[128:131], v2 offset:26624
    ds_read_b128 v[132:135], v2 offset:27648
    ds_read_b128 v[136:139], v2 offset:28672
    ds_read_b128 v[140:143], v2 offset:29696
    ds_read_b128 v[144:147], v2 offset:30720
    ds_read_b128 v[148:151], v2 offset:31744
    ds_read_b128 v[152:155], v2 offset:32768
    ds_read_b128 v[156:159], v2 offset:33792
    s_waitcnt vmcnt(7)
    ds_read_b128 v[160:163], v2 offset:39936
    ds_read_b128 v[164:167], v2 offset:40960
    ds_read_b128 v[168:171], v2 offset:41984
    ds_read_b128 v[172:175], v2 offset:43008
    ds_read_b128 v[176:179], v2 offset:44032
    ds_read_b128 v[180:183], v2 offset:45056
    ds_read_b128 v[184:187], v2 offset:46080
    ds_read_b128 v[188:191], v2 offset:47104
    ds_read_b128 v[192:195], v2 offset:48128
    s_waitcnt lgkmcnt(15)
    v_mfma_f32_16x16x32_bf16 v[88:91], v[124:127], v[72:75], v[88:91]
    s_waitcnt lgkmcnt(15)
    v_mfma_f32_16x16x32_bf16 v[92:95], v[128:131], v[72:75], v[92:95]
    s_waitcnt lgkmcnt(15)
    v_mfma_f32_16x16x32_bf16 v[96:99], v[132:135], v[72:75], v[96:99]
    s_waitcnt lgkmcnt(14)
    v_mfma_f32_16x16x32_bf16 v[100:103], v[136:139], v[72:75], v[100:103]
    s_waitcnt lgkmcnt(13)
    v_mfma_f32_16x16x32_bf16 v[104:107], v[140:143], v[72:75], v[104:107]
    s_waitcnt lgkmcnt(12)
    v_mfma_f32_16x16x32_bf16 v[108:111], v[144:147], v[72:75], v[108:111]
    s_waitcnt lgkmcnt(11)
    v_mfma_f32_16x16x32_bf16 v[112:115], v[148:151], v[72:75], v[112:115]
    s_waitcnt lgkmcnt(10)
    v_mfma_f32_16x16x32_bf16 v[116:119], v[152:155], v[72:75], v[116:119]
    s_waitcnt lgkmcnt(9)
    v_mfma_f32_16x16x32_bf16 v[120:123], v[156:159], v[72:75], v[120:123]
    s_add_u32 s44, s35, 0
    buffer_load_dword v204, v6, s[20:23], s44 offen
    s_add_u32 s44, s35, 7168
    buffer_load_dword v205, v6, s[20:23], s44 offen
    s_add_u32 s44, s35, 14336
    buffer_load_dword v206, v6, s[20:23], s44 offen
    s_add_u32 s44, s35, 21504
    buffer_load_dword v207, v6, s[20:23], s44 offen
    s_add_u32 s44, s35, 28672
    buffer_load_dword v208, v6, s[20:23], s44 offen
    s_add_u32 s44, s35, 35840
    buffer_load_dword v209, v6, s[20:23], s44 offen
    s_add_u32 s44, s35, 43008
    buffer_load_dword v210, v6, s[20:23], s44 offen
    s_add_u32 s44, s35, 50176
    buffer_load_dword v211, v6, s[20:23], s44 offen
    s_add_u32 s44, s35, 57344
    buffer_load_dword v212, v6, s[20:23], s44 offen
    s_add_u32 s44, s35, 64512
    buffer_load_dword v213, v6, s[20:23], s44 offen
    s_add_u32 s44, s35, 71680
    buffer_load_dword v214, v6, s[20:23], s44 offen
    s_add_u32 s44, s35, 78848
    buffer_load_dword v215, v6, s[20:23], s44 offen
    s_add_u32 s44, s35, 86016
    buffer_load_dword v216, v6, s[20:23], s44 offen
    s_add_u32 s44, s35, 93184
    buffer_load_dword v217, v6, s[20:23], s44 offen
    s_add_u32 s44, s35, 100352
    buffer_load_dword v218, v6, s[20:23], s44 offen
    s_add_u32 s44, s35, 107520
    buffer_load_dword v219, v6, s[20:23], s44 offen
    s_add_u32 s44, s35, 114688
    buffer_load_dword v220, v6, s[20:23], s44 offen
    s_add_u32 s44, s35, 121856
    buffer_load_dword v221, v6, s[20:23], s44 offen
    buffer_load_dwordx2 v[196:197], v7, s[16:19], s36 offen
    s_waitcnt vmcnt(25)
    s_waitcnt lgkmcnt(8)
    v_mfma_f32_16x16x32_bf16 v[88:91], v[160:163], v[76:79], v[88:91]
    s_waitcnt lgkmcnt(7)
    v_mfma_f32_16x16x32_bf16 v[92:95], v[164:167], v[76:79], v[92:95]
    s_waitcnt lgkmcnt(6)
    v_mfma_f32_16x16x32_bf16 v[96:99], v[168:171], v[76:79], v[96:99]
    s_waitcnt lgkmcnt(5)
    v_mfma_f32_16x16x32_bf16 v[100:103], v[172:175], v[76:79], v[100:103]
    s_waitcnt lgkmcnt(4)
    v_mfma_f32_16x16x32_bf16 v[104:107], v[176:179], v[76:79], v[104:107]
    s_waitcnt lgkmcnt(3)
    v_mfma_f32_16x16x32_bf16 v[108:111], v[180:183], v[76:79], v[108:111]
    s_waitcnt lgkmcnt(2)
    v_mfma_f32_16x16x32_bf16 v[112:115], v[184:187], v[76:79], v[112:115]
    s_waitcnt lgkmcnt(1)
    v_mfma_f32_16x16x32_bf16 v[116:119], v[188:191], v[76:79], v[116:119]
    s_waitcnt lgkmcnt(0)
    v_mfma_f32_16x16x32_bf16 v[120:123], v[192:195], v[76:79], v[120:123]
    s_waitcnt vmcnt(21)
    s_barrier
    ds_read_b128 v[124:127], v5 offset:5120
    ds_read_b128 v[128:131], v5 offset:6144
    ds_read_b128 v[132:135], v5 offset:7168
    ds_read_b128 v[136:139], v5 offset:8192
    ds_read_b128 v[140:143], v5 offset:9216
    ds_read_b128 v[144:147], v5 offset:10240
    ds_read_b128 v[148:151], v5 offset:11264
    ds_read_b128 v[152:155], v5 offset:12288
    ds_read_b128 v[156:159], v5 offset:13312
    s_waitcnt vmcnt(20)
    ds_read_b128 v[160:163], v5 offset:19456
    ds_read_b128 v[164:167], v5 offset:20480
    ds_read_b128 v[168:171], v5 offset:21504
    ds_read_b128 v[172:175], v5 offset:22528
    ds_read_b128 v[176:179], v5 offset:23552
    ds_read_b128 v[180:183], v5 offset:24576
    ds_read_b128 v[184:187], v5 offset:25600
    ds_read_b128 v[188:191], v5 offset:26624
    ds_read_b128 v[192:195], v5 offset:27648
    s_waitcnt lgkmcnt(15)
    v_mfma_f32_16x16x32_bf16 v[88:91], v[124:127], v[80:83], v[88:91]
    s_waitcnt lgkmcnt(15)
    v_mfma_f32_16x16x32_bf16 v[92:95], v[128:131], v[80:83], v[92:95]
    s_waitcnt lgkmcnt(15)
    v_mfma_f32_16x16x32_bf16 v[96:99], v[132:135], v[80:83], v[96:99]
    s_waitcnt lgkmcnt(14)
    v_mfma_f32_16x16x32_bf16 v[100:103], v[136:139], v[80:83], v[100:103]
    s_waitcnt lgkmcnt(13)
    v_mfma_f32_16x16x32_bf16 v[104:107], v[140:143], v[80:83], v[104:107]
    s_waitcnt lgkmcnt(12)
    v_mfma_f32_16x16x32_bf16 v[108:111], v[144:147], v[80:83], v[108:111]
    s_waitcnt lgkmcnt(11)
    v_mfma_f32_16x16x32_bf16 v[112:115], v[148:151], v[80:83], v[112:115]
    s_waitcnt lgkmcnt(10)
    v_mfma_f32_16x16x32_bf16 v[116:119], v[152:155], v[80:83], v[116:119]
    s_waitcnt lgkmcnt(9)
    v_mfma_f32_16x16x32_bf16 v[120:123], v[156:159], v[80:83], v[120:123]
    s_waitcnt vmcnt(19)
    s_waitcnt lgkmcnt(8)
    v_mfma_f32_16x16x32_bf16 v[88:91], v[160:163], v[84:87], v[88:91]
    s_waitcnt lgkmcnt(7)
    v_mfma_f32_16x16x32_bf16 v[92:95], v[164:167], v[84:87], v[92:95]
    s_waitcnt lgkmcnt(6)
    v_mfma_f32_16x16x32_bf16 v[96:99], v[168:171], v[84:87], v[96:99]
    s_waitcnt lgkmcnt(5)
    v_mfma_f32_16x16x32_bf16 v[100:103], v[172:175], v[84:87], v[100:103]
    s_waitcnt lgkmcnt(4)
    v_mfma_f32_16x16x32_bf16 v[104:107], v[176:179], v[84:87], v[104:107]
    s_waitcnt lgkmcnt(3)
    v_mfma_f32_16x16x32_bf16 v[108:111], v[180:183], v[84:87], v[108:111]
    s_waitcnt lgkmcnt(2)
    v_mfma_f32_16x16x32_bf16 v[112:115], v[184:187], v[84:87], v[112:115]
    s_waitcnt lgkmcnt(1)
    v_mfma_f32_16x16x32_bf16 v[116:119], v[188:191], v[84:87], v[116:119]
    s_waitcnt lgkmcnt(0)
    v_mfma_f32_16x16x32_bf16 v[120:123], v[192:195], v[84:87], v[120:123]
    s_waitcnt vmcnt(0)
    v_add_f32 v204, v204, v205
    v_add_f32 v204, v204, v206
    v_add_f32 v204, v204, v207
    v_add_f32 v204, v204, v208
    v_add_f32 v204, v204, v209
    v_add_f32 v204, v204, v210
    v_add_f32 v204, v204, v211
    v_add_f32 v204, v204, v212
    v_add_f32 v204, v204, v213
    v_add_f32 v204, v204, v214
    v_add_f32 v204, v204, v215
    v_add_f32 v204, v204, v216
    v_add_f32 v204, v204, v217
    v_add_f32 v204, v204, v218
    v_add_f32 v204, v204, v219
    v_add_f32 v204, v204, v220
    v_add_f32 v204, v204, v221
    v_add_u32 v6, 114688, v6
    ds_write_b32 v6, v204
    v_and_b32 v12, 1, v4
    v_cmp_eq_u32 vcc, 1, v12
    v_mov_b32 v12, 0x42200000
    v_mov_b32 v13, 0x42000000
    v_cndmask_b32 v12, v12, v13, vcc
    v_mov_b32 v8, v196
    v_mov_b32 v11, v197
    v_mul_f32 v11, 0x3ae38e39, v11
    v_cvt_pk_bf16_f32 v10, v8, v11
    v_lshlrev_b32 v8, 16, v10
    v_and_b32 v11, 0xffff0000, v10
    v_add_f32 v11, 0x3727c5ac, v11
    v_cvt_pk_bf16_f32 v10, v11, v11
    v_lshlrev_b32 v11, 16, v10
    v_sqrt_f32 v11, v11
    s_nop 0
    v_cvt_pk_bf16_f32 v10, v11, v11
    v_lshlrev_b32 v11, 16, v10
    v_rcp_f32 v9, v11
    s_waitcnt lgkmcnt(0)
    s_barrier
    v_lshlrev_b32 v6, 4, v4
    v_add_u32 v6, 114688, v6
    ds_read_b128 v[124:127], v6 offset:320
    ds_read_b128 v[128:131], v6 offset:384
    ds_read_b128 v[132:135], v6 offset:448
    ds_read_b128 v[136:139], v6 offset:512
    ds_read_b128 v[140:143], v6 offset:576
    ds_read_b128 v[144:147], v6 offset:640
    ds_read_b128 v[148:151], v6 offset:704
    ds_read_b128 v[152:155], v6 offset:768
    ds_read_b128 v[156:159], v6 offset:832
    s_waitcnt lgkmcnt(8)
    v_fma_f32 v88, -v8, v124, v88
    v_mul_f32 v88, v88, v9
    v_fma_f32 v89, -v8, v125, v89
    v_mul_f32 v89, v89, v9
    v_fma_f32 v90, -v8, v126, v90
    v_mul_f32 v90, v90, v9
    v_fma_f32 v91, -v8, v127, v91
    v_mul_f32 v91, v91, v9
    s_waitcnt lgkmcnt(7)
    v_fma_f32 v92, -v8, v128, v92
    v_mul_f32 v92, v92, v9
    v_fma_f32 v93, -v8, v129, v93
    v_mul_f32 v93, v93, v9
    v_fma_f32 v94, -v8, v130, v94
    v_mul_f32 v94, v94, v9
    v_fma_f32 v95, -v8, v131, v95
    v_mul_f32 v95, v95, v9
    s_waitcnt lgkmcnt(6)
    v_fma_f32 v96, -v8, v132, v96
    v_mul_f32 v96, v96, v9
    v_fma_f32 v97, -v8, v133, v97
    v_mul_f32 v97, v97, v9
    v_fma_f32 v98, -v8, v134, v98
    v_mul_f32 v98, v98, v9
    v_fma_f32 v99, -v8, v135, v99
    v_mul_f32 v99, v99, v9
    s_waitcnt lgkmcnt(5)
    v_fma_f32 v100, -v8, v136, v100
    v_mul_f32 v100, v100, v9
    v_fma_f32 v101, -v8, v137, v101
    v_mul_f32 v101, v101, v9
    v_fma_f32 v102, -v8, v138, v102
    v_mul_f32 v102, v102, v9
    v_fma_f32 v103, -v8, v139, v103
    v_mul_f32 v103, v103, v9
    s_waitcnt lgkmcnt(4)
    v_fma_f32 v104, -v8, v140, v104
    v_mul_f32 v104, v104, v9
    v_fma_f32 v105, -v8, v141, v105
    v_mul_f32 v105, v105, v9
    v_fma_f32 v106, -v8, v142, v106
    v_mul_f32 v106, v106, v9
    v_fma_f32 v107, -v8, v143, v107
    v_mul_f32 v107, v107, v9
    s_waitcnt lgkmcnt(3)
    v_fma_f32 v108, -v8, v144, v108
    v_mul_f32 v108, v108, v9
    v_fma_f32 v109, -v8, v145, v109
    v_mul_f32 v109, v109, v9
    v_fma_f32 v110, -v8, v146, v110
    v_mul_f32 v110, v110, v9
    v_fma_f32 v111, -v8, v147, v111
    v_mul_f32 v111, v111, v9
    s_waitcnt lgkmcnt(2)
    v_fma_f32 v112, -v8, v148, v112
    v_mul_f32 v112, v112, v9
    v_fma_f32 v113, -v8, v149, v113
    v_mul_f32 v113, v113, v9
    v_fma_f32 v114, -v8, v150, v114
    v_mul_f32 v114, v114, v9
    v_fma_f32 v115, -v8, v151, v115
    v_mul_f32 v115, v115, v9
    s_waitcnt lgkmcnt(1)
    v_fma_f32 v116, -v8, v152, v116
    v_mul_f32 v116, v116, v9
    v_fma_f32 v117, -v8, v153, v117
    v_mul_f32 v117, v117, v9
    v_fma_f32 v118, -v8, v154, v118
    v_mul_f32 v118, v118, v9
    v_fma_f32 v119, -v8, v155, v119
    v_mul_f32 v119, v119, v9
    s_waitcnt lgkmcnt(0)
    v_fma_f32 v120, -v8, v156, v120
    v_mul_f32 v120, v120, v9
    v_fma_f32 v121, -v8, v157, v121
    v_mul_f32 v121, v121, v9
    v_fma_f32 v122, -v8, v158, v122
    v_mul_f32 v122, v122, v9
    v_fma_f32 v123, -v8, v159, v123
    v_mul_f32 v123, v123, v9
    v_cvt_pk_bf16_f32 v10, v88, v89
    v_lshlrev_b32 v88, 16, v10
    v_and_b32 v89, 0xffff0000, v10
    v_cvt_pk_bf16_f32 v10, v90, v91
    v_lshlrev_b32 v90, 16, v10
    v_and_b32 v91, 0xffff0000, v10
    v_cvt_pk_bf16_f32 v10, v92, v93
    v_lshlrev_b32 v92, 16, v10
    v_and_b32 v93, 0xffff0000, v10
    v_cvt_pk_bf16_f32 v10, v94, v95
    v_lshlrev_b32 v94, 16, v10
    v_and_b32 v95, 0xffff0000, v10
    v_cvt_pk_bf16_f32 v10, v96, v97
    v_lshlrev_b32 v96, 16, v10
    v_and_b32 v97, 0xffff0000, v10
    v_cvt_pk_bf16_f32 v10, v98, v99
    v_lshlrev_b32 v98, 16, v10
    v_and_b32 v99, 0xffff0000, v10
    v_cvt_pk_bf16_f32 v10, v100, v101
    v_lshlrev_b32 v100, 16, v10
    v_and_b32 v101, 0xffff0000, v10
    v_cvt_pk_bf16_f32 v10, v102, v103
    v_lshlrev_b32 v102, 16, v10
    v_and_b32 v103, 0xffff0000, v10
    v_cvt_pk_bf16_f32 v10, v104, v105
    v_lshlrev_b32 v104, 16, v10
    v_and_b32 v105, 0xffff0000, v10
    v_cvt_pk_bf16_f32 v10, v106, v107
    v_lshlrev_b32 v106, 16, v10
    v_and_b32 v107, 0xffff0000, v10
    v_cvt_pk_bf16_f32 v10, v108, v109
    v_lshlrev_b32 v108, 16, v10
    v_and_b32 v109, 0xffff0000, v10
    v_cvt_pk_bf16_f32 v10, v110, v111
    v_lshlrev_b32 v110, 16, v10
    v_and_b32 v111, 0xffff0000, v10
    v_cvt_pk_bf16_f32 v10, v112, v113
    v_lshlrev_b32 v112, 16, v10
    v_and_b32 v113, 0xffff0000, v10
    v_cvt_pk_bf16_f32 v10, v114, v115
    v_lshlrev_b32 v114, 16, v10
    v_and_b32 v115, 0xffff0000, v10
    v_cvt_pk_bf16_f32 v10, v116, v117
    v_lshlrev_b32 v116, 16, v10
    v_and_b32 v117, 0xffff0000, v10
    v_cvt_pk_bf16_f32 v10, v118, v119
    v_lshlrev_b32 v118, 16, v10
    v_and_b32 v119, 0xffff0000, v10
    v_cvt_pk_bf16_f32 v10, v120, v121
    v_lshlrev_b32 v120, 16, v10
    v_and_b32 v121, 0xffff0000, v10
    v_cvt_pk_bf16_f32 v10, v122, v123
    v_lshlrev_b32 v122, 16, v10
    v_and_b32 v123, 0xffff0000, v10
    v_max3_f32 v58, v88, v89, v90
    v_min3_f32 v59, v88, v89, v90
    v_max3_f32 v58, v58, v91, v92
    v_min3_f32 v59, v59, v91, v92
    v_max3_f32 v58, v58, v93, v94
    v_min3_f32 v59, v59, v93, v94
    v_max3_f32 v58, v58, v95, v96
    v_min3_f32 v59, v59, v95, v96
    v_max3_f32 v58, v58, v97, v98
    v_min3_f32 v59, v59, v97, v98
    v_max3_f32 v58, v58, v99, v100
    v_min3_f32 v59, v59, v99, v100
    v_max3_f32 v58, v58, v101, v102
    v_min3_f32 v59, v59, v101, v102
    v_max3_f32 v58, v58, v103, v104
    v_min3_f32 v59, v59, v103, v104
    v_max_f32 v58, v58, v105
    v_min_f32 v59, v59, v105
    v_mov_b32 v62, 0x3fb8aa3b
    v_sub_f32 v40, v88, v58
    v_mul_f32 v40, v40, v62
    v_sub_f32 v41, v89, v58
    v_mul_f32 v41, v41, v62
    v_sub_f32 v42, v90, v58
    v_mul_f32 v42, v42, v62
    v_sub_f32 v43, v91, v58
    v_mul_f32 v43, v43, v62
    v_sub_f32 v44, v92, v58
    v_mul_f32 v44, v44, v62
    v_sub_f32 v45, v93, v58
    v_mul_f32 v45, v45, v62
    v_sub_f32 v46, v94, v58
    v_mul_f32 v46, v46, v62
    v_sub_f32 v47, v95, v58
    v_mul_f32 v47, v47, v62
    v_sub_f32 v48, v96, v58
    v_mul_f32 v48, v48, v62
    v_sub_f32 v49, v97, v58
    v_mul_f32 v49, v49, v62
    v_sub_f32 v50, v98, v58
    v_mul_f32 v50, v50, v62
    v_sub_f32 v51, v99, v58
    v_mul_f32 v51, v51, v62
    v_sub_f32 v52, v100, v58
    v_mul_f32 v52, v52, v62
    v_sub_f32 v53, v101, v58
    v_mul_f32 v53, v53, v62
    v_sub_f32 v54, v102, v58
    v_mul_f32 v54, v54, v62
    v_sub_f32 v55, v103, v58
    v_mul_f32 v55, v55, v62
    v_sub_f32 v56, v104, v58
    v_mul_f32 v56, v56, v62
    v_sub_f32 v57, v105, v58
    v_mul_f32 v57, v57, v62
    v_exp_f32 v40, v40
    v_exp_f32 v41, v41
    v_exp_f32 v42, v42
    v_exp_f32 v43, v43
    v_exp_f32 v44, v44
    v_exp_f32 v45, v45
    v_exp_f32 v46, v46
    v_exp_f32 v47, v47
    v_exp_f32 v48, v48
    v_exp_f32 v49, v49
    v_exp_f32 v50, v50
    v_exp_f32 v51, v51
    v_exp_f32 v52, v52
    v_exp_f32 v53, v53
    v_exp_f32 v54, v54
    v_exp_f32 v55, v55
    v_exp_f32 v56, v56
    v_exp_f32 v57, v57
    v_add_f32 v60, v40, v41
    v_add_f32 v60, v60, v42
    v_add_f32 v60, v60, v43
    v_add_f32 v60, v60, v44
    v_add_f32 v60, v60, v45
    v_add_f32 v60, v60, v46
    v_add_f32 v60, v60, v47
    v_add_f32 v60, v60, v48
    v_add_f32 v60, v60, v49
    v_add_f32 v60, v60, v50
    v_add_f32 v60, v60, v51
    v_add_f32 v60, v60, v52
    v_add_f32 v60, v60, v53
    v_add_f32 v60, v60, v54
    v_add_f32 v60, v60, v55
    v_add_f32 v60, v60, v56
    v_add_f32 v60, v60, v57
    v_rcp_f32 v61, v60
    s_nop 0
    v_mul_f32 v40, v40, v61
    v_mul_f32 v41, v41, v61
    v_mul_f32 v42, v42, v61
    v_mul_f32 v43, v43, v61
    v_mul_f32 v44, v44, v61
    v_mul_f32 v45, v45, v61
    v_mul_f32 v46, v46, v61
    v_mul_f32 v47, v47, v61
    v_mul_f32 v48, v48, v61
    v_mul_f32 v49, v49, v61
    v_mul_f32 v50, v50, v61
    v_mul_f32 v51, v51, v61
    v_mul_f32 v52, v52, v61
    v_mul_f32 v53, v53, v61
    v_mul_f32 v54, v54, v61
    v_mul_f32 v55, v55, v61
    v_mul_f32 v56, v56, v61
    v_mul_f32 v57, v57, v61
    v_cvt_pk_bf16_f32 v64, v40, v41
    v_cvt_pk_bf16_f32 v65, v42, v43
    v_cvt_pk_bf16_f32 v66, v44, v45
    v_cvt_pk_bf16_f32 v67, v46, v47
    v_cvt_pk_bf16_f32 v68, v48, v49
    v_cvt_pk_bf16_f32 v69, v50, v51
    v_cvt_pk_bf16_f32 v70, v52, v53
    v_cvt_pk_bf16_f32 v71, v54, v55
    v_cvt_pk_bf16_f32 v72, v56, v57
    v_sub_f32 v40, v59, v88
    v_mul_f32 v40, v40, v62
    v_sub_f32 v41, v59, v89
    v_mul_f32 v41, v41, v62
    v_sub_f32 v42, v59, v90
    v_mul_f32 v42, v42, v62
    v_sub_f32 v43, v59, v91
    v_mul_f32 v43, v43, v62
    v_sub_f32 v44, v59, v92
    v_mul_f32 v44, v44, v62
    v_sub_f32 v45, v59, v93
    v_mul_f32 v45, v45, v62
    v_sub_f32 v46, v59, v94
    v_mul_f32 v46, v46, v62
    v_sub_f32 v47, v59, v95
    v_mul_f32 v47, v47, v62
    v_sub_f32 v48, v59, v96
    v_mul_f32 v48, v48, v62
    v_sub_f32 v49, v59, v97
    v_mul_f32 v49, v49, v62
    v_sub_f32 v50, v59, v98
    v_mul_f32 v50, v50, v62
    v_sub_f32 v51, v59, v99
    v_mul_f32 v51, v51, v62
    v_sub_f32 v52, v59, v100
    v_mul_f32 v52, v52, v62
    v_sub_f32 v53, v59, v101
    v_mul_f32 v53, v53, v62
    v_sub_f32 v54, v59, v102
    v_mul_f32 v54, v54, v62
    v_sub_f32 v55, v59, v103
    v_mul_f32 v55, v55, v62
    v_sub_f32 v56, v59, v104
    v_mul_f32 v56, v56, v62
    v_sub_f32 v57, v59, v105
    v_mul_f32 v57, v57, v62
    v_exp_f32 v40, v40
    v_exp_f32 v41, v41
    v_exp_f32 v42, v42
    v_exp_f32 v43, v43
    v_exp_f32 v44, v44
    v_exp_f32 v45, v45
    v_exp_f32 v46, v46
    v_exp_f32 v47, v47
    v_exp_f32 v48, v48
    v_exp_f32 v49, v49
    v_exp_f32 v50, v50
    v_exp_f32 v51, v51
    v_exp_f32 v52, v52
    v_exp_f32 v53, v53
    v_exp_f32 v54, v54
    v_exp_f32 v55, v55
    v_exp_f32 v56, v56
    v_exp_f32 v57, v57
    v_add_f32 v60, v40, v41
    v_add_f32 v60, v60, v42
    v_add_f32 v60, v60, v43
    v_add_f32 v60, v60, v44
    v_add_f32 v60, v60, v45
    v_add_f32 v60, v60, v46
    v_add_f32 v60, v60, v47
    v_add_f32 v60, v60, v48
    v_add_f32 v60, v60, v49
    v_add_f32 v60, v60, v50
    v_add_f32 v60, v60, v51
    v_add_f32 v60, v60, v52
    v_add_f32 v60, v60, v53
    v_add_f32 v60, v60, v54
    v_add_f32 v60, v60, v55
    v_add_f32 v60, v60, v56
    v_add_f32 v60, v60, v57
    v_rcp_f32 v61, v60
    s_nop 0
    v_mul_f32 v40, v40, v61
    v_mul_f32 v41, v41, v61
    v_mul_f32 v42, v42, v61
    v_mul_f32 v43, v43, v61
    v_mul_f32 v44, v44, v61
    v_mul_f32 v45, v45, v61
    v_mul_f32 v46, v46, v61
    v_mul_f32 v47, v47, v61
    v_mul_f32 v48, v48, v61
    v_mul_f32 v49, v49, v61
    v_mul_f32 v50, v50, v61
    v_mul_f32 v51, v51, v61
    v_mul_f32 v52, v52, v61
    v_mul_f32 v53, v53, v61
    v_mul_f32 v54, v54, v61
    v_mul_f32 v55, v55, v61
    v_mul_f32 v56, v56, v61
    v_mul_f32 v57, v57, v61
    v_cvt_pk_bf16_f32 v73, v40, v41
    v_cvt_pk_bf16_f32 v74, v42, v43
    v_cvt_pk_bf16_f32 v75, v44, v45
    v_cvt_pk_bf16_f32 v76, v46, v47
    v_cvt_pk_bf16_f32 v77, v48, v49
    v_cvt_pk_bf16_f32 v78, v50, v51
    v_cvt_pk_bf16_f32 v79, v52, v53
    v_cvt_pk_bf16_f32 v80, v54, v55
    v_cvt_pk_bf16_f32 v81, v56, v57
    v_cvt_pk_bf16_f32 v16, v106, v107
    v_cvt_pk_bf16_f32 v17, v108, v109
    v_cvt_pk_bf16_f32 v18, v110, v111
    v_cvt_pk_bf16_f32 v19, v112, v113
    v_cvt_pk_bf16_f32 v20, v114, v115
    v_cvt_pk_bf16_f32 v21, v116, v117
    v_cvt_pk_bf16_f32 v22, v118, v119
    v_cvt_pk_bf16_f32 v23, v120, v121
    v_cvt_pk_bf16_f32 v24, v122, v123
    v_mul_u32_u24 v6, 11520, v4
    v_lshl_add_u32 v6, v3, 1, v6
    s_lshl_b32 s45, s51, 5
    v_add_u32 v6, s45, v6
    ds_write_b16 v6, v64 offset:0
    ds_write_b16_d16_hi v6, v64 offset:144
    ds_write_b16 v6, v65 offset:288
    ds_write_b16_d16_hi v6, v65 offset:432
    ds_write_b16 v6, v66 offset:576
    ds_write_b16_d16_hi v6, v66 offset:720
    ds_write_b16 v6, v67 offset:864
    ds_write_b16_d16_hi v6, v67 offset:1008
    ds_write_b16 v6, v68 offset:1152
    ds_write_b16_d16_hi v6, v68 offset:1296
    ds_write_b16 v6, v69 offset:1440
    ds_write_b16_d16_hi v6, v69 offset:1584
    ds_write_b16 v6, v70 offset:1728
    ds_write_b16_d16_hi v6, v70 offset:1872
    ds_write_b16 v6, v71 offset:2016
    ds_write_b16_d16_hi v6, v71 offset:2160
    ds_write_b16 v6, v72 offset:2304
    ds_write_b16_d16_hi v6, v72 offset:2448
    ds_write_b16 v6, v73 offset:2592
    ds_write_b16_d16_hi v6, v73 offset:2736
    ds_write_b16 v6, v74 offset:2880
    ds_write_b16_d16_hi v6, v74 offset:3024
    ds_write_b16 v6, v75 offset:3168
    ds_write_b16_d16_hi v6, v75 offset:3312
    ds_write_b16 v6, v76 offset:3456
    ds_write_b16_d16_hi v6, v76 offset:3600
    ds_write_b16 v6, v77 offset:3744
    ds_write_b16_d16_hi v6, v77 offset:3888
    ds_write_b16 v6, v78 offset:4032
    ds_write_b16_d16_hi v6, v78 offset:4176
    ds_write_b16 v6, v79 offset:4320
    ds_write_b16_d16_hi v6, v79 offset:4464
    ds_write_b16 v6, v80 offset:4608
    ds_write_b16_d16_hi v6, v80 offset:4752
    ds_write_b16 v6, v81 offset:4896
    ds_write_b16_d16_hi v6, v81 offset:5040
    ds_write_b16 v6, v16 offset:6912
    ds_write_b16_d16_hi v6, v16 offset:7056
    ds_write_b16 v6, v17 offset:7200
    ds_write_b16_d16_hi v6, v17 offset:7344
    ds_write_b16 v6, v18 offset:7488
    ds_write_b16_d16_hi v6, v18 offset:7632
    ds_write_b16 v6, v19 offset:7776
    ds_write_b16_d16_hi v6, v19 offset:7920
    ds_write_b16 v6, v20 offset:8064
    ds_write_b16_d16_hi v6, v20 offset:8208
    ds_write_b16 v6, v21 offset:8352
    ds_write_b16_d16_hi v6, v21 offset:8496
    ds_write_b16 v6, v22 offset:8640
    ds_write_b16_d16_hi v6, v22 offset:8784
    ds_write_b16 v6, v23 offset:8928
    ds_write_b16_d16_hi v6, v23 offset:9072
    ds_write_b16 v6, v24 offset:9216
    ds_write_b16_d16_hi v6, v24 offset:9360
    s_waitcnt lgkmcnt(0)
    s_barrier
.maindone_k1l0_kernel_3:
.End_k1l0_kernel_1:
    s_endpgm
.globl k2l0_kernel
.p2align 8
.type k2l0_kernel,@function
k2l0_kernel:
    s_cmp_ge_u32 s2, 256
    s_cbranch_scc1 .End_k2l0_kernel_1
    s_load_dwordx2 s[4:5], s[0:1], 88
    v_and_b32 v1, 63, v0
    v_lshrrev_b32 v2, 6, v0
    s_nop 0
    v_readfirstlane_b32 s3, v2
    v_and_b32 v3, 15, v1
    v_lshrrev_b32 v4, 4, v1
    v_lshlrev_b32 v5, 4, v1
    s_lshr_b32 s34, s2, 3
    s_and_b32 s32, s34, 3
    s_lshr_b32 s34, s34, 2
    s_and_b32 s33, s2, 7
    s_lshl_b32 s33, s33, 3
    s_add_u32 s33, s33, s34
    s_waitcnt lgkmcnt(0)
    s_add_u32 s8, s4, 0x400000
    s_addc_u32 s9, s5, 0
    s_and_b32 s9, s9, 0xffff
    s_mov_b32 s10, 0xd8000
    s_mov_b32 s11, 0x20000
    s_add_u32 s12, s4, 0x1800000
    s_addc_u32 s13, s5, 0
    s_and_b32 s13, s13, 0xffff
    s_mov_b32 s14, 0x240000
    s_mov_b32 s15, 0x20000
    s_add_u32 s16, s4, 0x1a80000
    s_addc_u32 s17, s5, 0
    s_and_b32 s17, s17, 0xffff
    s_mov_b32 s18, 0x240000
    s_mov_b32 s19, 0x20000
    s_add_u32 s20, s4, 0x2240000
    s_addc_u32 s21, s5, 0
    s_and_b32 s21, s21, 0xffff
    s_mov_b32 s22, 0x40000
    s_mov_b32 s23, 0x20000
    s_add_u32 s24, s4, 0x2400000
    s_addc_u32 s25, s5, 0
    s_and_b32 s25, s25, 0xffff
    s_mov_b32 s26, 0x480000
    s_mov_b32 s27, 0x20000
    s_add_u32 s28, s4, 0x2300000
    s_addc_u32 s29, s5, 0
    s_and_b32 s29, s29, 0xffff
    s_mov_b32 s30, 0x28000
    s_mov_b32 s31, 0x20000
    v_mov_b32 v11, 0x7ff00000
    v_lshlrev_b32 v6, 8, v4
    v_lshl_add_u32 v6, v3, 4, v6
    v_cmp_gt_u32 s[56:57], 10, v3
    s_nop 1
    v_cndmask_b32 v6, v11, v6, s[56:57]
    s_mul_i32 s53, s3, 3840
    v_mul_u32_u24 v7, 96, v4
    v_lshl_add_u32 v7, v3, 3, v7
    v_add_u32 v7, s53, v7
    v_mul_u32_u24 v12, 96, v3
    v_lshl_add_u32 v12, v4, 4, v12
    v_add_u32 v12, s53, v12
    v_mov_b32 v13, 19
    v_and_b32 v8, 3, v3
    v_cmp_eq_u32 vcc, 2, v8
    s_nop 1
    v_cndmask_b32 v13, v13, 18, vcc
    v_add_u32 v8, 16, v3
    v_cmp_gt_u32 vcc, 2, v3
    s_nop 1
    v_cndmask_b32 v13, v13, v8, vcc
    v_mul_u32_u24 v13, 96, v13
    v_lshl_add_u32 v13, v4, 4, v13
    v_add_u32 v13, s53, v13
    v_cmp_eq_u32 s[54:55], 0, v4
    v_lshlrev_b32 v8, 3, v3
    s_nop 0
    v_cndmask_b32 v8, v11, v8, s[54:55]
    s_lshl_b32 s34, s33, 6
    s_lshl_b32 s35, s3, 2
    s_add_u32 s34, s34, s35
    s_lshl_b32 s35, s34, 7
    s_add_u32 s35, s35, 4194304
    s_lshl_b32 s34, s34, 10
    s_mul_i32 s36, s3, 20480
    s_add_u32 s37, s36, 0
    buffer_load_dwordx4 v[124:127], v6, s[28:31], s37 offen offset:0
    buffer_load_dwordx4 v[128:131], v6, s[28:31], s37 offen offset:1024
    buffer_load_dwordx4 v[132:135], v6, s[28:31], s37 offen offset:2048
    buffer_load_dwordx4 v[136:139], v6, s[28:31], s37 offen offset:3072
    s_add_u32 s37, s37, 4096
    buffer_load_dwordx4 v[140:143], v6, s[28:31], s37 offen offset:0
    s_add_u32 s38, s34, 0
    buffer_load_dwordx4 v[144:147], v5, s[24:27], s38 offen
    s_add_u32 s38, s35, 0
    buffer_load_dwordx2 v[152:153], v8, s[24:27], s38 offen
    s_add_u32 s38, s34, 32768
    buffer_load_dwordx4 v[148:151], v5, s[24:27], s38 offen
    s_add_u32 s38, s35, 4096
    buffer_load_dwordx2 v[154:155], v8, s[24:27], s38 offen
    s_add_u32 s37, s36, 5120
    buffer_load_dwordx4 v[156:159], v6, s[28:31], s37 offen offset:0
    buffer_load_dwordx4 v[160:163], v6, s[28:31], s37 offen offset:1024
    buffer_load_dwordx4 v[164:167], v6, s[28:31], s37 offen offset:2048
    buffer_load_dwordx4 v[168:171], v6, s[28:31], s37 offen offset:3072
    s_add_u32 s37, s37, 4096
    buffer_load_dwordx4 v[172:175], v6, s[28:31], s37 offen offset:0
    s_add_u32 s38, s34, 1024
    buffer_load_dwordx4 v[176:179], v5, s[24:27], s38 offen
    s_add_u32 s38, s35, 128
    buffer_load_dwordx2 v[184:185], v8, s[24:27], s38 offen
    s_add_u32 s38, s34, 33792
    buffer_load_dwordx4 v[180:183], v5, s[24:27], s38 offen
    s_add_u32 s38, s35, 4224
    buffer_load_dwordx2 v[186:187], v8, s[24:27], s38 offen
    s_add_u32 s37, s36, 10240
    buffer_load_dwordx4 v[60:63], v6, s[28:31], s37 offen offset:0
    buffer_load_dwordx4 v[64:67], v6, s[28:31], s37 offen offset:1024
    buffer_load_dwordx4 v[68:71], v6, s[28:31], s37 offen offset:2048
    buffer_load_dwordx4 v[72:75], v6, s[28:31], s37 offen offset:3072
    s_add_u32 s37, s37, 4096
    buffer_load_dwordx4 v[76:79], v6, s[28:31], s37 offen offset:0
    s_add_u32 s38, s34, 2048
    buffer_load_dwordx4 v[80:83], v5, s[24:27], s38 offen
    s_add_u32 s38, s35, 256
    buffer_load_dwordx2 v[88:89], v8, s[24:27], s38 offen
    s_add_u32 s38, s34, 34816
    buffer_load_dwordx4 v[84:87], v5, s[24:27], s38 offen
    s_add_u32 s38, s35, 4352
    buffer_load_dwordx2 v[90:91], v8, s[24:27], s38 offen
    s_add_u32 s37, s36, 15360
    buffer_load_dwordx4 v[92:95], v6, s[28:31], s37 offen offset:0
    buffer_load_dwordx4 v[96:99], v6, s[28:31], s37 offen offset:1024
    buffer_load_dwordx4 v[100:103], v6, s[28:31], s37 offen offset:2048
    buffer_load_dwordx4 v[104:107], v6, s[28:31], s37 offen offset:3072
    s_add_u32 s37, s37, 4096
    buffer_load_dwordx4 v[108:111], v6, s[28:31], s37 offen offset:0
    s_add_u32 s38, s34, 3072
    buffer_load_dwordx4 v[112:115], v5, s[24:27], s38 offen
    s_add_u32 s38, s35, 384
    buffer_load_dwordx2 v[120:121], v8, s[24:27], s38 offen
    s_add_u32 s38, s34, 35840
    buffer_load_dwordx4 v[116:119], v5, s[24:27], s38 offen
    s_add_u32 s38, s35, 4480
    buffer_load_dwordx2 v[122:123], v8, s[24:27], s38 offen
    s_lshl_b32 s39, s32, 3
    s_add_u32 s39, s39, s3
    s_mul_i32 s39, s39, 27648
    s_add_u32 s40, s39, 0
    buffer_load_dwordx4 v[16:19], v5, s[8:11], s40 offen
    s_add_u32 s40, s39, 1024
    buffer_load_dwordx4 v[20:23], v5, s[8:11], s40 offen
    s_add_u32 s40, s39, 2048
    buffer_load_dwordx4 v[24:27], v5, s[8:11], s40 offen
    s_add_u32 s40, s39, 3072
    buffer_load_dwordx4 v[28:31], v5, s[8:11], s40 offen
    s_add_u32 s40, s39, 4096
    buffer_load_dwordx4 v[32:35], v5, s[8:11], s40 offen
    s_add_u32 s40, s39, 5120
    buffer_load_dwordx4 v[36:39], v5, s[8:11], s40 offen
    s_add_u32 s40, s39, 6144
    buffer_load_dwordx4 v[40:43], v5, s[8:11], s40 offen
    s_add_u32 s40, s39, 7168
    buffer_load_dwordx4 v[44:47], v5, s[8:11], s40 offen
    s_add_u32 s40, s39, 8192
    buffer_load_dwordx4 v[48:51], v5, s[8:11], s40 offen
    s_add_u32 s40, s39, 9216
    buffer_load_dwordx4 v[52:55], v5, s[8:11], s40 offen
    s_add_u32 s40, s39, 10240
    buffer_load_dwordx4 v[56:59], v5, s[8:11], s40 offen
    v_mov_b32 v10, 0x358637bd
    v_mov_b32 v254, 0
    v_mov_b32 v255, 0
    v_mov_b32 v9, 0
    s_waitcnt vmcnt(38)
    v_cvt_pk_bf16_f32 v124, v124, v125
    v_cvt_pk_bf16_f32 v125, v126, v127
    v_cvt_pk_bf16_f32 v128, v128, v129
    v_cvt_pk_bf16_f32 v129, v130, v131
    v_cvt_pk_bf16_f32 v132, v132, v133
    v_cvt_pk_bf16_f32 v133, v134, v135
    v_cvt_pk_bf16_f32 v136, v136, v137
    v_cvt_pk_bf16_f32 v137, v138, v139
    v_cvt_pk_bf16_f32 v140, v140, v141
    v_cvt_pk_bf16_f32 v141, v142, v143
    s_mov_b64 exec, s[56:57]
    ds_write_b64 v7, v[124:125] offset:0
    ds_write_b64 v7, v[128:129] offset:384
    ds_write_b64 v7, v[132:133] offset:768
    ds_write_b64 v7, v[136:137] offset:1152
    ds_write_b64 v7, v[140:141] offset:1536
    s_mov_b64 exec, -1
    ds_read_b128 v[236:239], v12 offset:0
    ds_read_b128 v[240:243], v12 offset:64
    ds_read_b128 v[244:247], v13 offset:0
    ds_read_b128 v[248:251], v13 offset:64
    s_waitcnt lgkmcnt(0)
    v_cndmask_b32 v240, v9, v240, s[54:55]
    v_cndmask_b32 v248, v9, v248, s[54:55]
    v_cndmask_b32 v241, v9, v241, s[54:55]
    v_cndmask_b32 v249, v9, v249, s[54:55]
    v_cndmask_b32 v242, v9, v242, s[54:55]
    v_cndmask_b32 v250, v9, v250, s[54:55]
    v_cndmask_b32 v243, v9, v243, s[54:55]
    v_cndmask_b32 v251, v9, v251, s[54:55]
    v_mov_b32 v252, v152
    v_mov_b32 v253, v153
    v_mfma_f32_16x16x32_bf16 v[220:223], v[236:239], v[144:147], 0
    s_nop 0
    v_mfma_f32_16x16x32_bf16 v[220:223], v[240:243], v[252:255], v[220:223]
    v_mfma_f32_16x16x32_bf16 v[224:227], v[244:247], v[144:147], 0
    v_mfma_f32_16x16x32_bf16 v[224:227], v[248:251], v[252:255], v[224:227]
    v_mov_b32 v252, v154
    v_mov_b32 v253, v155
    v_mfma_f32_16x16x32_bf16 v[228:231], v[236:239], v[148:151], 0
    s_nop 0
    v_mfma_f32_16x16x32_bf16 v[228:231], v[240:243], v[252:255], v[228:231]
    v_mfma_f32_16x16x32_bf16 v[232:235], v[244:247], v[148:151], 0
    v_mfma_f32_16x16x32_bf16 v[232:235], v[248:251], v[252:255], v[232:235]
    v_cvt_pk_bf16_f32 v11, v220, v221
    v_lshlrev_b32 v220, 16, v11
    v_and_b32 v221, 0xffff0000, v11
    v_cvt_pk_bf16_f32 v11, v222, v223
    v_lshlrev_b32 v222, 16, v11
    v_and_b32 v223, 0xffff0000, v11
    v_cvt_pk_bf16_f32 v11, v224, v225
    v_lshlrev_b32 v224, 16, v11
    v_and_b32 v225, 0xffff0000, v11
    v_cvt_pk_bf16_f32 v11, v226, v226
    v_lshlrev_b32 v226, 16, v11
    v_add_f32 v226, v226, v10
    v_cvt_pk_bf16_f32 v11, v226, v226
    v_lshlrev_b32 v226, 16, v11
    v_rcp_f32 v226, v226
    s_nop 0
    v_mul_f32 v220, v220, v226
    v_mul_f32 v221, v221, v226
    v_mul_f32 v222, v222, v226
    v_mul_f32 v223, v223, v226
    v_mul_f32 v224, v224, v226
    v_mul_f32 v225, v225, v226
    v_cvt_pk_bf16_f32 v196, v220, v221
    v_cvt_pk_bf16_f32 v197, v222, v223
    v_cvt_pk_bf16_f32 v198, v224, v225
    v_cvt_pk_bf16_f32 v11, v228, v229
    v_lshlrev_b32 v228, 16, v11
    v_and_b32 v229, 0xffff0000, v11
    v_cvt_pk_bf16_f32 v11, v230, v231
    v_lshlrev_b32 v230, 16, v11
    v_and_b32 v231, 0xffff0000, v11
    v_cvt_pk_bf16_f32 v11, v232, v233
    v_lshlrev_b32 v232, 16, v11
    v_and_b32 v233, 0xffff0000, v11
    v_cvt_pk_bf16_f32 v11, v234, v234
    v_lshlrev_b32 v234, 16, v11
    v_add_f32 v234, v234, v10
    v_cvt_pk_bf16_f32 v11, v234, v234
    v_lshlrev_b32 v234, 16, v11
    v_rcp_f32 v234, v234
    s_nop 0
    v_mul_f32 v228, v228, v234
    v_mul_f32 v229, v229, v234
    v_mul_f32 v230, v230, v234
    v_mul_f32 v231, v231, v234
    v_mul_f32 v232, v232, v234
    v_mul_f32 v233, v233, v234
    v_cvt_pk_bf16_f32 v208, v228, v229
    v_cvt_pk_bf16_f32 v209, v230, v231
    v_cvt_pk_bf16_f32 v210, v232, v233
    s_waitcnt vmcnt(29)
    v_cvt_pk_bf16_f32 v156, v156, v157
    v_cvt_pk_bf16_f32 v157, v158, v159
    v_cvt_pk_bf16_f32 v160, v160, v161
    v_cvt_pk_bf16_f32 v161, v162, v163
    v_cvt_pk_bf16_f32 v164, v164, v165
    v_cvt_pk_bf16_f32 v165, v166, v167
    v_cvt_pk_bf16_f32 v168, v168, v169
    v_cvt_pk_bf16_f32 v169, v170, v171
    v_cvt_pk_bf16_f32 v172, v172, v173
    v_cvt_pk_bf16_f32 v173, v174, v175
    s_mov_b64 exec, s[56:57]
    ds_write_b64 v7, v[156:157] offset:1920
    ds_write_b64 v7, v[160:161] offset:2304
    ds_write_b64 v7, v[164:165] offset:2688
    ds_write_b64 v7, v[168:169] offset:3072
    ds_write_b64 v7, v[172:173] offset:3456
    s_mov_b64 exec, -1
    ds_read_b128 v[236:239], v12 offset:1920
    ds_read_b128 v[240:243], v12 offset:1984
    ds_read_b128 v[244:247], v13 offset:1920
    ds_read_b128 v[248:251], v13 offset:1984
    s_waitcnt lgkmcnt(0)
    v_cndmask_b32 v240, v9, v240, s[54:55]
    v_cndmask_b32 v248, v9, v248, s[54:55]
    v_cndmask_b32 v241, v9, v241, s[54:55]
    v_cndmask_b32 v249, v9, v249, s[54:55]
    v_cndmask_b32 v242, v9, v242, s[54:55]
    v_cndmask_b32 v250, v9, v250, s[54:55]
    v_cndmask_b32 v243, v9, v243, s[54:55]
    v_cndmask_b32 v251, v9, v251, s[54:55]
    v_mov_b32 v252, v184
    v_mov_b32 v253, v185
    v_mfma_f32_16x16x32_bf16 v[220:223], v[236:239], v[176:179], 0
    s_nop 0
    v_mfma_f32_16x16x32_bf16 v[220:223], v[240:243], v[252:255], v[220:223]
    v_mfma_f32_16x16x32_bf16 v[224:227], v[244:247], v[176:179], 0
    v_mfma_f32_16x16x32_bf16 v[224:227], v[248:251], v[252:255], v[224:227]
    v_mov_b32 v252, v186
    v_mov_b32 v253, v187
    v_mfma_f32_16x16x32_bf16 v[228:231], v[236:239], v[180:183], 0
    s_nop 0
    v_mfma_f32_16x16x32_bf16 v[228:231], v[240:243], v[252:255], v[228:231]
    v_mfma_f32_16x16x32_bf16 v[232:235], v[244:247], v[180:183], 0
    v_mfma_f32_16x16x32_bf16 v[232:235], v[248:251], v[252:255], v[232:235]
    v_cvt_pk_bf16_f32 v11, v220, v221
    v_lshlrev_b32 v220, 16, v11
    v_and_b32 v221, 0xffff0000, v11
    v_cvt_pk_bf16_f32 v11, v222, v223
    v_lshlrev_b32 v222, 16, v11
    v_and_b32 v223, 0xffff0000, v11
    v_cvt_pk_bf16_f32 v11, v224, v225
    v_lshlrev_b32 v224, 16, v11
    v_and_b32 v225, 0xffff0000, v11
    v_cvt_pk_bf16_f32 v11, v226, v226
    v_lshlrev_b32 v226, 16, v11
    v_add_f32 v226, v226, v10
    v_cvt_pk_bf16_f32 v11, v226, v226
    v_lshlrev_b32 v226, 16, v11
    v_rcp_f32 v226, v226
    s_nop 0
    v_mul_f32 v220, v220, v226
    v_mul_f32 v221, v221, v226
    v_mul_f32 v222, v222, v226
    v_mul_f32 v223, v223, v226
    v_mul_f32 v224, v224, v226
    v_mul_f32 v225, v225, v226
    v_cvt_pk_bf16_f32 v199, v220, v221
    v_cvt_pk_bf16_f32 v200, v222, v223
    v_cvt_pk_bf16_f32 v201, v224, v225
    v_cvt_pk_bf16_f32 v11, v228, v229
    v_lshlrev_b32 v228, 16, v11
    v_and_b32 v229, 0xffff0000, v11
    v_cvt_pk_bf16_f32 v11, v230, v231
    v_lshlrev_b32 v230, 16, v11
    v_and_b32 v231, 0xffff0000, v11
    v_cvt_pk_bf16_f32 v11, v232, v233
    v_lshlrev_b32 v232, 16, v11
    v_and_b32 v233, 0xffff0000, v11
    v_cvt_pk_bf16_f32 v11, v234, v234
    v_lshlrev_b32 v234, 16, v11
    v_add_f32 v234, v234, v10
    v_cvt_pk_bf16_f32 v11, v234, v234
    v_lshlrev_b32 v234, 16, v11
    v_rcp_f32 v234, v234
    s_nop 0
    v_mul_f32 v228, v228, v234
    v_mul_f32 v229, v229, v234
    v_mul_f32 v230, v230, v234
    v_mul_f32 v231, v231, v234
    v_mul_f32 v232, v232, v234
    v_mul_f32 v233, v233, v234
    v_cvt_pk_bf16_f32 v211, v228, v229
    v_cvt_pk_bf16_f32 v212, v230, v231
    v_cvt_pk_bf16_f32 v213, v232, v233
    s_waitcnt vmcnt(20)
    v_cvt_pk_bf16_f32 v60, v60, v61
    v_cvt_pk_bf16_f32 v61, v62, v63
    v_cvt_pk_bf16_f32 v64, v64, v65
    v_cvt_pk_bf16_f32 v65, v66, v67
    v_cvt_pk_bf16_f32 v68, v68, v69
    v_cvt_pk_bf16_f32 v69, v70, v71
    v_cvt_pk_bf16_f32 v72, v72, v73
    v_cvt_pk_bf16_f32 v73, v74, v75
    v_cvt_pk_bf16_f32 v76, v76, v77
    v_cvt_pk_bf16_f32 v77, v78, v79
    s_mov_b64 exec, s[56:57]
    ds_write_b64 v7, v[60:61] offset:0
    ds_write_b64 v7, v[64:65] offset:384
    ds_write_b64 v7, v[68:69] offset:768
    ds_write_b64 v7, v[72:73] offset:1152
    ds_write_b64 v7, v[76:77] offset:1536
    s_mov_b64 exec, -1
    ds_read_b128 v[236:239], v12 offset:0
    ds_read_b128 v[240:243], v12 offset:64
    ds_read_b128 v[244:247], v13 offset:0
    ds_read_b128 v[248:251], v13 offset:64
    s_waitcnt lgkmcnt(0)
    v_cndmask_b32 v240, v9, v240, s[54:55]
    v_cndmask_b32 v248, v9, v248, s[54:55]
    v_cndmask_b32 v241, v9, v241, s[54:55]
    v_cndmask_b32 v249, v9, v249, s[54:55]
    v_cndmask_b32 v242, v9, v242, s[54:55]
    v_cndmask_b32 v250, v9, v250, s[54:55]
    v_cndmask_b32 v243, v9, v243, s[54:55]
    v_cndmask_b32 v251, v9, v251, s[54:55]
    v_mov_b32 v252, v88
    v_mov_b32 v253, v89
    v_mfma_f32_16x16x32_bf16 v[220:223], v[236:239], v[80:83], 0
    s_nop 0
    v_mfma_f32_16x16x32_bf16 v[220:223], v[240:243], v[252:255], v[220:223]
    v_mfma_f32_16x16x32_bf16 v[224:227], v[244:247], v[80:83], 0
    v_mfma_f32_16x16x32_bf16 v[224:227], v[248:251], v[252:255], v[224:227]
    v_mov_b32 v252, v90
    v_mov_b32 v253, v91
    v_mfma_f32_16x16x32_bf16 v[228:231], v[236:239], v[84:87], 0
    s_nop 0
    v_mfma_f32_16x16x32_bf16 v[228:231], v[240:243], v[252:255], v[228:231]
    v_mfma_f32_16x16x32_bf16 v[232:235], v[244:247], v[84:87], 0
    v_mfma_f32_16x16x32_bf16 v[232:235], v[248:251], v[252:255], v[232:235]
    s_add_u32 s40, s39, 11264
    buffer_load_dwordx4 v[60:63], v5, s[8:11], s40 offen
    s_add_u32 s40, s39, 12288
    buffer_load_dwordx4 v[64:67], v5, s[8:11], s40 offen
    s_add_u32 s40, s39, 13312
    buffer_load_dwordx4 v[68:71], v5, s[8:11], s40 offen
    s_add_u32 s40, s39, 14336
    buffer_load_dwordx4 v[72:75], v5, s[8:11], s40 offen
    s_add_u32 s40, s39, 15360
    buffer_load_dwordx4 v[76:79], v5, s[8:11], s40 offen
    s_add_u32 s40, s39, 16384
    buffer_load_dwordx4 v[80:83], v5, s[8:11], s40 offen
    s_add_u32 s40, s39, 17408
    buffer_load_dwordx4 v[84:87], v5, s[8:11], s40 offen
    s_add_u32 s40, s39, 18432
    buffer_load_dwordx4 v[88:91], v5, s[8:11], s40 offen
    v_cvt_pk_bf16_f32 v11, v220, v221
    v_lshlrev_b32 v220, 16, v11
    v_and_b32 v221, 0xffff0000, v11
    v_cvt_pk_bf16_f32 v11, v222, v223
    v_lshlrev_b32 v222, 16, v11
    v_and_b32 v223, 0xffff0000, v11
    v_cvt_pk_bf16_f32 v11, v224, v225
    v_lshlrev_b32 v224, 16, v11
    v_and_b32 v225, 0xffff0000, v11
    v_cvt_pk_bf16_f32 v11, v226, v226
    v_lshlrev_b32 v226, 16, v11
    v_add_f32 v226, v226, v10
    v_cvt_pk_bf16_f32 v11, v226, v226
    v_lshlrev_b32 v226, 16, v11
    v_rcp_f32 v226, v226
    s_nop 0
    v_mul_f32 v220, v220, v226
    v_mul_f32 v221, v221, v226
    v_mul_f32 v222, v222, v226
    v_mul_f32 v223, v223, v226
    v_mul_f32 v224, v224, v226
    v_mul_f32 v225, v225, v226
    v_cvt_pk_bf16_f32 v202, v220, v221
    v_cvt_pk_bf16_f32 v203, v222, v223
    v_cvt_pk_bf16_f32 v204, v224, v225
    v_cvt_pk_bf16_f32 v11, v228, v229
    v_lshlrev_b32 v228, 16, v11
    v_and_b32 v229, 0xffff0000, v11
    v_cvt_pk_bf16_f32 v11, v230, v231
    v_lshlrev_b32 v230, 16, v11
    v_and_b32 v231, 0xffff0000, v11
    v_cvt_pk_bf16_f32 v11, v232, v233
    v_lshlrev_b32 v232, 16, v11
    v_and_b32 v233, 0xffff0000, v11
    v_cvt_pk_bf16_f32 v11, v234, v234
    v_lshlrev_b32 v234, 16, v11
    v_add_f32 v234, v234, v10
    v_cvt_pk_bf16_f32 v11, v234, v234
    v_lshlrev_b32 v234, 16, v11
    v_rcp_f32 v234, v234
    s_nop 0
    v_mul_f32 v228, v228, v234
    v_mul_f32 v229, v229, v234
    v_mul_f32 v230, v230, v234
    v_mul_f32 v231, v231, v234
    v_mul_f32 v232, v232, v234
    v_mul_f32 v233, v233, v234
    v_cvt_pk_bf16_f32 v214, v228, v229
    v_cvt_pk_bf16_f32 v215, v230, v231
    v_cvt_pk_bf16_f32 v216, v232, v233
    s_waitcnt vmcnt(19)
    v_cvt_pk_bf16_f32 v92, v92, v93
    v_cvt_pk_bf16_f32 v93, v94, v95
    v_cvt_pk_bf16_f32 v96, v96, v97
    v_cvt_pk_bf16_f32 v97, v98, v99
    v_cvt_pk_bf16_f32 v100, v100, v101
    v_cvt_pk_bf16_f32 v101, v102, v103
    v_cvt_pk_bf16_f32 v104, v104, v105
    v_cvt_pk_bf16_f32 v105, v106, v107
    v_cvt_pk_bf16_f32 v108, v108, v109
    v_cvt_pk_bf16_f32 v109, v110, v111
    s_mov_b64 exec, s[56:57]
    ds_write_b64 v7, v[92:93] offset:1920
    ds_write_b64 v7, v[96:97] offset:2304
    ds_write_b64 v7, v[100:101] offset:2688
    ds_write_b64 v7, v[104:105] offset:3072
    ds_write_b64 v7, v[108:109] offset:3456
    s_mov_b64 exec, -1
    ds_read_b128 v[236:239], v12 offset:1920
    ds_read_b128 v[240:243], v12 offset:1984
    ds_read_b128 v[244:247], v13 offset:1920
    ds_read_b128 v[248:251], v13 offset:1984
    s_waitcnt lgkmcnt(0)
    v_cndmask_b32 v240, v9, v240, s[54:55]
    v_cndmask_b32 v248, v9, v248, s[54:55]
    v_cndmask_b32 v241, v9, v241, s[54:55]
    v_cndmask_b32 v249, v9, v249, s[54:55]
    v_cndmask_b32 v242, v9, v242, s[54:55]
    v_cndmask_b32 v250, v9, v250, s[54:55]
    v_cndmask_b32 v243, v9, v243, s[54:55]
    v_cndmask_b32 v251, v9, v251, s[54:55]
    v_mov_b32 v252, v120
    v_mov_b32 v253, v121
    v_mfma_f32_16x16x32_bf16 v[220:223], v[236:239], v[112:115], 0
    s_nop 0
    v_mfma_f32_16x16x32_bf16 v[220:223], v[240:243], v[252:255], v[220:223]
    v_mfma_f32_16x16x32_bf16 v[224:227], v[244:247], v[112:115], 0
    v_mfma_f32_16x16x32_bf16 v[224:227], v[248:251], v[252:255], v[224:227]
    v_mov_b32 v252, v122
    v_mov_b32 v253, v123
    v_mfma_f32_16x16x32_bf16 v[228:231], v[236:239], v[116:119], 0
    s_nop 0
    v_mfma_f32_16x16x32_bf16 v[228:231], v[240:243], v[252:255], v[228:231]
    v_mfma_f32_16x16x32_bf16 v[232:235], v[244:247], v[116:119], 0
    v_mfma_f32_16x16x32_bf16 v[232:235], v[248:251], v[252:255], v[232:235]
    s_add_u32 s40, s39, 19456
    buffer_load_dwordx4 v[92:95], v5, s[8:11], s40 offen
    s_add_u32 s40, s39, 20480
    buffer_load_dwordx4 v[96:99], v5, s[8:11], s40 offen
    s_add_u32 s40, s39, 21504
    buffer_load_dwordx4 v[100:103], v5, s[8:11], s40 offen
    s_add_u32 s40, s39, 22528
    buffer_load_dwordx4 v[104:107], v5, s[8:11], s40 offen
    s_add_u32 s40, s39, 23552
    buffer_load_dwordx4 v[108:111], v5, s[8:11], s40 offen
    s_add_u32 s40, s39, 24576
    buffer_load_dwordx4 v[112:115], v5, s[8:11], s40 offen
    s_add_u32 s40, s39, 25600
    buffer_load_dwordx4 v[116:119], v5, s[8:11], s40 offen
    s_add_u32 s40, s39, 26624
    buffer_load_dwordx4 v[120:123], v5, s[8:11], s40 offen
    v_cvt_pk_bf16_f32 v11, v220, v221
    v_lshlrev_b32 v220, 16, v11
    v_and_b32 v221, 0xffff0000, v11
    v_cvt_pk_bf16_f32 v11, v222, v223
    v_lshlrev_b32 v222, 16, v11
    v_and_b32 v223, 0xffff0000, v11
    v_cvt_pk_bf16_f32 v11, v224, v225
    v_lshlrev_b32 v224, 16, v11
    v_and_b32 v225, 0xffff0000, v11
    v_cvt_pk_bf16_f32 v11, v226, v226
    v_lshlrev_b32 v226, 16, v11
    v_add_f32 v226, v226, v10
    v_cvt_pk_bf16_f32 v11, v226, v226
    v_lshlrev_b32 v226, 16, v11
    v_rcp_f32 v226, v226
    s_nop 0
    v_mul_f32 v220, v220, v226
    v_mul_f32 v221, v221, v226
    v_mul_f32 v222, v222, v226
    v_mul_f32 v223, v223, v226
    v_mul_f32 v224, v224, v226
    v_mul_f32 v225, v225, v226
    v_cvt_pk_bf16_f32 v205, v220, v221
    v_cvt_pk_bf16_f32 v206, v222, v223
    v_cvt_pk_bf16_f32 v207, v224, v225
    v_cvt_pk_bf16_f32 v11, v228, v229
    v_lshlrev_b32 v228, 16, v11
    v_and_b32 v229, 0xffff0000, v11
    v_cvt_pk_bf16_f32 v11, v230, v231
    v_lshlrev_b32 v230, 16, v11
    v_and_b32 v231, 0xffff0000, v11
    v_cvt_pk_bf16_f32 v11, v232, v233
    v_lshlrev_b32 v232, 16, v11
    v_and_b32 v233, 0xffff0000, v11
    v_cvt_pk_bf16_f32 v11, v234, v234
    v_lshlrev_b32 v234, 16, v11
    v_add_f32 v234, v234, v10
    v_cvt_pk_bf16_f32 v11, v234, v234
    v_lshlrev_b32 v234, 16, v11
    v_rcp_f32 v234, v234
    s_nop 0
    v_mul_f32 v228, v228, v234
    v_mul_f32 v229, v229, v234
    v_mul_f32 v230, v230, v234
    v_mul_f32 v231, v231, v234
    v_mul_f32 v232, v232, v234
    v_mul_f32 v233, v233, v234
    v_cvt_pk_bf16_f32 v217, v228, v229
    v_cvt_pk_bf16_f32 v218, v230, v231
    v_cvt_pk_bf16_f32 v219, v232, v233
    s_barrier
    s_waitcnt vmcnt(26)
    v_mfma_f32_16x16x32_bf16 v[124:127], v[16:19], v[196:199], 0
    v_mfma_f32_16x16x32_bf16 v[160:163], v[16:19], v[208:211], 0
    s_waitcnt vmcnt(25)
    v_mfma_f32_16x16x32_bf16 v[128:131], v[20:23], v[196:199], 0
    v_mfma_f32_16x16x32_bf16 v[164:167], v[20:23], v[208:211], 0
    s_waitcnt vmcnt(24)
    v_mfma_f32_16x16x32_bf16 v[132:135], v[24:27], v[196:199], 0
    v_mfma_f32_16x16x32_bf16 v[168:171], v[24:27], v[208:211], 0
    s_waitcnt vmcnt(23)
    v_mfma_f32_16x16x32_bf16 v[136:139], v[28:31], v[196:199], 0
    v_mfma_f32_16x16x32_bf16 v[172:175], v[28:31], v[208:211], 0
    s_waitcnt vmcnt(22)
    v_mfma_f32_16x16x32_bf16 v[140:143], v[32:35], v[196:199], 0
    v_mfma_f32_16x16x32_bf16 v[176:179], v[32:35], v[208:211], 0
    s_waitcnt vmcnt(21)
    v_mfma_f32_16x16x32_bf16 v[144:147], v[36:39], v[196:199], 0
    v_mfma_f32_16x16x32_bf16 v[180:183], v[36:39], v[208:211], 0
    s_waitcnt vmcnt(20)
    v_mfma_f32_16x16x32_bf16 v[148:151], v[40:43], v[196:199], 0
    v_mfma_f32_16x16x32_bf16 v[184:187], v[40:43], v[208:211], 0
    s_waitcnt vmcnt(19)
    v_mfma_f32_16x16x32_bf16 v[152:155], v[44:47], v[196:199], 0
    v_mfma_f32_16x16x32_bf16 v[188:191], v[44:47], v[208:211], 0
    s_waitcnt vmcnt(18)
    v_mfma_f32_16x16x32_bf16 v[156:159], v[48:51], v[196:199], 0
    v_mfma_f32_16x16x32_bf16 v[192:195], v[48:51], v[208:211], 0
    s_waitcnt vmcnt(17)
    v_mfma_f32_16x16x32_bf16 v[124:127], v[52:55], v[200:203], v[124:127]
    v_mfma_f32_16x16x32_bf16 v[160:163], v[52:55], v[212:215], v[160:163]
    s_waitcnt vmcnt(16)
    v_mfma_f32_16x16x32_bf16 v[128:131], v[56:59], v[200:203], v[128:131]
    v_mfma_f32_16x16x32_bf16 v[164:167], v[56:59], v[212:215], v[164:167]
    s_waitcnt vmcnt(15)
    v_mfma_f32_16x16x32_bf16 v[132:135], v[60:63], v[200:203], v[132:135]
    v_mfma_f32_16x16x32_bf16 v[168:171], v[60:63], v[212:215], v[168:171]
    s_waitcnt vmcnt(14)
    v_mfma_f32_16x16x32_bf16 v[136:139], v[64:67], v[200:203], v[136:139]
    v_mfma_f32_16x16x32_bf16 v[172:175], v[64:67], v[212:215], v[172:175]
    s_waitcnt vmcnt(13)
    v_mfma_f32_16x16x32_bf16 v[140:143], v[68:71], v[200:203], v[140:143]
    v_mfma_f32_16x16x32_bf16 v[176:179], v[68:71], v[212:215], v[176:179]
    s_waitcnt vmcnt(12)
    v_mfma_f32_16x16x32_bf16 v[144:147], v[72:75], v[200:203], v[144:147]
    v_mfma_f32_16x16x32_bf16 v[180:183], v[72:75], v[212:215], v[180:183]
    s_waitcnt vmcnt(11)
    v_mfma_f32_16x16x32_bf16 v[148:151], v[76:79], v[200:203], v[148:151]
    v_mfma_f32_16x16x32_bf16 v[184:187], v[76:79], v[212:215], v[184:187]
    s_waitcnt vmcnt(10)
    v_mfma_f32_16x16x32_bf16 v[152:155], v[80:83], v[200:203], v[152:155]
    v_mfma_f32_16x16x32_bf16 v[188:191], v[80:83], v[212:215], v[188:191]
    s_waitcnt vmcnt(9)
    v_mfma_f32_16x16x32_bf16 v[156:159], v[84:87], v[200:203], v[156:159]
    v_mfma_f32_16x16x32_bf16 v[192:195], v[84:87], v[212:215], v[192:195]
    s_waitcnt vmcnt(8)
    v_mfma_f32_16x16x32_bf16 v[124:127], v[88:91], v[204:207], v[124:127]
    v_mfma_f32_16x16x32_bf16 v[160:163], v[88:91], v[216:219], v[160:163]
    s_waitcnt vmcnt(7)
    v_mfma_f32_16x16x32_bf16 v[128:131], v[92:95], v[204:207], v[128:131]
    v_mfma_f32_16x16x32_bf16 v[164:167], v[92:95], v[216:219], v[164:167]
    s_waitcnt vmcnt(6)
    v_mfma_f32_16x16x32_bf16 v[132:135], v[96:99], v[204:207], v[132:135]
    v_mfma_f32_16x16x32_bf16 v[168:171], v[96:99], v[216:219], v[168:171]
    s_waitcnt vmcnt(5)
    v_mfma_f32_16x16x32_bf16 v[136:139], v[100:103], v[204:207], v[136:139]
    v_mfma_f32_16x16x32_bf16 v[172:175], v[100:103], v[216:219], v[172:175]
    s_waitcnt vmcnt(4)
    v_mfma_f32_16x16x32_bf16 v[140:143], v[104:107], v[204:207], v[140:143]
    v_mfma_f32_16x16x32_bf16 v[176:179], v[104:107], v[216:219], v[176:179]
    s_waitcnt vmcnt(3)
    v_mfma_f32_16x16x32_bf16 v[144:147], v[108:111], v[204:207], v[144:147]
    v_mfma_f32_16x16x32_bf16 v[180:183], v[108:111], v[216:219], v[180:183]
    s_waitcnt vmcnt(2)
    v_mfma_f32_16x16x32_bf16 v[148:151], v[112:115], v[204:207], v[148:151]
    v_mfma_f32_16x16x32_bf16 v[184:187], v[112:115], v[216:219], v[184:187]
    s_waitcnt vmcnt(1)
    v_mfma_f32_16x16x32_bf16 v[152:155], v[116:119], v[204:207], v[152:155]
    v_mfma_f32_16x16x32_bf16 v[188:191], v[116:119], v[216:219], v[188:191]
    s_waitcnt vmcnt(0)
    v_mfma_f32_16x16x32_bf16 v[156:159], v[120:123], v[204:207], v[156:159]
    v_mfma_f32_16x16x32_bf16 v[192:195], v[120:123], v[216:219], v[192:195]
    s_mul_i32 s41, s3, 18432
    v_add_u32 v6, s41, v5
    ds_write_b128 v6, v[124:127] offset:0
    ds_write_b128 v6, v[128:131] offset:1024
    ds_write_b128 v6, v[132:135] offset:2048
    ds_write_b128 v6, v[136:139] offset:3072
    ds_write_b128 v6, v[140:143] offset:4096
    ds_write_b128 v6, v[144:147] offset:5120
    ds_write_b128 v6, v[148:151] offset:6144
    ds_write_b128 v6, v[152:155] offset:7168
    ds_write_b128 v6, v[156:159] offset:8192
    ds_write_b128 v6, v[160:163] offset:9216
    ds_write_b128 v6, v[164:167] offset:10240
    ds_write_b128 v6, v[168:171] offset:11264
    ds_write_b128 v6, v[172:175] offset:12288
    ds_write_b128 v6, v[176:179] offset:13312
    ds_write_b128 v6, v[180:183] offset:14336
    ds_write_b128 v6, v[184:187] offset:15360
    ds_write_b128 v6, v[188:191] offset:16384
    ds_write_b128 v6, v[192:195] offset:17408
    s_lshr_b32 s42, s3, 2
    s_and_b32 s43, s3, 3
    s_mul_i32 s44, s42, 9
    s_lshl_b32 s45, s43, 1
    s_add_u32 s44, s44, s45
    s_lshl_b32 s44, s44, 10
    v_add_u32 v7, s44, v5
    s_mul_i32 s46, s42, 9216
    s_add_u32 s46, s46, 8192
    v_add_u32 v8, s46, v5
    s_lshl_b32 s47, s33, 1
    s_add_u32 s47, s47, s42
    s_mul_i32 s48, s32, 18
    s_lshl_b32 s49, s43, 2
    s_add_u32 s49, s49, s48
    v_add_u32 v9, s49, v4
    v_lshrrev_b32 v10, 2, v9
    v_and_b32 v11, 3, v9
    v_lshlrev_b32 v10, 10, v10
    v_lshl_add_u32 v10, v11, 8, v10
    v_lshl_add_u32 v10, v3, 4, v10
    v_lshrrev_b32 v9, 1, v4
    v_add_u32 v9, s48, v9
    v_add_u32 v9, 16, v9
    v_lshrrev_b32 v12, 2, v9
    v_and_b32 v11, 3, v9
    v_lshlrev_b32 v12, 10, v12
    v_lshl_add_u32 v12, v11, 8, v12
    v_lshl_add_u32 v12, v3, 4, v12
    v_and_b32 v11, 1, v4
    v_lshl_add_u32 v12, v11, 3, v12
    s_mul_i32 s50, s47, 18432
    buffer_load_dwordx4 v[16:19], v10, s[12:15], s50 offen
    buffer_load_dwordx2 v[20:21], v12, s[12:15], s50 offen
    s_waitcnt lgkmcnt(0)
    s_barrier
    v_add_u32 v108, 0x10000, v7
    v_add_u32 v109, 0x20000, v7
    v_add_u32 v110, 0x10000, v8
    v_add_u32 v111, 0x20000, v8
    ds_read_b128 v[32:35], v7 offset:0
    ds_read_b128 v[36:39], v7 offset:1024
    ds_read_b128 v[40:43], v7 offset:18432
    ds_read_b128 v[44:47], v7 offset:19456
    ds_read_b128 v[48:51], v7 offset:36864
    ds_read_b128 v[52:55], v7 offset:37888
    ds_read_b128 v[56:59], v7 offset:55296
    ds_read_b128 v[60:63], v7 offset:56320
    ds_read_b128 v[64:67], v108 offset:8192
    ds_read_b128 v[68:71], v108 offset:9216
    ds_read_b128 v[72:75], v108 offset:26624
    ds_read_b128 v[76:79], v108 offset:27648
    ds_read_b128 v[80:83], v108 offset:45056
    ds_read_b128 v[84:87], v108 offset:46080
    ds_read_b128 v[88:91], v108 offset:63488
    ds_read_b128 v[92:95], v108 offset:64512
    s_waitcnt lgkmcnt(0)
    v_add_f32 v24, v32, v40
    v_add_f32 v24, v24, v48
    v_add_f32 v24, v24, v56
    v_add_f32 v24, v24, v64
    v_add_f32 v24, v24, v72
    v_add_f32 v24, v24, v80
    v_add_f32 v24, v24, v88
    v_add_f32 v25, v33, v41
    v_add_f32 v25, v25, v49
    v_add_f32 v25, v25, v57
    v_add_f32 v25, v25, v65
    v_add_f32 v25, v25, v73
    v_add_f32 v25, v25, v81
    v_add_f32 v25, v25, v89
    v_add_f32 v26, v34, v42
    v_add_f32 v26, v26, v50
    v_add_f32 v26, v26, v58
    v_add_f32 v26, v26, v66
    v_add_f32 v26, v26, v74
    v_add_f32 v26, v26, v82
    v_add_f32 v26, v26, v90
    v_add_f32 v27, v35, v43
    v_add_f32 v27, v27, v51
    v_add_f32 v27, v27, v59
    v_add_f32 v27, v27, v67
    v_add_f32 v27, v27, v75
    v_add_f32 v27, v27, v83
    v_add_f32 v27, v27, v91
    v_add_f32 v28, v36, v44
    v_add_f32 v28, v28, v52
    v_add_f32 v28, v28, v60
    v_add_f32 v28, v28, v68
    v_add_f32 v28, v28, v76
    v_add_f32 v28, v28, v84
    v_add_f32 v28, v28, v92
    v_add_f32 v29, v37, v45
    v_add_f32 v29, v29, v53
    v_add_f32 v29, v29, v61
    v_add_f32 v29, v29, v69
    v_add_f32 v29, v29, v77
    v_add_f32 v29, v29, v85
    v_add_f32 v29, v29, v93
    v_add_f32 v30, v38, v46
    v_add_f32 v30, v30, v54
    v_add_f32 v30, v30, v62
    v_add_f32 v30, v30, v70
    v_add_f32 v30, v30, v78
    v_add_f32 v30, v30, v86
    v_add_f32 v30, v30, v94
    v_add_f32 v31, v39, v47
    v_add_f32 v31, v31, v55
    v_add_f32 v31, v31, v63
    v_add_f32 v31, v31, v71
    v_add_f32 v31, v31, v79
    v_add_f32 v31, v31, v87
    v_add_f32 v31, v31, v95
    s_waitcnt vmcnt(0)
    v_cvt_pk_bf16_f32 v11, v24, v25
    v_lshlrev_b32 v24, 16, v11
    v_and_b32 v25, 0xffff0000, v11
    v_cvt_pk_bf16_f32 v11, v26, v27
    v_lshlrev_b32 v26, 16, v11
    v_and_b32 v27, 0xffff0000, v11
    v_cvt_pk_bf16_f32 v11, v28, v29
    v_lshlrev_b32 v28, 16, v11
    v_and_b32 v29, 0xffff0000, v11
    v_cvt_pk_bf16_f32 v11, v30, v31
    v_lshlrev_b32 v30, 16, v11
    v_and_b32 v31, 0xffff0000, v11
    v_lshlrev_b32 v13, 16, v16
    v_and_b32 v14, 0xffff0000, v16
    v_add_f32 v24, v24, v13
    v_add_f32 v25, v25, v14
    v_lshlrev_b32 v13, 16, v17
    v_and_b32 v14, 0xffff0000, v17
    v_add_f32 v26, v26, v13
    v_add_f32 v27, v27, v14
    v_lshlrev_b32 v13, 16, v18
    v_and_b32 v14, 0xffff0000, v18
    v_add_f32 v28, v28, v13
    v_add_f32 v29, v29, v14
    v_lshlrev_b32 v13, 16, v19
    v_and_b32 v14, 0xffff0000, v19
    v_add_f32 v30, v30, v13
    v_add_f32 v31, v31, v14
    v_cvt_pk_bf16_f32 v100, v24, v25
    v_cvt_pk_bf16_f32 v101, v26, v27
    v_cvt_pk_bf16_f32 v102, v28, v29
    v_cvt_pk_bf16_f32 v103, v30, v31
    buffer_store_dwordx4 v[100:103], v10, s[16:19], s50 offen sc1
    v_lshlrev_b32 v24, 16, v100
    v_and_b32 v25, 0xffff0000, v100
    v_lshlrev_b32 v26, 16, v101
    v_and_b32 v27, 0xffff0000, v101
    v_lshlrev_b32 v28, 16, v102
    v_and_b32 v29, 0xffff0000, v102
    v_lshlrev_b32 v30, 16, v103
    v_and_b32 v31, 0xffff0000, v103
    v_lshlrev_b32 v9, 3, v3
    v_mov_b32 v11, 0x7ff00000
    v_cmp_gt_u32 vcc, 16, v1
    s_nop 1
    v_cndmask_b32 v9, v11, v9, vcc
    s_lshl_b32 s51, s47, 11
    s_lshl_b32 s52, s32, 9
    s_add_u32 s51, s51, s52
    s_lshl_b32 s52, s43, 7
    s_add_u32 s51, s51, s52
    s_cmp_eq_u32 s43, 3
    s_cbranch_scc0 .noodd_k2l0_kernel_2
    ds_read_b128 v[32:35], v8 offset:0
    ds_read_b128 v[36:39], v8 offset:18432
    ds_read_b128 v[40:43], v8 offset:36864
    ds_read_b128 v[44:47], v8 offset:55296
    ds_read_b128 v[48:51], v110 offset:8192
    ds_read_b128 v[52:55], v110 offset:26624
    ds_read_b128 v[56:59], v110 offset:45056
    ds_read_b128 v[60:63], v110 offset:63488
    s_waitcnt lgkmcnt(0)
    v_add_f32 v128, v32, v36
    v_add_f32 v128, v128, v40
    v_add_f32 v128, v128, v44
    v_add_f32 v128, v128, v48
    v_add_f32 v128, v128, v52
    v_add_f32 v128, v128, v56
    v_add_f32 v128, v128, v60
    v_add_f32 v129, v33, v37
    v_add_f32 v129, v129, v41
    v_add_f32 v129, v129, v45
    v_add_f32 v129, v129, v49
    v_add_f32 v129, v129, v53
    v_add_f32 v129, v129, v57
    v_add_f32 v129, v129, v61
    v_add_f32 v130, v34, v38
    v_add_f32 v130, v130, v42
    v_add_f32 v130, v130, v46
    v_add_f32 v130, v130, v50
    v_add_f32 v130, v130, v54
    v_add_f32 v130, v130, v58
    v_add_f32 v130, v130, v62
    v_add_f32 v131, v35, v39
    v_add_f32 v131, v131, v43
    v_add_f32 v131, v131, v47
    v_add_f32 v131, v131, v51
    v_add_f32 v131, v131, v55
    v_add_f32 v131, v131, v59
    v_add_f32 v131, v131, v63
    v_cvt_pk_bf16_f32 v11, v128, v129
    v_lshlrev_b32 v128, 16, v11
    v_and_b32 v129, 0xffff0000, v11
    v_cvt_pk_bf16_f32 v11, v130, v131
    v_lshlrev_b32 v130, 16, v11
    v_and_b32 v131, 0xffff0000, v11
    v_lshlrev_b32 v13, 16, v20
    v_and_b32 v14, 0xffff0000, v20
    v_add_f32 v128, v128, v13
    v_add_f32 v129, v129, v14
    v_lshlrev_b32 v13, 16, v21
    v_and_b32 v14, 0xffff0000, v21
    v_add_f32 v130, v130, v13
    v_add_f32 v131, v131, v14
    v_cvt_pk_bf16_f32 v104, v128, v129
    v_cvt_pk_bf16_f32 v105, v130, v131
    buffer_store_dwordx2 v[104:105], v12, s[16:19], s50 offen sc1
    v_lshlrev_b32 v128, 16, v104
    v_and_b32 v129, 0xffff0000, v104
    v_lshlrev_b32 v130, 16, v105
    v_and_b32 v131, 0xffff0000, v105
    v_mov_b32 v106, 0
    v_add_f32 v106, v106, v24
    v_add_f32 v106, v106, v25
    v_add_f32 v106, v106, v26
    v_add_f32 v106, v106, v27
    v_add_f32 v106, v106, v28
    v_add_f32 v106, v106, v29
    v_add_f32 v106, v106, v30
    v_add_f32 v106, v106, v31
    v_add_f32 v106, v106, v128
    v_add_f32 v106, v106, v129
    v_add_f32 v106, v106, v130
    v_add_f32 v106, v106, v131
    v_mov_b32 v11, v106
    s_nop 1
    v_permlane16_swap_b32 v106, v11
    v_add_f32 v106, v106, v11
    v_mov_b32 v11, v106
    s_nop 1
    v_permlane32_swap_b32 v106, v11
    v_add_f32 v106, v106, v11
    v_mul_f32 v106, 0x3caaaaab, v106
    v_mov_b32 v107, 0
    v_sub_f32 v11, v24, v106
    v_fmac_f32 v107, v11, v11
    v_sub_f32 v11, v25, v106
    v_fmac_f32 v107, v11, v11
    v_sub_f32 v11, v26, v106
    v_fmac_f32 v107, v11, v11
    v_sub_f32 v11, v27, v106
    v_fmac_f32 v107, v11, v11
    v_sub_f32 v11, v28, v106
    v_fmac_f32 v107, v11, v11
    v_sub_f32 v11, v29, v106
    v_fmac_f32 v107, v11, v11
    v_sub_f32 v11, v30, v106
    v_fmac_f32 v107, v11, v11
    v_sub_f32 v11, v31, v106
    v_fmac_f32 v107, v11, v11
    v_sub_f32 v11, v128, v106
    v_fmac_f32 v107, v11, v11
    v_sub_f32 v11, v129, v106
    v_fmac_f32 v107, v11, v11
    v_sub_f32 v11, v130, v106
    v_fmac_f32 v107, v11, v11
    v_sub_f32 v11, v131, v106
    v_fmac_f32 v107, v11, v11
    v_mov_b32 v11, v107
    s_nop 1
    v_permlane16_swap_b32 v107, v11
    v_add_f32 v107, v107, v11
    v_mov_b32 v11, v107
    s_nop 1
    v_permlane32_swap_b32 v107, v11
    v_add_f32 v107, v107, v11
    buffer_store_dwordx2 v[106:107], v9, s[20:23], s51 offen sc1
    s_nop 0
    s_branch .join_k2l0_kernel_3
.noodd_k2l0_kernel_2:
    v_mov_b32 v106, 0
    v_add_f32 v106, v106, v24
    v_add_f32 v106, v106, v25
    v_add_f32 v106, v106, v26
    v_add_f32 v106, v106, v27
    v_add_f32 v106, v106, v28
    v_add_f32 v106, v106, v29
    v_add_f32 v106, v106, v30
    v_add_f32 v106, v106, v31
    v_mov_b32 v11, v106
    s_nop 1
    v_permlane16_swap_b32 v106, v11
    v_add_f32 v106, v106, v11
    v_mov_b32 v11, v106
    s_nop 1
    v_permlane32_swap_b32 v106, v11
    v_add_f32 v106, v106, v11
    v_mul_f32 v106, 0x3d000000, v106
    v_mov_b32 v107, 0
    v_sub_f32 v11, v24, v106
    v_fmac_f32 v107, v11, v11
    v_sub_f32 v11, v25, v106
    v_fmac_f32 v107, v11, v11
    v_sub_f32 v11, v26, v106
    v_fmac_f32 v107, v11, v11
    v_sub_f32 v11, v27, v106
    v_fmac_f32 v107, v11, v11
    v_sub_f32 v11, v28, v106
    v_fmac_f32 v107, v11, v11
    v_sub_f32 v11, v29, v106
    v_fmac_f32 v107, v11, v11
    v_sub_f32 v11, v30, v106
    v_fmac_f32 v107, v11, v11
    v_sub_f32 v11, v31, v106
    v_fmac_f32 v107, v11, v11
    v_mov_b32 v11, v107
    s_nop 1
    v_permlane16_swap_b32 v107, v11
    v_add_f32 v107, v107, v11
    v_mov_b32 v11, v107
    s_nop 1
    v_permlane32_swap_b32 v107, v11
    v_add_f32 v107, v107, v11
    buffer_store_dwordx2 v[106:107], v9, s[20:23], s51 offen sc1
    s_nop 0
.join_k2l0_kernel_3:
.End_k2l0_kernel_1:
    s_endpgm
.globl k3l0_kernel
.p2align 8
.type k3l0_kernel,@function
k3l0_kernel:
    s_cmp_ge_u32 s2, 256
    s_cbranch_scc1 .End_k3l0_kernel_1
    s_load_dwordx2 s[4:5], s[0:1], 88
    s_load_dwordx2 s[6:7], s[0:1], 48
    v_and_b32 v1, 63, v0
    v_lshrrev_b32 v2, 6, v0
    s_nop 0
    v_readfirstlane_b32 s3, v2
    v_and_b32 v3, 15, v1
    v_lshrrev_b32 v4, 4, v1
    v_lshlrev_b32 v5, 4, v1
    s_lshr_b32 s34, s2, 3
    s_bfe_u32 s32, s2, 0x20001
    s_lshl_b32 s32, s32, 3
    s_lshr_b32 s35, s34, 2
    s_add_u32 s32, s32, s35
    s_and_b32 s33, s2, 1
    s_lshl_b32 s33, s33, 2
    s_and_b32 s34, s34, 3
    s_add_u32 s33, s33, s34
    s_lshl_b32 s34, s33, 4
    s_lshl_b32 s35, s3, 1
    s_add_u32 s34, s34, s35
    s_waitcnt lgkmcnt(0)
    s_add_u32 s8, s4, 0x800000
    s_addc_u32 s9, s5, 0
    s_and_b32 s9, s9, 0xffff
    s_mov_b32 s10, 0x510000
    s_mov_b32 s11, 0x20000
    s_add_u32 s12, s4, 0x1a80000
    s_addc_u32 s13, s5, 0
    s_and_b32 s13, s13, 0xffff
    s_mov_b32 s14, 0x240000
    s_mov_b32 s15, 0x20000
    s_add_u32 s16, s4, 0x2240000
    s_addc_u32 s17, s5, 0
    s_and_b32 s17, s17, 0xffff
    s_mov_b32 s18, 0x40000
    s_mov_b32 s19, 0x20000
    s_add_u32 s20, s4, 0x240000
    s_addc_u32 s21, s5, 0
    s_and_b32 s21, s21, 0xffff
    s_mov_b32 s22, 0x4800
    s_mov_b32 s23, 0x20000
    s_mov_b32 s24, s6
    s_mov_b32 s25, s7
    s_and_b32 s25, s25, 0xffff
    s_mov_b32 s26, 0x2400
    s_mov_b32 s27, 0x20000
    s_add_u32 s28, s4, 0x2a00000
    s_addc_u32 s29, s5, 0
    s_and_b32 s29, s29, 0xffff
    s_mov_b32 s30, 0x1200000
    s_mov_b32 s31, 0x20000
    v_add_u32 v2, 0x10000, v5
    v_add_u32 v0, 0x20000, v5
    s_mul_i32 s38, s34, 18432
    s_lshl_b32 s40, s3, 10
    s_mul_i32 s41, s32, 165888
    s_add_u32 s42, s41, s40
    s_min_u32 s44, s40, 1024
    s_add_u32 s39, s38, 0
    buffer_load_dwordx4 v[16:19], v5, s[12:15], s39 offen
    s_add_u32 s39, s38, 18432
    buffer_load_dwordx4 v[20:23], v5, s[12:15], s39 offen
    s_add_u32 m0, s40, 0
    s_add_u32 s45, s42, 0
    buffer_load_dwordx4 v5, s[8:11], s45 offen lds
    s_add_u32 m0, s40, 8192
    s_add_u32 s45, s42, 8192
    buffer_load_dwordx4 v5, s[8:11], s45 offen lds
    s_add_u32 s39, s38, 1024
    buffer_load_dwordx4 v[24:27], v5, s[12:15], s39 offen
    s_add_u32 s39, s38, 19456
    buffer_load_dwordx4 v[28:31], v5, s[12:15], s39 offen
    s_add_u32 m0, s40, 16384
    s_add_u32 s45, s42, 16384
    buffer_load_dwordx4 v5, s[8:11], s45 offen lds
    s_add_u32 m0, s40, 24576
    s_add_u32 s45, s42, 24576
    buffer_load_dwordx4 v5, s[8:11], s45 offen lds
    s_add_u32 s39, s38, 2048
    buffer_load_dwordx4 v[32:35], v5, s[12:15], s39 offen
    s_add_u32 s39, s38, 20480
    buffer_load_dwordx4 v[36:39], v5, s[12:15], s39 offen
    s_add_u32 m0, s40, 32768
    s_add_u32 s45, s42, 32768
    buffer_load_dwordx4 v5, s[8:11], s45 offen lds
    s_add_u32 m0, s40, 40960
    s_add_u32 s45, s42, 40960
    buffer_load_dwordx4 v5, s[8:11], s45 offen lds
    s_waitcnt vmcnt(8)
    s_barrier
    ds_read_b128 v[152:155], v5 offset:0
    ds_read_b128 v[156:159], v5 offset:1024
    ds_read_b128 v[160:163], v5 offset:2048
    ds_read_b128 v[164:167], v5 offset:3072
    ds_read_b128 v[168:171], v5 offset:4096
    ds_read_b128 v[172:175], v5 offset:5120
    ds_read_b128 v[176:179], v5 offset:6144
    ds_read_b128 v[180:183], v5 offset:7168
    ds_read_b128 v[184:187], v5 offset:8192
    s_waitcnt lgkmcnt(8)
    v_mfma_f32_16x16x32_bf16 v[80:83], v[152:155], v[16:19], 0
    v_mfma_f32_16x16x32_bf16 v[116:119], v[152:155], v[20:23], 0
    s_waitcnt lgkmcnt(7)
    v_mfma_f32_16x16x32_bf16 v[84:87], v[156:159], v[16:19], 0
    v_mfma_f32_16x16x32_bf16 v[120:123], v[156:159], v[20:23], 0
    s_waitcnt lgkmcnt(6)
    v_mfma_f32_16x16x32_bf16 v[88:91], v[160:163], v[16:19], 0
    v_mfma_f32_16x16x32_bf16 v[124:127], v[160:163], v[20:23], 0
    s_waitcnt lgkmcnt(5)
    v_mfma_f32_16x16x32_bf16 v[92:95], v[164:167], v[16:19], 0
    v_mfma_f32_16x16x32_bf16 v[128:131], v[164:167], v[20:23], 0
    s_waitcnt lgkmcnt(4)
    v_mfma_f32_16x16x32_bf16 v[96:99], v[168:171], v[16:19], 0
    v_mfma_f32_16x16x32_bf16 v[132:135], v[168:171], v[20:23], 0
    ds_read_b128 v[152:155], v5 offset:9216
    ds_read_b128 v[156:159], v5 offset:10240
    ds_read_b128 v[160:163], v5 offset:11264
    ds_read_b128 v[164:167], v5 offset:12288
    ds_read_b128 v[168:171], v5 offset:13312
    s_waitcnt lgkmcnt(8)
    v_mfma_f32_16x16x32_bf16 v[100:103], v[172:175], v[16:19], 0
    v_mfma_f32_16x16x32_bf16 v[136:139], v[172:175], v[20:23], 0
    s_waitcnt lgkmcnt(7)
    v_mfma_f32_16x16x32_bf16 v[104:107], v[176:179], v[16:19], 0
    v_mfma_f32_16x16x32_bf16 v[140:143], v[176:179], v[20:23], 0
    s_waitcnt lgkmcnt(6)
    v_mfma_f32_16x16x32_bf16 v[108:111], v[180:183], v[16:19], 0
    v_mfma_f32_16x16x32_bf16 v[144:147], v[180:183], v[20:23], 0
    s_waitcnt lgkmcnt(5)
    v_mfma_f32_16x16x32_bf16 v[112:115], v[184:187], v[16:19], 0
    v_mfma_f32_16x16x32_bf16 v[148:151], v[184:187], v[20:23], 0
    s_add_u32 s39, s38, 3072
    buffer_load_dwordx4 v[40:43], v5, s[12:15], s39 offen
    s_add_u32 s39, s38, 21504
    buffer_load_dwordx4 v[44:47], v5, s[12:15], s39 offen
    s_waitcnt vmcnt(8)
    s_waitcnt lgkmcnt(4)
    v_mfma_f32_16x16x32_bf16 v[80:83], v[152:155], v[24:27], v[80:83]
    v_mfma_f32_16x16x32_bf16 v[116:119], v[152:155], v[28:31], v[116:119]
    s_waitcnt lgkmcnt(3)
    v_mfma_f32_16x16x32_bf16 v[84:87], v[156:159], v[24:27], v[84:87]
    v_mfma_f32_16x16x32_bf16 v[120:123], v[156:159], v[28:31], v[120:123]
    s_waitcnt lgkmcnt(2)
    v_mfma_f32_16x16x32_bf16 v[88:91], v[160:163], v[24:27], v[88:91]
    v_mfma_f32_16x16x32_bf16 v[124:127], v[160:163], v[28:31], v[124:127]
    s_waitcnt lgkmcnt(1)
    v_mfma_f32_16x16x32_bf16 v[92:95], v[164:167], v[24:27], v[92:95]
    v_mfma_f32_16x16x32_bf16 v[128:131], v[164:167], v[28:31], v[128:131]
    s_waitcnt lgkmcnt(0)
    v_mfma_f32_16x16x32_bf16 v[96:99], v[168:171], v[24:27], v[96:99]
    v_mfma_f32_16x16x32_bf16 v[132:135], v[168:171], v[28:31], v[132:135]
    s_waitcnt vmcnt(6)
    s_barrier
    s_add_u32 m0, s40, 49152
    s_add_u32 s45, s42, 49152
    buffer_load_dwordx4 v5, s[8:11], s45 offen lds
    s_add_u32 m0, s40, 57344
    s_add_u32 s45, s42, 57344
    buffer_load_dwordx4 v5, s[8:11], s45 offen lds
    ds_read_b128 v[172:175], v5 offset:14336
    ds_read_b128 v[176:179], v5 offset:15360
    ds_read_b128 v[180:183], v5 offset:16384
    ds_read_b128 v[184:187], v5 offset:17408
    ds_read_b128 v[152:155], v5 offset:18432
    ds_read_b128 v[156:159], v5 offset:19456
    ds_read_b128 v[160:163], v5 offset:20480
    ds_read_b128 v[164:167], v5 offset:21504
    ds_read_b128 v[168:171], v5 offset:22528
    s_waitcnt lgkmcnt(8)
    v_mfma_f32_16x16x32_bf16 v[100:103], v[172:175], v[24:27], v[100:103]
    v_mfma_f32_16x16x32_bf16 v[136:139], v[172:175], v[28:31], v[136:139]
    s_waitcnt lgkmcnt(7)
    v_mfma_f32_16x16x32_bf16 v[104:107], v[176:179], v[24:27], v[104:107]
    v_mfma_f32_16x16x32_bf16 v[140:143], v[176:179], v[28:31], v[140:143]
    s_waitcnt lgkmcnt(6)
    v_mfma_f32_16x16x32_bf16 v[108:111], v[180:183], v[24:27], v[108:111]
    v_mfma_f32_16x16x32_bf16 v[144:147], v[180:183], v[28:31], v[144:147]
    s_waitcnt lgkmcnt(5)
    v_mfma_f32_16x16x32_bf16 v[112:115], v[184:187], v[24:27], v[112:115]
    v_mfma_f32_16x16x32_bf16 v[148:151], v[184:187], v[28:31], v[148:151]
    s_add_u32 s39, s38, 4096
    buffer_load_dwordx4 v[16:19], v5, s[12:15], s39 offen
    s_add_u32 s39, s38, 22528
    buffer_load_dwordx4 v[20:23], v5, s[12:15], s39 offen
    s_waitcnt vmcnt(8)
    ds_read_b128 v[172:175], v5 offset:23552
    ds_read_b128 v[176:179], v5 offset:24576
    ds_read_b128 v[180:183], v5 offset:25600
    ds_read_b128 v[184:187], v5 offset:26624
    s_waitcnt lgkmcnt(8)
    v_mfma_f32_16x16x32_bf16 v[80:83], v[152:155], v[32:35], v[80:83]
    v_mfma_f32_16x16x32_bf16 v[116:119], v[152:155], v[36:39], v[116:119]
    s_waitcnt lgkmcnt(7)
    v_mfma_f32_16x16x32_bf16 v[84:87], v[156:159], v[32:35], v[84:87]
    v_mfma_f32_16x16x32_bf16 v[120:123], v[156:159], v[36:39], v[120:123]
    s_waitcnt lgkmcnt(6)
    v_mfma_f32_16x16x32_bf16 v[88:91], v[160:163], v[32:35], v[88:91]
    v_mfma_f32_16x16x32_bf16 v[124:127], v[160:163], v[36:39], v[124:127]
    s_waitcnt lgkmcnt(5)
    v_mfma_f32_16x16x32_bf16 v[92:95], v[164:167], v[32:35], v[92:95]
    v_mfma_f32_16x16x32_bf16 v[128:131], v[164:167], v[36:39], v[128:131]
    s_waitcnt lgkmcnt(4)
    v_mfma_f32_16x16x32_bf16 v[96:99], v[168:171], v[32:35], v[96:99]
    v_mfma_f32_16x16x32_bf16 v[132:135], v[168:171], v[36:39], v[132:135]
    ds_read_b128 v[152:155], v5 offset:27648
    ds_read_b128 v[156:159], v5 offset:28672
    ds_read_b128 v[160:163], v5 offset:29696
    ds_read_b128 v[164:167], v5 offset:30720
    ds_read_b128 v[168:171], v5 offset:31744
    s_waitcnt lgkmcnt(8)
    v_mfma_f32_16x16x32_bf16 v[100:103], v[172:175], v[32:35], v[100:103]
    v_mfma_f32_16x16x32_bf16 v[136:139], v[172:175], v[36:39], v[136:139]
    s_waitcnt lgkmcnt(7)
    v_mfma_f32_16x16x32_bf16 v[104:107], v[176:179], v[32:35], v[104:107]
    v_mfma_f32_16x16x32_bf16 v[140:143], v[176:179], v[36:39], v[140:143]
    s_waitcnt lgkmcnt(6)
    v_mfma_f32_16x16x32_bf16 v[108:111], v[180:183], v[32:35], v[108:111]
    v_mfma_f32_16x16x32_bf16 v[144:147], v[180:183], v[36:39], v[144:147]
    s_waitcnt lgkmcnt(5)
    v_mfma_f32_16x16x32_bf16 v[112:115], v[184:187], v[32:35], v[112:115]
    v_mfma_f32_16x16x32_bf16 v[148:151], v[184:187], v[36:39], v[148:151]
    s_add_u32 s39, s38, 5120
    buffer_load_dwordx4 v[24:27], v5, s[12:15], s39 offen
    s_add_u32 s39, s38, 23552
    buffer_load_dwordx4 v[28:31], v5, s[12:15], s39 offen
    s_waitcnt vmcnt(6)
    s_waitcnt lgkmcnt(4)
    v_mfma_f32_16x16x32_bf16 v[80:83], v[152:155], v[40:43], v[80:83]
    v_mfma_f32_16x16x32_bf16 v[116:119], v[152:155], v[44:47], v[116:119]
    s_waitcnt lgkmcnt(3)
    v_mfma_f32_16x16x32_bf16 v[84:87], v[156:159], v[40:43], v[84:87]
    v_mfma_f32_16x16x32_bf16 v[120:123], v[156:159], v[44:47], v[120:123]
    s_waitcnt lgkmcnt(2)
    v_mfma_f32_16x16x32_bf16 v[88:91], v[160:163], v[40:43], v[88:91]
    v_mfma_f32_16x16x32_bf16 v[124:127], v[160:163], v[44:47], v[124:127]
    s_waitcnt lgkmcnt(1)
    v_mfma_f32_16x16x32_bf16 v[92:95], v[164:167], v[40:43], v[92:95]
    v_mfma_f32_16x16x32_bf16 v[128:131], v[164:167], v[44:47], v[128:131]
    s_waitcnt lgkmcnt(0)
    v_mfma_f32_16x16x32_bf16 v[96:99], v[168:171], v[40:43], v[96:99]
    v_mfma_f32_16x16x32_bf16 v[132:135], v[168:171], v[44:47], v[132:135]
    s_barrier
    s_add_u32 m0, s40, 65536
    s_add_u32 s45, s42, 65536
    buffer_load_dwordx4 v5, s[8:11], s45 offen lds
    s_add_u32 m0, s40, 73728
    s_add_u32 s45, s42, 73728
    buffer_load_dwordx4 v5, s[8:11], s45 offen lds
    ds_read_b128 v[172:175], v5 offset:32768
    ds_read_b128 v[176:179], v5 offset:33792
    ds_read_b128 v[180:183], v5 offset:34816
    ds_read_b128 v[184:187], v5 offset:35840
    ds_read_b128 v[152:155], v5 offset:36864
    ds_read_b128 v[156:159], v5 offset:37888
    ds_read_b128 v[160:163], v5 offset:38912
    ds_read_b128 v[164:167], v5 offset:39936
    ds_read_b128 v[168:171], v5 offset:40960
    s_waitcnt lgkmcnt(8)
    v_mfma_f32_16x16x32_bf16 v[100:103], v[172:175], v[40:43], v[100:103]
    v_mfma_f32_16x16x32_bf16 v[136:139], v[172:175], v[44:47], v[136:139]
    s_waitcnt lgkmcnt(7)
    v_mfma_f32_16x16x32_bf16 v[104:107], v[176:179], v[40:43], v[104:107]
    v_mfma_f32_16x16x32_bf16 v[140:143], v[176:179], v[44:47], v[140:143]
    s_waitcnt lgkmcnt(6)
    v_mfma_f32_16x16x32_bf16 v[108:111], v[180:183], v[40:43], v[108:111]
    v_mfma_f32_16x16x32_bf16 v[144:147], v[180:183], v[44:47], v[144:147]
    s_waitcnt lgkmcnt(5)
    v_mfma_f32_16x16x32_bf16 v[112:115], v[184:187], v[40:43], v[112:115]
    v_mfma_f32_16x16x32_bf16 v[148:151], v[184:187], v[44:47], v[148:151]
    s_add_u32 s39, s38, 6144
    buffer_load_dwordx4 v[32:35], v5, s[12:15], s39 offen
    s_add_u32 s39, s38, 24576
    buffer_load_dwordx4 v[36:39], v5, s[12:15], s39 offen
    s_waitcnt vmcnt(6)
    ds_read_b128 v[172:175], v5 offset:41984
    ds_read_b128 v[176:179], v5 offset:43008
    ds_read_b128 v[180:183], v5 offset:44032
    ds_read_b128 v[184:187], v5 offset:45056
    s_waitcnt lgkmcnt(8)
    v_mfma_f32_16x16x32_bf16 v[80:83], v[152:155], v[16:19], v[80:83]
    v_mfma_f32_16x16x32_bf16 v[116:119], v[152:155], v[20:23], v[116:119]
    s_waitcnt lgkmcnt(7)
    v_mfma_f32_16x16x32_bf16 v[84:87], v[156:159], v[16:19], v[84:87]
    v_mfma_f32_16x16x32_bf16 v[120:123], v[156:159], v[20:23], v[120:123]
    s_waitcnt lgkmcnt(6)
    v_mfma_f32_16x16x32_bf16 v[88:91], v[160:163], v[16:19], v[88:91]
    v_mfma_f32_16x16x32_bf16 v[124:127], v[160:163], v[20:23], v[124:127]
    s_waitcnt lgkmcnt(5)
    v_mfma_f32_16x16x32_bf16 v[92:95], v[164:167], v[16:19], v[92:95]
    v_mfma_f32_16x16x32_bf16 v[128:131], v[164:167], v[20:23], v[128:131]
    s_waitcnt lgkmcnt(4)
    v_mfma_f32_16x16x32_bf16 v[96:99], v[168:171], v[16:19], v[96:99]
    v_mfma_f32_16x16x32_bf16 v[132:135], v[168:171], v[20:23], v[132:135]
    s_waitcnt lgkmcnt(3)
    v_mfma_f32_16x16x32_bf16 v[100:103], v[172:175], v[16:19], v[100:103]
    v_mfma_f32_16x16x32_bf16 v[136:139], v[172:175], v[20:23], v[136:139]
    s_waitcnt lgkmcnt(2)
    v_mfma_f32_16x16x32_bf16 v[104:107], v[176:179], v[16:19], v[104:107]
    v_mfma_f32_16x16x32_bf16 v[140:143], v[176:179], v[20:23], v[140:143]
    s_waitcnt lgkmcnt(1)
    v_mfma_f32_16x16x32_bf16 v[108:111], v[180:183], v[16:19], v[108:111]
    v_mfma_f32_16x16x32_bf16 v[144:147], v[180:183], v[20:23], v[144:147]
    s_waitcnt lgkmcnt(0)
    v_mfma_f32_16x16x32_bf16 v[112:115], v[184:187], v[16:19], v[112:115]
    v_mfma_f32_16x16x32_bf16 v[148:151], v[184:187], v[20:23], v[148:151]
    s_add_u32 s39, s38, 7168
    buffer_load_dwordx4 v[40:43], v5, s[12:15], s39 offen
    s_add_u32 s39, s38, 25600
    buffer_load_dwordx4 v[44:47], v5, s[12:15], s39 offen
    s_barrier
    s_add_u32 m0, s40, 81920
    s_add_u32 s45, s42, 81920
    buffer_load_dwordx4 v5, s[8:11], s45 offen lds
    s_add_u32 m0, s40, 90112
    s_add_u32 s45, s42, 90112
    buffer_load_dwordx4 v5, s[8:11], s45 offen lds
    ds_read_b128 v[152:155], v5 offset:46080
    ds_read_b128 v[156:159], v5 offset:47104
    ds_read_b128 v[160:163], v5 offset:48128
    ds_read_b128 v[164:167], v5 offset:49152
    ds_read_b128 v[168:171], v5 offset:50176
    s_waitcnt vmcnt(8)
    ds_read_b128 v[172:175], v5 offset:51200
    ds_read_b128 v[176:179], v5 offset:52224
    ds_read_b128 v[180:183], v5 offset:53248
    ds_read_b128 v[184:187], v5 offset:54272
    s_waitcnt lgkmcnt(8)
    v_mfma_f32_16x16x32_bf16 v[80:83], v[152:155], v[24:27], v[80:83]
    v_mfma_f32_16x16x32_bf16 v[116:119], v[152:155], v[28:31], v[116:119]
    s_waitcnt lgkmcnt(7)
    v_mfma_f32_16x16x32_bf16 v[84:87], v[156:159], v[24:27], v[84:87]
    v_mfma_f32_16x16x32_bf16 v[120:123], v[156:159], v[28:31], v[120:123]
    s_waitcnt lgkmcnt(6)
    v_mfma_f32_16x16x32_bf16 v[88:91], v[160:163], v[24:27], v[88:91]
    v_mfma_f32_16x16x32_bf16 v[124:127], v[160:163], v[28:31], v[124:127]
    s_waitcnt lgkmcnt(5)
    v_mfma_f32_16x16x32_bf16 v[92:95], v[164:167], v[24:27], v[92:95]
    v_mfma_f32_16x16x32_bf16 v[128:131], v[164:167], v[28:31], v[128:131]
    s_waitcnt lgkmcnt(4)
    v_mfma_f32_16x16x32_bf16 v[96:99], v[168:171], v[24:27], v[96:99]
    v_mfma_f32_16x16x32_bf16 v[132:135], v[168:171], v[28:31], v[132:135]
    ds_read_b128 v[152:155], v5 offset:55296
    ds_read_b128 v[156:159], v5 offset:56320
    ds_read_b128 v[160:163], v5 offset:57344
    ds_read_b128 v[164:167], v5 offset:58368
    ds_read_b128 v[168:171], v5 offset:59392
    s_waitcnt lgkmcnt(8)
    v_mfma_f32_16x16x32_bf16 v[100:103], v[172:175], v[24:27], v[100:103]
    v_mfma_f32_16x16x32_bf16 v[136:139], v[172:175], v[28:31], v[136:139]
    s_waitcnt lgkmcnt(7)
    v_mfma_f32_16x16x32_bf16 v[104:107], v[176:179], v[24:27], v[104:107]
    v_mfma_f32_16x16x32_bf16 v[140:143], v[176:179], v[28:31], v[140:143]
    s_waitcnt lgkmcnt(6)
    v_mfma_f32_16x16x32_bf16 v[108:111], v[180:183], v[24:27], v[108:111]
    v_mfma_f32_16x16x32_bf16 v[144:147], v[180:183], v[28:31], v[144:147]
    s_waitcnt lgkmcnt(5)
    v_mfma_f32_16x16x32_bf16 v[112:115], v[184:187], v[24:27], v[112:115]
    v_mfma_f32_16x16x32_bf16 v[148:151], v[184:187], v[28:31], v[148:151]
    s_add_u32 s39, s38, 8192
    buffer_load_dwordx4 v[16:19], v5, s[12:15], s39 offen
    s_add_u32 s39, s38, 26624
    buffer_load_dwordx4 v[20:23], v5, s[12:15], s39 offen
    s_waitcnt vmcnt(6)
    ds_read_b128 v[172:175], v5 offset:60416
    ds_read_b128 v[176:179], v5 offset:61440
    ds_read_b128 v[180:183], v5 offset:62464
    ds_read_b128 v[184:187], v5 offset:63488
    s_waitcnt lgkmcnt(8)
    v_mfma_f32_16x16x32_bf16 v[80:83], v[152:155], v[32:35], v[80:83]
    v_mfma_f32_16x16x32_bf16 v[116:119], v[152:155], v[36:39], v[116:119]
    s_waitcnt lgkmcnt(7)
    v_mfma_f32_16x16x32_bf16 v[84:87], v[156:159], v[32:35], v[84:87]
    v_mfma_f32_16x16x32_bf16 v[120:123], v[156:159], v[36:39], v[120:123]
    s_waitcnt lgkmcnt(6)
    v_mfma_f32_16x16x32_bf16 v[88:91], v[160:163], v[32:35], v[88:91]
    v_mfma_f32_16x16x32_bf16 v[124:127], v[160:163], v[36:39], v[124:127]
    s_waitcnt lgkmcnt(5)
    v_mfma_f32_16x16x32_bf16 v[92:95], v[164:167], v[32:35], v[92:95]
    v_mfma_f32_16x16x32_bf16 v[128:131], v[164:167], v[36:39], v[128:131]
    s_waitcnt lgkmcnt(4)
    v_mfma_f32_16x16x32_bf16 v[96:99], v[168:171], v[32:35], v[96:99]
    v_mfma_f32_16x16x32_bf16 v[132:135], v[168:171], v[36:39], v[132:135]
    s_waitcnt lgkmcnt(3)
    v_mfma_f32_16x16x32_bf16 v[100:103], v[172:175], v[32:35], v[100:103]
    v_mfma_f32_16x16x32_bf16 v[136:139], v[172:175], v[36:39], v[136:139]
    s_waitcnt lgkmcnt(2)
    v_mfma_f32_16x16x32_bf16 v[104:107], v[176:179], v[32:35], v[104:107]
    v_mfma_f32_16x16x32_bf16 v[140:143], v[176:179], v[36:39], v[140:143]
    s_waitcnt lgkmcnt(1)
    v_mfma_f32_16x16x32_bf16 v[108:111], v[180:183], v[32:35], v[108:111]
    v_mfma_f32_16x16x32_bf16 v[144:147], v[180:183], v[36:39], v[144:147]
    s_waitcnt lgkmcnt(0)
    v_mfma_f32_16x16x32_bf16 v[112:115], v[184:187], v[32:35], v[112:115]
    v_mfma_f32_16x16x32_bf16 v[148:151], v[184:187], v[36:39], v[148:151]
    s_add_u32 s39, s38, 9216
    buffer_load_dwordx4 v[24:27], v5, s[12:15], s39 offen
    s_add_u32 s39, s38, 27648
    buffer_load_dwordx4 v[28:31], v5, s[12:15], s39 offen
    s_barrier
    s_add_u32 m0, s40, 98304
    s_add_u32 s45, s42, 98304
    buffer_load_dwordx4 v5, s[8:11], s45 offen lds
    s_add_u32 m0, s40, 106496
    s_add_u32 s45, s42, 106496
    buffer_load_dwordx4 v5, s[8:11], s45 offen lds
    ds_read_b128 v[152:155], v5 offset:64512
    ds_read_b128 v[156:159], v2 offset:0
    ds_read_b128 v[160:163], v2 offset:1024
    ds_read_b128 v[164:167], v2 offset:2048
    ds_read_b128 v[168:171], v2 offset:3072
    s_waitcnt vmcnt(8)
    ds_read_b128 v[172:175], v2 offset:4096
    ds_read_b128 v[176:179], v2 offset:5120
    ds_read_b128 v[180:183], v2 offset:6144
    ds_read_b128 v[184:187], v2 offset:7168
    s_waitcnt lgkmcnt(8)
    v_mfma_f32_16x16x32_bf16 v[80:83], v[152:155], v[40:43], v[80:83]
    v_mfma_f32_16x16x32_bf16 v[116:119], v[152:155], v[44:47], v[116:119]
    s_waitcnt lgkmcnt(7)
    v_mfma_f32_16x16x32_bf16 v[84:87], v[156:159], v[40:43], v[84:87]
    v_mfma_f32_16x16x32_bf16 v[120:123], v[156:159], v[44:47], v[120:123]
    s_waitcnt lgkmcnt(6)
    v_mfma_f32_16x16x32_bf16 v[88:91], v[160:163], v[40:43], v[88:91]
    v_mfma_f32_16x16x32_bf16 v[124:127], v[160:163], v[44:47], v[124:127]
    s_waitcnt lgkmcnt(5)
    v_mfma_f32_16x16x32_bf16 v[92:95], v[164:167], v[40:43], v[92:95]
    v_mfma_f32_16x16x32_bf16 v[128:131], v[164:167], v[44:47], v[128:131]
    s_waitcnt lgkmcnt(4)
    v_mfma_f32_16x16x32_bf16 v[96:99], v[168:171], v[40:43], v[96:99]
    v_mfma_f32_16x16x32_bf16 v[132:135], v[168:171], v[44:47], v[132:135]
    ds_read_b128 v[152:155], v2 offset:8192
    ds_read_b128 v[156:159], v2 offset:9216
    ds_read_b128 v[160:163], v2 offset:10240
    ds_read_b128 v[164:167], v2 offset:11264
    ds_read_b128 v[168:171], v2 offset:12288
    s_waitcnt lgkmcnt(8)
    v_mfma_f32_16x16x32_bf16 v[100:103], v[172:175], v[40:43], v[100:103]
    v_mfma_f32_16x16x32_bf16 v[136:139], v[172:175], v[44:47], v[136:139]
    s_waitcnt lgkmcnt(7)
    v_mfma_f32_16x16x32_bf16 v[104:107], v[176:179], v[40:43], v[104:107]
    v_mfma_f32_16x16x32_bf16 v[140:143], v[176:179], v[44:47], v[140:143]
    s_waitcnt lgkmcnt(6)
    v_mfma_f32_16x16x32_bf16 v[108:111], v[180:183], v[40:43], v[108:111]
    v_mfma_f32_16x16x32_bf16 v[144:147], v[180:183], v[44:47], v[144:147]
    s_waitcnt lgkmcnt(5)
    v_mfma_f32_16x16x32_bf16 v[112:115], v[184:187], v[40:43], v[112:115]
    v_mfma_f32_16x16x32_bf16 v[148:151], v[184:187], v[44:47], v[148:151]
    s_add_u32 s39, s38, 10240
    buffer_load_dwordx4 v[32:35], v5, s[12:15], s39 offen
    s_add_u32 s39, s38, 28672
    buffer_load_dwordx4 v[36:39], v5, s[12:15], s39 offen
    s_waitcnt vmcnt(6)
    s_waitcnt lgkmcnt(4)
    v_mfma_f32_16x16x32_bf16 v[80:83], v[152:155], v[16:19], v[80:83]
    v_mfma_f32_16x16x32_bf16 v[116:119], v[152:155], v[20:23], v[116:119]
    s_waitcnt lgkmcnt(3)
    v_mfma_f32_16x16x32_bf16 v[84:87], v[156:159], v[16:19], v[84:87]
    v_mfma_f32_16x16x32_bf16 v[120:123], v[156:159], v[20:23], v[120:123]
    s_waitcnt lgkmcnt(2)
    v_mfma_f32_16x16x32_bf16 v[88:91], v[160:163], v[16:19], v[88:91]
    v_mfma_f32_16x16x32_bf16 v[124:127], v[160:163], v[20:23], v[124:127]
    s_waitcnt lgkmcnt(1)
    v_mfma_f32_16x16x32_bf16 v[92:95], v[164:167], v[16:19], v[92:95]
    v_mfma_f32_16x16x32_bf16 v[128:131], v[164:167], v[20:23], v[128:131]
    s_waitcnt lgkmcnt(0)
    v_mfma_f32_16x16x32_bf16 v[96:99], v[168:171], v[16:19], v[96:99]
    v_mfma_f32_16x16x32_bf16 v[132:135], v[168:171], v[20:23], v[132:135]
    s_barrier
    s_add_u32 m0, s40, 114688
    s_add_u32 s45, s42, 114688
    buffer_load_dwordx4 v5, s[8:11], s45 offen lds
    s_add_u32 m0, s40, 122880
    s_add_u32 s45, s42, 122880
    buffer_load_dwordx4 v5, s[8:11], s45 offen lds
    ds_read_b128 v[172:175], v2 offset:13312
    ds_read_b128 v[176:179], v2 offset:14336
    ds_read_b128 v[180:183], v2 offset:15360
    ds_read_b128 v[184:187], v2 offset:16384
    ds_read_b128 v[152:155], v2 offset:17408
    ds_read_b128 v[156:159], v2 offset:18432
    ds_read_b128 v[160:163], v2 offset:19456
    ds_read_b128 v[164:167], v2 offset:20480
    ds_read_b128 v[168:171], v2 offset:21504
    s_waitcnt lgkmcnt(8)
    v_mfma_f32_16x16x32_bf16 v[100:103], v[172:175], v[16:19], v[100:103]
    v_mfma_f32_16x16x32_bf16 v[136:139], v[172:175], v[20:23], v[136:139]
    s_waitcnt lgkmcnt(7)
    v_mfma_f32_16x16x32_bf16 v[104:107], v[176:179], v[16:19], v[104:107]
    v_mfma_f32_16x16x32_bf16 v[140:143], v[176:179], v[20:23], v[140:143]
    s_waitcnt lgkmcnt(6)
    v_mfma_f32_16x16x32_bf16 v[108:111], v[180:183], v[16:19], v[108:111]
    v_mfma_f32_16x16x32_bf16 v[144:147], v[180:183], v[20:23], v[144:147]
    s_waitcnt lgkmcnt(5)
    v_mfma_f32_16x16x32_bf16 v[112:115], v[184:187], v[16:19], v[112:115]
    v_mfma_f32_16x16x32_bf16 v[148:151], v[184:187], v[20:23], v[148:151]
    s_add_u32 s39, s38, 11264
    buffer_load_dwordx4 v[40:43], v5, s[12:15], s39 offen
    s_add_u32 s39, s38, 29696
    buffer_load_dwordx4 v[44:47], v5, s[12:15], s39 offen
    s_waitcnt vmcnt(8)
    ds_read_b128 v[172:175], v2 offset:22528
    ds_read_b128 v[176:179], v2 offset:23552
    ds_read_b128 v[180:183], v2 offset:24576
    ds_read_b128 v[184:187], v2 offset:25600
    s_waitcnt lgkmcnt(8)
    v_mfma_f32_16x16x32_bf16 v[80:83], v[152:155], v[24:27], v[80:83]
    v_mfma_f32_16x16x32_bf16 v[116:119], v[152:155], v[28:31], v[116:119]
    s_waitcnt lgkmcnt(7)
    v_mfma_f32_16x16x32_bf16 v[84:87], v[156:159], v[24:27], v[84:87]
    v_mfma_f32_16x16x32_bf16 v[120:123], v[156:159], v[28:31], v[120:123]
    s_waitcnt lgkmcnt(6)
    v_mfma_f32_16x16x32_bf16 v[88:91], v[160:163], v[24:27], v[88:91]
    v_mfma_f32_16x16x32_bf16 v[124:127], v[160:163], v[28:31], v[124:127]
    s_waitcnt lgkmcnt(5)
    v_mfma_f32_16x16x32_bf16 v[92:95], v[164:167], v[24:27], v[92:95]
    v_mfma_f32_16x16x32_bf16 v[128:131], v[164:167], v[28:31], v[128:131]
    s_waitcnt lgkmcnt(4)
    v_mfma_f32_16x16x32_bf16 v[96:99], v[168:171], v[24:27], v[96:99]
    v_mfma_f32_16x16x32_bf16 v[132:135], v[168:171], v[28:31], v[132:135]
    ds_read_b128 v[152:155], v2 offset:26624
    ds_read_b128 v[156:159], v2 offset:27648
    ds_read_b128 v[160:163], v2 offset:28672
    ds_read_b128 v[164:167], v2 offset:29696
    ds_read_b128 v[168:171], v2 offset:30720
    s_waitcnt lgkmcnt(8)
    v_mfma_f32_16x16x32_bf16 v[100:103], v[172:175], v[24:27], v[100:103]
    v_mfma_f32_16x16x32_bf16 v[136:139], v[172:175], v[28:31], v[136:139]
    s_waitcnt lgkmcnt(7)
    v_mfma_f32_16x16x32_bf16 v[104:107], v[176:179], v[24:27], v[104:107]
    v_mfma_f32_16x16x32_bf16 v[140:143], v[176:179], v[28:31], v[140:143]
    s_waitcnt lgkmcnt(6)
    v_mfma_f32_16x16x32_bf16 v[108:111], v[180:183], v[24:27], v[108:111]
    v_mfma_f32_16x16x32_bf16 v[144:147], v[180:183], v[28:31], v[144:147]
    s_waitcnt lgkmcnt(5)
    v_mfma_f32_16x16x32_bf16 v[112:115], v[184:187], v[24:27], v[112:115]
    v_mfma_f32_16x16x32_bf16 v[148:151], v[184:187], v[28:31], v[148:151]
    s_add_u32 s39, s38, 12288
    buffer_load_dwordx4 v[16:19], v5, s[12:15], s39 offen
    s_add_u32 s39, s38, 30720
    buffer_load_dwordx4 v[20:23], v5, s[12:15], s39 offen
    s_waitcnt vmcnt(6)
    s_waitcnt lgkmcnt(4)
    v_mfma_f32_16x16x32_bf16 v[80:83], v[152:155], v[32:35], v[80:83]
    v_mfma_f32_16x16x32_bf16 v[116:119], v[152:155], v[36:39], v[116:119]
    s_waitcnt lgkmcnt(3)
    v_mfma_f32_16x16x32_bf16 v[84:87], v[156:159], v[32:35], v[84:87]
    v_mfma_f32_16x16x32_bf16 v[120:123], v[156:159], v[36:39], v[120:123]
    s_waitcnt lgkmcnt(2)
    v_mfma_f32_16x16x32_bf16 v[88:91], v[160:163], v[32:35], v[88:91]
    v_mfma_f32_16x16x32_bf16 v[124:127], v[160:163], v[36:39], v[124:127]
    s_waitcnt lgkmcnt(1)
    v_mfma_f32_16x16x32_bf16 v[92:95], v[164:167], v[32:35], v[92:95]
    v_mfma_f32_16x16x32_bf16 v[128:131], v[164:167], v[36:39], v[128:131]
    s_waitcnt lgkmcnt(0)
    v_mfma_f32_16x16x32_bf16 v[96:99], v[168:171], v[32:35], v[96:99]
    v_mfma_f32_16x16x32_bf16 v[132:135], v[168:171], v[36:39], v[132:135]
    s_barrier
    s_add_u32 m0, s40, 131072
    s_add_u32 s45, s42, 131072
    buffer_load_dwordx4 v5, s[8:11], s45 offen lds
    s_add_u32 m0, s40, 139264
    s_add_u32 s45, s42, 139264
    buffer_load_dwordx4 v5, s[8:11], s45 offen lds
    ds_read_b128 v[172:175], v2 offset:31744
    ds_read_b128 v[176:179], v2 offset:32768
    ds_read_b128 v[180:183], v2 offset:33792
    ds_read_b128 v[184:187], v2 offset:34816
    ds_read_b128 v[152:155], v2 offset:35840
    ds_read_b128 v[156:159], v2 offset:36864
    ds_read_b128 v[160:163], v2 offset:37888
    ds_read_b128 v[164:167], v2 offset:38912
    ds_read_b128 v[168:171], v2 offset:39936
    s_waitcnt lgkmcnt(8)
    v_mfma_f32_16x16x32_bf16 v[100:103], v[172:175], v[32:35], v[100:103]
    v_mfma_f32_16x16x32_bf16 v[136:139], v[172:175], v[36:39], v[136:139]
    s_waitcnt lgkmcnt(7)
    v_mfma_f32_16x16x32_bf16 v[104:107], v[176:179], v[32:35], v[104:107]
    v_mfma_f32_16x16x32_bf16 v[140:143], v[176:179], v[36:39], v[140:143]
    s_waitcnt lgkmcnt(6)
    v_mfma_f32_16x16x32_bf16 v[108:111], v[180:183], v[32:35], v[108:111]
    v_mfma_f32_16x16x32_bf16 v[144:147], v[180:183], v[36:39], v[144:147]
    s_waitcnt lgkmcnt(5)
    v_mfma_f32_16x16x32_bf16 v[112:115], v[184:187], v[32:35], v[112:115]
    v_mfma_f32_16x16x32_bf16 v[148:151], v[184:187], v[36:39], v[148:151]
    s_add_u32 s39, s38, 13312
    buffer_load_dwordx4 v[24:27], v5, s[12:15], s39 offen
    s_add_u32 s39, s38, 31744
    buffer_load_dwordx4 v[28:31], v5, s[12:15], s39 offen
    s_waitcnt vmcnt(6)
    ds_read_b128 v[172:175], v2 offset:40960
    ds_read_b128 v[176:179], v2 offset:41984
    ds_read_b128 v[180:183], v2 offset:43008
    ds_read_b128 v[184:187], v2 offset:44032
    s_waitcnt lgkmcnt(8)
    v_mfma_f32_16x16x32_bf16 v[80:83], v[152:155], v[40:43], v[80:83]
    v_mfma_f32_16x16x32_bf16 v[116:119], v[152:155], v[44:47], v[116:119]
    s_waitcnt lgkmcnt(7)
    v_mfma_f32_16x16x32_bf16 v[84:87], v[156:159], v[40:43], v[84:87]
    v_mfma_f32_16x16x32_bf16 v[120:123], v[156:159], v[44:47], v[120:123]
    s_waitcnt lgkmcnt(6)
    v_mfma_f32_16x16x32_bf16 v[88:91], v[160:163], v[40:43], v[88:91]
    v_mfma_f32_16x16x32_bf16 v[124:127], v[160:163], v[44:47], v[124:127]
    s_waitcnt lgkmcnt(5)
    v_mfma_f32_16x16x32_bf16 v[92:95], v[164:167], v[40:43], v[92:95]
    v_mfma_f32_16x16x32_bf16 v[128:131], v[164:167], v[44:47], v[128:131]
    s_waitcnt lgkmcnt(4)
    v_mfma_f32_16x16x32_bf16 v[96:99], v[168:171], v[40:43], v[96:99]
    v_mfma_f32_16x16x32_bf16 v[132:135], v[168:171], v[44:47], v[132:135]
    s_waitcnt lgkmcnt(3)
    v_mfma_f32_16x16x32_bf16 v[100:103], v[172:175], v[40:43], v[100:103]
    v_mfma_f32_16x16x32_bf16 v[136:139], v[172:175], v[44:47], v[136:139]
    s_waitcnt lgkmcnt(2)
    v_mfma_f32_16x16x32_bf16 v[104:107], v[176:179], v[40:43], v[104:107]
    v_mfma_f32_16x16x32_bf16 v[140:143], v[176:179], v[44:47], v[140:143]
    s_waitcnt lgkmcnt(1)
    v_mfma_f32_16x16x32_bf16 v[108:111], v[180:183], v[40:43], v[108:111]
    v_mfma_f32_16x16x32_bf16 v[144:147], v[180:183], v[44:47], v[144:147]
    s_waitcnt lgkmcnt(0)
    v_mfma_f32_16x16x32_bf16 v[112:115], v[184:187], v[40:43], v[112:115]
    v_mfma_f32_16x16x32_bf16 v[148:151], v[184:187], v[44:47], v[148:151]
    s_add_u32 s39, s38, 14336
    buffer_load_dwordx4 v[32:35], v5, s[12:15], s39 offen
    s_add_u32 s39, s38, 32768
    buffer_load_dwordx4 v[36:39], v5, s[12:15], s39 offen
    s_barrier
    s_add_u32 m0, s40, 147456
    s_add_u32 s45, s42, 147456
    buffer_load_dwordx4 v5, s[8:11], s45 offen lds
    s_add_u32 m0, s40, 155648
    s_add_u32 s45, s42, 155648
    buffer_load_dwordx4 v5, s[8:11], s45 offen lds
    s_mov_b32 m0, s44
    s_add_u32 s45, s41, s44
    s_add_u32 s45, s45, 163840
    buffer_load_dwordx4 v5, s[8:11], s45 offen lds
    ds_read_b128 v[152:155], v2 offset:45056
    ds_read_b128 v[156:159], v2 offset:46080
    ds_read_b128 v[160:163], v2 offset:47104
    ds_read_b128 v[164:167], v2 offset:48128
    ds_read_b128 v[168:171], v2 offset:49152
    s_waitcnt vmcnt(9)
    ds_read_b128 v[172:175], v2 offset:50176
    ds_read_b128 v[176:179], v2 offset:51200
    ds_read_b128 v[180:183], v2 offset:52224
    ds_read_b128 v[184:187], v2 offset:53248
    s_waitcnt lgkmcnt(8)
    v_mfma_f32_16x16x32_bf16 v[80:83], v[152:155], v[16:19], v[80:83]
    v_mfma_f32_16x16x32_bf16 v[116:119], v[152:155], v[20:23], v[116:119]
    s_waitcnt lgkmcnt(7)
    v_mfma_f32_16x16x32_bf16 v[84:87], v[156:159], v[16:19], v[84:87]
    v_mfma_f32_16x16x32_bf16 v[120:123], v[156:159], v[20:23], v[120:123]
    s_waitcnt lgkmcnt(6)
    v_mfma_f32_16x16x32_bf16 v[88:91], v[160:163], v[16:19], v[88:91]
    v_mfma_f32_16x16x32_bf16 v[124:127], v[160:163], v[20:23], v[124:127]
    s_waitcnt lgkmcnt(5)
    v_mfma_f32_16x16x32_bf16 v[92:95], v[164:167], v[16:19], v[92:95]
    v_mfma_f32_16x16x32_bf16 v[128:131], v[164:167], v[20:23], v[128:131]
    s_waitcnt lgkmcnt(4)
    v_mfma_f32_16x16x32_bf16 v[96:99], v[168:171], v[16:19], v[96:99]
    v_mfma_f32_16x16x32_bf16 v[132:135], v[168:171], v[20:23], v[132:135]
    ds_read_b128 v[152:155], v2 offset:54272
    ds_read_b128 v[156:159], v2 offset:55296
    ds_read_b128 v[160:163], v2 offset:56320
    ds_read_b128 v[164:167], v2 offset:57344
    ds_read_b128 v[168:171], v2 offset:58368
    s_waitcnt lgkmcnt(8)
    v_mfma_f32_16x16x32_bf16 v[100:103], v[172:175], v[16:19], v[100:103]
    v_mfma_f32_16x16x32_bf16 v[136:139], v[172:175], v[20:23], v[136:139]
    s_waitcnt lgkmcnt(7)
    v_mfma_f32_16x16x32_bf16 v[104:107], v[176:179], v[16:19], v[104:107]
    v_mfma_f32_16x16x32_bf16 v[140:143], v[176:179], v[20:23], v[140:143]
    s_waitcnt lgkmcnt(6)
    v_mfma_f32_16x16x32_bf16 v[108:111], v[180:183], v[16:19], v[108:111]
    v_mfma_f32_16x16x32_bf16 v[144:147], v[180:183], v[20:23], v[144:147]
    s_waitcnt lgkmcnt(5)
    v_mfma_f32_16x16x32_bf16 v[112:115], v[184:187], v[16:19], v[112:115]
    v_mfma_f32_16x16x32_bf16 v[148:151], v[184:187], v[20:23], v[148:151]
    s_add_u32 s39, s38, 15360
    buffer_load_dwordx4 v[40:43], v5, s[12:15], s39 offen
    s_add_u32 s39, s38, 33792
    buffer_load_dwordx4 v[44:47], v5, s[12:15], s39 offen
    s_waitcnt vmcnt(7)
    ds_read_b128 v[172:175], v2 offset:59392
    ds_read_b128 v[176:179], v2 offset:60416
    ds_read_b128 v[180:183], v2 offset:61440
    ds_read_b128 v[184:187], v2 offset:62464
    s_waitcnt lgkmcnt(8)
    v_mfma_f32_16x16x32_bf16 v[80:83], v[152:155], v[24:27], v[80:83]
    v_mfma_f32_16x16x32_bf16 v[116:119], v[152:155], v[28:31], v[116:119]
    s_waitcnt lgkmcnt(7)
    v_mfma_f32_16x16x32_bf16 v[84:87], v[156:159], v[24:27], v[84:87]
    v_mfma_f32_16x16x32_bf16 v[120:123], v[156:159], v[28:31], v[120:123]
    s_waitcnt lgkmcnt(6)
    v_mfma_f32_16x16x32_bf16 v[88:91], v[160:163], v[24:27], v[88:91]
    v_mfma_f32_16x16x32_bf16 v[124:127], v[160:163], v[28:31], v[124:127]
    s_waitcnt lgkmcnt(5)
    v_mfma_f32_16x16x32_bf16 v[92:95], v[164:167], v[24:27], v[92:95]
    v_mfma_f32_16x16x32_bf16 v[128:131], v[164:167], v[28:31], v[128:131]
    s_waitcnt lgkmcnt(4)
    v_mfma_f32_16x16x32_bf16 v[96:99], v[168:171], v[24:27], v[96:99]
    v_mfma_f32_16x16x32_bf16 v[132:135], v[168:171], v[28:31], v[132:135]
    s_waitcnt lgkmcnt(3)
    v_mfma_f32_16x16x32_bf16 v[100:103], v[172:175], v[24:27], v[100:103]
    v_mfma_f32_16x16x32_bf16 v[136:139], v[172:175], v[28:31], v[136:139]
    s_waitcnt lgkmcnt(2)
    v_mfma_f32_16x16x32_bf16 v[104:107], v[176:179], v[24:27], v[104:107]
    v_mfma_f32_16x16x32_bf16 v[140:143], v[176:179], v[28:31], v[140:143]
    s_waitcnt lgkmcnt(1)
    v_mfma_f32_16x16x32_bf16 v[108:111], v[180:183], v[24:27], v[108:111]
    v_mfma_f32_16x16x32_bf16 v[144:147], v[180:183], v[28:31], v[144:147]
    s_waitcnt lgkmcnt(0)
    v_mfma_f32_16x16x32_bf16 v[112:115], v[184:187], v[24:27], v[112:115]
    v_mfma_f32_16x16x32_bf16 v[148:151], v[184:187], v[28:31], v[148:151]
    s_add_u32 s39, s38, 16384
    buffer_load_dwordx4 v[16:19], v5, s[12:15], s39 offen
    s_add_u32 s39, s38, 34816
    buffer_load_dwordx4 v[20:23], v5, s[12:15], s39 offen
    v_lshlrev_b32 v7, 3, v3
    v_lshl_add_u32 v7, v4, 7, v7
    s_lshl_b32 s36, s34, 11
    s_add_u32 s37, s36, 2048
    buffer_load_dwordx2 v[192:193], v7, s[16:19], s36 offen offset:0
    buffer_load_dwordx2 v[194:195], v7, s[16:19], s36 offen offset:512
    buffer_load_dwordx2 v[196:197], v7, s[16:19], s36 offen offset:1024
    buffer_load_dwordx2 v[198:199], v7, s[16:19], s36 offen offset:1536
    buffer_load_dwordx2 v[200:201], v7, s[16:19], s37 offen offset:0
    buffer_load_dwordx2 v[202:203], v7, s[16:19], s37 offen offset:512
    buffer_load_dwordx2 v[204:205], v7, s[16:19], s37 offen offset:1024
    buffer_load_dwordx2 v[206:207], v7, s[16:19], s37 offen offset:1536
    v_lshlrev_b32 v66, 5, v4
    v_lshlrev_b32 v67, 4, v4
    v_lshlrev_b32 v68, 3, v4
    s_mul_i32 s46, s32, 576
    s_mul_i32 s47, s32, 288
    buffer_load_dwordx4 v[208:211], v66, s[20:23], s46 offen offset:0
    buffer_load_dwordx4 v[212:215], v66, s[20:23], s46 offen offset:16
    buffer_load_dwordx4 v[48:51], v67, s[24:27], s47 offen offset:0
    buffer_load_dwordx4 v[216:219], v66, s[20:23], s46 offen offset:128
    buffer_load_dwordx4 v[220:223], v66, s[20:23], s46 offen offset:144
    buffer_load_dwordx4 v[52:55], v67, s[24:27], s47 offen offset:64
    buffer_load_dwordx4 v[224:227], v66, s[20:23], s46 offen offset:256
    buffer_load_dwordx4 v[228:231], v66, s[20:23], s46 offen offset:272
    buffer_load_dwordx4 v[56:59], v67, s[24:27], s47 offen offset:128
    buffer_load_dwordx4 v[232:235], v66, s[20:23], s46 offen offset:384
    buffer_load_dwordx4 v[236:239], v66, s[20:23], s46 offen offset:400
    buffer_load_dwordx4 v[60:63], v67, s[24:27], s47 offen offset:192
    buffer_load_dwordx4 v[240:243], v67, s[20:23], s46 offen offset:512
    buffer_load_dwordx2 v[64:65], v68, s[24:27], s47 offen offset:256
    s_barrier
    ds_read_b128 v[152:155], v2 offset:63488
    ds_read_b128 v[156:159], v2 offset:64512
    ds_read_b128 v[160:163], v0 offset:0
    ds_read_b128 v[164:167], v0 offset:1024
    ds_read_b128 v[168:171], v0 offset:2048
    s_waitcnt vmcnt(29)
    ds_read_b128 v[172:175], v0 offset:3072
    ds_read_b128 v[176:179], v0 offset:4096
    ds_read_b128 v[180:183], v0 offset:5120
    ds_read_b128 v[184:187], v0 offset:6144
    s_waitcnt lgkmcnt(8)
    v_mfma_f32_16x16x32_bf16 v[80:83], v[152:155], v[32:35], v[80:83]
    v_mfma_f32_16x16x32_bf16 v[116:119], v[152:155], v[36:39], v[116:119]
    s_waitcnt lgkmcnt(7)
    v_mfma_f32_16x16x32_bf16 v[84:87], v[156:159], v[32:35], v[84:87]
    v_mfma_f32_16x16x32_bf16 v[120:123], v[156:159], v[36:39], v[120:123]
    s_waitcnt lgkmcnt(6)
    v_mfma_f32_16x16x32_bf16 v[88:91], v[160:163], v[32:35], v[88:91]
    v_mfma_f32_16x16x32_bf16 v[124:127], v[160:163], v[36:39], v[124:127]
    s_waitcnt lgkmcnt(5)
    v_mfma_f32_16x16x32_bf16 v[92:95], v[164:167], v[32:35], v[92:95]
    v_mfma_f32_16x16x32_bf16 v[128:131], v[164:167], v[36:39], v[128:131]
    s_waitcnt lgkmcnt(4)
    v_mfma_f32_16x16x32_bf16 v[96:99], v[168:171], v[32:35], v[96:99]
    v_mfma_f32_16x16x32_bf16 v[132:135], v[168:171], v[36:39], v[132:135]
    ds_read_b128 v[152:155], v0 offset:7168
    ds_read_b128 v[156:159], v0 offset:8192
    ds_read_b128 v[160:163], v0 offset:9216
    ds_read_b128 v[164:167], v0 offset:10240
    ds_read_b128 v[168:171], v0 offset:11264
    s_waitcnt lgkmcnt(8)
    v_mfma_f32_16x16x32_bf16 v[100:103], v[172:175], v[32:35], v[100:103]
    v_mfma_f32_16x16x32_bf16 v[136:139], v[172:175], v[36:39], v[136:139]
    s_waitcnt lgkmcnt(7)
    v_mfma_f32_16x16x32_bf16 v[104:107], v[176:179], v[32:35], v[104:107]
    v_mfma_f32_16x16x32_bf16 v[140:143], v[176:179], v[36:39], v[140:143]
    s_waitcnt lgkmcnt(6)
    v_mfma_f32_16x16x32_bf16 v[108:111], v[180:183], v[32:35], v[108:111]
    v_mfma_f32_16x16x32_bf16 v[144:147], v[180:183], v[36:39], v[144:147]
    s_waitcnt lgkmcnt(5)
    v_mfma_f32_16x16x32_bf16 v[112:115], v[184:187], v[32:35], v[112:115]
    v_mfma_f32_16x16x32_bf16 v[148:151], v[184:187], v[36:39], v[148:151]
    s_add_u32 s39, s38, 17408
    buffer_load_dwordx4 v[24:27], v5, s[12:15], s39 offen
    s_add_u32 s39, s38, 35840
    buffer_load_dwordx4 v[28:31], v5, s[12:15], s39 offen
    s_waitcnt vmcnt(26)
    ds_read_b128 v[172:175], v0 offset:12288
    ds_read_b128 v[176:179], v0 offset:13312
    ds_read_b128 v[180:183], v0 offset:14336
    ds_read_b128 v[184:187], v0 offset:15360
    s_waitcnt lgkmcnt(8)
    v_mfma_f32_16x16x32_bf16 v[80:83], v[152:155], v[40:43], v[80:83]
    v_mfma_f32_16x16x32_bf16 v[116:119], v[152:155], v[44:47], v[116:119]
    s_waitcnt lgkmcnt(7)
    v_mfma_f32_16x16x32_bf16 v[84:87], v[156:159], v[40:43], v[84:87]
    v_mfma_f32_16x16x32_bf16 v[120:123], v[156:159], v[44:47], v[120:123]
    s_waitcnt lgkmcnt(6)
    v_mfma_f32_16x16x32_bf16 v[88:91], v[160:163], v[40:43], v[88:91]
    v_mfma_f32_16x16x32_bf16 v[124:127], v[160:163], v[44:47], v[124:127]
    s_waitcnt lgkmcnt(5)
    v_mfma_f32_16x16x32_bf16 v[92:95], v[164:167], v[40:43], v[92:95]
    v_mfma_f32_16x16x32_bf16 v[128:131], v[164:167], v[44:47], v[128:131]
    s_waitcnt lgkmcnt(4)
    v_mfma_f32_16x16x32_bf16 v[96:99], v[168:171], v[40:43], v[96:99]
    v_mfma_f32_16x16x32_bf16 v[132:135], v[168:171], v[44:47], v[132:135]
    s_waitcnt lgkmcnt(3)
    v_mfma_f32_16x16x32_bf16 v[100:103], v[172:175], v[40:43], v[100:103]
    v_mfma_f32_16x16x32_bf16 v[136:139], v[172:175], v[44:47], v[136:139]
    s_waitcnt lgkmcnt(2)
    v_mfma_f32_16x16x32_bf16 v[104:107], v[176:179], v[40:43], v[104:107]
    v_mfma_f32_16x16x32_bf16 v[140:143], v[176:179], v[44:47], v[140:143]
    s_waitcnt lgkmcnt(1)
    v_mfma_f32_16x16x32_bf16 v[108:111], v[180:183], v[40:43], v[108:111]
    v_mfma_f32_16x16x32_bf16 v[144:147], v[180:183], v[44:47], v[144:147]
    s_waitcnt lgkmcnt(0)
    v_mfma_f32_16x16x32_bf16 v[112:115], v[184:187], v[40:43], v[112:115]
    v_mfma_f32_16x16x32_bf16 v[148:151], v[184:187], v[44:47], v[148:151]
    s_barrier
    ds_read_b128 v[152:155], v0 offset:16384
    ds_read_b128 v[156:159], v0 offset:17408
    ds_read_b128 v[160:163], v0 offset:18432
    ds_read_b128 v[164:167], v0 offset:19456
    ds_read_b128 v[168:171], v0 offset:20480
    s_waitcnt vmcnt(24)
    ds_read_b128 v[172:175], v0 offset:21504
    ds_read_b128 v[176:179], v0 offset:22528
    ds_read_b128 v[180:183], v0 offset:23552
    ds_read_b128 v[184:187], v0 offset:24576
    s_waitcnt lgkmcnt(8)
    v_mfma_f32_16x16x32_bf16 v[80:83], v[152:155], v[16:19], v[80:83]
    v_mfma_f32_16x16x32_bf16 v[116:119], v[152:155], v[20:23], v[116:119]
    s_waitcnt lgkmcnt(7)
    v_mfma_f32_16x16x32_bf16 v[84:87], v[156:159], v[16:19], v[84:87]
    v_mfma_f32_16x16x32_bf16 v[120:123], v[156:159], v[20:23], v[120:123]
    s_waitcnt lgkmcnt(6)
    v_mfma_f32_16x16x32_bf16 v[88:91], v[160:163], v[16:19], v[88:91]
    v_mfma_f32_16x16x32_bf16 v[124:127], v[160:163], v[20:23], v[124:127]
    s_waitcnt lgkmcnt(5)
    v_mfma_f32_16x16x32_bf16 v[92:95], v[164:167], v[16:19], v[92:95]
    v_mfma_f32_16x16x32_bf16 v[128:131], v[164:167], v[20:23], v[128:131]
    s_waitcnt lgkmcnt(4)
    v_mfma_f32_16x16x32_bf16 v[96:99], v[168:171], v[16:19], v[96:99]
    v_mfma_f32_16x16x32_bf16 v[132:135], v[168:171], v[20:23], v[132:135]
    ds_read_b128 v[152:155], v0 offset:25600
    ds_read_b128 v[156:159], v0 offset:26624
    ds_read_b128 v[160:163], v0 offset:27648
    ds_read_b128 v[164:167], v0 offset:28672
    ds_read_b128 v[168:171], v0 offset:29696
    s_waitcnt lgkmcnt(8)
    v_mfma_f32_16x16x32_bf16 v[100:103], v[172:175], v[16:19], v[100:103]
    v_mfma_f32_16x16x32_bf16 v[136:139], v[172:175], v[20:23], v[136:139]
    s_waitcnt lgkmcnt(7)
    v_mfma_f32_16x16x32_bf16 v[104:107], v[176:179], v[16:19], v[104:107]
    v_mfma_f32_16x16x32_bf16 v[140:143], v[176:179], v[20:23], v[140:143]
    s_waitcnt lgkmcnt(6)
    v_mfma_f32_16x16x32_bf16 v[108:111], v[180:183], v[16:19], v[108:111]
    v_mfma_f32_16x16x32_bf16 v[144:147], v[180:183], v[20:23], v[144:147]
    s_waitcnt lgkmcnt(5)
    v_mfma_f32_16x16x32_bf16 v[112:115], v[184:187], v[16:19], v[112:115]
    v_mfma_f32_16x16x32_bf16 v[148:151], v[184:187], v[20:23], v[148:151]
    s_waitcnt vmcnt(0)
    s_waitcnt lgkmcnt(4)
    v_mfma_f32_16x16x32_bf16 v[80:83], v[152:155], v[24:27], v[80:83]
    v_mfma_f32_16x16x32_bf16 v[116:119], v[152:155], v[28:31], v[116:119]
    s_waitcnt lgkmcnt(3)
    v_mfma_f32_16x16x32_bf16 v[84:87], v[156:159], v[24:27], v[84:87]
    v_mfma_f32_16x16x32_bf16 v[120:123], v[156:159], v[28:31], v[120:123]
    s_waitcnt lgkmcnt(2)
    v_mfma_f32_16x16x32_bf16 v[88:91], v[160:163], v[24:27], v[88:91]
    v_mfma_f32_16x16x32_bf16 v[124:127], v[160:163], v[28:31], v[124:127]
    s_waitcnt lgkmcnt(1)
    v_mfma_f32_16x16x32_bf16 v[92:95], v[164:167], v[24:27], v[92:95]
    v_mfma_f32_16x16x32_bf16 v[128:131], v[164:167], v[28:31], v[128:131]
    s_waitcnt lgkmcnt(0)
    v_mfma_f32_16x16x32_bf16 v[96:99], v[168:171], v[24:27], v[96:99]
    v_mfma_f32_16x16x32_bf16 v[132:135], v[168:171], v[28:31], v[132:135]
    s_barrier
    ds_read_b128 v[172:175], v0 offset:30720
    ds_read_b128 v[176:179], v0 offset:31744
    ds_read_b128 v[180:183], v5 offset:0
    ds_read_b128 v[184:187], v5 offset:1024
    s_waitcnt lgkmcnt(3)
    v_mfma_f32_16x16x32_bf16 v[100:103], v[172:175], v[24:27], v[100:103]
    v_mfma_f32_16x16x32_bf16 v[136:139], v[172:175], v[28:31], v[136:139]
    s_waitcnt lgkmcnt(2)
    v_mfma_f32_16x16x32_bf16 v[104:107], v[176:179], v[24:27], v[104:107]
    v_mfma_f32_16x16x32_bf16 v[140:143], v[176:179], v[28:31], v[140:143]
    s_waitcnt lgkmcnt(1)
    v_mfma_f32_16x16x32_bf16 v[108:111], v[180:183], v[24:27], v[108:111]
    v_mfma_f32_16x16x32_bf16 v[144:147], v[180:183], v[28:31], v[144:147]
    s_waitcnt lgkmcnt(0)
    v_mfma_f32_16x16x32_bf16 v[112:115], v[184:187], v[24:27], v[112:115]
    v_mfma_f32_16x16x32_bf16 v[148:151], v[184:187], v[28:31], v[148:151]
    v_cmp_eq_u32 vcc, 3, v4
    v_mov_b32 v14, 0x42000000
    v_mov_b32 v13, 0x42400000
    v_cndmask_b32 v14, v14, v13, vcc
    v_add_f32 v8, v192, v194
    v_add_f32 v12, v196, v198
    v_add_f32 v8, v8, v12
    v_mul_f32 v8, v8, v14
    v_mov_b32 v12, v8
    s_nop 1
    v_permlane16_swap_b32 v8, v12
    v_add_f32 v8, v8, v12
    v_mov_b32 v12, v8
    s_nop 1
    v_permlane32_swap_b32 v8, v12
    v_add_f32 v8, v8, v12
    v_mul_f32 v8, 0x3ae38e39, v8
    v_mov_b32 v13, 0
    v_sub_f32 v12, v192, v8
    v_mul_f32 v12, v12, v12
    v_fmac_f32 v13, v12, v14
    v_add_f32 v13, v13, v193
    v_sub_f32 v12, v194, v8
    v_mul_f32 v12, v12, v12
    v_fmac_f32 v13, v12, v14
    v_add_f32 v13, v13, v195
    v_sub_f32 v12, v196, v8
    v_mul_f32 v12, v12, v12
    v_fmac_f32 v13, v12, v14
    v_add_f32 v13, v13, v197
    v_sub_f32 v12, v198, v8
    v_mul_f32 v12, v12, v12
    v_fmac_f32 v13, v12, v14
    v_add_f32 v13, v13, v199
    v_mov_b32 v12, v13
    s_nop 1
    v_permlane16_swap_b32 v13, v12
    v_add_f32 v13, v13, v12
    v_mov_b32 v12, v13
    s_nop 1
    v_permlane32_swap_b32 v13, v12
    v_add_f32 v13, v13, v12
    v_mul_f32 v13, 0x3ae38e39, v13
    v_cvt_pk_bf16_f32 v12, v8, v13
    v_lshlrev_b32 v8, 16, v12
    v_and_b32 v13, 0xffff0000, v12
    v_add_f32 v13, 0x3727c5ac, v13
    v_cvt_pk_bf16_f32 v12, v13, v13
    v_lshlrev_b32 v13, 16, v12
    v_sqrt_f32 v13, v13
    s_nop 0
    v_cvt_pk_bf16_f32 v12, v13, v13
    v_lshlrev_b32 v13, 16, v12
    v_rcp_f32 v9, v13
    v_add_f32 v10, v200, v202
    v_add_f32 v12, v204, v206
    v_add_f32 v10, v10, v12
    v_mul_f32 v10, v10, v14
    v_mov_b32 v12, v10
    s_nop 1
    v_permlane16_swap_b32 v10, v12
    v_add_f32 v10, v10, v12
    v_mov_b32 v12, v10
    s_nop 1
    v_permlane32_swap_b32 v10, v12
    v_add_f32 v10, v10, v12
    v_mul_f32 v10, 0x3ae38e39, v10
    v_mov_b32 v13, 0
    v_sub_f32 v12, v200, v10
    v_mul_f32 v12, v12, v12
    v_fmac_f32 v13, v12, v14
    v_add_f32 v13, v13, v201
    v_sub_f32 v12, v202, v10
    v_mul_f32 v12, v12, v12
    v_fmac_f32 v13, v12, v14
    v_add_f32 v13, v13, v203
    v_sub_f32 v12, v204, v10
    v_mul_f32 v12, v12, v12
    v_fmac_f32 v13, v12, v14
    v_add_f32 v13, v13, v205
    v_sub_f32 v12, v206, v10
    v_mul_f32 v12, v12, v12
    v_fmac_f32 v13, v12, v14
    v_add_f32 v13, v13, v207
    v_mov_b32 v12, v13
    s_nop 1
    v_permlane16_swap_b32 v13, v12
    v_add_f32 v13, v13, v12
    v_mov_b32 v12, v13
    s_nop 1
    v_permlane32_swap_b32 v13, v12
    v_add_f32 v13, v13, v12
    v_mul_f32 v13, 0x3ae38e39, v13
    v_cvt_pk_bf16_f32 v12, v10, v13
    v_lshlrev_b32 v10, 16, v12
    v_and_b32 v13, 0xffff0000, v12
    v_add_f32 v13, 0x3727c5ac, v13
    v_cvt_pk_bf16_f32 v12, v13, v13
    v_lshlrev_b32 v13, 16, v12
    v_sqrt_f32 v13, v13
    s_nop 0
    v_cvt_pk_bf16_f32 v12, v13, v13
    v_lshlrev_b32 v13, 16, v12
    v_rcp_f32 v11, v13
    s_mul_i32 s48, s32, 18
    v_add_u32 v13, s48, v4
    v_lshrrev_b32 v14, 2, v13
    v_and_b32 v15, 3, v13
    v_lshlrev_b32 v14, 10, v14
    v_lshl_add_u32 v14, v15, 8, v14
    v_lshl_add_u32 v14, v3, 4, v14
    v_lshrrev_b32 v13, 1, v4
    v_add_u32 v13, s48, v13
    v_add_u32 v13, 16, v13
    v_lshrrev_b32 v6, 2, v13
    v_and_b32 v15, 3, v13
    v_lshlrev_b32 v6, 10, v6
    v_lshl_add_u32 v6, v15, 8, v6
    v_lshl_add_u32 v6, v3, 4, v6
    v_and_b32 v15, 1, v4
    v_lshl_add_u32 v6, v15, 3, v6
    s_mul_i32 s49, s34, 147456
    s_add_u32 s50, s49, 147456
    s_waitcnt vmcnt(0)
    v_lshlrev_b32 v152, 16, v48
    v_and_b32 v153, 0xffff0000, v48
    v_lshlrev_b32 v154, 16, v49
    v_and_b32 v155, 0xffff0000, v49
    v_lshlrev_b32 v156, 16, v50
    v_and_b32 v157, 0xffff0000, v50
    v_lshlrev_b32 v158, 16, v51
    v_and_b32 v159, 0xffff0000, v51
    v_lshlrev_b32 v160, 16, v52
    v_and_b32 v161, 0xffff0000, v52
    v_lshlrev_b32 v162, 16, v53
    v_and_b32 v163, 0xffff0000, v53
    v_lshlrev_b32 v164, 16, v54
    v_and_b32 v165, 0xffff0000, v54
    v_lshlrev_b32 v166, 16, v55
    v_and_b32 v167, 0xffff0000, v55
    v_lshlrev_b32 v168, 16, v56
    v_and_b32 v169, 0xffff0000, v56
    v_lshlrev_b32 v170, 16, v57
    v_and_b32 v171, 0xffff0000, v57
    v_lshlrev_b32 v172, 16, v58
    v_and_b32 v173, 0xffff0000, v58
    v_lshlrev_b32 v174, 16, v59
    v_and_b32 v175, 0xffff0000, v59
    v_lshlrev_b32 v176, 16, v60
    v_and_b32 v177, 0xffff0000, v60
    v_lshlrev_b32 v178, 16, v61
    v_and_b32 v179, 0xffff0000, v61
    v_lshlrev_b32 v180, 16, v62
    v_and_b32 v181, 0xffff0000, v62
    v_lshlrev_b32 v182, 16, v63
    v_and_b32 v183, 0xffff0000, v63
    v_lshlrev_b32 v184, 16, v64
    v_and_b32 v185, 0xffff0000, v64
    v_lshlrev_b32 v186, 16, v65
    v_and_b32 v187, 0xffff0000, v65
    v_sub_f32 v70, 0, v8
    v_sub_f32 v71, 0, v8
    v_mov_b32 v72, v9
    v_mov_b32 v73, v9
    v_sub_f32 v74, 0, v10
    v_sub_f32 v75, 0, v10
    v_mov_b32 v76, v11
    v_mov_b32 v77, v11
    v_pk_fma_f32 v[80:81], v[208:209], v[70:71], v[80:81]
    v_pk_mul_f32 v[80:81], v[80:81], v[72:73]
    v_cvt_pk_bf16_f32 v78, v80, v81
    v_lshlrev_b32 v80, 16, v78
    v_and_b32 v81, 0xffff0000, v78
    v_pk_add_f32 v[80:81], v[80:81], v[152:153]
    v_cvt_pk_bf16_f32 v78, v80, v81
    v_pk_max_i16 v78, v78, 0
    v_lshlrev_b32 v80, 16, v78
    v_and_b32 v81, 0xffff0000, v78
    v_pk_mul_f32 v[80:81], v[80:81], v[80:81]
    v_cvt_pk_bf16_f32 v16, v80, v81
    v_pk_fma_f32 v[82:83], v[210:211], v[70:71], v[82:83]
    v_pk_mul_f32 v[82:83], v[82:83], v[72:73]
    v_cvt_pk_bf16_f32 v79, v82, v83
    v_lshlrev_b32 v82, 16, v79
    v_and_b32 v83, 0xffff0000, v79
    v_pk_add_f32 v[82:83], v[82:83], v[154:155]
    v_cvt_pk_bf16_f32 v79, v82, v83
    v_pk_max_i16 v79, v79, 0
    v_lshlrev_b32 v82, 16, v79
    v_and_b32 v83, 0xffff0000, v79
    v_pk_mul_f32 v[82:83], v[82:83], v[82:83]
    v_cvt_pk_bf16_f32 v17, v82, v83
    v_pk_fma_f32 v[84:85], v[212:213], v[70:71], v[84:85]
    v_pk_mul_f32 v[84:85], v[84:85], v[72:73]
    v_cvt_pk_bf16_f32 v78, v84, v85
    v_lshlrev_b32 v84, 16, v78
    v_and_b32 v85, 0xffff0000, v78
    v_pk_add_f32 v[84:85], v[84:85], v[156:157]
    v_cvt_pk_bf16_f32 v78, v84, v85
    v_pk_max_i16 v78, v78, 0
    v_lshlrev_b32 v84, 16, v78
    v_and_b32 v85, 0xffff0000, v78
    v_pk_mul_f32 v[84:85], v[84:85], v[84:85]
    v_cvt_pk_bf16_f32 v18, v84, v85
    v_pk_fma_f32 v[86:87], v[214:215], v[70:71], v[86:87]
    v_pk_mul_f32 v[86:87], v[86:87], v[72:73]
    v_cvt_pk_bf16_f32 v79, v86, v87
    v_lshlrev_b32 v86, 16, v79
    v_and_b32 v87, 0xffff0000, v79
    v_pk_add_f32 v[86:87], v[86:87], v[158:159]
    v_cvt_pk_bf16_f32 v79, v86, v87
    v_pk_max_i16 v79, v79, 0
    v_lshlrev_b32 v86, 16, v79
    v_and_b32 v87, 0xffff0000, v79
    v_pk_mul_f32 v[86:87], v[86:87], v[86:87]
    v_cvt_pk_bf16_f32 v19, v86, v87
    buffer_store_dwordx4 v[16:19], v14, s[28:31], s49 offen offset:0 sc1
    v_pk_fma_f32 v[88:89], v[216:217], v[70:71], v[88:89]
    v_pk_mul_f32 v[88:89], v[88:89], v[72:73]
    v_cvt_pk_bf16_f32 v78, v88, v89
    v_lshlrev_b32 v88, 16, v78
    v_and_b32 v89, 0xffff0000, v78
    v_pk_add_f32 v[88:89], v[88:89], v[160:161]
    v_cvt_pk_bf16_f32 v78, v88, v89
    v_pk_max_i16 v78, v78, 0
    v_lshlrev_b32 v88, 16, v78
    v_and_b32 v89, 0xffff0000, v78
    v_pk_mul_f32 v[88:89], v[88:89], v[88:89]
    v_cvt_pk_bf16_f32 v20, v88, v89
    v_pk_fma_f32 v[90:91], v[218:219], v[70:71], v[90:91]
    v_pk_mul_f32 v[90:91], v[90:91], v[72:73]
    v_cvt_pk_bf16_f32 v79, v90, v91
    v_lshlrev_b32 v90, 16, v79
    v_and_b32 v91, 0xffff0000, v79
    v_pk_add_f32 v[90:91], v[90:91], v[162:163]
    v_cvt_pk_bf16_f32 v79, v90, v91
    v_pk_max_i16 v79, v79, 0
    v_lshlrev_b32 v90, 16, v79
    v_and_b32 v91, 0xffff0000, v79
    v_pk_mul_f32 v[90:91], v[90:91], v[90:91]
    v_cvt_pk_bf16_f32 v21, v90, v91
    v_pk_fma_f32 v[92:93], v[220:221], v[70:71], v[92:93]
    v_pk_mul_f32 v[92:93], v[92:93], v[72:73]
    v_cvt_pk_bf16_f32 v78, v92, v93
    v_lshlrev_b32 v92, 16, v78
    v_and_b32 v93, 0xffff0000, v78
    v_pk_add_f32 v[92:93], v[92:93], v[164:165]
    v_cvt_pk_bf16_f32 v78, v92, v93
    v_pk_max_i16 v78, v78, 0
    v_lshlrev_b32 v92, 16, v78
    v_and_b32 v93, 0xffff0000, v78
    v_pk_mul_f32 v[92:93], v[92:93], v[92:93]
    v_cvt_pk_bf16_f32 v22, v92, v93
    v_pk_fma_f32 v[94:95], v[222:223], v[70:71], v[94:95]
    v_pk_mul_f32 v[94:95], v[94:95], v[72:73]
    v_cvt_pk_bf16_f32 v79, v94, v95
    v_lshlrev_b32 v94, 16, v79
    v_and_b32 v95, 0xffff0000, v79
    v_pk_add_f32 v[94:95], v[94:95], v[166:167]
    v_cvt_pk_bf16_f32 v79, v94, v95
    v_pk_max_i16 v79, v79, 0
    v_lshlrev_b32 v94, 16, v79
    v_and_b32 v95, 0xffff0000, v79
    v_pk_mul_f32 v[94:95], v[94:95], v[94:95]
    v_cvt_pk_bf16_f32 v23, v94, v95
    buffer_store_dwordx4 v[20:23], v14, s[28:31], s49 offen offset:1024 sc1
    v_pk_fma_f32 v[96:97], v[224:225], v[70:71], v[96:97]
    v_pk_mul_f32 v[96:97], v[96:97], v[72:73]
    v_cvt_pk_bf16_f32 v78, v96, v97
    v_lshlrev_b32 v96, 16, v78
    v_and_b32 v97, 0xffff0000, v78
    v_pk_add_f32 v[96:97], v[96:97], v[168:169]
    v_cvt_pk_bf16_f32 v78, v96, v97
    v_pk_max_i16 v78, v78, 0
    v_lshlrev_b32 v96, 16, v78
    v_and_b32 v97, 0xffff0000, v78
    v_pk_mul_f32 v[96:97], v[96:97], v[96:97]
    v_cvt_pk_bf16_f32 v24, v96, v97
    v_pk_fma_f32 v[98:99], v[226:227], v[70:71], v[98:99]
    v_pk_mul_f32 v[98:99], v[98:99], v[72:73]
    v_cvt_pk_bf16_f32 v79, v98, v99
    v_lshlrev_b32 v98, 16, v79
    v_and_b32 v99, 0xffff0000, v79
    v_pk_add_f32 v[98:99], v[98:99], v[170:171]
    v_cvt_pk_bf16_f32 v79, v98, v99
    v_pk_max_i16 v79, v79, 0
    v_lshlrev_b32 v98, 16, v79
    v_and_b32 v99, 0xffff0000, v79
    v_pk_mul_f32 v[98:99], v[98:99], v[98:99]
    v_cvt_pk_bf16_f32 v25, v98, v99
    v_pk_fma_f32 v[100:101], v[228:229], v[70:71], v[100:101]
    v_pk_mul_f32 v[100:101], v[100:101], v[72:73]
    v_cvt_pk_bf16_f32 v78, v100, v101
    v_lshlrev_b32 v100, 16, v78
    v_and_b32 v101, 0xffff0000, v78
    v_pk_add_f32 v[100:101], v[100:101], v[172:173]
    v_cvt_pk_bf16_f32 v78, v100, v101
    v_pk_max_i16 v78, v78, 0
    v_lshlrev_b32 v100, 16, v78
    v_and_b32 v101, 0xffff0000, v78
    v_pk_mul_f32 v[100:101], v[100:101], v[100:101]
    v_cvt_pk_bf16_f32 v26, v100, v101
    v_pk_fma_f32 v[102:103], v[230:231], v[70:71], v[102:103]
    v_pk_mul_f32 v[102:103], v[102:103], v[72:73]
    v_cvt_pk_bf16_f32 v79, v102, v103
    v_lshlrev_b32 v102, 16, v79
    v_and_b32 v103, 0xffff0000, v79
    v_pk_add_f32 v[102:103], v[102:103], v[174:175]
    v_cvt_pk_bf16_f32 v79, v102, v103
    v_pk_max_i16 v79, v79, 0
    v_lshlrev_b32 v102, 16, v79
    v_and_b32 v103, 0xffff0000, v79
    v_pk_mul_f32 v[102:103], v[102:103], v[102:103]
    v_cvt_pk_bf16_f32 v27, v102, v103
    buffer_store_dwordx4 v[24:27], v14, s[28:31], s49 offen offset:2048 sc1
    v_pk_fma_f32 v[104:105], v[232:233], v[70:71], v[104:105]
    v_pk_mul_f32 v[104:105], v[104:105], v[72:73]
    v_cvt_pk_bf16_f32 v78, v104, v105
    v_lshlrev_b32 v104, 16, v78
    v_and_b32 v105, 0xffff0000, v78
    v_pk_add_f32 v[104:105], v[104:105], v[176:177]
    v_cvt_pk_bf16_f32 v78, v104, v105
    v_pk_max_i16 v78, v78, 0
    v_lshlrev_b32 v104, 16, v78
    v_and_b32 v105, 0xffff0000, v78
    v_pk_mul_f32 v[104:105], v[104:105], v[104:105]
    v_cvt_pk_bf16_f32 v28, v104, v105
    v_pk_fma_f32 v[106:107], v[234:235], v[70:71], v[106:107]
    v_pk_mul_f32 v[106:107], v[106:107], v[72:73]
    v_cvt_pk_bf16_f32 v79, v106, v107
    v_lshlrev_b32 v106, 16, v79
    v_and_b32 v107, 0xffff0000, v79
    v_pk_add_f32 v[106:107], v[106:107], v[178:179]
    v_cvt_pk_bf16_f32 v79, v106, v107
    v_pk_max_i16 v79, v79, 0
    v_lshlrev_b32 v106, 16, v79
    v_and_b32 v107, 0xffff0000, v79
    v_pk_mul_f32 v[106:107], v[106:107], v[106:107]
    v_cvt_pk_bf16_f32 v29, v106, v107
    v_pk_fma_f32 v[108:109], v[236:237], v[70:71], v[108:109]
    v_pk_mul_f32 v[108:109], v[108:109], v[72:73]
    v_cvt_pk_bf16_f32 v78, v108, v109
    v_lshlrev_b32 v108, 16, v78
    v_and_b32 v109, 0xffff0000, v78
    v_pk_add_f32 v[108:109], v[108:109], v[180:181]
    v_cvt_pk_bf16_f32 v78, v108, v109
    v_pk_max_i16 v78, v78, 0
    v_lshlrev_b32 v108, 16, v78
    v_and_b32 v109, 0xffff0000, v78
    v_pk_mul_f32 v[108:109], v[108:109], v[108:109]
    v_cvt_pk_bf16_f32 v30, v108, v109
    v_pk_fma_f32 v[110:111], v[238:239], v[70:71], v[110:111]
    v_pk_mul_f32 v[110:111], v[110:111], v[72:73]
    v_cvt_pk_bf16_f32 v79, v110, v111
    v_lshlrev_b32 v110, 16, v79
    v_and_b32 v111, 0xffff0000, v79
    v_pk_add_f32 v[110:111], v[110:111], v[182:183]
    v_cvt_pk_bf16_f32 v79, v110, v111
    v_pk_max_i16 v79, v79, 0
    v_lshlrev_b32 v110, 16, v79
    v_and_b32 v111, 0xffff0000, v79
    v_pk_mul_f32 v[110:111], v[110:111], v[110:111]
    v_cvt_pk_bf16_f32 v31, v110, v111
    buffer_store_dwordx4 v[28:31], v14, s[28:31], s49 offen offset:3072 sc1
    v_pk_fma_f32 v[112:113], v[240:241], v[70:71], v[112:113]
    v_pk_mul_f32 v[112:113], v[112:113], v[72:73]
    v_cvt_pk_bf16_f32 v78, v112, v113
    v_lshlrev_b32 v112, 16, v78
    v_and_b32 v113, 0xffff0000, v78
    v_pk_add_f32 v[112:113], v[112:113], v[184:185]
    v_cvt_pk_bf16_f32 v78, v112, v113
    v_pk_max_i16 v78, v78, 0
    v_lshlrev_b32 v112, 16, v78
    v_and_b32 v113, 0xffff0000, v78
    v_pk_mul_f32 v[112:113], v[112:113], v[112:113]
    v_cvt_pk_bf16_f32 v32, v112, v113
    v_pk_fma_f32 v[114:115], v[242:243], v[70:71], v[114:115]
    v_pk_mul_f32 v[114:115], v[114:115], v[72:73]
    v_cvt_pk_bf16_f32 v79, v114, v115
    v_lshlrev_b32 v114, 16, v79
    v_and_b32 v115, 0xffff0000, v79
    v_pk_add_f32 v[114:115], v[114:115], v[186:187]
    v_cvt_pk_bf16_f32 v79, v114, v115
    v_pk_max_i16 v79, v79, 0
    v_lshlrev_b32 v114, 16, v79
    v_and_b32 v115, 0xffff0000, v79
    v_pk_mul_f32 v[114:115], v[114:115], v[114:115]
    v_cvt_pk_bf16_f32 v33, v114, v115
    buffer_store_dwordx2 v[32:33], v6, s[28:31], s49 offen sc1
    v_pk_fma_f32 v[116:117], v[208:209], v[74:75], v[116:117]
    v_pk_mul_f32 v[116:117], v[116:117], v[76:77]
    v_cvt_pk_bf16_f32 v78, v116, v117
    v_lshlrev_b32 v116, 16, v78
    v_and_b32 v117, 0xffff0000, v78
    v_pk_add_f32 v[116:117], v[116:117], v[152:153]
    v_cvt_pk_bf16_f32 v78, v116, v117
    v_pk_max_i16 v78, v78, 0
    v_lshlrev_b32 v116, 16, v78
    v_and_b32 v117, 0xffff0000, v78
    v_pk_mul_f32 v[116:117], v[116:117], v[116:117]
    v_cvt_pk_bf16_f32 v34, v116, v117
    v_pk_fma_f32 v[118:119], v[210:211], v[74:75], v[118:119]
    v_pk_mul_f32 v[118:119], v[118:119], v[76:77]
    v_cvt_pk_bf16_f32 v79, v118, v119
    v_lshlrev_b32 v118, 16, v79
    v_and_b32 v119, 0xffff0000, v79
    v_pk_add_f32 v[118:119], v[118:119], v[154:155]
    v_cvt_pk_bf16_f32 v79, v118, v119
    v_pk_max_i16 v79, v79, 0
    v_lshlrev_b32 v118, 16, v79
    v_and_b32 v119, 0xffff0000, v79
    v_pk_mul_f32 v[118:119], v[118:119], v[118:119]
    v_cvt_pk_bf16_f32 v35, v118, v119
    v_pk_fma_f32 v[120:121], v[212:213], v[74:75], v[120:121]
    v_pk_mul_f32 v[120:121], v[120:121], v[76:77]
    v_cvt_pk_bf16_f32 v78, v120, v121
    v_lshlrev_b32 v120, 16, v78
    v_and_b32 v121, 0xffff0000, v78
    v_pk_add_f32 v[120:121], v[120:121], v[156:157]
    v_cvt_pk_bf16_f32 v78, v120, v121
    v_pk_max_i16 v78, v78, 0
    v_lshlrev_b32 v120, 16, v78
    v_and_b32 v121, 0xffff0000, v78
    v_pk_mul_f32 v[120:121], v[120:121], v[120:121]
    v_cvt_pk_bf16_f32 v36, v120, v121
    v_pk_fma_f32 v[122:123], v[214:215], v[74:75], v[122:123]
    v_pk_mul_f32 v[122:123], v[122:123], v[76:77]
    v_cvt_pk_bf16_f32 v79, v122, v123
    v_lshlrev_b32 v122, 16, v79
    v_and_b32 v123, 0xffff0000, v79
    v_pk_add_f32 v[122:123], v[122:123], v[158:159]
    v_cvt_pk_bf16_f32 v79, v122, v123
    v_pk_max_i16 v79, v79, 0
    v_lshlrev_b32 v122, 16, v79
    v_and_b32 v123, 0xffff0000, v79
    v_pk_mul_f32 v[122:123], v[122:123], v[122:123]
    v_cvt_pk_bf16_f32 v37, v122, v123
    buffer_store_dwordx4 v[34:37], v14, s[28:31], s50 offen offset:0 sc1
    v_pk_fma_f32 v[124:125], v[216:217], v[74:75], v[124:125]
    v_pk_mul_f32 v[124:125], v[124:125], v[76:77]
    v_cvt_pk_bf16_f32 v78, v124, v125
    v_lshlrev_b32 v124, 16, v78
    v_and_b32 v125, 0xffff0000, v78
    v_pk_add_f32 v[124:125], v[124:125], v[160:161]
    v_cvt_pk_bf16_f32 v78, v124, v125
    v_pk_max_i16 v78, v78, 0
    v_lshlrev_b32 v124, 16, v78
    v_and_b32 v125, 0xffff0000, v78
    v_pk_mul_f32 v[124:125], v[124:125], v[124:125]
    v_cvt_pk_bf16_f32 v38, v124, v125
    v_pk_fma_f32 v[126:127], v[218:219], v[74:75], v[126:127]
    v_pk_mul_f32 v[126:127], v[126:127], v[76:77]
    v_cvt_pk_bf16_f32 v79, v126, v127
    v_lshlrev_b32 v126, 16, v79
    v_and_b32 v127, 0xffff0000, v79
    v_pk_add_f32 v[126:127], v[126:127], v[162:163]
    v_cvt_pk_bf16_f32 v79, v126, v127
    v_pk_max_i16 v79, v79, 0
    v_lshlrev_b32 v126, 16, v79
    v_and_b32 v127, 0xffff0000, v79
    v_pk_mul_f32 v[126:127], v[126:127], v[126:127]
    v_cvt_pk_bf16_f32 v39, v126, v127
    v_pk_fma_f32 v[128:129], v[220:221], v[74:75], v[128:129]
    v_pk_mul_f32 v[128:129], v[128:129], v[76:77]
    v_cvt_pk_bf16_f32 v78, v128, v129
    v_lshlrev_b32 v128, 16, v78
    v_and_b32 v129, 0xffff0000, v78
    v_pk_add_f32 v[128:129], v[128:129], v[164:165]
    v_cvt_pk_bf16_f32 v78, v128, v129
    v_pk_max_i16 v78, v78, 0
    v_lshlrev_b32 v128, 16, v78
    v_and_b32 v129, 0xffff0000, v78
    v_pk_mul_f32 v[128:129], v[128:129], v[128:129]
    v_cvt_pk_bf16_f32 v40, v128, v129
    v_pk_fma_f32 v[130:131], v[222:223], v[74:75], v[130:131]
    v_pk_mul_f32 v[130:131], v[130:131], v[76:77]
    v_cvt_pk_bf16_f32 v79, v130, v131
    v_lshlrev_b32 v130, 16, v79
    v_and_b32 v131, 0xffff0000, v79
    v_pk_add_f32 v[130:131], v[130:131], v[166:167]
    v_cvt_pk_bf16_f32 v79, v130, v131
    v_pk_max_i16 v79, v79, 0
    v_lshlrev_b32 v130, 16, v79
    v_and_b32 v131, 0xffff0000, v79
    v_pk_mul_f32 v[130:131], v[130:131], v[130:131]
    v_cvt_pk_bf16_f32 v41, v130, v131
    buffer_store_dwordx4 v[38:41], v14, s[28:31], s50 offen offset:1024 sc1
    v_pk_fma_f32 v[132:133], v[224:225], v[74:75], v[132:133]
    v_pk_mul_f32 v[132:133], v[132:133], v[76:77]
    v_cvt_pk_bf16_f32 v78, v132, v133
    v_lshlrev_b32 v132, 16, v78
    v_and_b32 v133, 0xffff0000, v78
    v_pk_add_f32 v[132:133], v[132:133], v[168:169]
    v_cvt_pk_bf16_f32 v78, v132, v133
    v_pk_max_i16 v78, v78, 0
    v_lshlrev_b32 v132, 16, v78
    v_and_b32 v133, 0xffff0000, v78
    v_pk_mul_f32 v[132:133], v[132:133], v[132:133]
    v_cvt_pk_bf16_f32 v42, v132, v133
    v_pk_fma_f32 v[134:135], v[226:227], v[74:75], v[134:135]
    v_pk_mul_f32 v[134:135], v[134:135], v[76:77]
    v_cvt_pk_bf16_f32 v79, v134, v135
    v_lshlrev_b32 v134, 16, v79
    v_and_b32 v135, 0xffff0000, v79
    v_pk_add_f32 v[134:135], v[134:135], v[170:171]
    v_cvt_pk_bf16_f32 v79, v134, v135
    v_pk_max_i16 v79, v79, 0
    v_lshlrev_b32 v134, 16, v79
    v_and_b32 v135, 0xffff0000, v79
    v_pk_mul_f32 v[134:135], v[134:135], v[134:135]
    v_cvt_pk_bf16_f32 v43, v134, v135
    v_pk_fma_f32 v[136:137], v[228:229], v[74:75], v[136:137]
    v_pk_mul_f32 v[136:137], v[136:137], v[76:77]
    v_cvt_pk_bf16_f32 v78, v136, v137
    v_lshlrev_b32 v136, 16, v78
    v_and_b32 v137, 0xffff0000, v78
    v_pk_add_f32 v[136:137], v[136:137], v[172:173]
    v_cvt_pk_bf16_f32 v78, v136, v137
    v_pk_max_i16 v78, v78, 0
    v_lshlrev_b32 v136, 16, v78
    v_and_b32 v137, 0xffff0000, v78
    v_pk_mul_f32 v[136:137], v[136:137], v[136:137]
    v_cvt_pk_bf16_f32 v44, v136, v137
    v_pk_fma_f32 v[138:139], v[230:231], v[74:75], v[138:139]
    v_pk_mul_f32 v[138:139], v[138:139], v[76:77]
    v_cvt_pk_bf16_f32 v79, v138, v139
    v_lshlrev_b32 v138, 16, v79
    v_and_b32 v139, 0xffff0000, v79
    v_pk_add_f32 v[138:139], v[138:139], v[174:175]
    v_cvt_pk_bf16_f32 v79, v138, v139
    v_pk_max_i16 v79, v79, 0
    v_lshlrev_b32 v138, 16, v79
    v_and_b32 v139, 0xffff0000, v79
    v_pk_mul_f32 v[138:139], v[138:139], v[138:139]
    v_cvt_pk_bf16_f32 v45, v138, v139
    buffer_store_dwordx4 v[42:45], v14, s[28:31], s50 offen offset:2048 sc1
    v_pk_fma_f32 v[140:141], v[232:233], v[74:75], v[140:141]
    v_pk_mul_f32 v[140:141], v[140:141], v[76:77]
    v_cvt_pk_bf16_f32 v78, v140, v141
    v_lshlrev_b32 v140, 16, v78
    v_and_b32 v141, 0xffff0000, v78
    v_pk_add_f32 v[140:141], v[140:141], v[176:177]
    v_cvt_pk_bf16_f32 v78, v140, v141
    v_pk_max_i16 v78, v78, 0
    v_lshlrev_b32 v140, 16, v78
    v_and_b32 v141, 0xffff0000, v78
    v_pk_mul_f32 v[140:141], v[140:141], v[140:141]
    v_cvt_pk_bf16_f32 v46, v140, v141
    v_pk_fma_f32 v[142:143], v[234:235], v[74:75], v[142:143]
    v_pk_mul_f32 v[142:143], v[142:143], v[76:77]
    v_cvt_pk_bf16_f32 v79, v142, v143
    v_lshlrev_b32 v142, 16, v79
    v_and_b32 v143, 0xffff0000, v79
    v_pk_add_f32 v[142:143], v[142:143], v[178:179]
    v_cvt_pk_bf16_f32 v79, v142, v143
    v_pk_max_i16 v79, v79, 0
    v_lshlrev_b32 v142, 16, v79
    v_and_b32 v143, 0xffff0000, v79
    v_pk_mul_f32 v[142:143], v[142:143], v[142:143]
    v_cvt_pk_bf16_f32 v47, v142, v143
    v_pk_fma_f32 v[144:145], v[236:237], v[74:75], v[144:145]
    v_pk_mul_f32 v[144:145], v[144:145], v[76:77]
    v_cvt_pk_bf16_f32 v78, v144, v145
    v_lshlrev_b32 v144, 16, v78
    v_and_b32 v145, 0xffff0000, v78
    v_pk_add_f32 v[144:145], v[144:145], v[180:181]
    v_cvt_pk_bf16_f32 v78, v144, v145
    v_pk_max_i16 v78, v78, 0
    v_lshlrev_b32 v144, 16, v78
    v_and_b32 v145, 0xffff0000, v78
    v_pk_mul_f32 v[144:145], v[144:145], v[144:145]
    v_cvt_pk_bf16_f32 v48, v144, v145
    v_pk_fma_f32 v[146:147], v[238:239], v[74:75], v[146:147]
    v_pk_mul_f32 v[146:147], v[146:147], v[76:77]
    v_cvt_pk_bf16_f32 v79, v146, v147
    v_lshlrev_b32 v146, 16, v79
    v_and_b32 v147, 0xffff0000, v79
    v_pk_add_f32 v[146:147], v[146:147], v[182:183]
    v_cvt_pk_bf16_f32 v79, v146, v147
    v_pk_max_i16 v79, v79, 0
    v_lshlrev_b32 v146, 16, v79
    v_and_b32 v147, 0xffff0000, v79
    v_pk_mul_f32 v[146:147], v[146:147], v[146:147]
    v_cvt_pk_bf16_f32 v49, v146, v147
    buffer_store_dwordx4 v[46:49], v14, s[28:31], s50 offen offset:3072 sc1
    v_pk_fma_f32 v[148:149], v[240:241], v[74:75], v[148:149]
    v_pk_mul_f32 v[148:149], v[148:149], v[76:77]
    v_cvt_pk_bf16_f32 v78, v148, v149
    v_lshlrev_b32 v148, 16, v78
    v_and_b32 v149, 0xffff0000, v78
    v_pk_add_f32 v[148:149], v[148:149], v[184:185]
    v_cvt_pk_bf16_f32 v78, v148, v149
    v_pk_max_i16 v78, v78, 0
    v_lshlrev_b32 v148, 16, v78
    v_and_b32 v149, 0xffff0000, v78
    v_pk_mul_f32 v[148:149], v[148:149], v[148:149]
    v_cvt_pk_bf16_f32 v50, v148, v149
    v_pk_fma_f32 v[150:151], v[242:243], v[74:75], v[150:151]
    v_pk_mul_f32 v[150:151], v[150:151], v[76:77]
    v_cvt_pk_bf16_f32 v79, v150, v151
    v_lshlrev_b32 v150, 16, v79
    v_and_b32 v151, 0xffff0000, v79
    v_pk_add_f32 v[150:151], v[150:151], v[186:187]
    v_cvt_pk_bf16_f32 v79, v150, v151
    v_pk_max_i16 v79, v79, 0
    v_lshlrev_b32 v150, 16, v79
    v_and_b32 v151, 0xffff0000, v79
    v_pk_mul_f32 v[150:151], v[150:151], v[150:151]
    v_cvt_pk_bf16_f32 v51, v150, v151
    buffer_store_dwordx2 v[50:51], v6, s[28:31], s50 offen sc1
    s_nop 0
.End_k3l0_kernel_1:
    s_endpgm
.globl k4l0_kernel
.p2align 8
.type k4l0_kernel,@function
k4l0_kernel:
    s_cmp_ge_u32 s2, 256
    s_cbranch_scc1 .End_k4l0_kernel_1
    s_load_dwordx2 s[4:5], s[0:1], 88
    s_load_dwordx2 s[6:7], s[0:1], 64
    s_load_dwordx2 s[52:53], s[0:1], 72
    v_and_b32 v1, 63, v0
    v_lshrrev_b32 v2, 6, v0
    s_nop 0
    v_readfirstlane_b32 s3, v2
    v_and_b32 v3, 15, v1
    v_lshrrev_b32 v4, 4, v1
    v_lshlrev_b32 v5, 4, v1
    s_lshr_b32 s34, s2, 3
    s_bfe_u32 s32, s2, 0x20001
    s_lshl_b32 s32, s32, 3
    s_and_b32 s35, s34, 7
    s_add_u32 s32, s32, s35
    s_and_b32 s33, s2, 1
    s_lshl_b32 s33, s33, 2
    s_lshr_b32 s34, s34, 3
    s_add_u32 s33, s33, s34
    s_waitcnt lgkmcnt(0)
    s_add_u32 s8, s4, 0x1000000
    s_addc_u32 s9, s5, 0
    s_and_b32 s9, s9, 0xffff
    s_mov_b32 s10, 0x5a0000
    s_mov_b32 s11, 0x20000
    s_add_u32 s12, s4, 0x2a00000
    s_addc_u32 s13, s5, 0
    s_and_b32 s13, s13, 0xffff
    s_mov_b32 s14, 0x1200000
    s_mov_b32 s15, 0x20000
    s_add_u32 s16, s4, 0x1a80000
    s_addc_u32 s17, s5, 0
    s_and_b32 s17, s17, 0xffff
    s_mov_b32 s18, 0x240000
    s_mov_b32 s19, 0x20000
    s_add_u32 s20, s4, 0x1d00000
    s_addc_u32 s21, s5, 0
    s_and_b32 s21, s21, 0xffff
    s_mov_b32 s22, 0x240000
    s_mov_b32 s23, 0x20000
    s_mov_b32 s24, s6
    s_mov_b32 s25, s7
    s_and_b32 s25, s25, 0xffff
    s_mov_b32 s26, 0x480
    s_mov_b32 s27, 0x20000
    s_add_u32 s28, s4, 0x2280000
    s_addc_u32 s29, s5, 0
    s_and_b32 s29, s29, 0xffff
    s_mov_b32 s30, 0x40000
    s_mov_b32 s31, 0x20000
    s_mul_i32 s35, s32, 589824
    s_mul_i32 s36, s3, 18432
    s_add_u32 s35, s35, s36
    s_mul_i32 s37, s33, 737280
    s_mul_i32 s38, s3, 92160
    s_add_u32 s37, s37, s38
    v_mov_b32 v7, 0x7ff00000
    v_cmp_gt_u32 vcc, 8, v3
    s_nop 1
    v_cndmask_b32 v6, v7, v5, vcc
    s_add_u32 s40, s35, 0
    buffer_load_dwordx4 v[92:95], v5, s[12:15], s40 offen
    s_add_u32 s40, s35, 147456
    buffer_load_dwordx4 v[96:99], v5, s[12:15], s40 offen
    s_add_u32 s40, s35, 294912
    buffer_load_dwordx4 v[100:103], v5, s[12:15], s40 offen
    s_add_u32 s40, s35, 442368
    buffer_load_dwordx4 v[104:107], v5, s[12:15], s40 offen
    s_add_u32 s39, s37, 0
    buffer_load_dwordx4 v[108:111], v5, s[8:11], s39 offen offset:0
    buffer_load_dwordx4 v[112:115], v5, s[8:11], s39 offen offset:1024
    buffer_load_dwordx4 v[116:119], v5, s[8:11], s39 offen offset:2048
    buffer_load_dwordx4 v[120:123], v5, s[8:11], s39 offen offset:3072
    s_add_u32 s39, s39, 4096
    buffer_load_dwordx4 v[124:127], v6, s[8:11], s39 offen
    s_add_u32 s40, s35, 1024
    buffer_load_dwordx4 v[128:131], v5, s[12:15], s40 offen
    s_add_u32 s40, s35, 148480
    buffer_load_dwordx4 v[132:135], v5, s[12:15], s40 offen
    s_add_u32 s40, s35, 295936
    buffer_load_dwordx4 v[136:139], v5, s[12:15], s40 offen
    s_add_u32 s40, s35, 443392
    buffer_load_dwordx4 v[140:143], v5, s[12:15], s40 offen
    s_add_u32 s39, s37, 5120
    buffer_load_dwordx4 v[144:147], v5, s[8:11], s39 offen offset:0
    buffer_load_dwordx4 v[148:151], v5, s[8:11], s39 offen offset:1024
    buffer_load_dwordx4 v[152:155], v5, s[8:11], s39 offen offset:2048
    buffer_load_dwordx4 v[156:159], v5, s[8:11], s39 offen offset:3072
    s_add_u32 s39, s39, 4096
    buffer_load_dwordx4 v[160:163], v6, s[8:11], s39 offen
    s_add_u32 s40, s35, 2048
    buffer_load_dwordx4 v[164:167], v5, s[12:15], s40 offen
    s_add_u32 s40, s35, 149504
    buffer_load_dwordx4 v[168:171], v5, s[12:15], s40 offen
    s_add_u32 s40, s35, 296960
    buffer_load_dwordx4 v[172:175], v5, s[12:15], s40 offen
    s_add_u32 s40, s35, 444416
    buffer_load_dwordx4 v[176:179], v5, s[12:15], s40 offen
    s_add_u32 s39, s37, 10240
    buffer_load_dwordx4 v[180:183], v5, s[8:11], s39 offen offset:0
    buffer_load_dwordx4 v[184:187], v5, s[8:11], s39 offen offset:1024
    buffer_load_dwordx4 v[188:191], v5, s[8:11], s39 offen offset:2048
    buffer_load_dwordx4 v[192:195], v5, s[8:11], s39 offen offset:3072
    s_add_u32 s39, s39, 4096
    buffer_load_dwordx4 v[196:199], v6, s[8:11], s39 offen
    s_add_u32 s40, s35, 3072
    buffer_load_dwordx4 v[200:203], v5, s[12:15], s40 offen
    s_add_u32 s40, s35, 150528
    buffer_load_dwordx4 v[204:207], v5, s[12:15], s40 offen
    s_add_u32 s40, s35, 297984
    buffer_load_dwordx4 v[208:211], v5, s[12:15], s40 offen
    s_add_u32 s40, s35, 445440
    buffer_load_dwordx4 v[212:215], v5, s[12:15], s40 offen
    s_add_u32 s39, s37, 15360
    buffer_load_dwordx4 v[216:219], v5, s[8:11], s39 offen offset:0
    buffer_load_dwordx4 v[220:223], v5, s[8:11], s39 offen offset:1024
    buffer_load_dwordx4 v[224:227], v5, s[8:11], s39 offen offset:2048
    buffer_load_dwordx4 v[228:231], v5, s[8:11], s39 offen offset:3072
    s_add_u32 s39, s39, 4096
    buffer_load_dwordx4 v[232:235], v6, s[8:11], s39 offen
    s_waitcnt vmcnt(32)
    s_waitcnt vmcnt(31)
    v_mfma_f32_16x16x32_bf16 v[12:15], v[108:111], v[92:95], 0
    v_mfma_f32_16x16x32_bf16 v[32:35], v[108:111], v[96:99], 0
    v_mfma_f32_16x16x32_bf16 v[52:55], v[108:111], v[100:103], 0
    v_mfma_f32_16x16x32_bf16 v[72:75], v[108:111], v[104:107], 0
    s_waitcnt vmcnt(30)
    v_mfma_f32_16x16x32_bf16 v[16:19], v[112:115], v[92:95], 0
    v_mfma_f32_16x16x32_bf16 v[36:39], v[112:115], v[96:99], 0
    v_mfma_f32_16x16x32_bf16 v[56:59], v[112:115], v[100:103], 0
    v_mfma_f32_16x16x32_bf16 v[76:79], v[112:115], v[104:107], 0
    s_waitcnt vmcnt(29)
    v_mfma_f32_16x16x32_bf16 v[20:23], v[116:119], v[92:95], 0
    v_mfma_f32_16x16x32_bf16 v[40:43], v[116:119], v[96:99], 0
    v_mfma_f32_16x16x32_bf16 v[60:63], v[116:119], v[100:103], 0
    v_mfma_f32_16x16x32_bf16 v[80:83], v[116:119], v[104:107], 0
    s_waitcnt vmcnt(28)
    v_mfma_f32_16x16x32_bf16 v[24:27], v[120:123], v[92:95], 0
    v_mfma_f32_16x16x32_bf16 v[44:47], v[120:123], v[96:99], 0
    v_mfma_f32_16x16x32_bf16 v[64:67], v[120:123], v[100:103], 0
    v_mfma_f32_16x16x32_bf16 v[84:87], v[120:123], v[104:107], 0
    s_waitcnt vmcnt(27)
    v_mfma_f32_16x16x32_bf16 v[28:31], v[124:127], v[92:95], 0
    v_mfma_f32_16x16x32_bf16 v[48:51], v[124:127], v[96:99], 0
    v_mfma_f32_16x16x32_bf16 v[68:71], v[124:127], v[100:103], 0
    v_mfma_f32_16x16x32_bf16 v[88:91], v[124:127], v[104:107], 0
    s_add_u32 s40, s35, 4096
    buffer_load_dwordx4 v[92:95], v5, s[12:15], s40 offen
    s_add_u32 s40, s35, 151552
    buffer_load_dwordx4 v[96:99], v5, s[12:15], s40 offen
    s_add_u32 s40, s35, 299008
    buffer_load_dwordx4 v[100:103], v5, s[12:15], s40 offen
    s_add_u32 s40, s35, 446464
    buffer_load_dwordx4 v[104:107], v5, s[12:15], s40 offen
    s_add_u32 s39, s37, 20480
    buffer_load_dwordx4 v[108:111], v5, s[8:11], s39 offen offset:0
    buffer_load_dwordx4 v[112:115], v5, s[8:11], s39 offen offset:1024
    buffer_load_dwordx4 v[116:119], v5, s[8:11], s39 offen offset:2048
    buffer_load_dwordx4 v[120:123], v5, s[8:11], s39 offen offset:3072
    s_add_u32 s39, s39, 4096
    buffer_load_dwordx4 v[124:127], v6, s[8:11], s39 offen
    s_waitcnt vmcnt(32)
    s_waitcnt vmcnt(31)
    v_mfma_f32_16x16x32_bf16 v[12:15], v[144:147], v[128:131], v[12:15]
    v_mfma_f32_16x16x32_bf16 v[32:35], v[144:147], v[132:135], v[32:35]
    v_mfma_f32_16x16x32_bf16 v[52:55], v[144:147], v[136:139], v[52:55]
    v_mfma_f32_16x16x32_bf16 v[72:75], v[144:147], v[140:143], v[72:75]
    s_waitcnt vmcnt(30)
    v_mfma_f32_16x16x32_bf16 v[16:19], v[148:151], v[128:131], v[16:19]
    v_mfma_f32_16x16x32_bf16 v[36:39], v[148:151], v[132:135], v[36:39]
    v_mfma_f32_16x16x32_bf16 v[56:59], v[148:151], v[136:139], v[56:59]
    v_mfma_f32_16x16x32_bf16 v[76:79], v[148:151], v[140:143], v[76:79]
    s_waitcnt vmcnt(29)
    v_mfma_f32_16x16x32_bf16 v[20:23], v[152:155], v[128:131], v[20:23]
    v_mfma_f32_16x16x32_bf16 v[40:43], v[152:155], v[132:135], v[40:43]
    v_mfma_f32_16x16x32_bf16 v[60:63], v[152:155], v[136:139], v[60:63]
    v_mfma_f32_16x16x32_bf16 v[80:83], v[152:155], v[140:143], v[80:83]
    s_waitcnt vmcnt(28)
    v_mfma_f32_16x16x32_bf16 v[24:27], v[156:159], v[128:131], v[24:27]
    v_mfma_f32_16x16x32_bf16 v[44:47], v[156:159], v[132:135], v[44:47]
    v_mfma_f32_16x16x32_bf16 v[64:67], v[156:159], v[136:139], v[64:67]
    v_mfma_f32_16x16x32_bf16 v[84:87], v[156:159], v[140:143], v[84:87]
    s_waitcnt vmcnt(27)
    v_mfma_f32_16x16x32_bf16 v[28:31], v[160:163], v[128:131], v[28:31]
    v_mfma_f32_16x16x32_bf16 v[48:51], v[160:163], v[132:135], v[48:51]
    v_mfma_f32_16x16x32_bf16 v[68:71], v[160:163], v[136:139], v[68:71]
    v_mfma_f32_16x16x32_bf16 v[88:91], v[160:163], v[140:143], v[88:91]
    s_add_u32 s40, s35, 5120
    buffer_load_dwordx4 v[128:131], v5, s[12:15], s40 offen
    s_add_u32 s40, s35, 152576
    buffer_load_dwordx4 v[132:135], v5, s[12:15], s40 offen
    s_add_u32 s40, s35, 300032
    buffer_load_dwordx4 v[136:139], v5, s[12:15], s40 offen
    s_add_u32 s40, s35, 447488
    buffer_load_dwordx4 v[140:143], v5, s[12:15], s40 offen
    s_add_u32 s39, s37, 25600
    buffer_load_dwordx4 v[144:147], v5, s[8:11], s39 offen offset:0
    buffer_load_dwordx4 v[148:151], v5, s[8:11], s39 offen offset:1024
    buffer_load_dwordx4 v[152:155], v5, s[8:11], s39 offen offset:2048
    buffer_load_dwordx4 v[156:159], v5, s[8:11], s39 offen offset:3072
    s_add_u32 s39, s39, 4096
    buffer_load_dwordx4 v[160:163], v6, s[8:11], s39 offen
    s_waitcnt vmcnt(32)
    s_waitcnt vmcnt(31)
    v_mfma_f32_16x16x32_bf16 v[12:15], v[180:183], v[164:167], v[12:15]
    v_mfma_f32_16x16x32_bf16 v[32:35], v[180:183], v[168:171], v[32:35]
    v_mfma_f32_16x16x32_bf16 v[52:55], v[180:183], v[172:175], v[52:55]
    v_mfma_f32_16x16x32_bf16 v[72:75], v[180:183], v[176:179], v[72:75]
    s_waitcnt vmcnt(30)
    v_mfma_f32_16x16x32_bf16 v[16:19], v[184:187], v[164:167], v[16:19]
    v_mfma_f32_16x16x32_bf16 v[36:39], v[184:187], v[168:171], v[36:39]
    v_mfma_f32_16x16x32_bf16 v[56:59], v[184:187], v[172:175], v[56:59]
    v_mfma_f32_16x16x32_bf16 v[76:79], v[184:187], v[176:179], v[76:79]
    s_waitcnt vmcnt(29)
    v_mfma_f32_16x16x32_bf16 v[20:23], v[188:191], v[164:167], v[20:23]
    v_mfma_f32_16x16x32_bf16 v[40:43], v[188:191], v[168:171], v[40:43]
    v_mfma_f32_16x16x32_bf16 v[60:63], v[188:191], v[172:175], v[60:63]
    v_mfma_f32_16x16x32_bf16 v[80:83], v[188:191], v[176:179], v[80:83]
    s_waitcnt vmcnt(28)
    v_mfma_f32_16x16x32_bf16 v[24:27], v[192:195], v[164:167], v[24:27]
    v_mfma_f32_16x16x32_bf16 v[44:47], v[192:195], v[168:171], v[44:47]
    v_mfma_f32_16x16x32_bf16 v[64:67], v[192:195], v[172:175], v[64:67]
    v_mfma_f32_16x16x32_bf16 v[84:87], v[192:195], v[176:179], v[84:87]
    s_waitcnt vmcnt(27)
    v_mfma_f32_16x16x32_bf16 v[28:31], v[196:199], v[164:167], v[28:31]
    v_mfma_f32_16x16x32_bf16 v[48:51], v[196:199], v[168:171], v[48:51]
    v_mfma_f32_16x16x32_bf16 v[68:71], v[196:199], v[172:175], v[68:71]
    v_mfma_f32_16x16x32_bf16 v[88:91], v[196:199], v[176:179], v[88:91]
    s_add_u32 s40, s35, 6144
    buffer_load_dwordx4 v[164:167], v5, s[12:15], s40 offen
    s_add_u32 s40, s35, 153600
    buffer_load_dwordx4 v[168:171], v5, s[12:15], s40 offen
    s_add_u32 s40, s35, 301056
    buffer_load_dwordx4 v[172:175], v5, s[12:15], s40 offen
    s_add_u32 s40, s35, 448512
    buffer_load_dwordx4 v[176:179], v5, s[12:15], s40 offen
    s_add_u32 s39, s37, 30720
    buffer_load_dwordx4 v[180:183], v5, s[8:11], s39 offen offset:0
    buffer_load_dwordx4 v[184:187], v5, s[8:11], s39 offen offset:1024
    buffer_load_dwordx4 v[188:191], v5, s[8:11], s39 offen offset:2048
    buffer_load_dwordx4 v[192:195], v5, s[8:11], s39 offen offset:3072
    s_add_u32 s39, s39, 4096
    buffer_load_dwordx4 v[196:199], v6, s[8:11], s39 offen
    s_waitcnt vmcnt(32)
    s_waitcnt vmcnt(31)
    v_mfma_f32_16x16x32_bf16 v[12:15], v[216:219], v[200:203], v[12:15]
    v_mfma_f32_16x16x32_bf16 v[32:35], v[216:219], v[204:207], v[32:35]
    v_mfma_f32_16x16x32_bf16 v[52:55], v[216:219], v[208:211], v[52:55]
    v_mfma_f32_16x16x32_bf16 v[72:75], v[216:219], v[212:215], v[72:75]
    s_waitcnt vmcnt(30)
    v_mfma_f32_16x16x32_bf16 v[16:19], v[220:223], v[200:203], v[16:19]
    v_mfma_f32_16x16x32_bf16 v[36:39], v[220:223], v[204:207], v[36:39]
    v_mfma_f32_16x16x32_bf16 v[56:59], v[220:223], v[208:211], v[56:59]
    v_mfma_f32_16x16x32_bf16 v[76:79], v[220:223], v[212:215], v[76:79]
    s_waitcnt vmcnt(29)
    v_mfma_f32_16x16x32_bf16 v[20:23], v[224:227], v[200:203], v[20:23]
    v_mfma_f32_16x16x32_bf16 v[40:43], v[224:227], v[204:207], v[40:43]
    v_mfma_f32_16x16x32_bf16 v[60:63], v[224:227], v[208:211], v[60:63]
    v_mfma_f32_16x16x32_bf16 v[80:83], v[224:227], v[212:215], v[80:83]
    s_waitcnt vmcnt(28)
    v_mfma_f32_16x16x32_bf16 v[24:27], v[228:231], v[200:203], v[24:27]
    v_mfma_f32_16x16x32_bf16 v[44:47], v[228:231], v[204:207], v[44:47]
    v_mfma_f32_16x16x32_bf16 v[64:67], v[228:231], v[208:211], v[64:67]
    v_mfma_f32_16x16x32_bf16 v[84:87], v[228:231], v[212:215], v[84:87]
    s_waitcnt vmcnt(27)
    v_mfma_f32_16x16x32_bf16 v[28:31], v[232:235], v[200:203], v[28:31]
    v_mfma_f32_16x16x32_bf16 v[48:51], v[232:235], v[204:207], v[48:51]
    v_mfma_f32_16x16x32_bf16 v[68:71], v[232:235], v[208:211], v[68:71]
    v_mfma_f32_16x16x32_bf16 v[88:91], v[232:235], v[212:215], v[88:91]
    s_add_u32 s40, s35, 7168
    buffer_load_dwordx4 v[200:203], v5, s[12:15], s40 offen
    s_add_u32 s40, s35, 154624
    buffer_load_dwordx4 v[204:207], v5, s[12:15], s40 offen
    s_add_u32 s40, s35, 302080
    buffer_load_dwordx4 v[208:211], v5, s[12:15], s40 offen
    s_add_u32 s40, s35, 449536
    buffer_load_dwordx4 v[212:215], v5, s[12:15], s40 offen
    s_add_u32 s39, s37, 35840
    buffer_load_dwordx4 v[216:219], v5, s[8:11], s39 offen offset:0
    buffer_load_dwordx4 v[220:223], v5, s[8:11], s39 offen offset:1024
    buffer_load_dwordx4 v[224:227], v5, s[8:11], s39 offen offset:2048
    buffer_load_dwordx4 v[228:231], v5, s[8:11], s39 offen offset:3072
    s_add_u32 s39, s39, 4096
    buffer_load_dwordx4 v[232:235], v6, s[8:11], s39 offen
    s_waitcnt vmcnt(32)
    s_waitcnt vmcnt(31)
    v_mfma_f32_16x16x32_bf16 v[12:15], v[108:111], v[92:95], v[12:15]
    v_mfma_f32_16x16x32_bf16 v[32:35], v[108:111], v[96:99], v[32:35]
    v_mfma_f32_16x16x32_bf16 v[52:55], v[108:111], v[100:103], v[52:55]
    v_mfma_f32_16x16x32_bf16 v[72:75], v[108:111], v[104:107], v[72:75]
    s_waitcnt vmcnt(30)
    v_mfma_f32_16x16x32_bf16 v[16:19], v[112:115], v[92:95], v[16:19]
    v_mfma_f32_16x16x32_bf16 v[36:39], v[112:115], v[96:99], v[36:39]
    v_mfma_f32_16x16x32_bf16 v[56:59], v[112:115], v[100:103], v[56:59]
    v_mfma_f32_16x16x32_bf16 v[76:79], v[112:115], v[104:107], v[76:79]
    s_waitcnt vmcnt(29)
    v_mfma_f32_16x16x32_bf16 v[20:23], v[116:119], v[92:95], v[20:23]
    v_mfma_f32_16x16x32_bf16 v[40:43], v[116:119], v[96:99], v[40:43]
    v_mfma_f32_16x16x32_bf16 v[60:63], v[116:119], v[100:103], v[60:63]
    v_mfma_f32_16x16x32_bf16 v[80:83], v[116:119], v[104:107], v[80:83]
    s_waitcnt vmcnt(28)
    v_mfma_f32_16x16x32_bf16 v[24:27], v[120:123], v[92:95], v[24:27]
    v_mfma_f32_16x16x32_bf16 v[44:47], v[120:123], v[96:99], v[44:47]
    v_mfma_f32_16x16x32_bf16 v[64:67], v[120:123], v[100:103], v[64:67]
    v_mfma_f32_16x16x32_bf16 v[84:87], v[120:123], v[104:107], v[84:87]
    s_waitcnt vmcnt(27)
    v_mfma_f32_16x16x32_bf16 v[28:31], v[124:127], v[92:95], v[28:31]
    v_mfma_f32_16x16x32_bf16 v[48:51], v[124:127], v[96:99], v[48:51]
    v_mfma_f32_16x16x32_bf16 v[68:71], v[124:127], v[100:103], v[68:71]
    v_mfma_f32_16x16x32_bf16 v[88:91], v[124:127], v[104:107], v[88:91]
    s_add_u32 s40, s35, 8192
    buffer_load_dwordx4 v[92:95], v5, s[12:15], s40 offen
    s_add_u32 s40, s35, 155648
    buffer_load_dwordx4 v[96:99], v5, s[12:15], s40 offen
    s_add_u32 s40, s35, 303104
    buffer_load_dwordx4 v[100:103], v5, s[12:15], s40 offen
    s_add_u32 s40, s35, 450560
    buffer_load_dwordx4 v[104:107], v5, s[12:15], s40 offen
    s_add_u32 s39, s37, 40960
    buffer_load_dwordx4 v[108:111], v5, s[8:11], s39 offen offset:0
    buffer_load_dwordx4 v[112:115], v5, s[8:11], s39 offen offset:1024
    buffer_load_dwordx4 v[116:119], v5, s[8:11], s39 offen offset:2048
    buffer_load_dwordx4 v[120:123], v5, s[8:11], s39 offen offset:3072
    s_add_u32 s39, s39, 4096
    buffer_load_dwordx4 v[124:127], v6, s[8:11], s39 offen
    s_waitcnt vmcnt(32)
    s_waitcnt vmcnt(31)
    v_mfma_f32_16x16x32_bf16 v[12:15], v[144:147], v[128:131], v[12:15]
    v_mfma_f32_16x16x32_bf16 v[32:35], v[144:147], v[132:135], v[32:35]
    v_mfma_f32_16x16x32_bf16 v[52:55], v[144:147], v[136:139], v[52:55]
    v_mfma_f32_16x16x32_bf16 v[72:75], v[144:147], v[140:143], v[72:75]
    s_waitcnt vmcnt(30)
    v_mfma_f32_16x16x32_bf16 v[16:19], v[148:151], v[128:131], v[16:19]
    v_mfma_f32_16x16x32_bf16 v[36:39], v[148:151], v[132:135], v[36:39]
    v_mfma_f32_16x16x32_bf16 v[56:59], v[148:151], v[136:139], v[56:59]
    v_mfma_f32_16x16x32_bf16 v[76:79], v[148:151], v[140:143], v[76:79]
    s_waitcnt vmcnt(29)
    v_mfma_f32_16x16x32_bf16 v[20:23], v[152:155], v[128:131], v[20:23]
    v_mfma_f32_16x16x32_bf16 v[40:43], v[152:155], v[132:135], v[40:43]
    v_mfma_f32_16x16x32_bf16 v[60:63], v[152:155], v[136:139], v[60:63]
    v_mfma_f32_16x16x32_bf16 v[80:83], v[152:155], v[140:143], v[80:83]
    s_waitcnt vmcnt(28)
    v_mfma_f32_16x16x32_bf16 v[24:27], v[156:159], v[128:131], v[24:27]
    v_mfma_f32_16x16x32_bf16 v[44:47], v[156:159], v[132:135], v[44:47]
    v_mfma_f32_16x16x32_bf16 v[64:67], v[156:159], v[136:139], v[64:67]
    v_mfma_f32_16x16x32_bf16 v[84:87], v[156:159], v[140:143], v[84:87]
    s_waitcnt vmcnt(27)
    v_mfma_f32_16x16x32_bf16 v[28:31], v[160:163], v[128:131], v[28:31]
    v_mfma_f32_16x16x32_bf16 v[48:51], v[160:163], v[132:135], v[48:51]
    v_mfma_f32_16x16x32_bf16 v[68:71], v[160:163], v[136:139], v[68:71]
    v_mfma_f32_16x16x32_bf16 v[88:91], v[160:163], v[140:143], v[88:91]
    s_add_u32 s40, s35, 9216
    buffer_load_dwordx4 v[128:131], v5, s[12:15], s40 offen
    s_add_u32 s40, s35, 156672
    buffer_load_dwordx4 v[132:135], v5, s[12:15], s40 offen
    s_add_u32 s40, s35, 304128
    buffer_load_dwordx4 v[136:139], v5, s[12:15], s40 offen
    s_add_u32 s40, s35, 451584
    buffer_load_dwordx4 v[140:143], v5, s[12:15], s40 offen
    s_add_u32 s39, s37, 46080
    buffer_load_dwordx4 v[144:147], v5, s[8:11], s39 offen offset:0
    buffer_load_dwordx4 v[148:151], v5, s[8:11], s39 offen offset:1024
    buffer_load_dwordx4 v[152:155], v5, s[8:11], s39 offen offset:2048
    buffer_load_dwordx4 v[156:159], v5, s[8:11], s39 offen offset:3072
    s_add_u32 s39, s39, 4096
    buffer_load_dwordx4 v[160:163], v6, s[8:11], s39 offen
    s_waitcnt vmcnt(32)
    s_waitcnt vmcnt(31)
    v_mfma_f32_16x16x32_bf16 v[12:15], v[180:183], v[164:167], v[12:15]
    v_mfma_f32_16x16x32_bf16 v[32:35], v[180:183], v[168:171], v[32:35]
    v_mfma_f32_16x16x32_bf16 v[52:55], v[180:183], v[172:175], v[52:55]
    v_mfma_f32_16x16x32_bf16 v[72:75], v[180:183], v[176:179], v[72:75]
    s_waitcnt vmcnt(30)
    v_mfma_f32_16x16x32_bf16 v[16:19], v[184:187], v[164:167], v[16:19]
    v_mfma_f32_16x16x32_bf16 v[36:39], v[184:187], v[168:171], v[36:39]
    v_mfma_f32_16x16x32_bf16 v[56:59], v[184:187], v[172:175], v[56:59]
    v_mfma_f32_16x16x32_bf16 v[76:79], v[184:187], v[176:179], v[76:79]
    s_waitcnt vmcnt(29)
    v_mfma_f32_16x16x32_bf16 v[20:23], v[188:191], v[164:167], v[20:23]
    v_mfma_f32_16x16x32_bf16 v[40:43], v[188:191], v[168:171], v[40:43]
    v_mfma_f32_16x16x32_bf16 v[60:63], v[188:191], v[172:175], v[60:63]
    v_mfma_f32_16x16x32_bf16 v[80:83], v[188:191], v[176:179], v[80:83]
    s_waitcnt vmcnt(28)
    v_mfma_f32_16x16x32_bf16 v[24:27], v[192:195], v[164:167], v[24:27]
    v_mfma_f32_16x16x32_bf16 v[44:47], v[192:195], v[168:171], v[44:47]
    v_mfma_f32_16x16x32_bf16 v[64:67], v[192:195], v[172:175], v[64:67]
    v_mfma_f32_16x16x32_bf16 v[84:87], v[192:195], v[176:179], v[84:87]
    s_waitcnt vmcnt(27)
    v_mfma_f32_16x16x32_bf16 v[28:31], v[196:199], v[164:167], v[28:31]
    v_mfma_f32_16x16x32_bf16 v[48:51], v[196:199], v[168:171], v[48:51]
    v_mfma_f32_16x16x32_bf16 v[68:71], v[196:199], v[172:175], v[68:71]
    v_mfma_f32_16x16x32_bf16 v[88:91], v[196:199], v[176:179], v[88:91]
    s_add_u32 s40, s35, 10240
    buffer_load_dwordx4 v[164:167], v5, s[12:15], s40 offen
    s_add_u32 s40, s35, 157696
    buffer_load_dwordx4 v[168:171], v5, s[12:15], s40 offen
    s_add_u32 s40, s35, 305152
    buffer_load_dwordx4 v[172:175], v5, s[12:15], s40 offen
    s_add_u32 s40, s35, 452608
    buffer_load_dwordx4 v[176:179], v5, s[12:15], s40 offen
    s_add_u32 s39, s37, 51200
    buffer_load_dwordx4 v[180:183], v5, s[8:11], s39 offen offset:0
    buffer_load_dwordx4 v[184:187], v5, s[8:11], s39 offen offset:1024
    buffer_load_dwordx4 v[188:191], v5, s[8:11], s39 offen offset:2048
    buffer_load_dwordx4 v[192:195], v5, s[8:11], s39 offen offset:3072
    s_add_u32 s39, s39, 4096
    buffer_load_dwordx4 v[196:199], v6, s[8:11], s39 offen
    s_waitcnt vmcnt(32)
    s_waitcnt vmcnt(31)
    v_mfma_f32_16x16x32_bf16 v[12:15], v[216:219], v[200:203], v[12:15]
    v_mfma_f32_16x16x32_bf16 v[32:35], v[216:219], v[204:207], v[32:35]
    v_mfma_f32_16x16x32_bf16 v[52:55], v[216:219], v[208:211], v[52:55]
    v_mfma_f32_16x16x32_bf16 v[72:75], v[216:219], v[212:215], v[72:75]
    s_waitcnt vmcnt(30)
    v_mfma_f32_16x16x32_bf16 v[16:19], v[220:223], v[200:203], v[16:19]
    v_mfma_f32_16x16x32_bf16 v[36:39], v[220:223], v[204:207], v[36:39]
    v_mfma_f32_16x16x32_bf16 v[56:59], v[220:223], v[208:211], v[56:59]
    v_mfma_f32_16x16x32_bf16 v[76:79], v[220:223], v[212:215], v[76:79]
    s_waitcnt vmcnt(29)
    v_mfma_f32_16x16x32_bf16 v[20:23], v[224:227], v[200:203], v[20:23]
    v_mfma_f32_16x16x32_bf16 v[40:43], v[224:227], v[204:207], v[40:43]
    v_mfma_f32_16x16x32_bf16 v[60:63], v[224:227], v[208:211], v[60:63]
    v_mfma_f32_16x16x32_bf16 v[80:83], v[224:227], v[212:215], v[80:83]
    s_waitcnt vmcnt(28)
    v_mfma_f32_16x16x32_bf16 v[24:27], v[228:231], v[200:203], v[24:27]
    v_mfma_f32_16x16x32_bf16 v[44:47], v[228:231], v[204:207], v[44:47]
    v_mfma_f32_16x16x32_bf16 v[64:67], v[228:231], v[208:211], v[64:67]
    v_mfma_f32_16x16x32_bf16 v[84:87], v[228:231], v[212:215], v[84:87]
    s_waitcnt vmcnt(27)
    v_mfma_f32_16x16x32_bf16 v[28:31], v[232:235], v[200:203], v[28:31]
    v_mfma_f32_16x16x32_bf16 v[48:51], v[232:235], v[204:207], v[48:51]
    v_mfma_f32_16x16x32_bf16 v[68:71], v[232:235], v[208:211], v[68:71]
    v_mfma_f32_16x16x32_bf16 v[88:91], v[232:235], v[212:215], v[88:91]
    s_add_u32 s40, s35, 11264
    buffer_load_dwordx4 v[200:203], v5, s[12:15], s40 offen
    s_add_u32 s40, s35, 158720
    buffer_load_dwordx4 v[204:207], v5, s[12:15], s40 offen
    s_add_u32 s40, s35, 306176
    buffer_load_dwordx4 v[208:211], v5, s[12:15], s40 offen
    s_add_u32 s40, s35, 453632
    buffer_load_dwordx4 v[212:215], v5, s[12:15], s40 offen
    s_add_u32 s39, s37, 56320
    buffer_load_dwordx4 v[216:219], v5, s[8:11], s39 offen offset:0
    buffer_load_dwordx4 v[220:223], v5, s[8:11], s39 offen offset:1024
    buffer_load_dwordx4 v[224:227], v5, s[8:11], s39 offen offset:2048
    buffer_load_dwordx4 v[228:231], v5, s[8:11], s39 offen offset:3072
    s_add_u32 s39, s39, 4096
    buffer_load_dwordx4 v[232:235], v6, s[8:11], s39 offen
    s_waitcnt vmcnt(32)
    s_waitcnt vmcnt(31)
    v_mfma_f32_16x16x32_bf16 v[12:15], v[108:111], v[92:95], v[12:15]
    v_mfma_f32_16x16x32_bf16 v[32:35], v[108:111], v[96:99], v[32:35]
    v_mfma_f32_16x16x32_bf16 v[52:55], v[108:111], v[100:103], v[52:55]
    v_mfma_f32_16x16x32_bf16 v[72:75], v[108:111], v[104:107], v[72:75]
    s_waitcnt vmcnt(30)
    v_mfma_f32_16x16x32_bf16 v[16:19], v[112:115], v[92:95], v[16:19]
    v_mfma_f32_16x16x32_bf16 v[36:39], v[112:115], v[96:99], v[36:39]
    v_mfma_f32_16x16x32_bf16 v[56:59], v[112:115], v[100:103], v[56:59]
    v_mfma_f32_16x16x32_bf16 v[76:79], v[112:115], v[104:107], v[76:79]
    s_waitcnt vmcnt(29)
    v_mfma_f32_16x16x32_bf16 v[20:23], v[116:119], v[92:95], v[20:23]
    v_mfma_f32_16x16x32_bf16 v[40:43], v[116:119], v[96:99], v[40:43]
    v_mfma_f32_16x16x32_bf16 v[60:63], v[116:119], v[100:103], v[60:63]
    v_mfma_f32_16x16x32_bf16 v[80:83], v[116:119], v[104:107], v[80:83]
    s_waitcnt vmcnt(28)
    v_mfma_f32_16x16x32_bf16 v[24:27], v[120:123], v[92:95], v[24:27]
    v_mfma_f32_16x16x32_bf16 v[44:47], v[120:123], v[96:99], v[44:47]
    v_mfma_f32_16x16x32_bf16 v[64:67], v[120:123], v[100:103], v[64:67]
    v_mfma_f32_16x16x32_bf16 v[84:87], v[120:123], v[104:107], v[84:87]
    s_waitcnt vmcnt(27)
    v_mfma_f32_16x16x32_bf16 v[28:31], v[124:127], v[92:95], v[28:31]
    v_mfma_f32_16x16x32_bf16 v[48:51], v[124:127], v[96:99], v[48:51]
    v_mfma_f32_16x16x32_bf16 v[68:71], v[124:127], v[100:103], v[68:71]
    v_mfma_f32_16x16x32_bf16 v[88:91], v[124:127], v[104:107], v[88:91]
    s_add_u32 s40, s35, 12288
    buffer_load_dwordx4 v[92:95], v5, s[12:15], s40 offen
    s_add_u32 s40, s35, 159744
    buffer_load_dwordx4 v[96:99], v5, s[12:15], s40 offen
    s_add_u32 s40, s35, 307200
    buffer_load_dwordx4 v[100:103], v5, s[12:15], s40 offen
    s_add_u32 s40, s35, 454656
    buffer_load_dwordx4 v[104:107], v5, s[12:15], s40 offen
    s_add_u32 s39, s37, 61440
    buffer_load_dwordx4 v[108:111], v5, s[8:11], s39 offen offset:0
    buffer_load_dwordx4 v[112:115], v5, s[8:11], s39 offen offset:1024
    buffer_load_dwordx4 v[116:119], v5, s[8:11], s39 offen offset:2048
    buffer_load_dwordx4 v[120:123], v5, s[8:11], s39 offen offset:3072
    s_add_u32 s39, s39, 4096
    buffer_load_dwordx4 v[124:127], v6, s[8:11], s39 offen
    s_waitcnt vmcnt(32)
    s_waitcnt vmcnt(31)
    v_mfma_f32_16x16x32_bf16 v[12:15], v[144:147], v[128:131], v[12:15]
    v_mfma_f32_16x16x32_bf16 v[32:35], v[144:147], v[132:135], v[32:35]
    v_mfma_f32_16x16x32_bf16 v[52:55], v[144:147], v[136:139], v[52:55]
    v_mfma_f32_16x16x32_bf16 v[72:75], v[144:147], v[140:143], v[72:75]
    s_waitcnt vmcnt(30)
    v_mfma_f32_16x16x32_bf16 v[16:19], v[148:151], v[128:131], v[16:19]
    v_mfma_f32_16x16x32_bf16 v[36:39], v[148:151], v[132:135], v[36:39]
    v_mfma_f32_16x16x32_bf16 v[56:59], v[148:151], v[136:139], v[56:59]
    v_mfma_f32_16x16x32_bf16 v[76:79], v[148:151], v[140:143], v[76:79]
    s_waitcnt vmcnt(29)
    v_mfma_f32_16x16x32_bf16 v[20:23], v[152:155], v[128:131], v[20:23]
    v_mfma_f32_16x16x32_bf16 v[40:43], v[152:155], v[132:135], v[40:43]
    v_mfma_f32_16x16x32_bf16 v[60:63], v[152:155], v[136:139], v[60:63]
    v_mfma_f32_16x16x32_bf16 v[80:83], v[152:155], v[140:143], v[80:83]
    s_waitcnt vmcnt(28)
    v_mfma_f32_16x16x32_bf16 v[24:27], v[156:159], v[128:131], v[24:27]
    v_mfma_f32_16x16x32_bf16 v[44:47], v[156:159], v[132:135], v[44:47]
    v_mfma_f32_16x16x32_bf16 v[64:67], v[156:159], v[136:139], v[64:67]
    v_mfma_f32_16x16x32_bf16 v[84:87], v[156:159], v[140:143], v[84:87]
    s_waitcnt vmcnt(27)
    v_mfma_f32_16x16x32_bf16 v[28:31], v[160:163], v[128:131], v[28:31]
    v_mfma_f32_16x16x32_bf16 v[48:51], v[160:163], v[132:135], v[48:51]
    v_mfma_f32_16x16x32_bf16 v[68:71], v[160:163], v[136:139], v[68:71]
    v_mfma_f32_16x16x32_bf16 v[88:91], v[160:163], v[140:143], v[88:91]
    s_add_u32 s40, s35, 13312
    buffer_load_dwordx4 v[128:131], v5, s[12:15], s40 offen
    s_add_u32 s40, s35, 160768
    buffer_load_dwordx4 v[132:135], v5, s[12:15], s40 offen
    s_add_u32 s40, s35, 308224
    buffer_load_dwordx4 v[136:139], v5, s[12:15], s40 offen
    s_add_u32 s40, s35, 455680
    buffer_load_dwordx4 v[140:143], v5, s[12:15], s40 offen
    s_add_u32 s39, s37, 66560
    buffer_load_dwordx4 v[144:147], v5, s[8:11], s39 offen offset:0
    buffer_load_dwordx4 v[148:151], v5, s[8:11], s39 offen offset:1024
    buffer_load_dwordx4 v[152:155], v5, s[8:11], s39 offen offset:2048
    buffer_load_dwordx4 v[156:159], v5, s[8:11], s39 offen offset:3072
    s_add_u32 s39, s39, 4096
    buffer_load_dwordx4 v[160:163], v6, s[8:11], s39 offen
    s_waitcnt vmcnt(32)
    s_waitcnt vmcnt(31)
    v_mfma_f32_16x16x32_bf16 v[12:15], v[180:183], v[164:167], v[12:15]
    v_mfma_f32_16x16x32_bf16 v[32:35], v[180:183], v[168:171], v[32:35]
    v_mfma_f32_16x16x32_bf16 v[52:55], v[180:183], v[172:175], v[52:55]
    v_mfma_f32_16x16x32_bf16 v[72:75], v[180:183], v[176:179], v[72:75]
    s_waitcnt vmcnt(30)
    v_mfma_f32_16x16x32_bf16 v[16:19], v[184:187], v[164:167], v[16:19]
    v_mfma_f32_16x16x32_bf16 v[36:39], v[184:187], v[168:171], v[36:39]
    v_mfma_f32_16x16x32_bf16 v[56:59], v[184:187], v[172:175], v[56:59]
    v_mfma_f32_16x16x32_bf16 v[76:79], v[184:187], v[176:179], v[76:79]
    s_waitcnt vmcnt(29)
    v_mfma_f32_16x16x32_bf16 v[20:23], v[188:191], v[164:167], v[20:23]
    v_mfma_f32_16x16x32_bf16 v[40:43], v[188:191], v[168:171], v[40:43]
    v_mfma_f32_16x16x32_bf16 v[60:63], v[188:191], v[172:175], v[60:63]
    v_mfma_f32_16x16x32_bf16 v[80:83], v[188:191], v[176:179], v[80:83]
    s_waitcnt vmcnt(28)
    v_mfma_f32_16x16x32_bf16 v[24:27], v[192:195], v[164:167], v[24:27]
    v_mfma_f32_16x16x32_bf16 v[44:47], v[192:195], v[168:171], v[44:47]
    v_mfma_f32_16x16x32_bf16 v[64:67], v[192:195], v[172:175], v[64:67]
    v_mfma_f32_16x16x32_bf16 v[84:87], v[192:195], v[176:179], v[84:87]
    s_waitcnt vmcnt(27)
    v_mfma_f32_16x16x32_bf16 v[28:31], v[196:199], v[164:167], v[28:31]
    v_mfma_f32_16x16x32_bf16 v[48:51], v[196:199], v[168:171], v[48:51]
    v_mfma_f32_16x16x32_bf16 v[68:71], v[196:199], v[172:175], v[68:71]
    v_mfma_f32_16x16x32_bf16 v[88:91], v[196:199], v[176:179], v[88:91]
    s_add_u32 s40, s35, 14336
    buffer_load_dwordx4 v[164:167], v5, s[12:15], s40 offen
    s_add_u32 s40, s35, 161792
    buffer_load_dwordx4 v[168:171], v5, s[12:15], s40 offen
    s_add_u32 s40, s35, 309248
    buffer_load_dwordx4 v[172:175], v5, s[12:15], s40 offen
    s_add_u32 s40, s35, 456704
    buffer_load_dwordx4 v[176:179], v5, s[12:15], s40 offen
    s_add_u32 s39, s37, 71680
    buffer_load_dwordx4 v[180:183], v5, s[8:11], s39 offen offset:0
    buffer_load_dwordx4 v[184:187], v5, s[8:11], s39 offen offset:1024
    buffer_load_dwordx4 v[188:191], v5, s[8:11], s39 offen offset:2048
    buffer_load_dwordx4 v[192:195], v5, s[8:11], s39 offen offset:3072
    s_add_u32 s39, s39, 4096
    buffer_load_dwordx4 v[196:199], v6, s[8:11], s39 offen
    s_waitcnt vmcnt(32)
    s_waitcnt vmcnt(31)
    v_mfma_f32_16x16x32_bf16 v[12:15], v[216:219], v[200:203], v[12:15]
    v_mfma_f32_16x16x32_bf16 v[32:35], v[216:219], v[204:207], v[32:35]
    v_mfma_f32_16x16x32_bf16 v[52:55], v[216:219], v[208:211], v[52:55]
    v_mfma_f32_16x16x32_bf16 v[72:75], v[216:219], v[212:215], v[72:75]
    s_waitcnt vmcnt(30)
    v_mfma_f32_16x16x32_bf16 v[16:19], v[220:223], v[200:203], v[16:19]
    v_mfma_f32_16x16x32_bf16 v[36:39], v[220:223], v[204:207], v[36:39]
    v_mfma_f32_16x16x32_bf16 v[56:59], v[220:223], v[208:211], v[56:59]
    v_mfma_f32_16x16x32_bf16 v[76:79], v[220:223], v[212:215], v[76:79]
    s_waitcnt vmcnt(29)
    v_mfma_f32_16x16x32_bf16 v[20:23], v[224:227], v[200:203], v[20:23]
    v_mfma_f32_16x16x32_bf16 v[40:43], v[224:227], v[204:207], v[40:43]
    v_mfma_f32_16x16x32_bf16 v[60:63], v[224:227], v[208:211], v[60:63]
    v_mfma_f32_16x16x32_bf16 v[80:83], v[224:227], v[212:215], v[80:83]
    s_waitcnt vmcnt(28)
    v_mfma_f32_16x16x32_bf16 v[24:27], v[228:231], v[200:203], v[24:27]
    v_mfma_f32_16x16x32_bf16 v[44:47], v[228:231], v[204:207], v[44:47]
    v_mfma_f32_16x16x32_bf16 v[64:67], v[228:231], v[208:211], v[64:67]
    v_mfma_f32_16x16x32_bf16 v[84:87], v[228:231], v[212:215], v[84:87]
    s_waitcnt vmcnt(27)
    v_mfma_f32_16x16x32_bf16 v[28:31], v[232:235], v[200:203], v[28:31]
    v_mfma_f32_16x16x32_bf16 v[48:51], v[232:235], v[204:207], v[48:51]
    v_mfma_f32_16x16x32_bf16 v[68:71], v[232:235], v[208:211], v[68:71]
    v_mfma_f32_16x16x32_bf16 v[88:91], v[232:235], v[212:215], v[88:91]
    s_add_u32 s40, s35, 15360
    buffer_load_dwordx4 v[200:203], v5, s[12:15], s40 offen
    s_add_u32 s40, s35, 162816
    buffer_load_dwordx4 v[204:207], v5, s[12:15], s40 offen
    s_add_u32 s40, s35, 310272
    buffer_load_dwordx4 v[208:211], v5, s[12:15], s40 offen
    s_add_u32 s40, s35, 457728
    buffer_load_dwordx4 v[212:215], v5, s[12:15], s40 offen
    s_add_u32 s39, s37, 76800
    buffer_load_dwordx4 v[216:219], v5, s[8:11], s39 offen offset:0
    buffer_load_dwordx4 v[220:223], v5, s[8:11], s39 offen offset:1024
    buffer_load_dwordx4 v[224:227], v5, s[8:11], s39 offen offset:2048
    buffer_load_dwordx4 v[228:231], v5, s[8:11], s39 offen offset:3072
    s_add_u32 s39, s39, 4096
    buffer_load_dwordx4 v[232:235], v6, s[8:11], s39 offen
    s_waitcnt vmcnt(32)
    s_waitcnt vmcnt(31)
    v_mfma_f32_16x16x32_bf16 v[12:15], v[108:111], v[92:95], v[12:15]
    v_mfma_f32_16x16x32_bf16 v[32:35], v[108:111], v[96:99], v[32:35]
    v_mfma_f32_16x16x32_bf16 v[52:55], v[108:111], v[100:103], v[52:55]
    v_mfma_f32_16x16x32_bf16 v[72:75], v[108:111], v[104:107], v[72:75]
    s_waitcnt vmcnt(30)
    v_mfma_f32_16x16x32_bf16 v[16:19], v[112:115], v[92:95], v[16:19]
    v_mfma_f32_16x16x32_bf16 v[36:39], v[112:115], v[96:99], v[36:39]
    v_mfma_f32_16x16x32_bf16 v[56:59], v[112:115], v[100:103], v[56:59]
    v_mfma_f32_16x16x32_bf16 v[76:79], v[112:115], v[104:107], v[76:79]
    s_waitcnt vmcnt(29)
    v_mfma_f32_16x16x32_bf16 v[20:23], v[116:119], v[92:95], v[20:23]
    v_mfma_f32_16x16x32_bf16 v[40:43], v[116:119], v[96:99], v[40:43]
    v_mfma_f32_16x16x32_bf16 v[60:63], v[116:119], v[100:103], v[60:63]
    v_mfma_f32_16x16x32_bf16 v[80:83], v[116:119], v[104:107], v[80:83]
    s_waitcnt vmcnt(28)
    v_mfma_f32_16x16x32_bf16 v[24:27], v[120:123], v[92:95], v[24:27]
    v_mfma_f32_16x16x32_bf16 v[44:47], v[120:123], v[96:99], v[44:47]
    v_mfma_f32_16x16x32_bf16 v[64:67], v[120:123], v[100:103], v[64:67]
    v_mfma_f32_16x16x32_bf16 v[84:87], v[120:123], v[104:107], v[84:87]
    s_waitcnt vmcnt(27)
    v_mfma_f32_16x16x32_bf16 v[28:31], v[124:127], v[92:95], v[28:31]
    v_mfma_f32_16x16x32_bf16 v[48:51], v[124:127], v[96:99], v[48:51]
    v_mfma_f32_16x16x32_bf16 v[68:71], v[124:127], v[100:103], v[68:71]
    v_mfma_f32_16x16x32_bf16 v[88:91], v[124:127], v[104:107], v[88:91]
    s_add_u32 s40, s35, 16384
    buffer_load_dwordx4 v[92:95], v5, s[12:15], s40 offen
    s_add_u32 s40, s35, 163840
    buffer_load_dwordx4 v[96:99], v5, s[12:15], s40 offen
    s_add_u32 s40, s35, 311296
    buffer_load_dwordx4 v[100:103], v5, s[12:15], s40 offen
    s_add_u32 s40, s35, 458752
    buffer_load_dwordx4 v[104:107], v5, s[12:15], s40 offen
    s_add_u32 s39, s37, 81920
    buffer_load_dwordx4 v[108:111], v5, s[8:11], s39 offen offset:0
    buffer_load_dwordx4 v[112:115], v5, s[8:11], s39 offen offset:1024
    buffer_load_dwordx4 v[116:119], v5, s[8:11], s39 offen offset:2048
    buffer_load_dwordx4 v[120:123], v5, s[8:11], s39 offen offset:3072
    s_add_u32 s39, s39, 4096
    buffer_load_dwordx4 v[124:127], v6, s[8:11], s39 offen
    s_waitcnt vmcnt(32)
    s_waitcnt vmcnt(31)
    v_mfma_f32_16x16x32_bf16 v[12:15], v[144:147], v[128:131], v[12:15]
    v_mfma_f32_16x16x32_bf16 v[32:35], v[144:147], v[132:135], v[32:35]
    v_mfma_f32_16x16x32_bf16 v[52:55], v[144:147], v[136:139], v[52:55]
    v_mfma_f32_16x16x32_bf16 v[72:75], v[144:147], v[140:143], v[72:75]
    s_waitcnt vmcnt(30)
    v_mfma_f32_16x16x32_bf16 v[16:19], v[148:151], v[128:131], v[16:19]
    v_mfma_f32_16x16x32_bf16 v[36:39], v[148:151], v[132:135], v[36:39]
    v_mfma_f32_16x16x32_bf16 v[56:59], v[148:151], v[136:139], v[56:59]
    v_mfma_f32_16x16x32_bf16 v[76:79], v[148:151], v[140:143], v[76:79]
    s_waitcnt vmcnt(29)
    v_mfma_f32_16x16x32_bf16 v[20:23], v[152:155], v[128:131], v[20:23]
    v_mfma_f32_16x16x32_bf16 v[40:43], v[152:155], v[132:135], v[40:43]
    v_mfma_f32_16x16x32_bf16 v[60:63], v[152:155], v[136:139], v[60:63]
    v_mfma_f32_16x16x32_bf16 v[80:83], v[152:155], v[140:143], v[80:83]
    s_waitcnt vmcnt(28)
    v_mfma_f32_16x16x32_bf16 v[24:27], v[156:159], v[128:131], v[24:27]
    v_mfma_f32_16x16x32_bf16 v[44:47], v[156:159], v[132:135], v[44:47]
    v_mfma_f32_16x16x32_bf16 v[64:67], v[156:159], v[136:139], v[64:67]
    v_mfma_f32_16x16x32_bf16 v[84:87], v[156:159], v[140:143], v[84:87]
    s_waitcnt vmcnt(27)
    v_mfma_f32_16x16x32_bf16 v[28:31], v[160:163], v[128:131], v[28:31]
    v_mfma_f32_16x16x32_bf16 v[48:51], v[160:163], v[132:135], v[48:51]
    v_mfma_f32_16x16x32_bf16 v[68:71], v[160:163], v[136:139], v[68:71]
    v_mfma_f32_16x16x32_bf16 v[88:91], v[160:163], v[140:143], v[88:91]
    s_add_u32 s40, s35, 17408
    buffer_load_dwordx4 v[128:131], v5, s[12:15], s40 offen
    s_add_u32 s40, s35, 164864
    buffer_load_dwordx4 v[132:135], v5, s[12:15], s40 offen
    s_add_u32 s40, s35, 312320
    buffer_load_dwordx4 v[136:139], v5, s[12:15], s40 offen
    s_add_u32 s40, s35, 459776
    buffer_load_dwordx4 v[140:143], v5, s[12:15], s40 offen
    s_add_u32 s39, s37, 87040
    buffer_load_dwordx4 v[144:147], v5, s[8:11], s39 offen offset:0
    buffer_load_dwordx4 v[148:151], v5, s[8:11], s39 offen offset:1024
    buffer_load_dwordx4 v[152:155], v5, s[8:11], s39 offen offset:2048
    buffer_load_dwordx4 v[156:159], v5, s[8:11], s39 offen offset:3072
    s_add_u32 s39, s39, 4096
    buffer_load_dwordx4 v[160:163], v6, s[8:11], s39 offen
    s_waitcnt vmcnt(32)
    s_waitcnt vmcnt(31)
    v_mfma_f32_16x16x32_bf16 v[12:15], v[180:183], v[164:167], v[12:15]
    v_mfma_f32_16x16x32_bf16 v[32:35], v[180:183], v[168:171], v[32:35]
    v_mfma_f32_16x16x32_bf16 v[52:55], v[180:183], v[172:175], v[52:55]
    v_mfma_f32_16x16x32_bf16 v[72:75], v[180:183], v[176:179], v[72:75]
    s_waitcnt vmcnt(30)
    v_mfma_f32_16x16x32_bf16 v[16:19], v[184:187], v[164:167], v[16:19]
    v_mfma_f32_16x16x32_bf16 v[36:39], v[184:187], v[168:171], v[36:39]
    v_mfma_f32_16x16x32_bf16 v[56:59], v[184:187], v[172:175], v[56:59]
    v_mfma_f32_16x16x32_bf16 v[76:79], v[184:187], v[176:179], v[76:79]
    s_waitcnt vmcnt(29)
    v_mfma_f32_16x16x32_bf16 v[20:23], v[188:191], v[164:167], v[20:23]
    v_mfma_f32_16x16x32_bf16 v[40:43], v[188:191], v[168:171], v[40:43]
    v_mfma_f32_16x16x32_bf16 v[60:63], v[188:191], v[172:175], v[60:63]
    v_mfma_f32_16x16x32_bf16 v[80:83], v[188:191], v[176:179], v[80:83]
    s_waitcnt vmcnt(28)
    v_mfma_f32_16x16x32_bf16 v[24:27], v[192:195], v[164:167], v[24:27]
    v_mfma_f32_16x16x32_bf16 v[44:47], v[192:195], v[168:171], v[44:47]
    v_mfma_f32_16x16x32_bf16 v[64:67], v[192:195], v[172:175], v[64:67]
    v_mfma_f32_16x16x32_bf16 v[84:87], v[192:195], v[176:179], v[84:87]
    s_waitcnt vmcnt(27)
    v_mfma_f32_16x16x32_bf16 v[28:31], v[196:199], v[164:167], v[28:31]
    v_mfma_f32_16x16x32_bf16 v[48:51], v[196:199], v[168:171], v[48:51]
    v_mfma_f32_16x16x32_bf16 v[68:71], v[196:199], v[172:175], v[68:71]
    v_mfma_f32_16x16x32_bf16 v[88:91], v[196:199], v[176:179], v[88:91]
    s_waitcnt vmcnt(23)
    s_waitcnt vmcnt(22)
    v_mfma_f32_16x16x32_bf16 v[12:15], v[216:219], v[200:203], v[12:15]
    v_mfma_f32_16x16x32_bf16 v[32:35], v[216:219], v[204:207], v[32:35]
    v_mfma_f32_16x16x32_bf16 v[52:55], v[216:219], v[208:211], v[52:55]
    v_mfma_f32_16x16x32_bf16 v[72:75], v[216:219], v[212:215], v[72:75]
    s_waitcnt vmcnt(21)
    v_mfma_f32_16x16x32_bf16 v[16:19], v[220:223], v[200:203], v[16:19]
    v_mfma_f32_16x16x32_bf16 v[36:39], v[220:223], v[204:207], v[36:39]
    v_mfma_f32_16x16x32_bf16 v[56:59], v[220:223], v[208:211], v[56:59]
    v_mfma_f32_16x16x32_bf16 v[76:79], v[220:223], v[212:215], v[76:79]
    s_waitcnt vmcnt(20)
    v_mfma_f32_16x16x32_bf16 v[20:23], v[224:227], v[200:203], v[20:23]
    v_mfma_f32_16x16x32_bf16 v[40:43], v[224:227], v[204:207], v[40:43]
    v_mfma_f32_16x16x32_bf16 v[60:63], v[224:227], v[208:211], v[60:63]
    v_mfma_f32_16x16x32_bf16 v[80:83], v[224:227], v[212:215], v[80:83]
    s_waitcnt vmcnt(19)
    v_mfma_f32_16x16x32_bf16 v[24:27], v[228:231], v[200:203], v[24:27]
    v_mfma_f32_16x16x32_bf16 v[44:47], v[228:231], v[204:207], v[44:47]
    v_mfma_f32_16x16x32_bf16 v[64:67], v[228:231], v[208:211], v[64:67]
    v_mfma_f32_16x16x32_bf16 v[84:87], v[228:231], v[212:215], v[84:87]
    s_waitcnt vmcnt(18)
    v_mfma_f32_16x16x32_bf16 v[28:31], v[232:235], v[200:203], v[28:31]
    v_mfma_f32_16x16x32_bf16 v[48:51], v[232:235], v[204:207], v[48:51]
    v_mfma_f32_16x16x32_bf16 v[68:71], v[232:235], v[208:211], v[68:71]
    v_mfma_f32_16x16x32_bf16 v[88:91], v[232:235], v[212:215], v[88:91]
    s_waitcnt vmcnt(14)
    s_waitcnt vmcnt(13)
    v_mfma_f32_16x16x32_bf16 v[12:15], v[108:111], v[92:95], v[12:15]
    v_mfma_f32_16x16x32_bf16 v[32:35], v[108:111], v[96:99], v[32:35]
    v_mfma_f32_16x16x32_bf16 v[52:55], v[108:111], v[100:103], v[52:55]
    v_mfma_f32_16x16x32_bf16 v[72:75], v[108:111], v[104:107], v[72:75]
    s_waitcnt vmcnt(12)
    v_mfma_f32_16x16x32_bf16 v[16:19], v[112:115], v[92:95], v[16:19]
    v_mfma_f32_16x16x32_bf16 v[36:39], v[112:115], v[96:99], v[36:39]
    v_mfma_f32_16x16x32_bf16 v[56:59], v[112:115], v[100:103], v[56:59]
    v_mfma_f32_16x16x32_bf16 v[76:79], v[112:115], v[104:107], v[76:79]
    s_waitcnt vmcnt(11)
    v_mfma_f32_16x16x32_bf16 v[20:23], v[116:119], v[92:95], v[20:23]
    v_mfma_f32_16x16x32_bf16 v[40:43], v[116:119], v[96:99], v[40:43]
    v_mfma_f32_16x16x32_bf16 v[60:63], v[116:119], v[100:103], v[60:63]
    v_mfma_f32_16x16x32_bf16 v[80:83], v[116:119], v[104:107], v[80:83]
    s_waitcnt vmcnt(10)
    v_mfma_f32_16x16x32_bf16 v[24:27], v[120:123], v[92:95], v[24:27]
    v_mfma_f32_16x16x32_bf16 v[44:47], v[120:123], v[96:99], v[44:47]
    v_mfma_f32_16x16x32_bf16 v[64:67], v[120:123], v[100:103], v[64:67]
    v_mfma_f32_16x16x32_bf16 v[84:87], v[120:123], v[104:107], v[84:87]
    s_waitcnt vmcnt(9)
    v_mfma_f32_16x16x32_bf16 v[28:31], v[124:127], v[92:95], v[28:31]
    v_mfma_f32_16x16x32_bf16 v[48:51], v[124:127], v[96:99], v[48:51]
    v_mfma_f32_16x16x32_bf16 v[68:71], v[124:127], v[100:103], v[68:71]
    v_mfma_f32_16x16x32_bf16 v[88:91], v[124:127], v[104:107], v[88:91]
    s_waitcnt vmcnt(5)
    s_waitcnt vmcnt(4)
    v_mfma_f32_16x16x32_bf16 v[12:15], v[144:147], v[128:131], v[12:15]
    v_mfma_f32_16x16x32_bf16 v[32:35], v[144:147], v[132:135], v[32:35]
    v_mfma_f32_16x16x32_bf16 v[52:55], v[144:147], v[136:139], v[52:55]
    v_mfma_f32_16x16x32_bf16 v[72:75], v[144:147], v[140:143], v[72:75]
    s_waitcnt vmcnt(3)
    v_mfma_f32_16x16x32_bf16 v[16:19], v[148:151], v[128:131], v[16:19]
    v_mfma_f32_16x16x32_bf16 v[36:39], v[148:151], v[132:135], v[36:39]
    v_mfma_f32_16x16x32_bf16 v[56:59], v[148:151], v[136:139], v[56:59]
    v_mfma_f32_16x16x32_bf16 v[76:79], v[148:151], v[140:143], v[76:79]
    s_waitcnt vmcnt(2)
    v_mfma_f32_16x16x32_bf16 v[20:23], v[152:155], v[128:131], v[20:23]
    v_mfma_f32_16x16x32_bf16 v[40:43], v[152:155], v[132:135], v[40:43]
    v_mfma_f32_16x16x32_bf16 v[60:63], v[152:155], v[136:139], v[60:63]
    v_mfma_f32_16x16x32_bf16 v[80:83], v[152:155], v[140:143], v[80:83]
    s_waitcnt vmcnt(1)
    v_mfma_f32_16x16x32_bf16 v[24:27], v[156:159], v[128:131], v[24:27]
    v_mfma_f32_16x16x32_bf16 v[44:47], v[156:159], v[132:135], v[44:47]
    v_mfma_f32_16x16x32_bf16 v[64:67], v[156:159], v[136:139], v[64:67]
    v_mfma_f32_16x16x32_bf16 v[84:87], v[156:159], v[140:143], v[84:87]
    s_waitcnt vmcnt(0)
    v_mfma_f32_16x16x32_bf16 v[28:31], v[160:163], v[128:131], v[28:31]
    v_mfma_f32_16x16x32_bf16 v[48:51], v[160:163], v[132:135], v[48:51]
    v_mfma_f32_16x16x32_bf16 v[68:71], v[160:163], v[136:139], v[68:71]
    v_mfma_f32_16x16x32_bf16 v[88:91], v[160:163], v[140:143], v[88:91]
    s_and_b32 s41, s3, 7
    s_mul_i32 s41, s41, 20480
    v_add_u32 v6, s41, v5
    ds_write_b128 v6, v[12:15] offset:0
    ds_write_b128 v6, v[16:19] offset:1024
    ds_write_b128 v6, v[20:23] offset:2048
    ds_write_b128 v6, v[24:27] offset:3072
    ds_write_b128 v6, v[28:31] offset:4096
    ds_write_b128 v6, v[32:35] offset:5120
    ds_write_b128 v6, v[36:39] offset:6144
    ds_write_b128 v6, v[40:43] offset:7168
    ds_write_b128 v6, v[44:47] offset:8192
    ds_write_b128 v6, v[48:51] offset:9216
    ds_write_b128 v6, v[52:55] offset:10240
    ds_write_b128 v6, v[56:59] offset:11264
    ds_write_b128 v6, v[60:63] offset:12288
    ds_write_b128 v6, v[64:67] offset:13312
    ds_write_b128 v6, v[68:71] offset:14336
    ds_write_b128 v6, v[72:75] offset:15360
    ds_write_b128 v6, v[76:79] offset:16384
    ds_write_b128 v6, v[80:83] offset:17408
    ds_write_b128 v6, v[84:87] offset:18432
    ds_write_b128 v6, v[88:91] offset:19456
    s_lshr_b32 s42, s3, 1
    s_and_b32 s43, s3, 1
    s_mul_i32 s44, s42, 5
    s_lshl_b32 s45, s43, 1
    s_add_u32 s45, s45, s44
    s_lshl_b32 s45, s45, 10
    v_add_u32 v7, s45, v5
    s_add_u32 s46, s44, 4
    s_lshl_b32 s46, s46, 10
    v_add_u32 v8, s46, v5
    s_lshl_b32 s47, s32, 2
    s_add_u32 s47, s47, s42
    s_mul_i32 s48, s33, 9
    s_lshl_b32 s49, s43, 2
    s_add_u32 s49, s49, s48
    v_add_u32 v9, s49, v4
    v_lshrrev_b32 v10, 2, v9
    v_and_b32 v11, 3, v9
    v_lshlrev_b32 v10, 10, v10
    v_lshl_add_u32 v10, v11, 8, v10
    v_lshl_add_u32 v10, v3, 4, v10
    s_add_u32 s50, s48, 8
    s_lshr_b32 s51, s50, 2
    s_lshl_b32 s51, s51, 10
    s_and_b32 s54, s50, 3
    s_lshl_b32 s54, s54, 8
    s_add_u32 s51, s51, s54
    v_lshlrev_b32 v92, 4, v3
    v_lshl_add_u32 v92, v4, 3, v92
    v_add_u32 v92, s51, v92
    v_mov_b32 v93, 0x7ff00000
    v_cmp_gt_u32 s[56:57], 2, v4
    s_nop 1
    v_cndmask_b32 v92, v93, v92, s[56:57]
    s_mul_i32 s55, s47, 18432
    v_lshlrev_b32 v94, 4, v9
    s_lshl_b32 s58, s50, 4
    v_lshlrev_b32 v95, 3, v4
    v_add_u32 v95, s58, v95
    v_cndmask_b32 v95, v93, v95, s[56:57]
    buffer_load_dwordx4 v[96:99], v10, s[16:19], s55 offen
    buffer_load_dwordx2 v[100:101], v92, s[16:19], s55 offen
    buffer_load_dwordx4 v[102:105], v94, s[24:27], 0 offen
    buffer_load_dwordx2 v[106:107], v95, s[24:27], 0 offen
    s_mov_b32 s59, s55
    v_add_u32 v108, 0x10000, v7
    v_add_u32 v109, 0x20000, v7
    v_add_u32 v110, 0x10000, v8
    v_add_u32 v111, 0x20000, v8
    s_waitcnt lgkmcnt(0)
    s_barrier
    ds_read_b128 v[12:15], v7 offset:0
    ds_read_b128 v[16:19], v7 offset:1024
    ds_read_b128 v[20:23], v7 offset:20480
    ds_read_b128 v[24:27], v7 offset:21504
    ds_read_b128 v[28:31], v7 offset:40960
    ds_read_b128 v[32:35], v7 offset:41984
    ds_read_b128 v[36:39], v7 offset:61440
    ds_read_b128 v[40:43], v7 offset:62464
    ds_read_b128 v[44:47], v108 offset:16384
    ds_read_b128 v[48:51], v108 offset:17408
    ds_read_b128 v[52:55], v108 offset:36864
    ds_read_b128 v[56:59], v108 offset:37888
    ds_read_b128 v[60:63], v108 offset:57344
    ds_read_b128 v[64:67], v108 offset:58368
    ds_read_b128 v[68:71], v109 offset:12288
    ds_read_b128 v[72:75], v109 offset:13312
    s_waitcnt lgkmcnt(0)
    v_add_f32 v76, v12, v20
    v_add_f32 v76, v76, v28
    v_add_f32 v76, v76, v36
    v_add_f32 v76, v76, v44
    v_add_f32 v76, v76, v52
    v_add_f32 v76, v76, v60
    v_add_f32 v76, v76, v68
    v_add_f32 v77, v13, v21
    v_add_f32 v77, v77, v29
    v_add_f32 v77, v77, v37
    v_add_f32 v77, v77, v45
    v_add_f32 v77, v77, v53
    v_add_f32 v77, v77, v61
    v_add_f32 v77, v77, v69
    v_add_f32 v78, v14, v22
    v_add_f32 v78, v78, v30
    v_add_f32 v78, v78, v38
    v_add_f32 v78, v78, v46
    v_add_f32 v78, v78, v54
    v_add_f32 v78, v78, v62
    v_add_f32 v78, v78, v70
    v_add_f32 v79, v15, v23
    v_add_f32 v79, v79, v31
    v_add_f32 v79, v79, v39
    v_add_f32 v79, v79, v47
    v_add_f32 v79, v79, v55
    v_add_f32 v79, v79, v63
    v_add_f32 v79, v79, v71
    v_add_f32 v80, v16, v24
    v_add_f32 v80, v80, v32
    v_add_f32 v80, v80, v40
    v_add_f32 v80, v80, v48
    v_add_f32 v80, v80, v56
    v_add_f32 v80, v80, v64
    v_add_f32 v80, v80, v72
    v_add_f32 v81, v17, v25
    v_add_f32 v81, v81, v33
    v_add_f32 v81, v81, v41
    v_add_f32 v81, v81, v49
    v_add_f32 v81, v81, v57
    v_add_f32 v81, v81, v65
    v_add_f32 v81, v81, v73
    v_add_f32 v82, v18, v26
    v_add_f32 v82, v82, v34
    v_add_f32 v82, v82, v42
    v_add_f32 v82, v82, v50
    v_add_f32 v82, v82, v58
    v_add_f32 v82, v82, v66
    v_add_f32 v82, v82, v74
    v_add_f32 v83, v19, v27
    v_add_f32 v83, v83, v35
    v_add_f32 v83, v83, v43
    v_add_f32 v83, v83, v51
    v_add_f32 v83, v83, v59
    v_add_f32 v83, v83, v67
    v_add_f32 v83, v83, v75
    s_waitcnt vmcnt(0)
    v_cvt_pk_bf16_f32 v120, v76, v77
    v_lshlrev_b32 v76, 16, v120
    v_and_b32 v77, 0xffff0000, v120
    v_cvt_pk_bf16_f32 v120, v78, v79
    v_lshlrev_b32 v78, 16, v120
    v_and_b32 v79, 0xffff0000, v120
    v_cvt_pk_bf16_f32 v120, v80, v81
    v_lshlrev_b32 v80, 16, v120
    v_and_b32 v81, 0xffff0000, v120
    v_cvt_pk_bf16_f32 v120, v82, v83
    v_lshlrev_b32 v82, 16, v120
    v_and_b32 v83, 0xffff0000, v120
    v_lshlrev_b32 v121, 16, v102
    v_and_b32 v122, 0xffff0000, v102
    v_add_f32 v76, v76, v121
    v_add_f32 v77, v77, v122
    v_lshlrev_b32 v121, 16, v103
    v_and_b32 v122, 0xffff0000, v103
    v_add_f32 v78, v78, v121
    v_add_f32 v79, v79, v122
    v_lshlrev_b32 v121, 16, v104
    v_and_b32 v122, 0xffff0000, v104
    v_add_f32 v80, v80, v121
    v_add_f32 v81, v81, v122
    v_lshlrev_b32 v121, 16, v105
    v_and_b32 v122, 0xffff0000, v105
    v_add_f32 v82, v82, v121
    v_add_f32 v83, v83, v122
    v_cvt_pk_bf16_f32 v120, v76, v77
    v_lshlrev_b32 v76, 16, v120
    v_and_b32 v77, 0xffff0000, v120
    v_cvt_pk_bf16_f32 v120, v78, v79
    v_lshlrev_b32 v78, 16, v120
    v_and_b32 v79, 0xffff0000, v120
    v_cvt_pk_bf16_f32 v120, v80, v81
    v_lshlrev_b32 v80, 16, v120
    v_and_b32 v81, 0xffff0000, v120
    v_cvt_pk_bf16_f32 v120, v82, v83
    v_lshlrev_b32 v82, 16, v120
    v_and_b32 v83, 0xffff0000, v120
    v_lshlrev_b32 v121, 16, v96
    v_and_b32 v122, 0xffff0000, v96
    v_add_f32 v76, v76, v121
    v_add_f32 v77, v77, v122
    v_lshlrev_b32 v121, 16, v97
    v_and_b32 v122, 0xffff0000, v97
    v_add_f32 v78, v78, v121
    v_add_f32 v79, v79, v122
    v_lshlrev_b32 v121, 16, v98
    v_and_b32 v122, 0xffff0000, v98
    v_add_f32 v80, v80, v121
    v_add_f32 v81, v81, v122
    v_lshlrev_b32 v121, 16, v99
    v_and_b32 v122, 0xffff0000, v99
    v_add_f32 v82, v82, v121
    v_add_f32 v83, v83, v122
    v_cvt_pk_bf16_f32 v112, v76, v77
    v_cvt_pk_bf16_f32 v113, v78, v79
    v_cvt_pk_bf16_f32 v114, v80, v81
    v_cvt_pk_bf16_f32 v115, v82, v83
    buffer_store_dwordx4 v[112:115], v10, s[20:23], s59 offen sc1
    v_lshlrev_b32 v76, 16, v112
    v_and_b32 v77, 0xffff0000, v112
    v_lshlrev_b32 v78, 16, v113
    v_and_b32 v79, 0xffff0000, v113
    v_lshlrev_b32 v80, 16, v114
    v_and_b32 v81, 0xffff0000, v114
    v_lshlrev_b32 v82, 16, v115
    v_and_b32 v83, 0xffff0000, v115
    v_lshlrev_b32 v9, 3, v3
    v_cmp_gt_u32 vcc, 16, v1
    s_nop 1
    v_cndmask_b32 v9, v93, v9, vcc
    s_lshl_b32 s60, s47, 11
    s_lshl_b32 s61, s33, 8
    s_add_u32 s60, s60, s61
    s_lshl_b32 s61, s43, 7
    s_add_u32 s60, s60, s61
    s_cmp_eq_u32 s43, 0
    s_cbranch_scc0 .noodd_k4l0_kernel_3
    ds_read_b128 v[12:15], v8 offset:0
    ds_read_b128 v[16:19], v8 offset:20480
    ds_read_b128 v[20:23], v8 offset:40960
    ds_read_b128 v[24:27], v8 offset:61440
    ds_read_b128 v[28:31], v110 offset:16384
    ds_read_b128 v[32:35], v110 offset:36864
    ds_read_b128 v[36:39], v110 offset:57344
    ds_read_b128 v[40:43], v111 offset:12288
    s_waitcnt lgkmcnt(0)
    v_add_f32 v84, v12, v16
    v_add_f32 v84, v84, v20
    v_add_f32 v84, v84, v24
    v_add_f32 v84, v84, v28
    v_add_f32 v84, v84, v32
    v_add_f32 v84, v84, v36
    v_add_f32 v84, v84, v40
    v_add_f32 v85, v13, v17
    v_add_f32 v85, v85, v21
    v_add_f32 v85, v85, v25
    v_add_f32 v85, v85, v29
    v_add_f32 v85, v85, v33
    v_add_f32 v85, v85, v37
    v_add_f32 v85, v85, v41
    v_add_f32 v86, v14, v18
    v_add_f32 v86, v86, v22
    v_add_f32 v86, v86, v26
    v_add_f32 v86, v86, v30
    v_add_f32 v86, v86, v34
    v_add_f32 v86, v86, v38
    v_add_f32 v86, v86, v42
    v_add_f32 v87, v15, v19
    v_add_f32 v87, v87, v23
    v_add_f32 v87, v87, v27
    v_add_f32 v87, v87, v31
    v_add_f32 v87, v87, v35
    v_add_f32 v87, v87, v39
    v_add_f32 v87, v87, v43
    v_cvt_pk_bf16_f32 v120, v84, v85
    v_lshlrev_b32 v84, 16, v120
    v_and_b32 v85, 0xffff0000, v120
    v_cvt_pk_bf16_f32 v120, v86, v87
    v_lshlrev_b32 v86, 16, v120
    v_and_b32 v87, 0xffff0000, v120
    v_lshlrev_b32 v121, 16, v106
    v_and_b32 v122, 0xffff0000, v106
    v_add_f32 v84, v84, v121
    v_add_f32 v85, v85, v122
    v_lshlrev_b32 v121, 16, v107
    v_and_b32 v122, 0xffff0000, v107
    v_add_f32 v86, v86, v121
    v_add_f32 v87, v87, v122
    v_cvt_pk_bf16_f32 v120, v84, v85
    v_lshlrev_b32 v84, 16, v120
    v_and_b32 v85, 0xffff0000, v120
    v_cvt_pk_bf16_f32 v120, v86, v87
    v_lshlrev_b32 v86, 16, v120
    v_and_b32 v87, 0xffff0000, v120
    v_lshlrev_b32 v121, 16, v100
    v_and_b32 v122, 0xffff0000, v100
    v_add_f32 v84, v84, v121
    v_add_f32 v85, v85, v122
    v_lshlrev_b32 v121, 16, v101
    v_and_b32 v122, 0xffff0000, v101
    v_add_f32 v86, v86, v121
    v_add_f32 v87, v87, v122
    v_cvt_pk_bf16_f32 v116, v84, v85
    v_cvt_pk_bf16_f32 v117, v86, v87
    buffer_store_dwordx2 v[116:117], v92, s[20:23], s59 offen sc1
    v_lshlrev_b32 v84, 16, v116
    v_and_b32 v85, 0xffff0000, v116
    v_lshlrev_b32 v86, 16, v117
    v_and_b32 v87, 0xffff0000, v117
    v_mov_b32 v118, 0
    v_add_f32 v118, v118, v76
    v_add_f32 v118, v118, v77
    v_add_f32 v118, v118, v78
    v_add_f32 v118, v118, v79
    v_add_f32 v118, v118, v80
    v_add_f32 v118, v118, v81
    v_add_f32 v118, v118, v82
    v_add_f32 v118, v118, v83
    v_cndmask_b32 v120, 0, v84, s[56:57]
    v_add_f32 v118, v118, v120
    v_cndmask_b32 v120, 0, v85, s[56:57]
    v_add_f32 v118, v118, v120
    v_cndmask_b32 v120, 0, v86, s[56:57]
    v_add_f32 v118, v118, v120
    v_cndmask_b32 v120, 0, v87, s[56:57]
    v_add_f32 v118, v118, v120
    v_mov_b32 v120, v118
    s_nop 1
    v_permlane16_swap_b32 v118, v120
    v_add_f32 v118, v118, v120
    v_mov_b32 v120, v118
    s_nop 1
    v_permlane32_swap_b32 v118, v120
    v_add_f32 v118, v118, v120
    v_mul_f32 v118, 0x3ccccccd, v118
    v_mov_b32 v119, 0
    v_sub_f32 v120, v76, v118
    v_fmac_f32 v119, v120, v120
    v_sub_f32 v120, v77, v118
    v_fmac_f32 v119, v120, v120
    v_sub_f32 v120, v78, v118
    v_fmac_f32 v119, v120, v120
    v_sub_f32 v120, v79, v118
    v_fmac_f32 v119, v120, v120
    v_sub_f32 v120, v80, v118
    v_fmac_f32 v119, v120, v120
    v_sub_f32 v120, v81, v118
    v_fmac_f32 v119, v120, v120
    v_sub_f32 v120, v82, v118
    v_fmac_f32 v119, v120, v120
    v_sub_f32 v120, v83, v118
    v_fmac_f32 v119, v120, v120
    v_sub_f32 v120, v84, v118
    v_cndmask_b32 v120, 0, v120, s[56:57]
    v_fmac_f32 v119, v120, v120
    v_sub_f32 v120, v85, v118
    v_cndmask_b32 v120, 0, v120, s[56:57]
    v_fmac_f32 v119, v120, v120
    v_sub_f32 v120, v86, v118
    v_cndmask_b32 v120, 0, v120, s[56:57]
    v_fmac_f32 v119, v120, v120
    v_sub_f32 v120, v87, v118
    v_cndmask_b32 v120, 0, v120, s[56:57]
    v_fmac_f32 v119, v120, v120
    v_mov_b32 v120, v119
    s_nop 1
    v_permlane16_swap_b32 v119, v120
    v_add_f32 v119, v119, v120
    v_mov_b32 v120, v119
    s_nop 1
    v_permlane32_swap_b32 v119, v120
    v_add_f32 v119, v119, v120
    buffer_store_dwordx2 v[118:119], v9, s[28:31], s60 offen sc1
    s_nop 0
    s_branch .join_k4l0_kernel_4
.noodd_k4l0_kernel_3:
    v_mov_b32 v118, 0
    v_add_f32 v118, v118, v76
    v_add_f32 v118, v118, v77
    v_add_f32 v118, v118, v78
    v_add_f32 v118, v118, v79
    v_add_f32 v118, v118, v80
    v_add_f32 v118, v118, v81
    v_add_f32 v118, v118, v82
    v_add_f32 v118, v118, v83
    v_mov_b32 v120, v118
    s_nop 1
    v_permlane16_swap_b32 v118, v120
    v_add_f32 v118, v118, v120
    v_mov_b32 v120, v118
    s_nop 1
    v_permlane32_swap_b32 v118, v120
    v_add_f32 v118, v118, v120
    v_mul_f32 v118, 0x3d000000, v118
    v_mov_b32 v119, 0
    v_sub_f32 v120, v76, v118
    v_fmac_f32 v119, v120, v120
    v_sub_f32 v120, v77, v118
    v_fmac_f32 v119, v120, v120
    v_sub_f32 v120, v78, v118
    v_fmac_f32 v119, v120, v120
    v_sub_f32 v120, v79, v118
    v_fmac_f32 v119, v120, v120
    v_sub_f32 v120, v80, v118
    v_fmac_f32 v119, v120, v120
    v_sub_f32 v120, v81, v118
    v_fmac_f32 v119, v120, v120
    v_sub_f32 v120, v82, v118
    v_fmac_f32 v119, v120, v120
    v_sub_f32 v120, v83, v118
    v_fmac_f32 v119, v120, v120
    v_mov_b32 v120, v119
    s_nop 1
    v_permlane16_swap_b32 v119, v120
    v_add_f32 v119, v119, v120
    v_mov_b32 v120, v119
    s_nop 1
    v_permlane32_swap_b32 v119, v120
    v_add_f32 v119, v119, v120
    buffer_store_dwordx2 v[118:119], v9, s[28:31], s60 offen sc1
    s_nop 0
    s_branch .join_k4l0_kernel_4
.join_k4l0_kernel_4:
.End_k4l0_kernel_1:
    s_endpgm
.globl k1l1_kernel
.p2align 8
.type k1l1_kernel,@function
k1l1_kernel:
    s_cmp_ge_u32 s2, 256
    s_cbranch_scc1 .End_k1l1_kernel_1
    s_load_dwordx2 s[4:5], s[0:1], 88
    v_and_b32 v1, 63, v0
    v_lshrrev_b32 v2, 6, v0
    s_nop 0
    v_readfirstlane_b32 s3, v2
    v_and_b32 v3, 15, v1
    v_lshrrev_b32 v4, 4, v1
    v_lshlrev_b32 v5, 4, v1
    s_lshr_b32 s34, s2, 3
    s_and_b32 s32, s2, 1
    s_lshl_b32 s32, s32, 2
    s_and_b32 s35, s34, 3
    s_add_u32 s32, s32, s35
    s_bfe_u32 s33, s2, 0x20001
    s_lshl_b32 s33, s33, 3
    s_lshr_b32 s34, s34, 2
    s_add_u32 s33, s33, s34
    s_and_b32 s51, s3, 3
    s_lshl_b32 s34, s33, 2
    s_add_u32 s34, s34, s51
    s_waitcnt lgkmcnt(0)
    s_mov_b32 s8, s4
    s_mov_b32 s9, s5
    s_and_b32 s9, s9, 0xffff
    s_mov_b32 s10, 0x1f8000
    s_mov_b32 s11, 0x20000
    s_add_u32 s12, s4, 0x1d00000
    s_addc_u32 s13, s5, 0
    s_and_b32 s13, s13, 0xffff
    s_mov_b32 s14, 0x240000
    s_mov_b32 s15, 0x20000
    s_add_u32 s16, s4, 0x2280000
    s_addc_u32 s17, s5, 0
    s_and_b32 s17, s17, 0xffff
    s_mov_b32 s18, 0x40000
    s_mov_b32 s19, 0x20000
    s_add_u32 s20, s4, 0x200000
    s_addc_u32 s21, s5, 0
    s_and_b32 s21, s21, 0xffff
    s_mov_b32 s22, 0x1f800
    s_mov_b32 s23, 0x20000
    s_add_u32 s24, s4, 0x2400000
    s_addc_u32 s25, s5, 0
    s_and_b32 s25, s25, 0xffff
    s_mov_b32 s26, 0x480000
    s_mov_b32 s27, 0x20000
    s_add_u32 s28, s4, 0x2340000
    s_addc_u32 s29, s5, 0
    s_and_b32 s29, s29, 0xffff
    s_mov_b32 s30, 0x28000
    s_mov_b32 s31, 0x20000
    v_add_u32 v2, 0x10000, v5
    v_add_u32 v15, 0x20000, v5
    s_mul_i32 s37, s34, 18432
    s_lshl_b32 s39, s3, 10
    s_mul_i32 s40, s32, 258048
    s_add_u32 s41, s40, s39
    s_min_u32 s42, s39, 3072
    v_lshlrev_b32 v6, 2, v0
    s_mul_i32 s35, s32, 896
    v_lshlrev_b32 v7, 3, v3
    v_lshl_add_u32 v7, v4, 7, v7
    s_lshl_b32 s36, s34, 11
    s_cmp_ge_u32 s3, 4
    s_cbranch_scc1 .kv_k1l1_kernel_2
    s_add_u32 s38, s37, 0
    buffer_load_dwordx4 v[16:19], v5, s[12:15], s38 offen
    s_add_u32 s38, s37, 1024
    buffer_load_dwordx4 v[20:23], v5, s[12:15], s38 offen
    s_add_u32 m0, s39, 0
    s_add_u32 s43, s41, 0
    buffer_load_dwordx4 v5, s[8:11], s43 offen lds
    s_add_u32 m0, s39, 8192
    s_add_u32 s43, s41, 8192
    buffer_load_dwordx4 v5, s[8:11], s43 offen lds
    s_add_u32 m0, s39, 16384
    s_add_u32 s43, s41, 16384
    buffer_load_dwordx4 v5, s[8:11], s43 offen lds
    s_add_u32 m0, s42, 24576
    s_add_u32 s43, s40, s42
    s_add_u32 s43, s43, 24576
    buffer_load_dwordx4 v5, s[8:11], s43 offen lds
    s_add_u32 s38, s37, 2048
    buffer_load_dwordx4 v[24:27], v5, s[12:15], s38 offen
    s_add_u32 s38, s37, 3072
    buffer_load_dwordx4 v[28:31], v5, s[12:15], s38 offen
    s_add_u32 m0, s39, 28672
    s_add_u32 s43, s41, 28672
    buffer_load_dwordx4 v5, s[8:11], s43 offen lds
    s_add_u32 m0, s39, 36864
    s_add_u32 s43, s41, 36864
    buffer_load_dwordx4 v5, s[8:11], s43 offen lds
    s_add_u32 m0, s39, 45056
    s_add_u32 s43, s41, 45056
    buffer_load_dwordx4 v5, s[8:11], s43 offen lds
    s_add_u32 m0, s42, 53248
    s_add_u32 s43, s40, s42
    s_add_u32 s43, s43, 53248
    buffer_load_dwordx4 v5, s[8:11], s43 offen lds
    s_waitcnt vmcnt(6)
    s_barrier
    s_add_u32 m0, s39, 57344
    s_add_u32 s43, s41, 57344
    buffer_load_dwordx4 v5, s[8:11], s43 offen lds
    s_add_u32 m0, s39, 65536
    s_add_u32 s43, s41, 65536
    buffer_load_dwordx4 v5, s[8:11], s43 offen lds
    s_add_u32 m0, s39, 73728
    s_add_u32 s43, s41, 73728
    buffer_load_dwordx4 v5, s[8:11], s43 offen lds
    s_add_u32 m0, s42, 81920
    s_add_u32 s43, s40, s42
    s_add_u32 s43, s43, 81920
    buffer_load_dwordx4 v5, s[8:11], s43 offen lds
    ds_read_b128 v[124:127], v5 offset:0
    ds_read_b128 v[128:131], v5 offset:1024
    ds_read_b128 v[132:135], v5 offset:2048
    ds_read_b128 v[136:139], v5 offset:3072
    ds_read_b128 v[140:143], v5 offset:4096
    ds_read_b128 v[160:163], v5 offset:14336
    ds_read_b128 v[164:167], v5 offset:15360
    ds_read_b128 v[168:171], v5 offset:16384
    ds_read_b128 v[172:175], v5 offset:17408
    ds_read_b128 v[176:179], v5 offset:18432
    s_waitcnt lgkmcnt(9)
    v_mfma_f32_16x16x32_bf16 v[88:91], v[124:127], v[16:19], 0
    s_waitcnt lgkmcnt(8)
    v_mfma_f32_16x16x32_bf16 v[92:95], v[128:131], v[16:19], 0
    s_waitcnt lgkmcnt(7)
    v_mfma_f32_16x16x32_bf16 v[96:99], v[132:135], v[16:19], 0
    s_waitcnt lgkmcnt(6)
    v_mfma_f32_16x16x32_bf16 v[100:103], v[136:139], v[16:19], 0
    s_waitcnt lgkmcnt(5)
    v_mfma_f32_16x16x32_bf16 v[104:107], v[140:143], v[16:19], 0
    s_add_u32 s38, s37, 4096
    buffer_load_dwordx4 v[32:35], v5, s[12:15], s38 offen
    s_waitcnt lgkmcnt(4)
    v_mfma_f32_16x16x32_bf16 v[88:91], v[160:163], v[20:23], v[88:91]
    s_waitcnt lgkmcnt(3)
    v_mfma_f32_16x16x32_bf16 v[92:95], v[164:167], v[20:23], v[92:95]
    s_waitcnt lgkmcnt(2)
    v_mfma_f32_16x16x32_bf16 v[96:99], v[168:171], v[20:23], v[96:99]
    s_waitcnt lgkmcnt(1)
    v_mfma_f32_16x16x32_bf16 v[100:103], v[172:175], v[20:23], v[100:103]
    s_waitcnt lgkmcnt(0)
    v_mfma_f32_16x16x32_bf16 v[104:107], v[176:179], v[20:23], v[104:107]
    s_add_u32 s38, s37, 5120
    buffer_load_dwordx4 v[36:39], v5, s[12:15], s38 offen
    s_waitcnt vmcnt(6)
    s_barrier
    s_add_u32 m0, s39, 86016
    s_add_u32 s43, s41, 86016
    buffer_load_dwordx4 v5, s[8:11], s43 offen lds
    s_add_u32 m0, s39, 94208
    s_add_u32 s43, s41, 94208
    buffer_load_dwordx4 v5, s[8:11], s43 offen lds
    s_add_u32 m0, s39, 102400
    s_add_u32 s43, s41, 102400
    buffer_load_dwordx4 v5, s[8:11], s43 offen lds
    s_add_u32 m0, s42, 110592
    s_add_u32 s43, s40, s42
    s_add_u32 s43, s43, 110592
    buffer_load_dwordx4 v5, s[8:11], s43 offen lds
    ds_read_b128 v[124:127], v5 offset:28672
    ds_read_b128 v[128:131], v5 offset:29696
    ds_read_b128 v[132:135], v5 offset:30720
    ds_read_b128 v[136:139], v5 offset:31744
    ds_read_b128 v[140:143], v5 offset:32768
    ds_read_b128 v[160:163], v5 offset:43008
    ds_read_b128 v[164:167], v5 offset:44032
    ds_read_b128 v[168:171], v5 offset:45056
    ds_read_b128 v[172:175], v5 offset:46080
    ds_read_b128 v[176:179], v5 offset:47104
    s_waitcnt lgkmcnt(9)
    v_mfma_f32_16x16x32_bf16 v[88:91], v[124:127], v[24:27], v[88:91]
    s_waitcnt lgkmcnt(8)
    v_mfma_f32_16x16x32_bf16 v[92:95], v[128:131], v[24:27], v[92:95]
    s_waitcnt lgkmcnt(7)
    v_mfma_f32_16x16x32_bf16 v[96:99], v[132:135], v[24:27], v[96:99]
    s_waitcnt lgkmcnt(6)
    v_mfma_f32_16x16x32_bf16 v[100:103], v[136:139], v[24:27], v[100:103]
    s_waitcnt lgkmcnt(5)
    v_mfma_f32_16x16x32_bf16 v[104:107], v[140:143], v[24:27], v[104:107]
    s_add_u32 s38, s37, 6144
    buffer_load_dwordx4 v[40:43], v5, s[12:15], s38 offen
    s_waitcnt lgkmcnt(4)
    v_mfma_f32_16x16x32_bf16 v[88:91], v[160:163], v[28:31], v[88:91]
    s_waitcnt lgkmcnt(3)
    v_mfma_f32_16x16x32_bf16 v[92:95], v[164:167], v[28:31], v[92:95]
    s_waitcnt lgkmcnt(2)
    v_mfma_f32_16x16x32_bf16 v[96:99], v[168:171], v[28:31], v[96:99]
    s_waitcnt lgkmcnt(1)
    v_mfma_f32_16x16x32_bf16 v[100:103], v[172:175], v[28:31], v[100:103]
    s_waitcnt lgkmcnt(0)
    v_mfma_f32_16x16x32_bf16 v[104:107], v[176:179], v[28:31], v[104:107]
    s_add_u32 s38, s37, 7168
    buffer_load_dwordx4 v[44:47], v5, s[12:15], s38 offen
    s_waitcnt vmcnt(8)
    s_barrier
    s_add_u32 m0, s39, 0
    s_add_u32 s43, s41, 114688
    buffer_load_dwordx4 v5, s[8:11], s43 offen lds
    s_add_u32 m0, s39, 8192
    s_add_u32 s43, s41, 122880
    buffer_load_dwordx4 v5, s[8:11], s43 offen lds
    s_add_u32 m0, s39, 16384
    s_add_u32 s43, s41, 131072
    buffer_load_dwordx4 v5, s[8:11], s43 offen lds
    s_add_u32 m0, s42, 24576
    s_add_u32 s43, s40, s42
    s_add_u32 s43, s43, 139264
    buffer_load_dwordx4 v5, s[8:11], s43 offen lds
    ds_read_b128 v[124:127], v5 offset:57344
    ds_read_b128 v[128:131], v5 offset:58368
    ds_read_b128 v[132:135], v5 offset:59392
    ds_read_b128 v[136:139], v5 offset:60416
    ds_read_b128 v[140:143], v5 offset:61440
    s_waitcnt vmcnt(11)
    ds_read_b128 v[160:163], v2 offset:6144
    ds_read_b128 v[164:167], v2 offset:7168
    ds_read_b128 v[168:171], v2 offset:8192
    ds_read_b128 v[172:175], v2 offset:9216
    ds_read_b128 v[176:179], v2 offset:10240
    s_waitcnt lgkmcnt(9)
    v_mfma_f32_16x16x32_bf16 v[88:91], v[124:127], v[32:35], v[88:91]
    s_waitcnt lgkmcnt(8)
    v_mfma_f32_16x16x32_bf16 v[92:95], v[128:131], v[32:35], v[92:95]
    s_waitcnt lgkmcnt(7)
    v_mfma_f32_16x16x32_bf16 v[96:99], v[132:135], v[32:35], v[96:99]
    s_waitcnt lgkmcnt(6)
    v_mfma_f32_16x16x32_bf16 v[100:103], v[136:139], v[32:35], v[100:103]
    s_waitcnt lgkmcnt(5)
    v_mfma_f32_16x16x32_bf16 v[104:107], v[140:143], v[32:35], v[104:107]
    s_add_u32 s38, s37, 8192
    buffer_load_dwordx4 v[48:51], v5, s[12:15], s38 offen
    s_waitcnt vmcnt(11)
    s_waitcnt lgkmcnt(4)
    v_mfma_f32_16x16x32_bf16 v[88:91], v[160:163], v[36:39], v[88:91]
    s_waitcnt lgkmcnt(3)
    v_mfma_f32_16x16x32_bf16 v[92:95], v[164:167], v[36:39], v[92:95]
    s_waitcnt lgkmcnt(2)
    v_mfma_f32_16x16x32_bf16 v[96:99], v[168:171], v[36:39], v[96:99]
    s_waitcnt lgkmcnt(1)
    v_mfma_f32_16x16x32_bf16 v[100:103], v[172:175], v[36:39], v[100:103]
    s_waitcnt lgkmcnt(0)
    v_mfma_f32_16x16x32_bf16 v[104:107], v[176:179], v[36:39], v[104:107]
    s_add_u32 s38, s37, 9216
    buffer_load_dwordx4 v[52:55], v5, s[12:15], s38 offen
    s_waitcnt vmcnt(8)
    s_barrier
    s_add_u32 m0, s39, 28672
    s_add_u32 s43, s41, 143360
    buffer_load_dwordx4 v5, s[8:11], s43 offen lds
    s_add_u32 m0, s39, 36864
    s_add_u32 s43, s41, 151552
    buffer_load_dwordx4 v5, s[8:11], s43 offen lds
    s_add_u32 m0, s39, 45056
    s_add_u32 s43, s41, 159744
    buffer_load_dwordx4 v5, s[8:11], s43 offen lds
    s_add_u32 m0, s42, 53248
    s_add_u32 s43, s40, s42
    s_add_u32 s43, s43, 167936
    buffer_load_dwordx4 v5, s[8:11], s43 offen lds
    ds_read_b128 v[124:127], v2 offset:20480
    ds_read_b128 v[128:131], v2 offset:21504
    ds_read_b128 v[132:135], v2 offset:22528
    ds_read_b128 v[136:139], v2 offset:23552
    ds_read_b128 v[140:143], v2 offset:24576
    s_waitcnt vmcnt(11)
    ds_read_b128 v[160:163], v2 offset:34816
    ds_read_b128 v[164:167], v2 offset:35840
    ds_read_b128 v[168:171], v2 offset:36864
    ds_read_b128 v[172:175], v2 offset:37888
    ds_read_b128 v[176:179], v2 offset:38912
    s_waitcnt lgkmcnt(9)
    v_mfma_f32_16x16x32_bf16 v[88:91], v[124:127], v[40:43], v[88:91]
    s_waitcnt lgkmcnt(8)
    v_mfma_f32_16x16x32_bf16 v[92:95], v[128:131], v[40:43], v[92:95]
    s_waitcnt lgkmcnt(7)
    v_mfma_f32_16x16x32_bf16 v[96:99], v[132:135], v[40:43], v[96:99]
    s_waitcnt lgkmcnt(6)
    v_mfma_f32_16x16x32_bf16 v[100:103], v[136:139], v[40:43], v[100:103]
    s_waitcnt lgkmcnt(5)
    v_mfma_f32_16x16x32_bf16 v[104:107], v[140:143], v[40:43], v[104:107]
    s_add_u32 s38, s37, 10240
    buffer_load_dwordx4 v[56:59], v5, s[12:15], s38 offen
    s_waitcnt vmcnt(11)
    s_waitcnt lgkmcnt(4)
    v_mfma_f32_16x16x32_bf16 v[88:91], v[160:163], v[44:47], v[88:91]
    s_waitcnt lgkmcnt(3)
    v_mfma_f32_16x16x32_bf16 v[92:95], v[164:167], v[44:47], v[92:95]
    s_waitcnt lgkmcnt(2)
    v_mfma_f32_16x16x32_bf16 v[96:99], v[168:171], v[44:47], v[96:99]
    s_waitcnt lgkmcnt(1)
    v_mfma_f32_16x16x32_bf16 v[100:103], v[172:175], v[44:47], v[100:103]
    s_waitcnt lgkmcnt(0)
    v_mfma_f32_16x16x32_bf16 v[104:107], v[176:179], v[44:47], v[104:107]
    s_add_u32 s38, s37, 11264
    buffer_load_dwordx4 v[60:63], v5, s[12:15], s38 offen
    s_waitcnt vmcnt(8)
    s_barrier
    s_add_u32 m0, s39, 57344
    s_add_u32 s43, s41, 172032
    buffer_load_dwordx4 v5, s[8:11], s43 offen lds
    s_add_u32 m0, s39, 65536
    s_add_u32 s43, s41, 180224
    buffer_load_dwordx4 v5, s[8:11], s43 offen lds
    s_add_u32 m0, s39, 73728
    s_add_u32 s43, s41, 188416
    buffer_load_dwordx4 v5, s[8:11], s43 offen lds
    s_add_u32 m0, s42, 81920
    s_add_u32 s43, s40, s42
    s_add_u32 s43, s43, 196608
    buffer_load_dwordx4 v5, s[8:11], s43 offen lds
    ds_read_b128 v[124:127], v5 offset:0
    ds_read_b128 v[128:131], v5 offset:1024
    ds_read_b128 v[132:135], v5 offset:2048
    ds_read_b128 v[136:139], v5 offset:3072
    ds_read_b128 v[140:143], v5 offset:4096
    s_waitcnt vmcnt(11)
    ds_read_b128 v[160:163], v5 offset:14336
    ds_read_b128 v[164:167], v5 offset:15360
    ds_read_b128 v[168:171], v5 offset:16384
    ds_read_b128 v[172:175], v5 offset:17408
    ds_read_b128 v[176:179], v5 offset:18432
    s_waitcnt lgkmcnt(9)
    v_mfma_f32_16x16x32_bf16 v[88:91], v[124:127], v[48:51], v[88:91]
    s_waitcnt lgkmcnt(8)
    v_mfma_f32_16x16x32_bf16 v[92:95], v[128:131], v[48:51], v[92:95]
    s_waitcnt lgkmcnt(7)
    v_mfma_f32_16x16x32_bf16 v[96:99], v[132:135], v[48:51], v[96:99]
    s_waitcnt lgkmcnt(6)
    v_mfma_f32_16x16x32_bf16 v[100:103], v[136:139], v[48:51], v[100:103]
    s_waitcnt lgkmcnt(5)
    v_mfma_f32_16x16x32_bf16 v[104:107], v[140:143], v[48:51], v[104:107]
    s_add_u32 s38, s37, 12288
    buffer_load_dwordx4 v[64:67], v5, s[12:15], s38 offen
    s_waitcnt vmcnt(11)
    s_waitcnt lgkmcnt(4)
    v_mfma_f32_16x16x32_bf16 v[88:91], v[160:163], v[52:55], v[88:91]
    s_waitcnt lgkmcnt(3)
    v_mfma_f32_16x16x32_bf16 v[92:95], v[164:167], v[52:55], v[92:95]
    s_waitcnt lgkmcnt(2)
    v_mfma_f32_16x16x32_bf16 v[96:99], v[168:171], v[52:55], v[96:99]
    s_waitcnt lgkmcnt(1)
    v_mfma_f32_16x16x32_bf16 v[100:103], v[172:175], v[52:55], v[100:103]
    s_waitcnt lgkmcnt(0)
    v_mfma_f32_16x16x32_bf16 v[104:107], v[176:179], v[52:55], v[104:107]
    s_add_u32 s38, s37, 13312
    buffer_load_dwordx4 v[68:71], v5, s[12:15], s38 offen
    s_waitcnt vmcnt(8)
    s_barrier
    s_add_u32 m0, s39, 86016
    s_add_u32 s43, s41, 200704
    buffer_load_dwordx4 v5, s[8:11], s43 offen lds
    s_add_u32 m0, s39, 94208
    s_add_u32 s43, s41, 208896
    buffer_load_dwordx4 v5, s[8:11], s43 offen lds
    s_add_u32 m0, s39, 102400
    s_add_u32 s43, s41, 217088
    buffer_load_dwordx4 v5, s[8:11], s43 offen lds
    s_add_u32 m0, s42, 110592
    s_add_u32 s43, s40, s42
    s_add_u32 s43, s43, 225280
    buffer_load_dwordx4 v5, s[8:11], s43 offen lds
    ds_read_b128 v[124:127], v5 offset:28672
    ds_read_b128 v[128:131], v5 offset:29696
    ds_read_b128 v[132:135], v5 offset:30720
    ds_read_b128 v[136:139], v5 offset:31744
    ds_read_b128 v[140:143], v5 offset:32768
    s_waitcnt vmcnt(11)
    ds_read_b128 v[160:163], v5 offset:43008
    ds_read_b128 v[164:167], v5 offset:44032
    ds_read_b128 v[168:171], v5 offset:45056
    ds_read_b128 v[172:175], v5 offset:46080
    ds_read_b128 v[176:179], v5 offset:47104
    s_waitcnt lgkmcnt(9)
    v_mfma_f32_16x16x32_bf16 v[88:91], v[124:127], v[56:59], v[88:91]
    s_waitcnt lgkmcnt(8)
    v_mfma_f32_16x16x32_bf16 v[92:95], v[128:131], v[56:59], v[92:95]
    s_waitcnt lgkmcnt(7)
    v_mfma_f32_16x16x32_bf16 v[96:99], v[132:135], v[56:59], v[96:99]
    s_waitcnt lgkmcnt(6)
    v_mfma_f32_16x16x32_bf16 v[100:103], v[136:139], v[56:59], v[100:103]
    s_waitcnt lgkmcnt(5)
    v_mfma_f32_16x16x32_bf16 v[104:107], v[140:143], v[56:59], v[104:107]
    s_add_u32 s38, s37, 14336
    buffer_load_dwordx4 v[72:75], v5, s[12:15], s38 offen
    s_waitcnt vmcnt(11)
    s_waitcnt lgkmcnt(4)
    v_mfma_f32_16x16x32_bf16 v[88:91], v[160:163], v[60:63], v[88:91]
    s_waitcnt lgkmcnt(3)
    v_mfma_f32_16x16x32_bf16 v[92:95], v[164:167], v[60:63], v[92:95]
    s_waitcnt lgkmcnt(2)
    v_mfma_f32_16x16x32_bf16 v[96:99], v[168:171], v[60:63], v[96:99]
    s_waitcnt lgkmcnt(1)
    v_mfma_f32_16x16x32_bf16 v[100:103], v[172:175], v[60:63], v[100:103]
    s_waitcnt lgkmcnt(0)
    v_mfma_f32_16x16x32_bf16 v[104:107], v[176:179], v[60:63], v[104:107]
    s_add_u32 s38, s37, 15360
    buffer_load_dwordx4 v[76:79], v5, s[12:15], s38 offen
    s_waitcnt vmcnt(8)
    s_barrier
    s_add_u32 m0, s39, 0
    s_add_u32 s43, s41, 229376
    buffer_load_dwordx4 v5, s[8:11], s43 offen lds
    s_add_u32 m0, s39, 8192
    s_add_u32 s43, s41, 237568
    buffer_load_dwordx4 v5, s[8:11], s43 offen lds
    s_add_u32 m0, s39, 16384
    s_add_u32 s43, s41, 245760
    buffer_load_dwordx4 v5, s[8:11], s43 offen lds
    s_add_u32 m0, s42, 24576
    s_add_u32 s43, s40, s42
    s_add_u32 s43, s43, 253952
    buffer_load_dwordx4 v5, s[8:11], s43 offen lds
    ds_read_b128 v[124:127], v5 offset:57344
    ds_read_b128 v[128:131], v5 offset:58368
    ds_read_b128 v[132:135], v5 offset:59392
    ds_read_b128 v[136:139], v5 offset:60416
    ds_read_b128 v[140:143], v5 offset:61440
    s_waitcnt vmcnt(11)
    ds_read_b128 v[160:163], v2 offset:6144
    ds_read_b128 v[164:167], v2 offset:7168
    ds_read_b128 v[168:171], v2 offset:8192
    ds_read_b128 v[172:175], v2 offset:9216
    ds_read_b128 v[176:179], v2 offset:10240
    s_waitcnt lgkmcnt(9)
    v_mfma_f32_16x16x32_bf16 v[88:91], v[124:127], v[64:67], v[88:91]
    s_waitcnt lgkmcnt(8)
    v_mfma_f32_16x16x32_bf16 v[92:95], v[128:131], v[64:67], v[92:95]
    s_waitcnt lgkmcnt(7)
    v_mfma_f32_16x16x32_bf16 v[96:99], v[132:135], v[64:67], v[96:99]
    s_waitcnt lgkmcnt(6)
    v_mfma_f32_16x16x32_bf16 v[100:103], v[136:139], v[64:67], v[100:103]
    s_waitcnt lgkmcnt(5)
    v_mfma_f32_16x16x32_bf16 v[104:107], v[140:143], v[64:67], v[104:107]
    s_add_u32 s38, s37, 16384
    buffer_load_dwordx4 v[80:83], v5, s[12:15], s38 offen
    s_waitcnt vmcnt(11)
    s_waitcnt lgkmcnt(4)
    v_mfma_f32_16x16x32_bf16 v[88:91], v[160:163], v[68:71], v[88:91]
    s_waitcnt lgkmcnt(3)
    v_mfma_f32_16x16x32_bf16 v[92:95], v[164:167], v[68:71], v[92:95]
    s_waitcnt lgkmcnt(2)
    v_mfma_f32_16x16x32_bf16 v[96:99], v[168:171], v[68:71], v[96:99]
    s_waitcnt lgkmcnt(1)
    v_mfma_f32_16x16x32_bf16 v[100:103], v[172:175], v[68:71], v[100:103]
    s_waitcnt lgkmcnt(0)
    v_mfma_f32_16x16x32_bf16 v[104:107], v[176:179], v[68:71], v[104:107]
    s_add_u32 s38, s37, 17408
    buffer_load_dwordx4 v[84:87], v5, s[12:15], s38 offen
    s_waitcnt vmcnt(8)
    s_barrier
    ds_read_b128 v[124:127], v2 offset:20480
    ds_read_b128 v[128:131], v2 offset:21504
    ds_read_b128 v[132:135], v2 offset:22528
    ds_read_b128 v[136:139], v2 offset:23552
    ds_read_b128 v[140:143], v2 offset:24576
    s_waitcnt vmcnt(7)
    ds_read_b128 v[160:163], v2 offset:34816
    ds_read_b128 v[164:167], v2 offset:35840
    ds_read_b128 v[168:171], v2 offset:36864
    ds_read_b128 v[172:175], v2 offset:37888
    ds_read_b128 v[176:179], v2 offset:38912
    s_waitcnt lgkmcnt(9)
    v_mfma_f32_16x16x32_bf16 v[88:91], v[124:127], v[72:75], v[88:91]
    s_waitcnt lgkmcnt(8)
    v_mfma_f32_16x16x32_bf16 v[92:95], v[128:131], v[72:75], v[92:95]
    s_waitcnt lgkmcnt(7)
    v_mfma_f32_16x16x32_bf16 v[96:99], v[132:135], v[72:75], v[96:99]
    s_waitcnt lgkmcnt(6)
    v_mfma_f32_16x16x32_bf16 v[100:103], v[136:139], v[72:75], v[100:103]
    s_waitcnt lgkmcnt(5)
    v_mfma_f32_16x16x32_bf16 v[104:107], v[140:143], v[72:75], v[104:107]
    s_add_u32 s44, s35, 0
    buffer_load_dword v204, v6, s[20:23], s44 offen
    s_add_u32 s44, s35, 7168
    buffer_load_dword v205, v6, s[20:23], s44 offen
    s_add_u32 s44, s35, 14336
    buffer_load_dword v206, v6, s[20:23], s44 offen
    s_add_u32 s44, s35, 21504
    buffer_load_dword v207, v6, s[20:23], s44 offen
    s_add_u32 s44, s35, 28672
    buffer_load_dword v208, v6, s[20:23], s44 offen
    s_add_u32 s44, s35, 35840
    buffer_load_dword v209, v6, s[20:23], s44 offen
    s_add_u32 s44, s35, 43008
    buffer_load_dword v210, v6, s[20:23], s44 offen
    s_add_u32 s44, s35, 50176
    buffer_load_dword v211, v6, s[20:23], s44 offen
    s_add_u32 s44, s35, 57344
    buffer_load_dword v212, v6, s[20:23], s44 offen
    s_add_u32 s44, s35, 64512
    buffer_load_dword v213, v6, s[20:23], s44 offen
    s_add_u32 s44, s35, 71680
    buffer_load_dword v214, v6, s[20:23], s44 offen
    s_add_u32 s44, s35, 78848
    buffer_load_dword v215, v6, s[20:23], s44 offen
    s_add_u32 s44, s35, 86016
    buffer_load_dword v216, v6, s[20:23], s44 offen
    s_add_u32 s44, s35, 93184
    buffer_load_dword v217, v6, s[20:23], s44 offen
    s_add_u32 s44, s35, 100352
    buffer_load_dword v218, v6, s[20:23], s44 offen
    s_add_u32 s44, s35, 107520
    buffer_load_dword v219, v6, s[20:23], s44 offen
    s_add_u32 s44, s35, 114688
    buffer_load_dword v220, v6, s[20:23], s44 offen
    s_add_u32 s44, s35, 121856
    buffer_load_dword v221, v6, s[20:23], s44 offen
    buffer_load_dwordx2 v[196:197], v7, s[16:19], s36 offen offset:0
    buffer_load_dwordx2 v[198:199], v7, s[16:19], s36 offen offset:512
    buffer_load_dwordx2 v[200:201], v7, s[16:19], s36 offen offset:1024
    buffer_load_dwordx2 v[202:203], v7, s[16:19], s36 offen offset:1536
    s_waitcnt vmcnt(28)
    s_waitcnt lgkmcnt(4)
    v_mfma_f32_16x16x32_bf16 v[88:91], v[160:163], v[76:79], v[88:91]
    s_waitcnt lgkmcnt(3)
    v_mfma_f32_16x16x32_bf16 v[92:95], v[164:167], v[76:79], v[92:95]
    s_waitcnt lgkmcnt(2)
    v_mfma_f32_16x16x32_bf16 v[96:99], v[168:171], v[76:79], v[96:99]
    s_waitcnt lgkmcnt(1)
    v_mfma_f32_16x16x32_bf16 v[100:103], v[172:175], v[76:79], v[100:103]
    s_waitcnt lgkmcnt(0)
    v_mfma_f32_16x16x32_bf16 v[104:107], v[176:179], v[76:79], v[104:107]
    s_waitcnt vmcnt(24)
    s_barrier
    ds_read_b128 v[124:127], v5 offset:0
    ds_read_b128 v[128:131], v5 offset:1024
    ds_read_b128 v[132:135], v5 offset:2048
    ds_read_b128 v[136:139], v5 offset:3072
    ds_read_b128 v[140:143], v5 offset:4096
    s_waitcnt vmcnt(23)
    ds_read_b128 v[160:163], v5 offset:14336
    ds_read_b128 v[164:167], v5 offset:15360
    ds_read_b128 v[168:171], v5 offset:16384
    ds_read_b128 v[172:175], v5 offset:17408
    ds_read_b128 v[176:179], v5 offset:18432
    s_waitcnt lgkmcnt(9)
    v_mfma_f32_16x16x32_bf16 v[88:91], v[124:127], v[80:83], v[88:91]
    s_waitcnt lgkmcnt(8)
    v_mfma_f32_16x16x32_bf16 v[92:95], v[128:131], v[80:83], v[92:95]
    s_waitcnt lgkmcnt(7)
    v_mfma_f32_16x16x32_bf16 v[96:99], v[132:135], v[80:83], v[96:99]
    s_waitcnt lgkmcnt(6)
    v_mfma_f32_16x16x32_bf16 v[100:103], v[136:139], v[80:83], v[100:103]
    s_waitcnt lgkmcnt(5)
    v_mfma_f32_16x16x32_bf16 v[104:107], v[140:143], v[80:83], v[104:107]
    s_waitcnt vmcnt(22)
    s_waitcnt lgkmcnt(4)
    v_mfma_f32_16x16x32_bf16 v[88:91], v[160:163], v[84:87], v[88:91]
    s_waitcnt lgkmcnt(3)
    v_mfma_f32_16x16x32_bf16 v[92:95], v[164:167], v[84:87], v[92:95]
    s_waitcnt lgkmcnt(2)
    v_mfma_f32_16x16x32_bf16 v[96:99], v[168:171], v[84:87], v[96:99]
    s_waitcnt lgkmcnt(1)
    v_mfma_f32_16x16x32_bf16 v[100:103], v[172:175], v[84:87], v[100:103]
    s_waitcnt lgkmcnt(0)
    v_mfma_f32_16x16x32_bf16 v[104:107], v[176:179], v[84:87], v[104:107]
    s_waitcnt vmcnt(0)
    v_add_f32 v204, v204, v205
    v_add_f32 v204, v204, v206
    v_add_f32 v204, v204, v207
    v_add_f32 v204, v204, v208
    v_add_f32 v204, v204, v209
    v_add_f32 v204, v204, v210
    v_add_f32 v204, v204, v211
    v_add_f32 v204, v204, v212
    v_add_f32 v204, v204, v213
    v_add_f32 v204, v204, v214
    v_add_f32 v204, v204, v215
    v_add_f32 v204, v204, v216
    v_add_f32 v204, v204, v217
    v_add_f32 v204, v204, v218
    v_add_f32 v204, v204, v219
    v_add_f32 v204, v204, v220
    v_add_f32 v204, v204, v221
    v_add_u32 v6, 114688, v6
    ds_write_b32 v6, v204
    v_and_b32 v12, 1, v4
    v_cmp_eq_u32 vcc, 1, v12
    v_mov_b32 v12, 0x42200000
    v_mov_b32 v13, 0x42000000
    v_cndmask_b32 v12, v12, v13, vcc
    v_add_f32 v8, v196, v198
    v_add_f32 v10, v200, v202
    v_add_f32 v8, v8, v10
    v_mul_f32 v8, v8, v12
    v_mov_b32 v10, v8
    s_nop 1
    v_permlane16_swap_b32 v8, v10
    v_add_f32 v8, v8, v10
    v_mov_b32 v10, v8
    s_nop 1
    v_permlane32_swap_b32 v8, v10
    v_add_f32 v8, v8, v10
    v_mul_f32 v8, 0x3ae38e39, v8
    v_mov_b32 v11, 0
    v_sub_f32 v10, v196, v8
    v_mul_f32 v10, v10, v10
    v_fmac_f32 v11, v10, v12
    v_add_f32 v11, v11, v197
    v_sub_f32 v10, v198, v8
    v_mul_f32 v10, v10, v10
    v_fmac_f32 v11, v10, v12
    v_add_f32 v11, v11, v199
    v_sub_f32 v10, v200, v8
    v_mul_f32 v10, v10, v10
    v_fmac_f32 v11, v10, v12
    v_add_f32 v11, v11, v201
    v_sub_f32 v10, v202, v8
    v_mul_f32 v10, v10, v10
    v_fmac_f32 v11, v10, v12
    v_add_f32 v11, v11, v203
    v_mov_b32 v10, v11
    s_nop 1
    v_permlane16_swap_b32 v11, v10
    v_add_f32 v11, v11, v10
    v_mov_b32 v10, v11
    s_nop 1
    v_permlane32_swap_b32 v11, v10
    v_add_f32 v11, v11, v10
    v_mul_f32 v11, 0x3ae38e39, v11
    v_cvt_pk_bf16_f32 v10, v8, v11
    v_lshlrev_b32 v8, 16, v10
    v_and_b32 v11, 0xffff0000, v10
    v_add_f32 v11, 0x3727c5ac, v11
    v_cvt_pk_bf16_f32 v10, v11, v11
    v_lshlrev_b32 v11, 16, v10
    v_sqrt_f32 v11, v11
    s_nop 0
    v_cvt_pk_bf16_f32 v10, v11, v11
    v_lshlrev_b32 v11, 16, v10
    v_rcp_f32 v9, v11
    s_waitcnt lgkmcnt(0)
    s_barrier
    v_lshlrev_b32 v6, 4, v4
    v_add_u32 v6, 114688, v6
    ds_read_b128 v[124:127], v6 offset:0
    ds_read_b128 v[128:131], v6 offset:64
    ds_read_b128 v[132:135], v6 offset:128
    ds_read_b128 v[136:139], v6 offset:192
    ds_read_b128 v[140:143], v6 offset:256
    s_waitcnt lgkmcnt(4)
    v_fma_f32 v88, -v8, v124, v88
    v_mul_f32 v88, v88, v9
    v_fma_f32 v89, -v8, v125, v89
    v_mul_f32 v89, v89, v9
    v_fma_f32 v90, -v8, v126, v90
    v_mul_f32 v90, v90, v9
    v_fma_f32 v91, -v8, v127, v91
    v_mul_f32 v91, v91, v9
    s_waitcnt lgkmcnt(3)
    v_fma_f32 v92, -v8, v128, v92
    v_mul_f32 v92, v92, v9
    v_fma_f32 v93, -v8, v129, v93
    v_mul_f32 v93, v93, v9
    v_fma_f32 v94, -v8, v130, v94
    v_mul_f32 v94, v94, v9
    v_fma_f32 v95, -v8, v131, v95
    v_mul_f32 v95, v95, v9
    s_waitcnt lgkmcnt(2)
    v_fma_f32 v96, -v8, v132, v96
    v_mul_f32 v96, v96, v9
    v_fma_f32 v97, -v8, v133, v97
    v_mul_f32 v97, v97, v9
    v_fma_f32 v98, -v8, v134, v98
    v_mul_f32 v98, v98, v9
    v_fma_f32 v99, -v8, v135, v99
    v_mul_f32 v99, v99, v9
    s_waitcnt lgkmcnt(1)
    v_fma_f32 v100, -v8, v136, v100
    v_mul_f32 v100, v100, v9
    v_fma_f32 v101, -v8, v137, v101
    v_mul_f32 v101, v101, v9
    v_fma_f32 v102, -v8, v138, v102
    v_mul_f32 v102, v102, v9
    v_fma_f32 v103, -v8, v139, v103
    v_mul_f32 v103, v103, v9
    s_waitcnt lgkmcnt(0)
    v_fma_f32 v104, -v8, v140, v104
    v_mul_f32 v104, v104, v9
    v_fma_f32 v105, -v8, v141, v105
    v_mul_f32 v105, v105, v9
    v_cvt_pk_bf16_f32 v10, v88, v89
    v_lshlrev_b32 v88, 16, v10
    v_and_b32 v89, 0xffff0000, v10
    v_cvt_pk_bf16_f32 v10, v90, v91
    v_lshlrev_b32 v90, 16, v10
    v_and_b32 v91, 0xffff0000, v10
    v_cvt_pk_bf16_f32 v10, v92, v93
    v_lshlrev_b32 v92, 16, v10
    v_and_b32 v93, 0xffff0000, v10
    v_cvt_pk_bf16_f32 v10, v94, v95
    v_lshlrev_b32 v94, 16, v10
    v_and_b32 v95, 0xffff0000, v10
    v_cvt_pk_bf16_f32 v10, v96, v97
    v_lshlrev_b32 v96, 16, v10
    v_and_b32 v97, 0xffff0000, v10
    v_cvt_pk_bf16_f32 v10, v98, v99
    v_lshlrev_b32 v98, 16, v10
    v_and_b32 v99, 0xffff0000, v10
    v_cvt_pk_bf16_f32 v10, v100, v101
    v_lshlrev_b32 v100, 16, v10
    v_and_b32 v101, 0xffff0000, v10
    v_cvt_pk_bf16_f32 v10, v102, v103
    v_lshlrev_b32 v102, 16, v10
    v_and_b32 v103, 0xffff0000, v10
    v_cvt_pk_bf16_f32 v10, v104, v105
    v_lshlrev_b32 v104, 16, v10
    v_and_b32 v105, 0xffff0000, v10
    v_max3_f32 v58, v88, v89, v90
    v_min3_f32 v59, v88, v89, v90
    v_max3_f32 v58, v58, v91, v92
    v_min3_f32 v59, v59, v91, v92
    v_max3_f32 v58, v58, v93, v94
    v_min3_f32 v59, v59, v93, v94
    v_max3_f32 v58, v58, v95, v96
    v_min3_f32 v59, v59, v95, v96
    v_max3_f32 v58, v58, v97, v98
    v_min3_f32 v59, v59, v97, v98
    v_max3_f32 v58, v58, v99, v100
    v_min3_f32 v59, v59, v99, v100
    v_max3_f32 v58, v58, v101, v102
    v_min3_f32 v59, v59, v101, v102
    v_max3_f32 v58, v58, v103, v104
    v_min3_f32 v59, v59, v103, v104
    v_max_f32 v58, v58, v105
    v_min_f32 v59, v59, v105
    v_mov_b32 v62, 0x3fb8aa3b
    v_sub_f32 v40, v88, v58
    v_mul_f32 v40, v40, v62
    v_sub_f32 v41, v89, v58
    v_mul_f32 v41, v41, v62
    v_sub_f32 v42, v90, v58
    v_mul_f32 v42, v42, v62
    v_sub_f32 v43, v91, v58
    v_mul_f32 v43, v43, v62
    v_sub_f32 v44, v92, v58
    v_mul_f32 v44, v44, v62
    v_sub_f32 v45, v93, v58
    v_mul_f32 v45, v45, v62
    v_sub_f32 v46, v94, v58
    v_mul_f32 v46, v46, v62
    v_sub_f32 v47, v95, v58
    v_mul_f32 v47, v47, v62
    v_sub_f32 v48, v96, v58
    v_mul_f32 v48, v48, v62
    v_sub_f32 v49, v97, v58
    v_mul_f32 v49, v49, v62
    v_sub_f32 v50, v98, v58
    v_mul_f32 v50, v50, v62
    v_sub_f32 v51, v99, v58
    v_mul_f32 v51, v51, v62
    v_sub_f32 v52, v100, v58
    v_mul_f32 v52, v52, v62
    v_sub_f32 v53, v101, v58
    v_mul_f32 v53, v53, v62
    v_sub_f32 v54, v102, v58
    v_mul_f32 v54, v54, v62
    v_sub_f32 v55, v103, v58
    v_mul_f32 v55, v55, v62
    v_sub_f32 v56, v104, v58
    v_mul_f32 v56, v56, v62
    v_sub_f32 v57, v105, v58
    v_mul_f32 v57, v57, v62
    v_exp_f32 v40, v40
    v_exp_f32 v41, v41
    v_exp_f32 v42, v42
    v_exp_f32 v43, v43
    v_exp_f32 v44, v44
    v_exp_f32 v45, v45
    v_exp_f32 v46, v46
    v_exp_f32 v47, v47
    v_exp_f32 v48, v48
    v_exp_f32 v49, v49
    v_exp_f32 v50, v50
    v_exp_f32 v51, v51
    v_exp_f32 v52, v52
    v_exp_f32 v53, v53
    v_exp_f32 v54, v54
    v_exp_f32 v55, v55
    v_exp_f32 v56, v56
    v_exp_f32 v57, v57
    v_add_f32 v60, v40, v41
    v_add_f32 v60, v60, v42
    v_add_f32 v60, v60, v43
    v_add_f32 v60, v60, v44
    v_add_f32 v60, v60, v45
    v_add_f32 v60, v60, v46
    v_add_f32 v60, v60, v47
    v_add_f32 v60, v60, v48
    v_add_f32 v60, v60, v49
    v_add_f32 v60, v60, v50
    v_add_f32 v60, v60, v51
    v_add_f32 v60, v60, v52
    v_add_f32 v60, v60, v53
    v_add_f32 v60, v60, v54
    v_add_f32 v60, v60, v55
    v_add_f32 v60, v60, v56
    v_add_f32 v60, v60, v57
    v_rcp_f32 v61, v60
    s_nop 0
    v_mul_f32 v40, v40, v61
    v_mul_f32 v41, v41, v61
    v_mul_f32 v42, v42, v61
    v_mul_f32 v43, v43, v61
    v_mul_f32 v44, v44, v61
    v_mul_f32 v45, v45, v61
    v_mul_f32 v46, v46, v61
    v_mul_f32 v47, v47, v61
    v_mul_f32 v48, v48, v61
    v_mul_f32 v49, v49, v61
    v_mul_f32 v50, v50, v61
    v_mul_f32 v51, v51, v61
    v_mul_f32 v52, v52, v61
    v_mul_f32 v53, v53, v61
    v_mul_f32 v54, v54, v61
    v_mul_f32 v55, v55, v61
    v_mul_f32 v56, v56, v61
    v_mul_f32 v57, v57, v61
    v_cvt_pk_bf16_f32 v16, v40, v41
    v_cvt_pk_bf16_f32 v17, v42, v43
    v_cvt_pk_bf16_f32 v18, v44, v45
    v_cvt_pk_bf16_f32 v19, v46, v47
    v_cvt_pk_bf16_f32 v20, v48, v49
    v_cvt_pk_bf16_f32 v21, v50, v51
    v_cvt_pk_bf16_f32 v22, v52, v53
    v_cvt_pk_bf16_f32 v23, v54, v55
    v_cvt_pk_bf16_f32 v24, v56, v57
    v_sub_f32 v40, v59, v88
    v_mul_f32 v40, v40, v62
    v_sub_f32 v41, v59, v89
    v_mul_f32 v41, v41, v62
    v_sub_f32 v42, v59, v90
    v_mul_f32 v42, v42, v62
    v_sub_f32 v43, v59, v91
    v_mul_f32 v43, v43, v62
    v_sub_f32 v44, v59, v92
    v_mul_f32 v44, v44, v62
    v_sub_f32 v45, v59, v93
    v_mul_f32 v45, v45, v62
    v_sub_f32 v46, v59, v94
    v_mul_f32 v46, v46, v62
    v_sub_f32 v47, v59, v95
    v_mul_f32 v47, v47, v62
    v_sub_f32 v48, v59, v96
    v_mul_f32 v48, v48, v62
    v_sub_f32 v49, v59, v97
    v_mul_f32 v49, v49, v62
    v_sub_f32 v50, v59, v98
    v_mul_f32 v50, v50, v62
    v_sub_f32 v51, v59, v99
    v_mul_f32 v51, v51, v62
    v_sub_f32 v52, v59, v100
    v_mul_f32 v52, v52, v62
    v_sub_f32 v53, v59, v101
    v_mul_f32 v53, v53, v62
    v_sub_f32 v54, v59, v102
    v_mul_f32 v54, v54, v62
    v_sub_f32 v55, v59, v103
    v_mul_f32 v55, v55, v62
    v_sub_f32 v56, v59, v104
    v_mul_f32 v56, v56, v62
    v_sub_f32 v57, v59, v105
    v_mul_f32 v57, v57, v62
    v_exp_f32 v40, v40
    v_exp_f32 v41, v41
    v_exp_f32 v42, v42
    v_exp_f32 v43, v43
    v_exp_f32 v44, v44
    v_exp_f32 v45, v45
    v_exp_f32 v46, v46
    v_exp_f32 v47, v47
    v_exp_f32 v48, v48
    v_exp_f32 v49, v49
    v_exp_f32 v50, v50
    v_exp_f32 v51, v51
    v_exp_f32 v52, v52
    v_exp_f32 v53, v53
    v_exp_f32 v54, v54
    v_exp_f32 v55, v55
    v_exp_f32 v56, v56
    v_exp_f32 v57, v57
    v_add_f32 v60, v40, v41
    v_add_f32 v60, v60, v42
    v_add_f32 v60, v60, v43
    v_add_f32 v60, v60, v44
    v_add_f32 v60, v60, v45
    v_add_f32 v60, v60, v46
    v_add_f32 v60, v60, v47
    v_add_f32 v60, v60, v48
    v_add_f32 v60, v60, v49
    v_add_f32 v60, v60, v50
    v_add_f32 v60, v60, v51
    v_add_f32 v60, v60, v52
    v_add_f32 v60, v60, v53
    v_add_f32 v60, v60, v54
    v_add_f32 v60, v60, v55
    v_add_f32 v60, v60, v56
    v_add_f32 v60, v60, v57
    v_rcp_f32 v61, v60
    s_nop 0
    v_mul_f32 v40, v40, v61
    v_mul_f32 v41, v41, v61
    v_mul_f32 v42, v42, v61
    v_mul_f32 v43, v43, v61
    v_mul_f32 v44, v44, v61
    v_mul_f32 v45, v45, v61
    v_mul_f32 v46, v46, v61
    v_mul_f32 v47, v47, v61
    v_mul_f32 v48, v48, v61
    v_mul_f32 v49, v49, v61
    v_mul_f32 v50, v50, v61
    v_mul_f32 v51, v51, v61
    v_mul_f32 v52, v52, v61
    v_mul_f32 v53, v53, v61
    v_mul_f32 v54, v54, v61
    v_mul_f32 v55, v55, v61
    v_mul_f32 v56, v56, v61
    v_mul_f32 v57, v57, v61
    v_cvt_pk_bf16_f32 v25, v40, v41
    v_cvt_pk_bf16_f32 v26, v42, v43
    v_cvt_pk_bf16_f32 v27, v44, v45
    v_cvt_pk_bf16_f32 v28, v46, v47
    v_cvt_pk_bf16_f32 v29, v48, v49
    v_cvt_pk_bf16_f32 v30, v50, v51
    v_cvt_pk_bf16_f32 v31, v52, v53
    v_cvt_pk_bf16_f32 v32, v54, v55
    v_cvt_pk_bf16_f32 v33, v56, v57
    v_lshlrev_b32 v6, 10, v4
    v_lshl_add_u32 v6, v3, 4, v6
    v_lshlrev_b32 v7, 7, v4
    v_lshl_add_u32 v7, v3, 3, v7
    s_lshl_b32 s43, s34, 5
    s_lshl_b32 s44, s32, 2
    s_add_u32 s43, s43, s44
    s_lshl_b32 s44, s43, 7
    s_add_u32 s44, s44, 4194304
    s_lshl_b32 s43, s43, 10
    buffer_store_dwordx4 v[16:19], v6, s[24:27], s43 offen offset:0 sc1
    buffer_store_dwordx4 v[20:23], v6, s[24:27], s43 offen offset:256 sc1
    buffer_store_dwordx4 v[24:27], v6, s[24:27], s43 offen offset:512 sc1
    buffer_store_dwordx4 v[28:31], v6, s[24:27], s43 offen offset:768 sc1
    buffer_store_dwordx2 v[32:33], v7, s[24:27], s44 offen sc1
    s_barrier
    v_mul_u32_u24 v6, 144, v3
    v_lshl_add_u32 v6, v4, 4, v6
    s_mul_i32 s45, s3, 11520
    v_add_u32 v6, s45, v6
    ds_read_b128 v[64:67], v6 offset:6912
    ds_read_b128 v[68:71], v6 offset:6976
    ds_read_b128 v[72:75], v6 offset:9216
    ds_read_b128 v[76:79], v6 offset:9280
    ds_read_b128 v[80:83], v6 offset:0
    ds_read_b128 v[84:87], v6 offset:64
    ds_read_b128 v[88:91], v6 offset:2304
    ds_read_b128 v[92:95], v6 offset:2368
    ds_read_b128 v[96:99], v6 offset:4608
    ds_read_b128 v[100:103], v6 offset:4672
    v_mov_b32 v10, 0
    v_mov_b32 v11, 0x3f803f80
    v_cmp_eq_u32 vcc, 2, v3
    s_nop 1
    v_cndmask_b32 v10, v10, v11, vcc
    v_cmp_gt_u32 s[46:47], 2, v3
    v_cmp_gt_u32 s[48:49], 4, v3
    v_mov_b32 v11, 0
    s_waitcnt lgkmcnt(0)
    v_cndmask_b32 v72, v10, v72, s[46:47]
    v_cndmask_b32 v96, v11, v96, s[48:49]
    v_cndmask_b32 v73, v10, v73, s[46:47]
    v_cndmask_b32 v97, v11, v97, s[48:49]
    v_cndmask_b32 v74, v10, v74, s[46:47]
    v_cndmask_b32 v98, v11, v98, s[48:49]
    v_cndmask_b32 v75, v10, v75, s[46:47]
    v_cndmask_b32 v99, v11, v99, s[48:49]
    v_cndmask_b32 v76, v10, v76, s[46:47]
    v_cndmask_b32 v100, v11, v100, s[48:49]
    v_cndmask_b32 v77, v10, v77, s[46:47]
    v_cndmask_b32 v101, v11, v101, s[48:49]
    v_cndmask_b32 v78, v10, v78, s[46:47]
    v_cndmask_b32 v102, v11, v102, s[48:49]
    v_cndmask_b32 v79, v10, v79, s[46:47]
    v_cndmask_b32 v103, v11, v103, s[48:49]
    v_mfma_f32_16x16x32_bf16 v[104:107], v[64:67], v[80:83], 0
    v_mfma_f32_16x16x32_bf16 v[108:111], v[64:67], v[88:91], 0
    v_mfma_f32_16x16x32_bf16 v[112:115], v[64:67], v[96:99], 0
    v_mfma_f32_16x16x32_bf16 v[116:119], v[72:75], v[80:83], 0
    v_mfma_f32_16x16x32_bf16 v[120:123], v[72:75], v[88:91], 0
    v_mfma_f32_16x16x32_bf16 v[124:127], v[72:75], v[96:99], 0
    v_mfma_f32_16x16x32_bf16 v[104:107], v[68:71], v[84:87], v[104:107]
    v_mfma_f32_16x16x32_bf16 v[108:111], v[68:71], v[92:95], v[108:111]
    v_mfma_f32_16x16x32_bf16 v[112:115], v[68:71], v[100:103], v[112:115]
    v_mfma_f32_16x16x32_bf16 v[116:119], v[76:79], v[84:87], v[116:119]
    v_mfma_f32_16x16x32_bf16 v[120:123], v[76:79], v[92:95], v[120:123]
    v_mfma_f32_16x16x32_bf16 v[124:127], v[76:79], v[100:103], v[124:127]
    s_lshl_b32 s50, s32, 2
    s_add_u32 s50, s50, s3
    s_mul_i32 s50, s50, 5120
    v_lshlrev_b32 v6, 10, v4
    v_lshl_add_u32 v6, v3, 2, v6
    v_mov_b32 v12, 0x7ff00000
    v_cndmask_b32 v7, v12, v6, s[48:49]
    v_lshlrev_b32 v13, 2, v3
    v_add_u32 v13, 4096, v13
    v_cmp_eq_u32 vcc, 0, v4
    s_nop 1
    v_cndmask_b32 v13, v12, v13, vcc
    v_cndmask_b32 v14, v12, v13, s[48:49]
    buffer_atomic_add_f32 v104, v6, s[28:31], s50 offen offset:0
    buffer_atomic_add_f32 v105, v6, s[28:31], s50 offen offset:256
    buffer_atomic_add_f32 v106, v6, s[28:31], s50 offen offset:512
    buffer_atomic_add_f32 v107, v6, s[28:31], s50 offen offset:768
    buffer_atomic_add_f32 v108, v6, s[28:31], s50 offen offset:64
    buffer_atomic_add_f32 v109, v6, s[28:31], s50 offen offset:320
    buffer_atomic_add_f32 v110, v6, s[28:31], s50 offen offset:576
    buffer_atomic_add_f32 v111, v6, s[28:31], s50 offen offset:832
    buffer_atomic_add_f32 v112, v7, s[28:31], s50 offen offset:128
    buffer_atomic_add_f32 v113, v7, s[28:31], s50 offen offset:384
    buffer_atomic_add_f32 v114, v7, s[28:31], s50 offen offset:640
    buffer_atomic_add_f32 v115, v7, s[28:31], s50 offen offset:896
    buffer_atomic_add_f32 v116, v13, s[28:31], s50 offen offset:0
    buffer_atomic_add_f32 v117, v13, s[28:31], s50 offen offset:256
    buffer_atomic_add_f32 v118, v13, s[28:31], s50 offen offset:512
    buffer_atomic_add_f32 v120, v13, s[28:31], s50 offen offset:64
    buffer_atomic_add_f32 v121, v13, s[28:31], s50 offen offset:320
    buffer_atomic_add_f32 v122, v13, s[28:31], s50 offen offset:576
    buffer_atomic_add_f32 v124, v14, s[28:31], s50 offen offset:128
    buffer_atomic_add_f32 v125, v14, s[28:31], s50 offen offset:384
    buffer_atomic_add_f32 v126, v14, s[28:31], s50 offen offset:640
    s_branch .maindone_k1l1_kernel_3
.kv_k1l1_kernel_2:
    s_add_u32 s38, s37, 0
    buffer_load_dwordx4 v[16:19], v5, s[12:15], s38 offen
    s_add_u32 s38, s37, 1024
    buffer_load_dwordx4 v[20:23], v5, s[12:15], s38 offen
    s_add_u32 m0, s39, 0
    s_add_u32 s43, s41, 0
    buffer_load_dwordx4 v5, s[8:11], s43 offen lds
    s_add_u32 m0, s39, 8192
    s_add_u32 s43, s41, 8192
    buffer_load_dwordx4 v5, s[8:11], s43 offen lds
    s_add_u32 m0, s39, 16384
    s_add_u32 s43, s41, 16384
    buffer_load_dwordx4 v5, s[8:11], s43 offen lds
    s_add_u32 m0, s42, 24576
    s_add_u32 s43, s40, s42
    s_add_u32 s43, s43, 24576
    buffer_load_dwordx4 v5, s[8:11], s43 offen lds
    s_add_u32 s38, s37, 2048
    buffer_load_dwordx4 v[24:27], v5, s[12:15], s38 offen
    s_add_u32 s38, s37, 3072
    buffer_load_dwordx4 v[28:31], v5, s[12:15], s38 offen
    s_add_u32 m0, s39, 28672
    s_add_u32 s43, s41, 28672
    buffer_load_dwordx4 v5, s[8:11], s43 offen lds
    s_add_u32 m0, s39, 36864
    s_add_u32 s43, s41, 36864
    buffer_load_dwordx4 v5, s[8:11], s43 offen lds
    s_add_u32 m0, s39, 45056
    s_add_u32 s43, s41, 45056
    buffer_load_dwordx4 v5, s[8:11], s43 offen lds
    s_add_u32 m0, s42, 53248
    s_add_u32 s43, s40, s42
    s_add_u32 s43, s43, 53248
    buffer_load_dwordx4 v5, s[8:11], s43 offen lds
    s_waitcnt vmcnt(6)
    s_barrier
    s_add_u32 m0, s39, 57344
    s_add_u32 s43, s41, 57344
    buffer_load_dwordx4 v5, s[8:11], s43 offen lds
    s_add_u32 m0, s39, 65536
    s_add_u32 s43, s41, 65536
    buffer_load_dwordx4 v5, s[8:11], s43 offen lds
    s_add_u32 m0, s39, 73728
    s_add_u32 s43, s41, 73728
    buffer_load_dwordx4 v5, s[8:11], s43 offen lds
    s_add_u32 m0, s42, 81920
    s_add_u32 s43, s40, s42
    s_add_u32 s43, s43, 81920
    buffer_load_dwordx4 v5, s[8:11], s43 offen lds
    ds_read_b128 v[124:127], v5 offset:5120
    ds_read_b128 v[128:131], v5 offset:6144
    ds_read_b128 v[132:135], v5 offset:7168
    ds_read_b128 v[136:139], v5 offset:8192
    ds_read_b128 v[140:143], v5 offset:9216
    ds_read_b128 v[144:147], v5 offset:10240
    ds_read_b128 v[148:151], v5 offset:11264
    ds_read_b128 v[152:155], v5 offset:12288
    ds_read_b128 v[156:159], v5 offset:13312
    ds_read_b128 v[160:163], v5 offset:19456
    ds_read_b128 v[164:167], v5 offset:20480
    ds_read_b128 v[168:171], v5 offset:21504
    ds_read_b128 v[172:175], v5 offset:22528
    ds_read_b128 v[176:179], v5 offset:23552
    ds_read_b128 v[180:183], v5 offset:24576
    ds_read_b128 v[184:187], v5 offset:25600
    ds_read_b128 v[188:191], v5 offset:26624
    ds_read_b128 v[192:195], v5 offset:27648
    s_waitcnt lgkmcnt(15)
    v_mfma_f32_16x16x32_bf16 v[88:91], v[124:127], v[16:19], 0
    s_waitcnt lgkmcnt(15)
    v_mfma_f32_16x16x32_bf16 v[92:95], v[128:131], v[16:19], 0
    s_waitcnt lgkmcnt(15)
    v_mfma_f32_16x16x32_bf16 v[96:99], v[132:135], v[16:19], 0
    s_waitcnt lgkmcnt(14)
    v_mfma_f32_16x16x32_bf16 v[100:103], v[136:139], v[16:19], 0
    s_waitcnt lgkmcnt(13)
    v_mfma_f32_16x16x32_bf16 v[104:107], v[140:143], v[16:19], 0
    s_waitcnt lgkmcnt(12)
    v_mfma_f32_16x16x32_bf16 v[108:111], v[144:147], v[16:19], 0
    s_waitcnt lgkmcnt(11)
    v_mfma_f32_16x16x32_bf16 v[112:115], v[148:151], v[16:19], 0
    s_waitcnt lgkmcnt(10)
    v_mfma_f32_16x16x32_bf16 v[116:119], v[152:155], v[16:19], 0
    s_waitcnt lgkmcnt(9)
    v_mfma_f32_16x16x32_bf16 v[120:123], v[156:159], v[16:19], 0
    s_add_u32 s38, s37, 4096
    buffer_load_dwordx4 v[32:35], v5, s[12:15], s38 offen
    s_waitcnt lgkmcnt(8)
    v_mfma_f32_16x16x32_bf16 v[88:91], v[160:163], v[20:23], v[88:91]
    s_waitcnt lgkmcnt(7)
    v_mfma_f32_16x16x32_bf16 v[92:95], v[164:167], v[20:23], v[92:95]
    s_waitcnt lgkmcnt(6)
    v_mfma_f32_16x16x32_bf16 v[96:99], v[168:171], v[20:23], v[96:99]
    s_waitcnt lgkmcnt(5)
    v_mfma_f32_16x16x32_bf16 v[100:103], v[172:175], v[20:23], v[100:103]
    s_waitcnt lgkmcnt(4)
    v_mfma_f32_16x16x32_bf16 v[104:107], v[176:179], v[20:23], v[104:107]
    s_waitcnt lgkmcnt(3)
    v_mfma_f32_16x16x32_bf16 v[108:111], v[180:183], v[20:23], v[108:111]
    s_waitcnt lgkmcnt(2)
    v_mfma_f32_16x16x32_bf16 v[112:115], v[184:187], v[20:23], v[112:115]
    s_waitcnt lgkmcnt(1)
    v_mfma_f32_16x16x32_bf16 v[116:119], v[188:191], v[20:23], v[116:119]
    s_waitcnt lgkmcnt(0)
    v_mfma_f32_16x16x32_bf16 v[120:123], v[192:195], v[20:23], v[120:123]
    s_add_u32 s38, s37, 5120
    buffer_load_dwordx4 v[36:39], v5, s[12:15], s38 offen
    s_waitcnt vmcnt(6)
    s_barrier
    s_add_u32 m0, s39, 86016
    s_add_u32 s43, s41, 86016
    buffer_load_dwordx4 v5, s[8:11], s43 offen lds
    s_add_u32 m0, s39, 94208
    s_add_u32 s43, s41, 94208
    buffer_load_dwordx4 v5, s[8:11], s43 offen lds
    s_add_u32 m0, s39, 102400
    s_add_u32 s43, s41, 102400
    buffer_load_dwordx4 v5, s[8:11], s43 offen lds
    s_add_u32 m0, s42, 110592
    s_add_u32 s43, s40, s42
    s_add_u32 s43, s43, 110592
    buffer_load_dwordx4 v5, s[8:11], s43 offen lds
    ds_read_b128 v[124:127], v5 offset:33792
    ds_read_b128 v[128:131], v5 offset:34816
    ds_read_b128 v[132:135], v5 offset:35840
    ds_read_b128 v[136:139], v5 offset:36864
    ds_read_b128 v[140:143], v5 offset:37888
    ds_read_b128 v[144:147], v5 offset:38912
    ds_read_b128 v[148:151], v5 offset:39936
    ds_read_b128 v[152:155], v5 offset:40960
    ds_read_b128 v[156:159], v5 offset:41984
    ds_read_b128 v[160:163], v5 offset:48128
    ds_read_b128 v[164:167], v5 offset:49152
    ds_read_b128 v[168:171], v5 offset:50176
    ds_read_b128 v[172:175], v5 offset:51200
    ds_read_b128 v[176:179], v5 offset:52224
    ds_read_b128 v[180:183], v5 offset:53248
    ds_read_b128 v[184:187], v5 offset:54272
    ds_read_b128 v[188:191], v5 offset:55296
    ds_read_b128 v[192:195], v5 offset:56320
    s_waitcnt lgkmcnt(15)
    v_mfma_f32_16x16x32_bf16 v[88:91], v[124:127], v[24:27], v[88:91]
    s_waitcnt lgkmcnt(15)
    v_mfma_f32_16x16x32_bf16 v[92:95], v[128:131], v[24:27], v[92:95]
    s_waitcnt lgkmcnt(15)
    v_mfma_f32_16x16x32_bf16 v[96:99], v[132:135], v[24:27], v[96:99]
    s_waitcnt lgkmcnt(14)
    v_mfma_f32_16x16x32_bf16 v[100:103], v[136:139], v[24:27], v[100:103]
    s_waitcnt lgkmcnt(13)
    v_mfma_f32_16x16x32_bf16 v[104:107], v[140:143], v[24:27], v[104:107]
    s_waitcnt lgkmcnt(12)
    v_mfma_f32_16x16x32_bf16 v[108:111], v[144:147], v[24:27], v[108:111]
    s_waitcnt lgkmcnt(11)
    v_mfma_f32_16x16x32_bf16 v[112:115], v[148:151], v[24:27], v[112:115]
    s_waitcnt lgkmcnt(10)
    v_mfma_f32_16x16x32_bf16 v[116:119], v[152:155], v[24:27], v[116:119]
    s_waitcnt lgkmcnt(9)
    v_mfma_f32_16x16x32_bf16 v[120:123], v[156:159], v[24:27], v[120:123]
    s_add_u32 s38, s37, 6144
    buffer_load_dwordx4 v[40:43], v5, s[12:15], s38 offen
    s_waitcnt lgkmcnt(8)
    v_mfma_f32_16x16x32_bf16 v[88:91], v[160:163], v[28:31], v[88:91]
    s_waitcnt lgkmcnt(7)
    v_mfma_f32_16x16x32_bf16 v[92:95], v[164:167], v[28:31], v[92:95]
    s_waitcnt lgkmcnt(6)
    v_mfma_f32_16x16x32_bf16 v[96:99], v[168:171], v[28:31], v[96:99]
    s_waitcnt lgkmcnt(5)
    v_mfma_f32_16x16x32_bf16 v[100:103], v[172:175], v[28:31], v[100:103]
    s_waitcnt lgkmcnt(4)
    v_mfma_f32_16x16x32_bf16 v[104:107], v[176:179], v[28:31], v[104:107]
    s_waitcnt lgkmcnt(3)
    v_mfma_f32_16x16x32_bf16 v[108:111], v[180:183], v[28:31], v[108:111]
    s_waitcnt lgkmcnt(2)
    v_mfma_f32_16x16x32_bf16 v[112:115], v[184:187], v[28:31], v[112:115]
    s_waitcnt lgkmcnt(1)
    v_mfma_f32_16x16x32_bf16 v[116:119], v[188:191], v[28:31], v[116:119]
    s_waitcnt lgkmcnt(0)
    v_mfma_f32_16x16x32_bf16 v[120:123], v[192:195], v[28:31], v[120:123]
    s_add_u32 s38, s37, 7168
    buffer_load_dwordx4 v[44:47], v5, s[12:15], s38 offen
    s_waitcnt vmcnt(8)
    s_barrier
    s_add_u32 m0, s39, 0
    s_add_u32 s43, s41, 114688
    buffer_load_dwordx4 v5, s[8:11], s43 offen lds
    s_add_u32 m0, s39, 8192
    s_add_u32 s43, s41, 122880
    buffer_load_dwordx4 v5, s[8:11], s43 offen lds
    s_add_u32 m0, s39, 16384
    s_add_u32 s43, s41, 131072
    buffer_load_dwordx4 v5, s[8:11], s43 offen lds
    s_add_u32 m0, s42, 24576
    s_add_u32 s43, s40, s42
    s_add_u32 s43, s43, 139264
    buffer_load_dwordx4 v5, s[8:11], s43 offen lds
    ds_read_b128 v[124:127], v5 offset:62464
    ds_read_b128 v[128:131], v5 offset:63488
    ds_read_b128 v[132:135], v5 offset:64512
    ds_read_b128 v[136:139], v2 offset:0
    ds_read_b128 v[140:143], v2 offset:1024
    ds_read_b128 v[144:147], v2 offset:2048
    ds_read_b128 v[148:151], v2 offset:3072
    ds_read_b128 v[152:155], v2 offset:4096
    ds_read_b128 v[156:159], v2 offset:5120
    s_waitcnt vmcnt(11)
    ds_read_b128 v[160:163], v2 offset:11264
    ds_read_b128 v[164:167], v2 offset:12288
    ds_read_b128 v[168:171], v2 offset:13312
    ds_read_b128 v[172:175], v2 offset:14336
    ds_read_b128 v[176:179], v2 offset:15360
    ds_read_b128 v[180:183], v2 offset:16384
    ds_read_b128 v[184:187], v2 offset:17408
    ds_read_b128 v[188:191], v2 offset:18432
    ds_read_b128 v[192:195], v2 offset:19456
    s_waitcnt lgkmcnt(15)
    v_mfma_f32_16x16x32_bf16 v[88:91], v[124:127], v[32:35], v[88:91]
    s_waitcnt lgkmcnt(15)
    v_mfma_f32_16x16x32_bf16 v[92:95], v[128:131], v[32:35], v[92:95]
    s_waitcnt lgkmcnt(15)
    v_mfma_f32_16x16x32_bf16 v[96:99], v[132:135], v[32:35], v[96:99]
    s_waitcnt lgkmcnt(14)
    v_mfma_f32_16x16x32_bf16 v[100:103], v[136:139], v[32:35], v[100:103]
    s_waitcnt lgkmcnt(13)
    v_mfma_f32_16x16x32_bf16 v[104:107], v[140:143], v[32:35], v[104:107]
    s_waitcnt lgkmcnt(12)
    v_mfma_f32_16x16x32_bf16 v[108:111], v[144:147], v[32:35], v[108:111]
    s_waitcnt lgkmcnt(11)
    v_mfma_f32_16x16x32_bf16 v[112:115], v[148:151], v[32:35], v[112:115]
    s_waitcnt lgkmcnt(10)
    v_mfma_f32_16x16x32_bf16 v[116:119], v[152:155], v[32:35], v[116:119]
    s_waitcnt lgkmcnt(9)
    v_mfma_f32_16x16x32_bf16 v[120:123], v[156:159], v[32:35], v[120:123]
    s_add_u32 s38, s37, 8192
    buffer_load_dwordx4 v[48:51], v5, s[12:15], s38 offen
    s_waitcnt vmcnt(11)
    s_waitcnt lgkmcnt(8)
    v_mfma_f32_16x16x32_bf16 v[88:91], v[160:163], v[36:39], v[88:91]
    s_waitcnt lgkmcnt(7)
    v_mfma_f32_16x16x32_bf16 v[92:95], v[164:167], v[36:39], v[92:95]
    s_waitcnt lgkmcnt(6)
    v_mfma_f32_16x16x32_bf16 v[96:99], v[168:171], v[36:39], v[96:99]
    s_waitcnt lgkmcnt(5)
    v_mfma_f32_16x16x32_bf16 v[100:103], v[172:175], v[36:39], v[100:103]
    s_waitcnt lgkmcnt(4)
    v_mfma_f32_16x16x32_bf16 v[104:107], v[176:179], v[36:39], v[104:107]
    s_waitcnt lgkmcnt(3)
    v_mfma_f32_16x16x32_bf16 v[108:111], v[180:183], v[36:39], v[108:111]
    s_waitcnt lgkmcnt(2)
    v_mfma_f32_16x16x32_bf16 v[112:115], v[184:187], v[36:39], v[112:115]
    s_waitcnt lgkmcnt(1)
    v_mfma_f32_16x16x32_bf16 v[116:119], v[188:191], v[36:39], v[116:119]
    s_waitcnt lgkmcnt(0)
    v_mfma_f32_16x16x32_bf16 v[120:123], v[192:195], v[36:39], v[120:123]
    s_add_u32 s38, s37, 9216
    buffer_load_dwordx4 v[52:55], v5, s[12:15], s38 offen
    s_waitcnt vmcnt(8)
    s_barrier
    s_add_u32 m0, s39, 28672
    s_add_u32 s43, s41, 143360
    buffer_load_dwordx4 v5, s[8:11], s43 offen lds
    s_add_u32 m0, s39, 36864
    s_add_u32 s43, s41, 151552
    buffer_load_dwordx4 v5, s[8:11], s43 offen lds
    s_add_u32 m0, s39, 45056
    s_add_u32 s43, s41, 159744
    buffer_load_dwordx4 v5, s[8:11], s43 offen lds
    s_add_u32 m0, s42, 53248
    s_add_u32 s43, s40, s42
    s_add_u32 s43, s43, 167936
    buffer_load_dwordx4 v5, s[8:11], s43 offen lds
    ds_read_b128 v[124:127], v2 offset:25600
    ds_read_b128 v[128:131], v2 offset:26624
    ds_read_b128 v[132:135], v2 offset:27648
    ds_read_b128 v[136:139], v2 offset:28672
    ds_read_b128 v[140:143], v2 offset:29696
    ds_read_b128 v[144:147], v2 offset:30720
    ds_read_b128 v[148:151], v2 offset:31744
    ds_read_b128 v[152:155], v2 offset:32768
    ds_read_b128 v[156:159], v2 offset:33792
    s_waitcnt vmcnt(11)
    ds_read_b128 v[160:163], v2 offset:39936
    ds_read_b128 v[164:167], v2 offset:40960
    ds_read_b128 v[168:171], v2 offset:41984
    ds_read_b128 v[172:175], v2 offset:43008
    ds_read_b128 v[176:179], v2 offset:44032
    ds_read_b128 v[180:183], v2 offset:45056
    ds_read_b128 v[184:187], v2 offset:46080
    ds_read_b128 v[188:191], v2 offset:47104
    ds_read_b128 v[192:195], v2 offset:48128
    s_waitcnt lgkmcnt(15)
    v_mfma_f32_16x16x32_bf16 v[88:91], v[124:127], v[40:43], v[88:91]
    s_waitcnt lgkmcnt(15)
    v_mfma_f32_16x16x32_bf16 v[92:95], v[128:131], v[40:43], v[92:95]
    s_waitcnt lgkmcnt(15)
    v_mfma_f32_16x16x32_bf16 v[96:99], v[132:135], v[40:43], v[96:99]
    s_waitcnt lgkmcnt(14)
    v_mfma_f32_16x16x32_bf16 v[100:103], v[136:139], v[40:43], v[100:103]
    s_waitcnt lgkmcnt(13)
    v_mfma_f32_16x16x32_bf16 v[104:107], v[140:143], v[40:43], v[104:107]
    s_waitcnt lgkmcnt(12)
    v_mfma_f32_16x16x32_bf16 v[108:111], v[144:147], v[40:43], v[108:111]
    s_waitcnt lgkmcnt(11)
    v_mfma_f32_16x16x32_bf16 v[112:115], v[148:151], v[40:43], v[112:115]
    s_waitcnt lgkmcnt(10)
    v_mfma_f32_16x16x32_bf16 v[116:119], v[152:155], v[40:43], v[116:119]
    s_waitcnt lgkmcnt(9)
    v_mfma_f32_16x16x32_bf16 v[120:123], v[156:159], v[40:43], v[120:123]
    s_add_u32 s38, s37, 10240
    buffer_load_dwordx4 v[56:59], v5, s[12:15], s38 offen
    s_waitcnt vmcnt(11)
    s_waitcnt lgkmcnt(8)
    v_mfma_f32_16x16x32_bf16 v[88:91], v[160:163], v[44:47], v[88:91]
    s_waitcnt lgkmcnt(7)
    v_mfma_f32_16x16x32_bf16 v[92:95], v[164:167], v[44:47], v[92:95]
    s_waitcnt lgkmcnt(6)
    v_mfma_f32_16x16x32_bf16 v[96:99], v[168:171], v[44:47], v[96:99]
    s_waitcnt lgkmcnt(5)
    v_mfma_f32_16x16x32_bf16 v[100:103], v[172:175], v[44:47], v[100:103]
    s_waitcnt lgkmcnt(4)
    v_mfma_f32_16x16x32_bf16 v[104:107], v[176:179], v[44:47], v[104:107]
    s_waitcnt lgkmcnt(3)
    v_mfma_f32_16x16x32_bf16 v[108:111], v[180:183], v[44:47], v[108:111]
    s_waitcnt lgkmcnt(2)
    v_mfma_f32_16x16x32_bf16 v[112:115], v[184:187], v[44:47], v[112:115]
    s_waitcnt lgkmcnt(1)
    v_mfma_f32_16x16x32_bf16 v[116:119], v[188:191], v[44:47], v[116:119]
    s_waitcnt lgkmcnt(0)
    v_mfma_f32_16x16x32_bf16 v[120:123], v[192:195], v[44:47], v[120:123]
    s_add_u32 s38, s37, 11264
    buffer_load_dwordx4 v[60:63], v5, s[12:15], s38 offen
    s_waitcnt vmcnt(8)
    s_barrier
    s_add_u32 m0, s39, 57344
    s_add_u32 s43, s41, 172032
    buffer_load_dwordx4 v5, s[8:11], s43 offen lds
    s_add_u32 m0, s39, 65536
    s_add_u32 s43, s41, 180224
    buffer_load_dwordx4 v5, s[8:11], s43 offen lds
    s_add_u32 m0, s39, 73728
    s_add_u32 s43, s41, 188416
    buffer_load_dwordx4 v5, s[8:11], s43 offen lds
    s_add_u32 m0, s42, 81920
    s_add_u32 s43, s40, s42
    s_add_u32 s43, s43, 196608
    buffer_load_dwordx4 v5, s[8:11], s43 offen lds
    ds_read_b128 v[124:127], v5 offset:5120
    ds_read_b128 v[128:131], v5 offset:6144
    ds_read_b128 v[132:135], v5 offset:7168
    ds_read_b128 v[136:139], v5 offset:8192
    ds_read_b128 v[140:143], v5 offset:9216
    ds_read_b128 v[144:147], v5 offset:10240
    ds_read_b128 v[148:151], v5 offset:11264
    ds_read_b128 v[152:155], v5 offset:12288
    ds_read_b128 v[156:159], v5 offset:13312
    s_waitcnt vmcnt(11)
    ds_read_b128 v[160:163], v5 offset:19456
    ds_read_b128 v[164:167], v5 offset:20480
    ds_read_b128 v[168:171], v5 offset:21504
    ds_read_b128 v[172:175], v5 offset:22528
    ds_read_b128 v[176:179], v5 offset:23552
    ds_read_b128 v[180:183], v5 offset:24576
    ds_read_b128 v[184:187], v5 offset:25600
    ds_read_b128 v[188:191], v5 offset:26624
    ds_read_b128 v[192:195], v5 offset:27648
    s_waitcnt lgkmcnt(15)
    v_mfma_f32_16x16x32_bf16 v[88:91], v[124:127], v[48:51], v[88:91]
    s_waitcnt lgkmcnt(15)
    v_mfma_f32_16x16x32_bf16 v[92:95], v[128:131], v[48:51], v[92:95]
    s_waitcnt lgkmcnt(15)
    v_mfma_f32_16x16x32_bf16 v[96:99], v[132:135], v[48:51], v[96:99]
    s_waitcnt lgkmcnt(14)
    v_mfma_f32_16x16x32_bf16 v[100:103], v[136:139], v[48:51], v[100:103]
    s_waitcnt lgkmcnt(13)
    v_mfma_f32_16x16x32_bf16 v[104:107], v[140:143], v[48:51], v[104:107]
    s_waitcnt lgkmcnt(12)
    v_mfma_f32_16x16x32_bf16 v[108:111], v[144:147], v[48:51], v[108:111]
    s_waitcnt lgkmcnt(11)
    v_mfma_f32_16x16x32_bf16 v[112:115], v[148:151], v[48:51], v[112:115]
    s_waitcnt lgkmcnt(10)
    v_mfma_f32_16x16x32_bf16 v[116:119], v[152:155], v[48:51], v[116:119]
    s_waitcnt lgkmcnt(9)
    v_mfma_f32_16x16x32_bf16 v[120:123], v[156:159], v[48:51], v[120:123]
    s_add_u32 s38, s37, 12288
    buffer_load_dwordx4 v[64:67], v5, s[12:15], s38 offen
    s_waitcnt vmcnt(11)
    s_waitcnt lgkmcnt(8)
    v_mfma_f32_16x16x32_bf16 v[88:91], v[160:163], v[52:55], v[88:91]
    s_waitcnt lgkmcnt(7)
    v_mfma_f32_16x16x32_bf16 v[92:95], v[164:167], v[52:55], v[92:95]
    s_waitcnt lgkmcnt(6)
    v_mfma_f32_16x16x32_bf16 v[96:99], v[168:171], v[52:55], v[96:99]
    s_waitcnt lgkmcnt(5)
    v_mfma_f32_16x16x32_bf16 v[100:103], v[172:175], v[52:55], v[100:103]
    s_waitcnt lgkmcnt(4)
    v_mfma_f32_16x16x32_bf16 v[104:107], v[176:179], v[52:55], v[104:107]
    s_waitcnt lgkmcnt(3)
    v_mfma_f32_16x16x32_bf16 v[108:111], v[180:183], v[52:55], v[108:111]
    s_waitcnt lgkmcnt(2)
    v_mfma_f32_16x16x32_bf16 v[112:115], v[184:187], v[52:55], v[112:115]
    s_waitcnt lgkmcnt(1)
    v_mfma_f32_16x16x32_bf16 v[116:119], v[188:191], v[52:55], v[116:119]
    s_waitcnt lgkmcnt(0)
    v_mfma_f32_16x16x32_bf16 v[120:123], v[192:195], v[52:55], v[120:123]
    s_add_u32 s38, s37, 13312
    buffer_load_dwordx4 v[68:71], v5, s[12:15], s38 offen
    s_waitcnt vmcnt(8)
    s_barrier
    s_add_u32 m0, s39, 86016
    s_add_u32 s43, s41, 200704
    buffer_load_dwordx4 v5, s[8:11], s43 offen lds
    s_add_u32 m0, s39, 94208
    s_add_u32 s43, s41, 208896
    buffer_load_dwordx4 v5, s[8:11], s43 offen lds
    s_add_u32 m0, s39, 102400
    s_add_u32 s43, s41, 217088
    buffer_load_dwordx4 v5, s[8:11], s43 offen lds
    s_add_u32 m0, s42, 110592
    s_add_u32 s43, s40, s42
    s_add_u32 s43, s43, 225280
    buffer_load_dwordx4 v5, s[8:11], s43 offen lds
    ds_read_b128 v[124:127], v5 offset:33792
    ds_read_b128 v[128:131], v5 offset:34816
    ds_read_b128 v[132:135], v5 offset:35840
    ds_read_b128 v[136:139], v5 offset:36864
    ds_read_b128 v[140:143], v5 offset:37888
    ds_read_b128 v[144:147], v5 offset:38912
    ds_read_b128 v[148:151], v5 offset:39936
    ds_read_b128 v[152:155], v5 offset:40960
    ds_read_b128 v[156:159], v5 offset:41984
    s_waitcnt vmcnt(11)
    ds_read_b128 v[160:163], v5 offset:48128
    ds_read_b128 v[164:167], v5 offset:49152
    ds_read_b128 v[168:171], v5 offset:50176
    ds_read_b128 v[172:175], v5 offset:51200
    ds_read_b128 v[176:179], v5 offset:52224
    ds_read_b128 v[180:183], v5 offset:53248
    ds_read_b128 v[184:187], v5 offset:54272
    ds_read_b128 v[188:191], v5 offset:55296
    ds_read_b128 v[192:195], v5 offset:56320
    s_waitcnt lgkmcnt(15)
    v_mfma_f32_16x16x32_bf16 v[88:91], v[124:127], v[56:59], v[88:91]
    s_waitcnt lgkmcnt(15)
    v_mfma_f32_16x16x32_bf16 v[92:95], v[128:131], v[56:59], v[92:95]
    s_waitcnt lgkmcnt(15)
    v_mfma_f32_16x16x32_bf16 v[96:99], v[132:135], v[56:59], v[96:99]
    s_waitcnt lgkmcnt(14)
    v_mfma_f32_16x16x32_bf16 v[100:103], v[136:139], v[56:59], v[100:103]
    s_waitcnt lgkmcnt(13)
    v_mfma_f32_16x16x32_bf16 v[104:107], v[140:143], v[56:59], v[104:107]
    s_waitcnt lgkmcnt(12)
    v_mfma_f32_16x16x32_bf16 v[108:111], v[144:147], v[56:59], v[108:111]
    s_waitcnt lgkmcnt(11)
    v_mfma_f32_16x16x32_bf16 v[112:115], v[148:151], v[56:59], v[112:115]
    s_waitcnt lgkmcnt(10)
    v_mfma_f32_16x16x32_bf16 v[116:119], v[152:155], v[56:59], v[116:119]
    s_waitcnt lgkmcnt(9)
    v_mfma_f32_16x16x32_bf16 v[120:123], v[156:159], v[56:59], v[120:123]
    s_add_u32 s38, s37, 14336
    buffer_load_dwordx4 v[72:75], v5, s[12:15], s38 offen
    s_waitcnt vmcnt(11)
    s_waitcnt lgkmcnt(8)
    v_mfma_f32_16x16x32_bf16 v[88:91], v[160:163], v[60:63], v[88:91]
    s_waitcnt lgkmcnt(7)
    v_mfma_f32_16x16x32_bf16 v[92:95], v[164:167], v[60:63], v[92:95]
    s_waitcnt lgkmcnt(6)
    v_mfma_f32_16x16x32_bf16 v[96:99], v[168:171], v[60:63], v[96:99]
    s_waitcnt lgkmcnt(5)
    v_mfma_f32_16x16x32_bf16 v[100:103], v[172:175], v[60:63], v[100:103]
    s_waitcnt lgkmcnt(4)
    v_mfma_f32_16x16x32_bf16 v[104:107], v[176:179], v[60:63], v[104:107]
    s_waitcnt lgkmcnt(3)
    v_mfma_f32_16x16x32_bf16 v[108:111], v[180:183], v[60:63], v[108:111]
    s_waitcnt lgkmcnt(2)
    v_mfma_f32_16x16x32_bf16 v[112:115], v[184:187], v[60:63], v[112:115]
    s_waitcnt lgkmcnt(1)
    v_mfma_f32_16x16x32_bf16 v[116:119], v[188:191], v[60:63], v[116:119]
    s_waitcnt lgkmcnt(0)
    v_mfma_f32_16x16x32_bf16 v[120:123], v[192:195], v[60:63], v[120:123]
    s_add_u32 s38, s37, 15360
    buffer_load_dwordx4 v[76:79], v5, s[12:15], s38 offen
    s_waitcnt vmcnt(8)
    s_barrier
    s_add_u32 m0, s39, 0
    s_add_u32 s43, s41, 229376
    buffer_load_dwordx4 v5, s[8:11], s43 offen lds
    s_add_u32 m0, s39, 8192
    s_add_u32 s43, s41, 237568
    buffer_load_dwordx4 v5, s[8:11], s43 offen lds
    s_add_u32 m0, s39, 16384
    s_add_u32 s43, s41, 245760
    buffer_load_dwordx4 v5, s[8:11], s43 offen lds
    s_add_u32 m0, s42, 24576
    s_add_u32 s43, s40, s42
    s_add_u32 s43, s43, 253952
    buffer_load_dwordx4 v5, s[8:11], s43 offen lds
    ds_read_b128 v[124:127], v5 offset:62464
    ds_read_b128 v[128:131], v5 offset:63488
    ds_read_b128 v[132:135], v5 offset:64512
    ds_read_b128 v[136:139], v2 offset:0
    ds_read_b128 v[140:143], v2 offset:1024
    ds_read_b128 v[144:147], v2 offset:2048
    ds_read_b128 v[148:151], v2 offset:3072
    ds_read_b128 v[152:155], v2 offset:4096
    ds_read_b128 v[156:159], v2 offset:5120
    s_waitcnt vmcnt(11)
    ds_read_b128 v[160:163], v2 offset:11264
    ds_read_b128 v[164:167], v2 offset:12288
    ds_read_b128 v[168:171], v2 offset:13312
    ds_read_b128 v[172:175], v2 offset:14336
    ds_read_b128 v[176:179], v2 offset:15360
    ds_read_b128 v[180:183], v2 offset:16384
    ds_read_b128 v[184:187], v2 offset:17408
    ds_read_b128 v[188:191], v2 offset:18432
    ds_read_b128 v[192:195], v2 offset:19456
    s_waitcnt lgkmcnt(15)
    v_mfma_f32_16x16x32_bf16 v[88:91], v[124:127], v[64:67], v[88:91]
    s_waitcnt lgkmcnt(15)
    v_mfma_f32_16x16x32_bf16 v[92:95], v[128:131], v[64:67], v[92:95]
    s_waitcnt lgkmcnt(15)
    v_mfma_f32_16x16x32_bf16 v[96:99], v[132:135], v[64:67], v[96:99]
    s_waitcnt lgkmcnt(14)
    v_mfma_f32_16x16x32_bf16 v[100:103], v[136:139], v[64:67], v[100:103]
    s_waitcnt lgkmcnt(13)
    v_mfma_f32_16x16x32_bf16 v[104:107], v[140:143], v[64:67], v[104:107]
    s_waitcnt lgkmcnt(12)
    v_mfma_f32_16x16x32_bf16 v[108:111], v[144:147], v[64:67], v[108:111]
    s_waitcnt lgkmcnt(11)
    v_mfma_f32_16x16x32_bf16 v[112:115], v[148:151], v[64:67], v[112:115]
    s_waitcnt lgkmcnt(10)
    v_mfma_f32_16x16x32_bf16 v[116:119], v[152:155], v[64:67], v[116:119]
    s_waitcnt lgkmcnt(9)
    v_mfma_f32_16x16x32_bf16 v[120:123], v[156:159], v[64:67], v[120:123]
    s_add_u32 s38, s37, 16384
    buffer_load_dwordx4 v[80:83], v5, s[12:15], s38 offen
    s_waitcnt vmcnt(11)
    s_waitcnt lgkmcnt(8)
    v_mfma_f32_16x16x32_bf16 v[88:91], v[160:163], v[68:71], v[88:91]
    s_waitcnt lgkmcnt(7)
    v_mfma_f32_16x16x32_bf16 v[92:95], v[164:167], v[68:71], v[92:95]
    s_waitcnt lgkmcnt(6)
    v_mfma_f32_16x16x32_bf16 v[96:99], v[168:171], v[68:71], v[96:99]
    s_waitcnt lgkmcnt(5)
    v_mfma_f32_16x16x32_bf16 v[100:103], v[172:175], v[68:71], v[100:103]
    s_waitcnt lgkmcnt(4)
    v_mfma_f32_16x16x32_bf16 v[104:107], v[176:179], v[68:71], v[104:107]
    s_waitcnt lgkmcnt(3)
    v_mfma_f32_16x16x32_bf16 v[108:111], v[180:183], v[68:71], v[108:111]
    s_waitcnt lgkmcnt(2)
    v_mfma_f32_16x16x32_bf16 v[112:115], v[184:187], v[68:71], v[112:115]
    s_waitcnt lgkmcnt(1)
    v_mfma_f32_16x16x32_bf16 v[116:119], v[188:191], v[68:71], v[116:119]
    s_waitcnt lgkmcnt(0)
    v_mfma_f32_16x16x32_bf16 v[120:123], v[192:195], v[68:71], v[120:123]
    s_add_u32 s38, s37, 17408
    buffer_load_dwordx4 v[84:87], v5, s[12:15], s38 offen
    s_waitcnt vmcnt(8)
    s_barrier
    ds_read_b128 v[124:127], v2 offset:25600
    ds_read_b128 v[128:131], v2 offset:26624
    ds_read_b128 v[132:135], v2 offset:27648
    ds_read_b128 v[136:139], v2 offset:28672
    ds_read_b128 v[140:143], v2 offset:29696
    ds_read_b128 v[144:147], v2 offset:30720
    ds_read_b128 v[148:151], v2 offset:31744
    ds_read_b128 v[152:155], v2 offset:32768
    ds_read_b128 v[156:159], v2 offset:33792
    s_waitcnt vmcnt(7)
    ds_read_b128 v[160:163], v2 offset:39936
    ds_read_b128 v[164:167], v2 offset:40960
    ds_read_b128 v[168:171], v2 offset:41984
    ds_read_b128 v[172:175], v2 offset:43008
    ds_read_b128 v[176:179], v2 offset:44032
    ds_read_b128 v[180:183], v2 offset:45056
    ds_read_b128 v[184:187], v2 offset:46080
    ds_read_b128 v[188:191], v2 offset:47104
    ds_read_b128 v[192:195], v2 offset:48128
    s_waitcnt lgkmcnt(15)
    v_mfma_f32_16x16x32_bf16 v[88:91], v[124:127], v[72:75], v[88:91]
    s_waitcnt lgkmcnt(15)
    v_mfma_f32_16x16x32_bf16 v[92:95], v[128:131], v[72:75], v[92:95]
    s_waitcnt lgkmcnt(15)
    v_mfma_f32_16x16x32_bf16 v[96:99], v[132:135], v[72:75], v[96:99]
    s_waitcnt lgkmcnt(14)
    v_mfma_f32_16x16x32_bf16 v[100:103], v[136:139], v[72:75], v[100:103]
    s_waitcnt lgkmcnt(13)
    v_mfma_f32_16x16x32_bf16 v[104:107], v[140:143], v[72:75], v[104:107]
    s_waitcnt lgkmcnt(12)
    v_mfma_f32_16x16x32_bf16 v[108:111], v[144:147], v[72:75], v[108:111]
    s_waitcnt lgkmcnt(11)
    v_mfma_f32_16x16x32_bf16 v[112:115], v[148:151], v[72:75], v[112:115]
    s_waitcnt lgkmcnt(10)
    v_mfma_f32_16x16x32_bf16 v[116:119], v[152:155], v[72:75], v[116:119]
    s_waitcnt lgkmcnt(9)
    v_mfma_f32_16x16x32_bf16 v[120:123], v[156:159], v[72:75], v[120:123]
    s_add_u32 s44, s35, 0
    buffer_load_dword v204, v6, s[20:23], s44 offen
    s_add_u32 s44, s35, 7168
    buffer_load_dword v205, v6, s[20:23], s44 offen
    s_add_u32 s44, s35, 14336
    buffer_load_dword v206, v6, s[20:23], s44 offen
    s_add_u32 s44, s35, 21504
    buffer_load_dword v207, v6, s[20:23], s44 offen
    s_add_u32 s44, s35, 28672
    buffer_load_dword v208, v6, s[20:23], s44 offen
    s_add_u32 s44, s35, 35840
    buffer_load_dword v209, v6, s[20:23], s44 offen
    s_add_u32 s44, s35, 43008
    buffer_load_dword v210, v6, s[20:23], s44 offen
    s_add_u32 s44, s35, 50176
    buffer_load_dword v211, v6, s[20:23], s44 offen
    s_add_u32 s44, s35, 57344
    buffer_load_dword v212, v6, s[20:23], s44 offen
    s_add_u32 s44, s35, 64512
    buffer_load_dword v213, v6, s[20:23], s44 offen
    s_add_u32 s44, s35, 71680
    buffer_load_dword v214, v6, s[20:23], s44 offen
    s_add_u32 s44, s35, 78848
    buffer_load_dword v215, v6, s[20:23], s44 offen
    s_add_u32 s44, s35, 86016
    buffer_load_dword v216, v6, s[20:23], s44 offen
    s_add_u32 s44, s35, 93184
    buffer_load_dword v217, v6, s[20:23], s44 offen
    s_add_u32 s44, s35, 100352
    buffer_load_dword v218, v6, s[20:23], s44 offen
    s_add_u32 s44, s35, 107520
    buffer_load_dword v219, v6, s[20:23], s44 offen
    s_add_u32 s44, s35, 114688
    buffer_load_dword v220, v6, s[20:23], s44 offen
    s_add_u32 s44, s35, 121856
    buffer_load_dword v221, v6, s[20:23], s44 offen
    buffer_load_dwordx2 v[196:197], v7, s[16:19], s36 offen offset:0
    buffer_load_dwordx2 v[198:199], v7, s[16:19], s36 offen offset:512
    buffer_load_dwordx2 v[200:201], v7, s[16:19], s36 offen offset:1024
    buffer_load_dwordx2 v[202:203], v7, s[16:19], s36 offen offset:1536
    s_waitcnt vmcnt(28)
    s_waitcnt lgkmcnt(8)
    v_mfma_f32_16x16x32_bf16 v[88:91], v[160:163], v[76:79], v[88:91]
    s_waitcnt lgkmcnt(7)
    v_mfma_f32_16x16x32_bf16 v[92:95], v[164:167], v[76:79], v[92:95]
    s_waitcnt lgkmcnt(6)
    v_mfma_f32_16x16x32_bf16 v[96:99], v[168:171], v[76:79], v[96:99]
    s_waitcnt lgkmcnt(5)
    v_mfma_f32_16x16x32_bf16 v[100:103], v[172:175], v[76:79], v[100:103]
    s_waitcnt lgkmcnt(4)
    v_mfma_f32_16x16x32_bf16 v[104:107], v[176:179], v[76:79], v[104:107]
    s_waitcnt lgkmcnt(3)
    v_mfma_f32_16x16x32_bf16 v[108:111], v[180:183], v[76:79], v[108:111]
    s_waitcnt lgkmcnt(2)
    v_mfma_f32_16x16x32_bf16 v[112:115], v[184:187], v[76:79], v[112:115]
    s_waitcnt lgkmcnt(1)
    v_mfma_f32_16x16x32_bf16 v[116:119], v[188:191], v[76:79], v[116:119]
    s_waitcnt lgkmcnt(0)
    v_mfma_f32_16x16x32_bf16 v[120:123], v[192:195], v[76:79], v[120:123]
    s_waitcnt vmcnt(24)
    s_barrier
    ds_read_b128 v[124:127], v5 offset:5120
    ds_read_b128 v[128:131], v5 offset:6144
    ds_read_b128 v[132:135], v5 offset:7168
    ds_read_b128 v[136:139], v5 offset:8192
    ds_read_b128 v[140:143], v5 offset:9216
    ds_read_b128 v[144:147], v5 offset:10240
    ds_read_b128 v[148:151], v5 offset:11264
    ds_read_b128 v[152:155], v5 offset:12288
    ds_read_b128 v[156:159], v5 offset:13312
    s_waitcnt vmcnt(23)
    ds_read_b128 v[160:163], v5 offset:19456
    ds_read_b128 v[164:167], v5 offset:20480
    ds_read_b128 v[168:171], v5 offset:21504
    ds_read_b128 v[172:175], v5 offset:22528
    ds_read_b128 v[176:179], v5 offset:23552
    ds_read_b128 v[180:183], v5 offset:24576
    ds_read_b128 v[184:187], v5 offset:25600
    ds_read_b128 v[188:191], v5 offset:26624
    ds_read_b128 v[192:195], v5 offset:27648
    s_waitcnt lgkmcnt(15)
    v_mfma_f32_16x16x32_bf16 v[88:91], v[124:127], v[80:83], v[88:91]
    s_waitcnt lgkmcnt(15)
    v_mfma_f32_16x16x32_bf16 v[92:95], v[128:131], v[80:83], v[92:95]
    s_waitcnt lgkmcnt(15)
    v_mfma_f32_16x16x32_bf16 v[96:99], v[132:135], v[80:83], v[96:99]
    s_waitcnt lgkmcnt(14)
    v_mfma_f32_16x16x32_bf16 v[100:103], v[136:139], v[80:83], v[100:103]
    s_waitcnt lgkmcnt(13)
    v_mfma_f32_16x16x32_bf16 v[104:107], v[140:143], v[80:83], v[104:107]
    s_waitcnt lgkmcnt(12)
    v_mfma_f32_16x16x32_bf16 v[108:111], v[144:147], v[80:83], v[108:111]
    s_waitcnt lgkmcnt(11)
    v_mfma_f32_16x16x32_bf16 v[112:115], v[148:151], v[80:83], v[112:115]
    s_waitcnt lgkmcnt(10)
    v_mfma_f32_16x16x32_bf16 v[116:119], v[152:155], v[80:83], v[116:119]
    s_waitcnt lgkmcnt(9)
    v_mfma_f32_16x16x32_bf16 v[120:123], v[156:159], v[80:83], v[120:123]
    s_waitcnt vmcnt(22)
    s_waitcnt lgkmcnt(8)
    v_mfma_f32_16x16x32_bf16 v[88:91], v[160:163], v[84:87], v[88:91]
    s_waitcnt lgkmcnt(7)
    v_mfma_f32_16x16x32_bf16 v[92:95], v[164:167], v[84:87], v[92:95]
    s_waitcnt lgkmcnt(6)
    v_mfma_f32_16x16x32_bf16 v[96:99], v[168:171], v[84:87], v[96:99]
    s_waitcnt lgkmcnt(5)
    v_mfma_f32_16x16x32_bf16 v[100:103], v[172:175], v[84:87], v[100:103]
    s_waitcnt lgkmcnt(4)
    v_mfma_f32_16x16x32_bf16 v[104:107], v[176:179], v[84:87], v[104:107]
    s_waitcnt lgkmcnt(3)
    v_mfma_f32_16x16x32_bf16 v[108:111], v[180:183], v[84:87], v[108:111]
    s_waitcnt lgkmcnt(2)
    v_mfma_f32_16x16x32_bf16 v[112:115], v[184:187], v[84:87], v[112:115]
    s_waitcnt lgkmcnt(1)
    v_mfma_f32_16x16x32_bf16 v[116:119], v[188:191], v[84:87], v[116:119]
    s_waitcnt lgkmcnt(0)
    v_mfma_f32_16x16x32_bf16 v[120:123], v[192:195], v[84:87], v[120:123]
    s_waitcnt vmcnt(0)
    v_add_f32 v204, v204, v205
    v_add_f32 v204, v204, v206
    v_add_f32 v204, v204, v207
    v_add_f32 v204, v204, v208
    v_add_f32 v204, v204, v209
    v_add_f32 v204, v204, v210
    v_add_f32 v204, v204, v211
    v_add_f32 v204, v204, v212
    v_add_f32 v204, v204, v213
    v_add_f32 v204, v204, v214
    v_add_f32 v204, v204, v215
    v_add_f32 v204, v204, v216
    v_add_f32 v204, v204, v217
    v_add_f32 v204, v204, v218
    v_add_f32 v204, v204, v219
    v_add_f32 v204, v204, v220
    v_add_f32 v204, v204, v221
    v_add_u32 v6, 114688, v6
    ds_write_b32 v6, v204
    v_and_b32 v12, 1, v4
    v_cmp_eq_u32 vcc, 1, v12
    v_mov_b32 v12, 0x42200000
    v_mov_b32 v13, 0x42000000
    v_cndmask_b32 v12, v12, v13, vcc
    v_add_f32 v8, v196, v198
    v_add_f32 v10, v200, v202
    v_add_f32 v8, v8, v10
    v_mul_f32 v8, v8, v12
    v_mov_b32 v10, v8
    s_nop 1
    v_permlane16_swap_b32 v8, v10
    v_add_f32 v8, v8, v10
    v_mov_b32 v10, v8
    s_nop 1
    v_permlane32_swap_b32 v8, v10
    v_add_f32 v8, v8, v10
    v_mul_f32 v8, 0x3ae38e39, v8
    v_mov_b32 v11, 0
    v_sub_f32 v10, v196, v8
    v_mul_f32 v10, v10, v10
    v_fmac_f32 v11, v10, v12
    v_add_f32 v11, v11, v197
    v_sub_f32 v10, v198, v8
    v_mul_f32 v10, v10, v10
    v_fmac_f32 v11, v10, v12
    v_add_f32 v11, v11, v199
    v_sub_f32 v10, v200, v8
    v_mul_f32 v10, v10, v10
    v_fmac_f32 v11, v10, v12
    v_add_f32 v11, v11, v201
    v_sub_f32 v10, v202, v8
    v_mul_f32 v10, v10, v10
    v_fmac_f32 v11, v10, v12
    v_add_f32 v11, v11, v203
    v_mov_b32 v10, v11
    s_nop 1
    v_permlane16_swap_b32 v11, v10
    v_add_f32 v11, v11, v10
    v_mov_b32 v10, v11
    s_nop 1
    v_permlane32_swap_b32 v11, v10
    v_add_f32 v11, v11, v10
    v_mul_f32 v11, 0x3ae38e39, v11
    v_cvt_pk_bf16_f32 v10, v8, v11
    v_lshlrev_b32 v8, 16, v10
    v_and_b32 v11, 0xffff0000, v10
    v_add_f32 v11, 0x3727c5ac, v11
    v_cvt_pk_bf16_f32 v10, v11, v11
    v_lshlrev_b32 v11, 16, v10
    v_sqrt_f32 v11, v11
    s_nop 0
    v_cvt_pk_bf16_f32 v10, v11, v11
    v_lshlrev_b32 v11, 16, v10
    v_rcp_f32 v9, v11
    s_waitcnt lgkmcnt(0)
    s_barrier
    v_lshlrev_b32 v6, 4, v4
    v_add_u32 v6, 114688, v6
    ds_read_b128 v[124:127], v6 offset:320
    ds_read_b128 v[128:131], v6 offset:384
    ds_read_b128 v[132:135], v6 offset:448
    ds_read_b128 v[136:139], v6 offset:512
    ds_read_b128 v[140:143], v6 offset:576
    ds_read_b128 v[144:147], v6 offset:640
    ds_read_b128 v[148:151], v6 offset:704
    ds_read_b128 v[152:155], v6 offset:768
    ds_read_b128 v[156:159], v6 offset:832
    s_waitcnt lgkmcnt(8)
    v_fma_f32 v88, -v8, v124, v88
    v_mul_f32 v88, v88, v9
    v_fma_f32 v89, -v8, v125, v89
    v_mul_f32 v89, v89, v9
    v_fma_f32 v90, -v8, v126, v90
    v_mul_f32 v90, v90, v9
    v_fma_f32 v91, -v8, v127, v91
    v_mul_f32 v91, v91, v9
    s_waitcnt lgkmcnt(7)
    v_fma_f32 v92, -v8, v128, v92
    v_mul_f32 v92, v92, v9
    v_fma_f32 v93, -v8, v129, v93
    v_mul_f32 v93, v93, v9
    v_fma_f32 v94, -v8, v130, v94
    v_mul_f32 v94, v94, v9
    v_fma_f32 v95, -v8, v131, v95
    v_mul_f32 v95, v95, v9
    s_waitcnt lgkmcnt(6)
    v_fma_f32 v96, -v8, v132, v96
    v_mul_f32 v96, v96, v9
    v_fma_f32 v97, -v8, v133, v97
    v_mul_f32 v97, v97, v9
    v_fma_f32 v98, -v8, v134, v98
    v_mul_f32 v98, v98, v9
    v_fma_f32 v99, -v8, v135, v99
    v_mul_f32 v99, v99, v9
    s_waitcnt lgkmcnt(5)
    v_fma_f32 v100, -v8, v136, v100
    v_mul_f32 v100, v100, v9
    v_fma_f32 v101, -v8, v137, v101
    v_mul_f32 v101, v101, v9
    v_fma_f32 v102, -v8, v138, v102
    v_mul_f32 v102, v102, v9
    v_fma_f32 v103, -v8, v139, v103
    v_mul_f32 v103, v103, v9
    s_waitcnt lgkmcnt(4)
    v_fma_f32 v104, -v8, v140, v104
    v_mul_f32 v104, v104, v9
    v_fma_f32 v105, -v8, v141, v105
    v_mul_f32 v105, v105, v9
    v_fma_f32 v106, -v8, v142, v106
    v_mul_f32 v106, v106, v9
    v_fma_f32 v107, -v8, v143, v107
    v_mul_f32 v107, v107, v9
    s_waitcnt lgkmcnt(3)
    v_fma_f32 v108, -v8, v144, v108
    v_mul_f32 v108, v108, v9
    v_fma_f32 v109, -v8, v145, v109
    v_mul_f32 v109, v109, v9
    v_fma_f32 v110, -v8, v146, v110
    v_mul_f32 v110, v110, v9
    v_fma_f32 v111, -v8, v147, v111
    v_mul_f32 v111, v111, v9
    s_waitcnt lgkmcnt(2)
    v_fma_f32 v112, -v8, v148, v112
    v_mul_f32 v112, v112, v9
    v_fma_f32 v113, -v8, v149, v113
    v_mul_f32 v113, v113, v9
    v_fma_f32 v114, -v8, v150, v114
    v_mul_f32 v114, v114, v9
    v_fma_f32 v115, -v8, v151, v115
    v_mul_f32 v115, v115, v9
    s_waitcnt lgkmcnt(1)
    v_fma_f32 v116, -v8, v152, v116
    v_mul_f32 v116, v116, v9
    v_fma_f32 v117, -v8, v153, v117
    v_mul_f32 v117, v117, v9
    v_fma_f32 v118, -v8, v154, v118
    v_mul_f32 v118, v118, v9
    v_fma_f32 v119, -v8, v155, v119
    v_mul_f32 v119, v119, v9
    s_waitcnt lgkmcnt(0)
    v_fma_f32 v120, -v8, v156, v120
    v_mul_f32 v120, v120, v9
    v_fma_f32 v121, -v8, v157, v121
    v_mul_f32 v121, v121, v9
    v_fma_f32 v122, -v8, v158, v122
    v_mul_f32 v122, v122, v9
    v_fma_f32 v123, -v8, v159, v123
    v_mul_f32 v123, v123, v9
    v_cvt_pk_bf16_f32 v10, v88, v89
    v_lshlrev_b32 v88, 16, v10
    v_and_b32 v89, 0xffff0000, v10
    v_cvt_pk_bf16_f32 v10, v90, v91
    v_lshlrev_b32 v90, 16, v10
    v_and_b32 v91, 0xffff0000, v10
    v_cvt_pk_bf16_f32 v10, v92, v93
    v_lshlrev_b32 v92, 16, v10
    v_and_b32 v93, 0xffff0000, v10
    v_cvt_pk_bf16_f32 v10, v94, v95
    v_lshlrev_b32 v94, 16, v10
    v_and_b32 v95, 0xffff0000, v10
    v_cvt_pk_bf16_f32 v10, v96, v97
    v_lshlrev_b32 v96, 16, v10
    v_and_b32 v97, 0xffff0000, v10
    v_cvt_pk_bf16_f32 v10, v98, v99
    v_lshlrev_b32 v98, 16, v10
    v_and_b32 v99, 0xffff0000, v10
    v_cvt_pk_bf16_f32 v10, v100, v101
    v_lshlrev_b32 v100, 16, v10
    v_and_b32 v101, 0xffff0000, v10
    v_cvt_pk_bf16_f32 v10, v102, v103
    v_lshlrev_b32 v102, 16, v10
    v_and_b32 v103, 0xffff0000, v10
    v_cvt_pk_bf16_f32 v10, v104, v105
    v_lshlrev_b32 v104, 16, v10
    v_and_b32 v105, 0xffff0000, v10
    v_cvt_pk_bf16_f32 v10, v106, v107
    v_lshlrev_b32 v106, 16, v10
    v_and_b32 v107, 0xffff0000, v10
    v_cvt_pk_bf16_f32 v10, v108, v109
    v_lshlrev_b32 v108, 16, v10
    v_and_b32 v109, 0xffff0000, v10
    v_cvt_pk_bf16_f32 v10, v110, v111
    v_lshlrev_b32 v110, 16, v10
    v_and_b32 v111, 0xffff0000, v10
    v_cvt_pk_bf16_f32 v10, v112, v113
    v_lshlrev_b32 v112, 16, v10
    v_and_b32 v113, 0xffff0000, v10
    v_cvt_pk_bf16_f32 v10, v114, v115
    v_lshlrev_b32 v114, 16, v10
    v_and_b32 v115, 0xffff0000, v10
    v_cvt_pk_bf16_f32 v10, v116, v117
    v_lshlrev_b32 v116, 16, v10
    v_and_b32 v117, 0xffff0000, v10
    v_cvt_pk_bf16_f32 v10, v118, v119
    v_lshlrev_b32 v118, 16, v10
    v_and_b32 v119, 0xffff0000, v10
    v_cvt_pk_bf16_f32 v10, v120, v121
    v_lshlrev_b32 v120, 16, v10
    v_and_b32 v121, 0xffff0000, v10
    v_cvt_pk_bf16_f32 v10, v122, v123
    v_lshlrev_b32 v122, 16, v10
    v_and_b32 v123, 0xffff0000, v10
    v_max3_f32 v58, v88, v89, v90
    v_min3_f32 v59, v88, v89, v90
    v_max3_f32 v58, v58, v91, v92
    v_min3_f32 v59, v59, v91, v92
    v_max3_f32 v58, v58, v93, v94
    v_min3_f32 v59, v59, v93, v94
    v_max3_f32 v58, v58, v95, v96
    v_min3_f32 v59, v59, v95, v96
    v_max3_f32 v58, v58, v97, v98
    v_min3_f32 v59, v59, v97, v98
    v_max3_f32 v58, v58, v99, v100
    v_min3_f32 v59, v59, v99, v100
    v_max3_f32 v58, v58, v101, v102
    v_min3_f32 v59, v59, v101, v102
    v_max3_f32 v58, v58, v103, v104
    v_min3_f32 v59, v59, v103, v104
    v_max_f32 v58, v58, v105
    v_min_f32 v59, v59, v105
    v_mov_b32 v62, 0x3fb8aa3b
    v_sub_f32 v40, v88, v58
    v_mul_f32 v40, v40, v62
    v_sub_f32 v41, v89, v58
    v_mul_f32 v41, v41, v62
    v_sub_f32 v42, v90, v58
    v_mul_f32 v42, v42, v62
    v_sub_f32 v43, v91, v58
    v_mul_f32 v43, v43, v62
    v_sub_f32 v44, v92, v58
    v_mul_f32 v44, v44, v62
    v_sub_f32 v45, v93, v58
    v_mul_f32 v45, v45, v62
    v_sub_f32 v46, v94, v58
    v_mul_f32 v46, v46, v62
    v_sub_f32 v47, v95, v58
    v_mul_f32 v47, v47, v62
    v_sub_f32 v48, v96, v58
    v_mul_f32 v48, v48, v62
    v_sub_f32 v49, v97, v58
    v_mul_f32 v49, v49, v62
    v_sub_f32 v50, v98, v58
    v_mul_f32 v50, v50, v62
    v_sub_f32 v51, v99, v58
    v_mul_f32 v51, v51, v62
    v_sub_f32 v52, v100, v58
    v_mul_f32 v52, v52, v62
    v_sub_f32 v53, v101, v58
    v_mul_f32 v53, v53, v62
    v_sub_f32 v54, v102, v58
    v_mul_f32 v54, v54, v62
    v_sub_f32 v55, v103, v58
    v_mul_f32 v55, v55, v62
    v_sub_f32 v56, v104, v58
    v_mul_f32 v56, v56, v62
    v_sub_f32 v57, v105, v58
    v_mul_f32 v57, v57, v62
    v_exp_f32 v40, v40
    v_exp_f32 v41, v41
    v_exp_f32 v42, v42
    v_exp_f32 v43, v43
    v_exp_f32 v44, v44
    v_exp_f32 v45, v45
    v_exp_f32 v46, v46
    v_exp_f32 v47, v47
    v_exp_f32 v48, v48
    v_exp_f32 v49, v49
    v_exp_f32 v50, v50
    v_exp_f32 v51, v51
    v_exp_f32 v52, v52
    v_exp_f32 v53, v53
    v_exp_f32 v54, v54
    v_exp_f32 v55, v55
    v_exp_f32 v56, v56
    v_exp_f32 v57, v57
    v_add_f32 v60, v40, v41
    v_add_f32 v60, v60, v42
    v_add_f32 v60, v60, v43
    v_add_f32 v60, v60, v44
    v_add_f32 v60, v60, v45
    v_add_f32 v60, v60, v46
    v_add_f32 v60, v60, v47
    v_add_f32 v60, v60, v48
    v_add_f32 v60, v60, v49
    v_add_f32 v60, v60, v50
    v_add_f32 v60, v60, v51
    v_add_f32 v60, v60, v52
    v_add_f32 v60, v60, v53
    v_add_f32 v60, v60, v54
    v_add_f32 v60, v60, v55
    v_add_f32 v60, v60, v56
    v_add_f32 v60, v60, v57
    v_rcp_f32 v61, v60
    s_nop 0
    v_mul_f32 v40, v40, v61
    v_mul_f32 v41, v41, v61
    v_mul_f32 v42, v42, v61
    v_mul_f32 v43, v43, v61
    v_mul_f32 v44, v44, v61
    v_mul_f32 v45, v45, v61
    v_mul_f32 v46, v46, v61
    v_mul_f32 v47, v47, v61
    v_mul_f32 v48, v48, v61
    v_mul_f32 v49, v49, v61
    v_mul_f32 v50, v50, v61
    v_mul_f32 v51, v51, v61
    v_mul_f32 v52, v52, v61
    v_mul_f32 v53, v53, v61
    v_mul_f32 v54, v54, v61
    v_mul_f32 v55, v55, v61
    v_mul_f32 v56, v56, v61
    v_mul_f32 v57, v57, v61
    v_cvt_pk_bf16_f32 v64, v40, v41
    v_cvt_pk_bf16_f32 v65, v42, v43
    v_cvt_pk_bf16_f32 v66, v44, v45
    v_cvt_pk_bf16_f32 v67, v46, v47
    v_cvt_pk_bf16_f32 v68, v48, v49
    v_cvt_pk_bf16_f32 v69, v50, v51
    v_cvt_pk_bf16_f32 v70, v52, v53
    v_cvt_pk_bf16_f32 v71, v54, v55
    v_cvt_pk_bf16_f32 v72, v56, v57
    v_sub_f32 v40, v59, v88
    v_mul_f32 v40, v40, v62
    v_sub_f32 v41, v59, v89
    v_mul_f32 v41, v41, v62
    v_sub_f32 v42, v59, v90
    v_mul_f32 v42, v42, v62
    v_sub_f32 v43, v59, v91
    v_mul_f32 v43, v43, v62
    v_sub_f32 v44, v59, v92
    v_mul_f32 v44, v44, v62
    v_sub_f32 v45, v59, v93
    v_mul_f32 v45, v45, v62
    v_sub_f32 v46, v59, v94
    v_mul_f32 v46, v46, v62
    v_sub_f32 v47, v59, v95
    v_mul_f32 v47, v47, v62
    v_sub_f32 v48, v59, v96
    v_mul_f32 v48, v48, v62
    v_sub_f32 v49, v59, v97
    v_mul_f32 v49, v49, v62
    v_sub_f32 v50, v59, v98
    v_mul_f32 v50, v50, v62
    v_sub_f32 v51, v59, v99
    v_mul_f32 v51, v51, v62
    v_sub_f32 v52, v59, v100
    v_mul_f32 v52, v52, v62
    v_sub_f32 v53, v59, v101
    v_mul_f32 v53, v53, v62
    v_sub_f32 v54, v59, v102
    v_mul_f32 v54, v54, v62
    v_sub_f32 v55, v59, v103
    v_mul_f32 v55, v55, v62
    v_sub_f32 v56, v59, v104
    v_mul_f32 v56, v56, v62
    v_sub_f32 v57, v59, v105
    v_mul_f32 v57, v57, v62
    v_exp_f32 v40, v40
    v_exp_f32 v41, v41
    v_exp_f32 v42, v42
    v_exp_f32 v43, v43
    v_exp_f32 v44, v44
    v_exp_f32 v45, v45
    v_exp_f32 v46, v46
    v_exp_f32 v47, v47
    v_exp_f32 v48, v48
    v_exp_f32 v49, v49
    v_exp_f32 v50, v50
    v_exp_f32 v51, v51
    v_exp_f32 v52, v52
    v_exp_f32 v53, v53
    v_exp_f32 v54, v54
    v_exp_f32 v55, v55
    v_exp_f32 v56, v56
    v_exp_f32 v57, v57
    v_add_f32 v60, v40, v41
    v_add_f32 v60, v60, v42
    v_add_f32 v60, v60, v43
    v_add_f32 v60, v60, v44
    v_add_f32 v60, v60, v45
    v_add_f32 v60, v60, v46
    v_add_f32 v60, v60, v47
    v_add_f32 v60, v60, v48
    v_add_f32 v60, v60, v49
    v_add_f32 v60, v60, v50
    v_add_f32 v60, v60, v51
    v_add_f32 v60, v60, v52
    v_add_f32 v60, v60, v53
    v_add_f32 v60, v60, v54
    v_add_f32 v60, v60, v55
    v_add_f32 v60, v60, v56
    v_add_f32 v60, v60, v57
    v_rcp_f32 v61, v60
    s_nop 0
    v_mul_f32 v40, v40, v61
    v_mul_f32 v41, v41, v61
    v_mul_f32 v42, v42, v61
    v_mul_f32 v43, v43, v61
    v_mul_f32 v44, v44, v61
    v_mul_f32 v45, v45, v61
    v_mul_f32 v46, v46, v61
    v_mul_f32 v47, v47, v61
    v_mul_f32 v48, v48, v61
    v_mul_f32 v49, v49, v61
    v_mul_f32 v50, v50, v61
    v_mul_f32 v51, v51, v61
    v_mul_f32 v52, v52, v61
    v_mul_f32 v53, v53, v61
    v_mul_f32 v54, v54, v61
    v_mul_f32 v55, v55, v61
    v_mul_f32 v56, v56, v61
    v_mul_f32 v57, v57, v61
    v_cvt_pk_bf16_f32 v73, v40, v41
    v_cvt_pk_bf16_f32 v74, v42, v43
    v_cvt_pk_bf16_f32 v75, v44, v45
    v_cvt_pk_bf16_f32 v76, v46, v47
    v_cvt_pk_bf16_f32 v77, v48, v49
    v_cvt_pk_bf16_f32 v78, v50, v51
    v_cvt_pk_bf16_f32 v79, v52, v53
    v_cvt_pk_bf16_f32 v80, v54, v55
    v_cvt_pk_bf16_f32 v81, v56, v57
    v_cvt_pk_bf16_f32 v16, v106, v107
    v_cvt_pk_bf16_f32 v17, v108, v109
    v_cvt_pk_bf16_f32 v18, v110, v111
    v_cvt_pk_bf16_f32 v19, v112, v113
    v_cvt_pk_bf16_f32 v20, v114, v115
    v_cvt_pk_bf16_f32 v21, v116, v117
    v_cvt_pk_bf16_f32 v22, v118, v119
    v_cvt_pk_bf16_f32 v23, v120, v121
    v_cvt_pk_bf16_f32 v24, v122, v123
    v_mul_u32_u24 v6, 11520, v4
    v_lshl_add_u32 v6, v3, 1, v6
    s_lshl_b32 s45, s51, 5
    v_add_u32 v6, s45, v6
    ds_write_b16 v6, v64 offset:0
    ds_write_b16_d16_hi v6, v64 offset:144
    ds_write_b16 v6, v65 offset:288
    ds_write_b16_d16_hi v6, v65 offset:432
    ds_write_b16 v6, v66 offset:576
    ds_write_b16_d16_hi v6, v66 offset:720
    ds_write_b16 v6, v67 offset:864
    ds_write_b16_d16_hi v6, v67 offset:1008
    ds_write_b16 v6, v68 offset:1152
    ds_write_b16_d16_hi v6, v68 offset:1296
    ds_write_b16 v6, v69 offset:1440
    ds_write_b16_d16_hi v6, v69 offset:1584
    ds_write_b16 v6, v70 offset:1728
    ds_write_b16_d16_hi v6, v70 offset:1872
    ds_write_b16 v6, v71 offset:2016
    ds_write_b16_d16_hi v6, v71 offset:2160
    ds_write_b16 v6, v72 offset:2304
    ds_write_b16_d16_hi v6, v72 offset:2448
    ds_write_b16 v6, v73 offset:2592
    ds_write_b16_d16_hi v6, v73 offset:2736
    ds_write_b16 v6, v74 offset:2880
    ds_write_b16_d16_hi v6, v74 offset:3024
    ds_write_b16 v6, v75 offset:3168
    ds_write_b16_d16_hi v6, v75 offset:3312
    ds_write_b16 v6, v76 offset:3456
    ds_write_b16_d16_hi v6, v76 offset:3600
    ds_write_b16 v6, v77 offset:3744
    ds_write_b16_d16_hi v6, v77 offset:3888
    ds_write_b16 v6, v78 offset:4032
    ds_write_b16_d16_hi v6, v78 offset:4176
    ds_write_b16 v6, v79 offset:4320
    ds_write_b16_d16_hi v6, v79 offset:4464
    ds_write_b16 v6, v80 offset:4608
    ds_write_b16_d16_hi v6, v80 offset:4752
    ds_write_b16 v6, v81 offset:4896
    ds_write_b16_d16_hi v6, v81 offset:5040
    ds_write_b16 v6, v16 offset:6912
    ds_write_b16_d16_hi v6, v16 offset:7056
    ds_write_b16 v6, v17 offset:7200
    ds_write_b16_d16_hi v6, v17 offset:7344
    ds_write_b16 v6, v18 offset:7488
    ds_write_b16_d16_hi v6, v18 offset:7632
    ds_write_b16 v6, v19 offset:7776
    ds_write_b16_d16_hi v6, v19 offset:7920
    ds_write_b16 v6, v20 offset:8064
    ds_write_b16_d16_hi v6, v20 offset:8208
    ds_write_b16 v6, v21 offset:8352
    ds_write_b16_d16_hi v6, v21 offset:8496
    ds_write_b16 v6, v22 offset:8640
    ds_write_b16_d16_hi v6, v22 offset:8784
    ds_write_b16 v6, v23 offset:8928
    ds_write_b16_d16_hi v6, v23 offset:9072
    ds_write_b16 v6, v24 offset:9216
    ds_write_b16_d16_hi v6, v24 offset:9360
    s_waitcnt lgkmcnt(0)
    s_barrier
.maindone_k1l1_kernel_3:
.End_k1l1_kernel_1:
    s_endpgm
.globl k2l1_kernel
.p2align 8
.type k2l1_kernel,@function
k2l1_kernel:
    s_cmp_ge_u32 s2, 256
    s_cbranch_scc1 .End_k2l1_kernel_1
    s_load_dwordx2 s[4:5], s[0:1], 88
    v_and_b32 v1, 63, v0
    v_lshrrev_b32 v2, 6, v0
    s_nop 0
    v_readfirstlane_b32 s3, v2
    v_and_b32 v3, 15, v1
    v_lshrrev_b32 v4, 4, v1
    v_lshlrev_b32 v5, 4, v1
    s_lshr_b32 s34, s2, 3
    s_and_b32 s32, s34, 3
    s_lshr_b32 s34, s34, 2
    s_and_b32 s33, s2, 7
    s_lshl_b32 s33, s33, 3
    s_add_u32 s33, s33, s34
    s_waitcnt lgkmcnt(0)
    s_add_u32 s8, s4, 0x400000
    s_addc_u32 s9, s5, 0
    s_and_b32 s9, s9, 0xffff
    s_mov_b32 s10, 0xd8000
    s_mov_b32 s11, 0x20000
    s_add_u32 s12, s4, 0x1d00000
    s_addc_u32 s13, s5, 0
    s_and_b32 s13, s13, 0xffff
    s_mov_b32 s14, 0x240000
    s_mov_b32 s15, 0x20000
    s_add_u32 s16, s4, 0x1f80000
    s_addc_u32 s17, s5, 0
    s_and_b32 s17, s17, 0xffff
    s_mov_b32 s18, 0x240000
    s_mov_b32 s19, 0x20000
    s_add_u32 s20, s4, 0x22c0000
    s_addc_u32 s21, s5, 0
    s_and_b32 s21, s21, 0xffff
    s_mov_b32 s22, 0x40000
    s_mov_b32 s23, 0x20000
    s_add_u32 s24, s4, 0x2400000
    s_addc_u32 s25, s5, 0
    s_and_b32 s25, s25, 0xffff
    s_mov_b32 s26, 0x480000
    s_mov_b32 s27, 0x20000
    s_add_u32 s28, s4, 0x2340000
    s_addc_u32 s29, s5, 0
    s_and_b32 s29, s29, 0xffff
    s_mov_b32 s30, 0x28000
    s_mov_b32 s31, 0x20000
    v_mov_b32 v11, 0x7ff00000
    v_lshlrev_b32 v6, 8, v4
    v_lshl_add_u32 v6, v3, 4, v6
    v_cmp_gt_u32 s[56:57], 10, v3
    s_nop 1
    v_cndmask_b32 v6, v11, v6, s[56:57]
    s_mul_i32 s53, s3, 3840
    v_mul_u32_u24 v7, 96, v4
    v_lshl_add_u32 v7, v3, 3, v7
    v_add_u32 v7, s53, v7
    v_mul_u32_u24 v12, 96, v3
    v_lshl_add_u32 v12, v4, 4, v12
    v_add_u32 v12, s53, v12
    v_mov_b32 v13, 19
    v_and_b32 v8, 3, v3
    v_cmp_eq_u32 vcc, 2, v8
    s_nop 1
    v_cndmask_b32 v13, v13, 18, vcc
    v_add_u32 v8, 16, v3
    v_cmp_gt_u32 vcc, 2, v3
    s_nop 1
    v_cndmask_b32 v13, v13, v8, vcc
    v_mul_u32_u24 v13, 96, v13
    v_lshl_add_u32 v13, v4, 4, v13
    v_add_u32 v13, s53, v13
    v_cmp_eq_u32 s[54:55], 0, v4
    v_lshlrev_b32 v8, 3, v3
    s_nop 0
    v_cndmask_b32 v8, v11, v8, s[54:55]
    s_lshl_b32 s34, s33, 6
    s_lshl_b32 s35, s3, 2
    s_add_u32 s34, s34, s35
    s_lshl_b32 s35, s34, 7
    s_add_u32 s35, s35, 4194304
    s_lshl_b32 s34, s34, 10
    s_mul_i32 s36, s3, 20480
    s_add_u32 s37, s36, 0
    buffer_load_dwordx4 v[124:127], v6, s[28:31], s37 offen offset:0
    buffer_load_dwordx4 v[128:131], v6, s[28:31], s37 offen offset:1024
    buffer_load_dwordx4 v[132:135], v6, s[28:31], s37 offen offset:2048
    buffer_load_dwordx4 v[136:139], v6, s[28:31], s37 offen offset:3072
    s_add_u32 s37, s37, 4096
    buffer_load_dwordx4 v[140:143], v6, s[28:31], s37 offen offset:0
    s_add_u32 s38, s34, 0
    buffer_load_dwordx4 v[144:147], v5, s[24:27], s38 offen
    s_add_u32 s38, s35, 0
    buffer_load_dwordx2 v[152:153], v8, s[24:27], s38 offen
    s_add_u32 s38, s34, 32768
    buffer_load_dwordx4 v[148:151], v5, s[24:27], s38 offen
    s_add_u32 s38, s35, 4096
    buffer_load_dwordx2 v[154:155], v8, s[24:27], s38 offen
    s_add_u32 s37, s36, 5120
    buffer_load_dwordx4 v[156:159], v6, s[28:31], s37 offen offset:0
    buffer_load_dwordx4 v[160:163], v6, s[28:31], s37 offen offset:1024
    buffer_load_dwordx4 v[164:167], v6, s[28:31], s37 offen offset:2048
    buffer_load_dwordx4 v[168:171], v6, s[28:31], s37 offen offset:3072
    s_add_u32 s37, s37, 4096
    buffer_load_dwordx4 v[172:175], v6, s[28:31], s37 offen offset:0
    s_add_u32 s38, s34, 1024
    buffer_load_dwordx4 v[176:179], v5, s[24:27], s38 offen
    s_add_u32 s38, s35, 128
    buffer_load_dwordx2 v[184:185], v8, s[24:27], s38 offen
    s_add_u32 s38, s34, 33792
    buffer_load_dwordx4 v[180:183], v5, s[24:27], s38 offen
    s_add_u32 s38, s35, 4224
    buffer_load_dwordx2 v[186:187], v8, s[24:27], s38 offen
    s_add_u32 s37, s36, 10240
    buffer_load_dwordx4 v[60:63], v6, s[28:31], s37 offen offset:0
    buffer_load_dwordx4 v[64:67], v6, s[28:31], s37 offen offset:1024
    buffer_load_dwordx4 v[68:71], v6, s[28:31], s37 offen offset:2048
    buffer_load_dwordx4 v[72:75], v6, s[28:31], s37 offen offset:3072
    s_add_u32 s37, s37, 4096
    buffer_load_dwordx4 v[76:79], v6, s[28:31], s37 offen offset:0
    s_add_u32 s38, s34, 2048
    buffer_load_dwordx4 v[80:83], v5, s[24:27], s38 offen
    s_add_u32 s38, s35, 256
    buffer_load_dwordx2 v[88:89], v8, s[24:27], s38 offen
    s_add_u32 s38, s34, 34816
    buffer_load_dwordx4 v[84:87], v5, s[24:27], s38 offen
    s_add_u32 s38, s35, 4352
    buffer_load_dwordx2 v[90:91], v8, s[24:27], s38 offen
    s_add_u32 s37, s36, 15360
    buffer_load_dwordx4 v[92:95], v6, s[28:31], s37 offen offset:0
    buffer_load_dwordx4 v[96:99], v6, s[28:31], s37 offen offset:1024
    buffer_load_dwordx4 v[100:103], v6, s[28:31], s37 offen offset:2048
    buffer_load_dwordx4 v[104:107], v6, s[28:31], s37 offen offset:3072
    s_add_u32 s37, s37, 4096
    buffer_load_dwordx4 v[108:111], v6, s[28:31], s37 offen offset:0
    s_add_u32 s38, s34, 3072
    buffer_load_dwordx4 v[112:115], v5, s[24:27], s38 offen
    s_add_u32 s38, s35, 384
    buffer_load_dwordx2 v[120:121], v8, s[24:27], s38 offen
    s_add_u32 s38, s34, 35840
    buffer_load_dwordx4 v[116:119], v5, s[24:27], s38 offen
    s_add_u32 s38, s35, 4480
    buffer_load_dwordx2 v[122:123], v8, s[24:27], s38 offen
    s_lshl_b32 s39, s32, 3
    s_add_u32 s39, s39, s3
    s_mul_i32 s39, s39, 27648
    s_add_u32 s40, s39, 0
    buffer_load_dwordx4 v[16:19], v5, s[8:11], s40 offen
    s_add_u32 s40, s39, 1024
    buffer_load_dwordx4 v[20:23], v5, s[8:11], s40 offen
    s_add_u32 s40, s39, 2048
    buffer_load_dwordx4 v[24:27], v5, s[8:11], s40 offen
    s_add_u32 s40, s39, 3072
    buffer_load_dwordx4 v[28:31], v5, s[8:11], s40 offen
    s_add_u32 s40, s39, 4096
    buffer_load_dwordx4 v[32:35], v5, s[8:11], s40 offen
    s_add_u32 s40, s39, 5120
    buffer_load_dwordx4 v[36:39], v5, s[8:11], s40 offen
    s_add_u32 s40, s39, 6144
    buffer_load_dwordx4 v[40:43], v5, s[8:11], s40 offen
    s_add_u32 s40, s39, 7168
    buffer_load_dwordx4 v[44:47], v5, s[8:11], s40 offen
    s_add_u32 s40, s39, 8192
    buffer_load_dwordx4 v[48:51], v5, s[8:11], s40 offen
    s_add_u32 s40, s39, 9216
    buffer_load_dwordx4 v[52:55], v5, s[8:11], s40 offen
    s_add_u32 s40, s39, 10240
    buffer_load_dwordx4 v[56:59], v5, s[8:11], s40 offen
    v_mov_b32 v10, 0x358637bd
    v_mov_b32 v254, 0
    v_mov_b32 v255, 0
    v_mov_b32 v9, 0
    s_waitcnt vmcnt(38)
    v_cvt_pk_bf16_f32 v124, v124, v125
    v_cvt_pk_bf16_f32 v125, v126, v127
    v_cvt_pk_bf16_f32 v128, v128, v129
    v_cvt_pk_bf16_f32 v129, v130, v131
    v_cvt_pk_bf16_f32 v132, v132, v133
    v_cvt_pk_bf16_f32 v133, v134, v135
    v_cvt_pk_bf16_f32 v136, v136, v137
    v_cvt_pk_bf16_f32 v137, v138, v139
    v_cvt_pk_bf16_f32 v140, v140, v141
    v_cvt_pk_bf16_f32 v141, v142, v143
    s_mov_b64 exec, s[56:57]
    ds_write_b64 v7, v[124:125] offset:0
    ds_write_b64 v7, v[128:129] offset:384
    ds_write_b64 v7, v[132:133] offset:768
    ds_write_b64 v7, v[136:137] offset:1152
    ds_write_b64 v7, v[140:141] offset:1536
    s_mov_b64 exec, -1
    ds_read_b128 v[236:239], v12 offset:0
    ds_read_b128 v[240:243], v12 offset:64
    ds_read_b128 v[244:247], v13 offset:0
    ds_read_b128 v[248:251], v13 offset:64
    s_waitcnt lgkmcnt(0)
    v_cndmask_b32 v240, v9, v240, s[54:55]
    v_cndmask_b32 v248, v9, v248, s[54:55]
    v_cndmask_b32 v241, v9, v241, s[54:55]
    v_cndmask_b32 v249, v9, v249, s[54:55]
    v_cndmask_b32 v242, v9, v242, s[54:55]
    v_cndmask_b32 v250, v9, v250, s[54:55]
    v_cndmask_b32 v243, v9, v243, s[54:55]
    v_cndmask_b32 v251, v9, v251, s[54:55]
    v_mov_b32 v252, v152
    v_mov_b32 v253, v153
    v_mfma_f32_16x16x32_bf16 v[220:223], v[236:239], v[144:147], 0
    s_nop 0
    v_mfma_f32_16x16x32_bf16 v[220:223], v[240:243], v[252:255], v[220:223]
    v_mfma_f32_16x16x32_bf16 v[224:227], v[244:247], v[144:147], 0
    v_mfma_f32_16x16x32_bf16 v[224:227], v[248:251], v[252:255], v[224:227]
    v_mov_b32 v252, v154
    v_mov_b32 v253, v155
    v_mfma_f32_16x16x32_bf16 v[228:231], v[236:239], v[148:151], 0
    s_nop 0
    v_mfma_f32_16x16x32_bf16 v[228:231], v[240:243], v[252:255], v[228:231]
    v_mfma_f32_16x16x32_bf16 v[232:235], v[244:247], v[148:151], 0
    v_mfma_f32_16x16x32_bf16 v[232:235], v[248:251], v[252:255], v[232:235]
    v_cvt_pk_bf16_f32 v11, v220, v221
    v_lshlrev_b32 v220, 16, v11
    v_and_b32 v221, 0xffff0000, v11
    v_cvt_pk_bf16_f32 v11, v222, v223
    v_lshlrev_b32 v222, 16, v11
    v_and_b32 v223, 0xffff0000, v11
    v_cvt_pk_bf16_f32 v11, v224, v225
    v_lshlrev_b32 v224, 16, v11
    v_and_b32 v225, 0xffff0000, v11
    v_cvt_pk_bf16_f32 v11, v226, v226
    v_lshlrev_b32 v226, 16, v11
    v_add_f32 v226, v226, v10
    v_cvt_pk_bf16_f32 v11, v226, v226
    v_lshlrev_b32 v226, 16, v11
    v_rcp_f32 v226, v226
    s_nop 0
    v_mul_f32 v220, v220, v226
    v_mul_f32 v221, v221, v226
    v_mul_f32 v222, v222, v226
    v_mul_f32 v223, v223, v226
    v_mul_f32 v224, v224, v226
    v_mul_f32 v225, v225, v226
    v_cvt_pk_bf16_f32 v196, v220, v221
    v_cvt_pk_bf16_f32 v197, v222, v223
    v_cvt_pk_bf16_f32 v198, v224, v225
    v_cvt_pk_bf16_f32 v11, v228, v229
    v_lshlrev_b32 v228, 16, v11
    v_and_b32 v229, 0xffff0000, v11
    v_cvt_pk_bf16_f32 v11, v230, v231
    v_lshlrev_b32 v230, 16, v11
    v_and_b32 v231, 0xffff0000, v11
    v_cvt_pk_bf16_f32 v11, v232, v233
    v_lshlrev_b32 v232, 16, v11
    v_and_b32 v233, 0xffff0000, v11
    v_cvt_pk_bf16_f32 v11, v234, v234
    v_lshlrev_b32 v234, 16, v11
    v_add_f32 v234, v234, v10
    v_cvt_pk_bf16_f32 v11, v234, v234
    v_lshlrev_b32 v234, 16, v11
    v_rcp_f32 v234, v234
    s_nop 0
    v_mul_f32 v228, v228, v234
    v_mul_f32 v229, v229, v234
    v_mul_f32 v230, v230, v234
    v_mul_f32 v231, v231, v234
    v_mul_f32 v232, v232, v234
    v_mul_f32 v233, v233, v234
    v_cvt_pk_bf16_f32 v208, v228, v229
    v_cvt_pk_bf16_f32 v209, v230, v231
    v_cvt_pk_bf16_f32 v210, v232, v233
    s_waitcnt vmcnt(29)
    v_cvt_pk_bf16_f32 v156, v156, v157
    v_cvt_pk_bf16_f32 v157, v158, v159
    v_cvt_pk_bf16_f32 v160, v160, v161
    v_cvt_pk_bf16_f32 v161, v162, v163
    v_cvt_pk_bf16_f32 v164, v164, v165
    v_cvt_pk_bf16_f32 v165, v166, v167
    v_cvt_pk_bf16_f32 v168, v168, v169
    v_cvt_pk_bf16_f32 v169, v170, v171
    v_cvt_pk_bf16_f32 v172, v172, v173
    v_cvt_pk_bf16_f32 v173, v174, v175
    s_mov_b64 exec, s[56:57]
    ds_write_b64 v7, v[156:157] offset:1920
    ds_write_b64 v7, v[160:161] offset:2304
    ds_write_b64 v7, v[164:165] offset:2688
    ds_write_b64 v7, v[168:169] offset:3072
    ds_write_b64 v7, v[172:173] offset:3456
    s_mov_b64 exec, -1
    ds_read_b128 v[236:239], v12 offset:1920
    ds_read_b128 v[240:243], v12 offset:1984
    ds_read_b128 v[244:247], v13 offset:1920
    ds_read_b128 v[248:251], v13 offset:1984
    s_waitcnt lgkmcnt(0)
    v_cndmask_b32 v240, v9, v240, s[54:55]
    v_cndmask_b32 v248, v9, v248, s[54:55]
    v_cndmask_b32 v241, v9, v241, s[54:55]
    v_cndmask_b32 v249, v9, v249, s[54:55]
    v_cndmask_b32 v242, v9, v242, s[54:55]
    v_cndmask_b32 v250, v9, v250, s[54:55]
    v_cndmask_b32 v243, v9, v243, s[54:55]
    v_cndmask_b32 v251, v9, v251, s[54:55]
    v_mov_b32 v252, v184
    v_mov_b32 v253, v185
    v_mfma_f32_16x16x32_bf16 v[220:223], v[236:239], v[176:179], 0
    s_nop 0
    v_mfma_f32_16x16x32_bf16 v[220:223], v[240:243], v[252:255], v[220:223]
    v_mfma_f32_16x16x32_bf16 v[224:227], v[244:247], v[176:179], 0
    v_mfma_f32_16x16x32_bf16 v[224:227], v[248:251], v[252:255], v[224:227]
    v_mov_b32 v252, v186
    v_mov_b32 v253, v187
    v_mfma_f32_16x16x32_bf16 v[228:231], v[236:239], v[180:183], 0
    s_nop 0
    v_mfma_f32_16x16x32_bf16 v[228:231], v[240:243], v[252:255], v[228:231]
    v_mfma_f32_16x16x32_bf16 v[232:235], v[244:247], v[180:183], 0
    v_mfma_f32_16x16x32_bf16 v[232:235], v[248:251], v[252:255], v[232:235]
    v_cvt_pk_bf16_f32 v11, v220, v221
    v_lshlrev_b32 v220, 16, v11
    v_and_b32 v221, 0xffff0000, v11
    v_cvt_pk_bf16_f32 v11, v222, v223
    v_lshlrev_b32 v222, 16, v11
    v_and_b32 v223, 0xffff0000, v11
    v_cvt_pk_bf16_f32 v11, v224, v225
    v_lshlrev_b32 v224, 16, v11
    v_and_b32 v225, 0xffff0000, v11
    v_cvt_pk_bf16_f32 v11, v226, v226
    v_lshlrev_b32 v226, 16, v11
    v_add_f32 v226, v226, v10
    v_cvt_pk_bf16_f32 v11, v226, v226
    v_lshlrev_b32 v226, 16, v11
    v_rcp_f32 v226, v226
    s_nop 0
    v_mul_f32 v220, v220, v226
    v_mul_f32 v221, v221, v226
    v_mul_f32 v222, v222, v226
    v_mul_f32 v223, v223, v226
    v_mul_f32 v224, v224, v226
    v_mul_f32 v225, v225, v226
    v_cvt_pk_bf16_f32 v199, v220, v221
    v_cvt_pk_bf16_f32 v200, v222, v223
    v_cvt_pk_bf16_f32 v201, v224, v225
    v_cvt_pk_bf16_f32 v11, v228, v229
    v_lshlrev_b32 v228, 16, v11
    v_and_b32 v229, 0xffff0000, v11
    v_cvt_pk_bf16_f32 v11, v230, v231
    v_lshlrev_b32 v230, 16, v11
    v_and_b32 v231, 0xffff0000, v11
    v_cvt_pk_bf16_f32 v11, v232, v233
    v_lshlrev_b32 v232, 16, v11
    v_and_b32 v233, 0xffff0000, v11
    v_cvt_pk_bf16_f32 v11, v234, v234
    v_lshlrev_b32 v234, 16, v11
    v_add_f32 v234, v234, v10
    v_cvt_pk_bf16_f32 v11, v234, v234
    v_lshlrev_b32 v234, 16, v11
    v_rcp_f32 v234, v234
    s_nop 0
    v_mul_f32 v228, v228, v234
    v_mul_f32 v229, v229, v234
    v_mul_f32 v230, v230, v234
    v_mul_f32 v231, v231, v234
    v_mul_f32 v232, v232, v234
    v_mul_f32 v233, v233, v234
    v_cvt_pk_bf16_f32 v211, v228, v229
    v_cvt_pk_bf16_f32 v212, v230, v231
    v_cvt_pk_bf16_f32 v213, v232, v233
    s_waitcnt vmcnt(20)
    v_cvt_pk_bf16_f32 v60, v60, v61
    v_cvt_pk_bf16_f32 v61, v62, v63
    v_cvt_pk_bf16_f32 v64, v64, v65
    v_cvt_pk_bf16_f32 v65, v66, v67
    v_cvt_pk_bf16_f32 v68, v68, v69
    v_cvt_pk_bf16_f32 v69, v70, v71
    v_cvt_pk_bf16_f32 v72, v72, v73
    v_cvt_pk_bf16_f32 v73, v74, v75
    v_cvt_pk_bf16_f32 v76, v76, v77
    v_cvt_pk_bf16_f32 v77, v78, v79
    s_mov_b64 exec, s[56:57]
    ds_write_b64 v7, v[60:61] offset:0
    ds_write_b64 v7, v[64:65] offset:384
    ds_write_b64 v7, v[68:69] offset:768
    ds_write_b64 v7, v[72:73] offset:1152
    ds_write_b64 v7, v[76:77] offset:1536
    s_mov_b64 exec, -1
    ds_read_b128 v[236:239], v12 offset:0
    ds_read_b128 v[240:243], v12 offset:64
    ds_read_b128 v[244:247], v13 offset:0
    ds_read_b128 v[248:251], v13 offset:64
    s_waitcnt lgkmcnt(0)
    v_cndmask_b32 v240, v9, v240, s[54:55]
    v_cndmask_b32 v248, v9, v248, s[54:55]
    v_cndmask_b32 v241, v9, v241, s[54:55]
    v_cndmask_b32 v249, v9, v249, s[54:55]
    v_cndmask_b32 v242, v9, v242, s[54:55]
    v_cndmask_b32 v250, v9, v250, s[54:55]
    v_cndmask_b32 v243, v9, v243, s[54:55]
    v_cndmask_b32 v251, v9, v251, s[54:55]
    v_mov_b32 v252, v88
    v_mov_b32 v253, v89
    v_mfma_f32_16x16x32_bf16 v[220:223], v[236:239], v[80:83], 0
    s_nop 0
    v_mfma_f32_16x16x32_bf16 v[220:223], v[240:243], v[252:255], v[220:223]
    v_mfma_f32_16x16x32_bf16 v[224:227], v[244:247], v[80:83], 0
    v_mfma_f32_16x16x32_bf16 v[224:227], v[248:251], v[252:255], v[224:227]
    v_mov_b32 v252, v90
    v_mov_b32 v253, v91
    v_mfma_f32_16x16x32_bf16 v[228:231], v[236:239], v[84:87], 0
    s_nop 0
    v_mfma_f32_16x16x32_bf16 v[228:231], v[240:243], v[252:255], v[228:231]
    v_mfma_f32_16x16x32_bf16 v[232:235], v[244:247], v[84:87], 0
    v_mfma_f32_16x16x32_bf16 v[232:235], v[248:251], v[252:255], v[232:235]
    s_add_u32 s40, s39, 11264
    buffer_load_dwordx4 v[60:63], v5, s[8:11], s40 offen
    s_add_u32 s40, s39, 12288
    buffer_load_dwordx4 v[64:67], v5, s[8:11], s40 offen
    s_add_u32 s40, s39, 13312
    buffer_load_dwordx4 v[68:71], v5, s[8:11], s40 offen
    s_add_u32 s40, s39, 14336
    buffer_load_dwordx4 v[72:75], v5, s[8:11], s40 offen
    s_add_u32 s40, s39, 15360
    buffer_load_dwordx4 v[76:79], v5, s[8:11], s40 offen
    s_add_u32 s40, s39, 16384
    buffer_load_dwordx4 v[80:83], v5, s[8:11], s40 offen
    s_add_u32 s40, s39, 17408
    buffer_load_dwordx4 v[84:87], v5, s[8:11], s40 offen
    s_add_u32 s40, s39, 18432
    buffer_load_dwordx4 v[88:91], v5, s[8:11], s40 offen
    v_cvt_pk_bf16_f32 v11, v220, v221
    v_lshlrev_b32 v220, 16, v11
    v_and_b32 v221, 0xffff0000, v11
    v_cvt_pk_bf16_f32 v11, v222, v223
    v_lshlrev_b32 v222, 16, v11
    v_and_b32 v223, 0xffff0000, v11
    v_cvt_pk_bf16_f32 v11, v224, v225
    v_lshlrev_b32 v224, 16, v11
    v_and_b32 v225, 0xffff0000, v11
    v_cvt_pk_bf16_f32 v11, v226, v226
    v_lshlrev_b32 v226, 16, v11
    v_add_f32 v226, v226, v10
    v_cvt_pk_bf16_f32 v11, v226, v226
    v_lshlrev_b32 v226, 16, v11
    v_rcp_f32 v226, v226
    s_nop 0
    v_mul_f32 v220, v220, v226
    v_mul_f32 v221, v221, v226
    v_mul_f32 v222, v222, v226
    v_mul_f32 v223, v223, v226
    v_mul_f32 v224, v224, v226
    v_mul_f32 v225, v225, v226
    v_cvt_pk_bf16_f32 v202, v220, v221
    v_cvt_pk_bf16_f32 v203, v222, v223
    v_cvt_pk_bf16_f32 v204, v224, v225
    v_cvt_pk_bf16_f32 v11, v228, v229
    v_lshlrev_b32 v228, 16, v11
    v_and_b32 v229, 0xffff0000, v11
    v_cvt_pk_bf16_f32 v11, v230, v231
    v_lshlrev_b32 v230, 16, v11
    v_and_b32 v231, 0xffff0000, v11
    v_cvt_pk_bf16_f32 v11, v232, v233
    v_lshlrev_b32 v232, 16, v11
    v_and_b32 v233, 0xffff0000, v11
    v_cvt_pk_bf16_f32 v11, v234, v234
    v_lshlrev_b32 v234, 16, v11
    v_add_f32 v234, v234, v10
    v_cvt_pk_bf16_f32 v11, v234, v234
    v_lshlrev_b32 v234, 16, v11
    v_rcp_f32 v234, v234
    s_nop 0
    v_mul_f32 v228, v228, v234
    v_mul_f32 v229, v229, v234
    v_mul_f32 v230, v230, v234
    v_mul_f32 v231, v231, v234
    v_mul_f32 v232, v232, v234
    v_mul_f32 v233, v233, v234
    v_cvt_pk_bf16_f32 v214, v228, v229
    v_cvt_pk_bf16_f32 v215, v230, v231
    v_cvt_pk_bf16_f32 v216, v232, v233
    s_waitcnt vmcnt(19)
    v_cvt_pk_bf16_f32 v92, v92, v93
    v_cvt_pk_bf16_f32 v93, v94, v95
    v_cvt_pk_bf16_f32 v96, v96, v97
    v_cvt_pk_bf16_f32 v97, v98, v99
    v_cvt_pk_bf16_f32 v100, v100, v101
    v_cvt_pk_bf16_f32 v101, v102, v103
    v_cvt_pk_bf16_f32 v104, v104, v105
    v_cvt_pk_bf16_f32 v105, v106, v107
    v_cvt_pk_bf16_f32 v108, v108, v109
    v_cvt_pk_bf16_f32 v109, v110, v111
    s_mov_b64 exec, s[56:57]
    ds_write_b64 v7, v[92:93] offset:1920
    ds_write_b64 v7, v[96:97] offset:2304
    ds_write_b64 v7, v[100:101] offset:2688
    ds_write_b64 v7, v[104:105] offset:3072
    ds_write_b64 v7, v[108:109] offset:3456
    s_mov_b64 exec, -1
    ds_read_b128 v[236:239], v12 offset:1920
    ds_read_b128 v[240:243], v12 offset:1984
    ds_read_b128 v[244:247], v13 offset:1920
    ds_read_b128 v[248:251], v13 offset:1984
    s_waitcnt lgkmcnt(0)
    v_cndmask_b32 v240, v9, v240, s[54:55]
    v_cndmask_b32 v248, v9, v248, s[54:55]
    v_cndmask_b32 v241, v9, v241, s[54:55]
    v_cndmask_b32 v249, v9, v249, s[54:55]
    v_cndmask_b32 v242, v9, v242, s[54:55]
    v_cndmask_b32 v250, v9, v250, s[54:55]
    v_cndmask_b32 v243, v9, v243, s[54:55]
    v_cndmask_b32 v251, v9, v251, s[54:55]
    v_mov_b32 v252, v120
    v_mov_b32 v253, v121
    v_mfma_f32_16x16x32_bf16 v[220:223], v[236:239], v[112:115], 0
    s_nop 0
    v_mfma_f32_16x16x32_bf16 v[220:223], v[240:243], v[252:255], v[220:223]
    v_mfma_f32_16x16x32_bf16 v[224:227], v[244:247], v[112:115], 0
    v_mfma_f32_16x16x32_bf16 v[224:227], v[248:251], v[252:255], v[224:227]
    v_mov_b32 v252, v122
    v_mov_b32 v253, v123
    v_mfma_f32_16x16x32_bf16 v[228:231], v[236:239], v[116:119], 0
    s_nop 0
    v_mfma_f32_16x16x32_bf16 v[228:231], v[240:243], v[252:255], v[228:231]
    v_mfma_f32_16x16x32_bf16 v[232:235], v[244:247], v[116:119], 0
    v_mfma_f32_16x16x32_bf16 v[232:235], v[248:251], v[252:255], v[232:235]
    s_add_u32 s40, s39, 19456
    buffer_load_dwordx4 v[92:95], v5, s[8:11], s40 offen
    s_add_u32 s40, s39, 20480
    buffer_load_dwordx4 v[96:99], v5, s[8:11], s40 offen
    s_add_u32 s40, s39, 21504
    buffer_load_dwordx4 v[100:103], v5, s[8:11], s40 offen
    s_add_u32 s40, s39, 22528
    buffer_load_dwordx4 v[104:107], v5, s[8:11], s40 offen
    s_add_u32 s40, s39, 23552
    buffer_load_dwordx4 v[108:111], v5, s[8:11], s40 offen
    s_add_u32 s40, s39, 24576
    buffer_load_dwordx4 v[112:115], v5, s[8:11], s40 offen
    s_add_u32 s40, s39, 25600
    buffer_load_dwordx4 v[116:119], v5, s[8:11], s40 offen
    s_add_u32 s40, s39, 26624
    buffer_load_dwordx4 v[120:123], v5, s[8:11], s40 offen
    v_cvt_pk_bf16_f32 v11, v220, v221
    v_lshlrev_b32 v220, 16, v11
    v_and_b32 v221, 0xffff0000, v11
    v_cvt_pk_bf16_f32 v11, v222, v223
    v_lshlrev_b32 v222, 16, v11
    v_and_b32 v223, 0xffff0000, v11
    v_cvt_pk_bf16_f32 v11, v224, v225
    v_lshlrev_b32 v224, 16, v11
    v_and_b32 v225, 0xffff0000, v11
    v_cvt_pk_bf16_f32 v11, v226, v226
    v_lshlrev_b32 v226, 16, v11
    v_add_f32 v226, v226, v10
    v_cvt_pk_bf16_f32 v11, v226, v226
    v_lshlrev_b32 v226, 16, v11
    v_rcp_f32 v226, v226
    s_nop 0
    v_mul_f32 v220, v220, v226
    v_mul_f32 v221, v221, v226
    v_mul_f32 v222, v222, v226
    v_mul_f32 v223, v223, v226
    v_mul_f32 v224, v224, v226
    v_mul_f32 v225, v225, v226
    v_cvt_pk_bf16_f32 v205, v220, v221
    v_cvt_pk_bf16_f32 v206, v222, v223
    v_cvt_pk_bf16_f32 v207, v224, v225
    v_cvt_pk_bf16_f32 v11, v228, v229
    v_lshlrev_b32 v228, 16, v11
    v_and_b32 v229, 0xffff0000, v11
    v_cvt_pk_bf16_f32 v11, v230, v231
    v_lshlrev_b32 v230, 16, v11
    v_and_b32 v231, 0xffff0000, v11
    v_cvt_pk_bf16_f32 v11, v232, v233
    v_lshlrev_b32 v232, 16, v11
    v_and_b32 v233, 0xffff0000, v11
    v_cvt_pk_bf16_f32 v11, v234, v234
    v_lshlrev_b32 v234, 16, v11
    v_add_f32 v234, v234, v10
    v_cvt_pk_bf16_f32 v11, v234, v234
    v_lshlrev_b32 v234, 16, v11
    v_rcp_f32 v234, v234
    s_nop 0
    v_mul_f32 v228, v228, v234
    v_mul_f32 v229, v229, v234
    v_mul_f32 v230, v230, v234
    v_mul_f32 v231, v231, v234
    v_mul_f32 v232, v232, v234
    v_mul_f32 v233, v233, v234
    v_cvt_pk_bf16_f32 v217, v228, v229
    v_cvt_pk_bf16_f32 v218, v230, v231
    v_cvt_pk_bf16_f32 v219, v232, v233
    s_barrier
    s_waitcnt vmcnt(26)
    v_mfma_f32_16x16x32_bf16 v[124:127], v[16:19], v[196:199], 0
    v_mfma_f32_16x16x32_bf16 v[160:163], v[16:19], v[208:211], 0
    s_waitcnt vmcnt(25)
    v_mfma_f32_16x16x32_bf16 v[128:131], v[20:23], v[196:199], 0
    v_mfma_f32_16x16x32_bf16 v[164:167], v[20:23], v[208:211], 0
    s_waitcnt vmcnt(24)
    v_mfma_f32_16x16x32_bf16 v[132:135], v[24:27], v[196:199], 0
    v_mfma_f32_16x16x32_bf16 v[168:171], v[24:27], v[208:211], 0
    s_waitcnt vmcnt(23)
    v_mfma_f32_16x16x32_bf16 v[136:139], v[28:31], v[196:199], 0
    v_mfma_f32_16x16x32_bf16 v[172:175], v[28:31], v[208:211], 0
    s_waitcnt vmcnt(22)
    v_mfma_f32_16x16x32_bf16 v[140:143], v[32:35], v[196:199], 0
    v_mfma_f32_16x16x32_bf16 v[176:179], v[32:35], v[208:211], 0
    s_waitcnt vmcnt(21)
    v_mfma_f32_16x16x32_bf16 v[144:147], v[36:39], v[196:199], 0
    v_mfma_f32_16x16x32_bf16 v[180:183], v[36:39], v[208:211], 0
    s_waitcnt vmcnt(20)
    v_mfma_f32_16x16x32_bf16 v[148:151], v[40:43], v[196:199], 0
    v_mfma_f32_16x16x32_bf16 v[184:187], v[40:43], v[208:211], 0
    s_waitcnt vmcnt(19)
    v_mfma_f32_16x16x32_bf16 v[152:155], v[44:47], v[196:199], 0
    v_mfma_f32_16x16x32_bf16 v[188:191], v[44:47], v[208:211], 0
    s_waitcnt vmcnt(18)
    v_mfma_f32_16x16x32_bf16 v[156:159], v[48:51], v[196:199], 0
    v_mfma_f32_16x16x32_bf16 v[192:195], v[48:51], v[208:211], 0
    s_waitcnt vmcnt(17)
    v_mfma_f32_16x16x32_bf16 v[124:127], v[52:55], v[200:203], v[124:127]
    v_mfma_f32_16x16x32_bf16 v[160:163], v[52:55], v[212:215], v[160:163]
    s_waitcnt vmcnt(16)
    v_mfma_f32_16x16x32_bf16 v[128:131], v[56:59], v[200:203], v[128:131]
    v_mfma_f32_16x16x32_bf16 v[164:167], v[56:59], v[212:215], v[164:167]
    s_waitcnt vmcnt(15)
    v_mfma_f32_16x16x32_bf16 v[132:135], v[60:63], v[200:203], v[132:135]
    v_mfma_f32_16x16x32_bf16 v[168:171], v[60:63], v[212:215], v[168:171]
    s_waitcnt vmcnt(14)
    v_mfma_f32_16x16x32_bf16 v[136:139], v[64:67], v[200:203], v[136:139]
    v_mfma_f32_16x16x32_bf16 v[172:175], v[64:67], v[212:215], v[172:175]
    s_waitcnt vmcnt(13)
    v_mfma_f32_16x16x32_bf16 v[140:143], v[68:71], v[200:203], v[140:143]
    v_mfma_f32_16x16x32_bf16 v[176:179], v[68:71], v[212:215], v[176:179]
    s_waitcnt vmcnt(12)
    v_mfma_f32_16x16x32_bf16 v[144:147], v[72:75], v[200:203], v[144:147]
    v_mfma_f32_16x16x32_bf16 v[180:183], v[72:75], v[212:215], v[180:183]
    s_waitcnt vmcnt(11)
    v_mfma_f32_16x16x32_bf16 v[148:151], v[76:79], v[200:203], v[148:151]
    v_mfma_f32_16x16x32_bf16 v[184:187], v[76:79], v[212:215], v[184:187]
    s_waitcnt vmcnt(10)
    v_mfma_f32_16x16x32_bf16 v[152:155], v[80:83], v[200:203], v[152:155]
    v_mfma_f32_16x16x32_bf16 v[188:191], v[80:83], v[212:215], v[188:191]
    s_waitcnt vmcnt(9)
    v_mfma_f32_16x16x32_bf16 v[156:159], v[84:87], v[200:203], v[156:159]
    v_mfma_f32_16x16x32_bf16 v[192:195], v[84:87], v[212:215], v[192:195]
    s_waitcnt vmcnt(8)
    v_mfma_f32_16x16x32_bf16 v[124:127], v[88:91], v[204:207], v[124:127]
    v_mfma_f32_16x16x32_bf16 v[160:163], v[88:91], v[216:219], v[160:163]
    s_waitcnt vmcnt(7)
    v_mfma_f32_16x16x32_bf16 v[128:131], v[92:95], v[204:207], v[128:131]
    v_mfma_f32_16x16x32_bf16 v[164:167], v[92:95], v[216:219], v[164:167]
    s_waitcnt vmcnt(6)
    v_mfma_f32_16x16x32_bf16 v[132:135], v[96:99], v[204:207], v[132:135]
    v_mfma_f32_16x16x32_bf16 v[168:171], v[96:99], v[216:219], v[168:171]
    s_waitcnt vmcnt(5)
    v_mfma_f32_16x16x32_bf16 v[136:139], v[100:103], v[204:207], v[136:139]
    v_mfma_f32_16x16x32_bf16 v[172:175], v[100:103], v[216:219], v[172:175]
    s_waitcnt vmcnt(4)
    v_mfma_f32_16x16x32_bf16 v[140:143], v[104:107], v[204:207], v[140:143]
    v_mfma_f32_16x16x32_bf16 v[176:179], v[104:107], v[216:219], v[176:179]
    s_waitcnt vmcnt(3)
    v_mfma_f32_16x16x32_bf16 v[144:147], v[108:111], v[204:207], v[144:147]
    v_mfma_f32_16x16x32_bf16 v[180:183], v[108:111], v[216:219], v[180:183]
    s_waitcnt vmcnt(2)
    v_mfma_f32_16x16x32_bf16 v[148:151], v[112:115], v[204:207], v[148:151]
    v_mfma_f32_16x16x32_bf16 v[184:187], v[112:115], v[216:219], v[184:187]
    s_waitcnt vmcnt(1)
    v_mfma_f32_16x16x32_bf16 v[152:155], v[116:119], v[204:207], v[152:155]
    v_mfma_f32_16x16x32_bf16 v[188:191], v[116:119], v[216:219], v[188:191]
    s_waitcnt vmcnt(0)
    v_mfma_f32_16x16x32_bf16 v[156:159], v[120:123], v[204:207], v[156:159]
    v_mfma_f32_16x16x32_bf16 v[192:195], v[120:123], v[216:219], v[192:195]
    s_mul_i32 s41, s3, 18432
    v_add_u32 v6, s41, v5
    ds_write_b128 v6, v[124:127] offset:0
    ds_write_b128 v6, v[128:131] offset:1024
    ds_write_b128 v6, v[132:135] offset:2048
    ds_write_b128 v6, v[136:139] offset:3072
    ds_write_b128 v6, v[140:143] offset:4096
    ds_write_b128 v6, v[144:147] offset:5120
    ds_write_b128 v6, v[148:151] offset:6144
    ds_write_b128 v6, v[152:155] offset:7168
    ds_write_b128 v6, v[156:159] offset:8192
    ds_write_b128 v6, v[160:163] offset:9216
    ds_write_b128 v6, v[164:167] offset:10240
    ds_write_b128 v6, v[168:171] offset:11264
    ds_write_b128 v6, v[172:175] offset:12288
    ds_write_b128 v6, v[176:179] offset:13312
    ds_write_b128 v6, v[180:183] offset:14336
    ds_write_b128 v6, v[184:187] offset:15360
    ds_write_b128 v6, v[188:191] offset:16384
    ds_write_b128 v6, v[192:195] offset:17408
    s_lshr_b32 s42, s3, 2
    s_and_b32 s43, s3, 3
    s_mul_i32 s44, s42, 9
    s_lshl_b32 s45, s43, 1
    s_add_u32 s44, s44, s45
    s_lshl_b32 s44, s44, 10
    v_add_u32 v7, s44, v5
    s_mul_i32 s46, s42, 9216
    s_add_u32 s46, s46, 8192
    v_add_u32 v8, s46, v5
    s_lshl_b32 s47, s33, 1
    s_add_u32 s47, s47, s42
    s_mul_i32 s48, s32, 18
    s_lshl_b32 s49, s43, 2
    s_add_u32 s49, s49, s48
    v_add_u32 v9, s49, v4
    v_lshrrev_b32 v10, 2, v9
    v_and_b32 v11, 3, v9
    v_lshlrev_b32 v10, 10, v10
    v_lshl_add_u32 v10, v11, 8, v10
    v_lshl_add_u32 v10, v3, 4, v10
    v_lshrrev_b32 v9, 1, v4
    v_add_u32 v9, s48, v9
    v_add_u32 v9, 16, v9
    v_lshrrev_b32 v12, 2, v9
    v_and_b32 v11, 3, v9
    v_lshlrev_b32 v12, 10, v12
    v_lshl_add_u32 v12, v11, 8, v12
    v_lshl_add_u32 v12, v3, 4, v12
    v_and_b32 v11, 1, v4
    v_lshl_add_u32 v12, v11, 3, v12
    s_mul_i32 s50, s47, 18432
    buffer_load_dwordx4 v[16:19], v10, s[12:15], s50 offen
    buffer_load_dwordx2 v[20:21], v12, s[12:15], s50 offen
    s_waitcnt lgkmcnt(0)
    s_barrier
    v_add_u32 v108, 0x10000, v7
    v_add_u32 v109, 0x20000, v7
    v_add_u32 v110, 0x10000, v8
    v_add_u32 v111, 0x20000, v8
    ds_read_b128 v[32:35], v7 offset:0
    ds_read_b128 v[36:39], v7 offset:1024
    ds_read_b128 v[40:43], v7 offset:18432
    ds_read_b128 v[44:47], v7 offset:19456
    ds_read_b128 v[48:51], v7 offset:36864
    ds_read_b128 v[52:55], v7 offset:37888
    ds_read_b128 v[56:59], v7 offset:55296
    ds_read_b128 v[60:63], v7 offset:56320
    ds_read_b128 v[64:67], v108 offset:8192
    ds_read_b128 v[68:71], v108 offset:9216
    ds_read_b128 v[72:75], v108 offset:26624
    ds_read_b128 v[76:79], v108 offset:27648
    ds_read_b128 v[80:83], v108 offset:45056
    ds_read_b128 v[84:87], v108 offset:46080
    ds_read_b128 v[88:91], v108 offset:63488
    ds_read_b128 v[92:95], v108 offset:64512
    s_waitcnt lgkmcnt(0)
    v_add_f32 v24, v32, v40
    v_add_f32 v24, v24, v48
    v_add_f32 v24, v24, v56
    v_add_f32 v24, v24, v64
    v_add_f32 v24, v24, v72
    v_add_f32 v24, v24, v80
    v_add_f32 v24, v24, v88
    v_add_f32 v25, v33, v41
    v_add_f32 v25, v25, v49
    v_add_f32 v25, v25, v57
    v_add_f32 v25, v25, v65
    v_add_f32 v25, v25, v73
    v_add_f32 v25, v25, v81
    v_add_f32 v25, v25, v89
    v_add_f32 v26, v34, v42
    v_add_f32 v26, v26, v50
    v_add_f32 v26, v26, v58
    v_add_f32 v26, v26, v66
    v_add_f32 v26, v26, v74
    v_add_f32 v26, v26, v82
    v_add_f32 v26, v26, v90
    v_add_f32 v27, v35, v43
    v_add_f32 v27, v27, v51
    v_add_f32 v27, v27, v59
    v_add_f32 v27, v27, v67
    v_add_f32 v27, v27, v75
    v_add_f32 v27, v27, v83
    v_add_f32 v27, v27, v91
    v_add_f32 v28, v36, v44
    v_add_f32 v28, v28, v52
    v_add_f32 v28, v28, v60
    v_add_f32 v28, v28, v68
    v_add_f32 v28, v28, v76
    v_add_f32 v28, v28, v84
    v_add_f32 v28, v28, v92
    v_add_f32 v29, v37, v45
    v_add_f32 v29, v29, v53
    v_add_f32 v29, v29, v61
    v_add_f32 v29, v29, v69
    v_add_f32 v29, v29, v77
    v_add_f32 v29, v29, v85
    v_add_f32 v29, v29, v93
    v_add_f32 v30, v38, v46
    v_add_f32 v30, v30, v54
    v_add_f32 v30, v30, v62
    v_add_f32 v30, v30, v70
    v_add_f32 v30, v30, v78
    v_add_f32 v30, v30, v86
    v_add_f32 v30, v30, v94
    v_add_f32 v31, v39, v47
    v_add_f32 v31, v31, v55
    v_add_f32 v31, v31, v63
    v_add_f32 v31, v31, v71
    v_add_f32 v31, v31, v79
    v_add_f32 v31, v31, v87
    v_add_f32 v31, v31, v95
    s_waitcnt vmcnt(0)
    v_cvt_pk_bf16_f32 v11, v24, v25
    v_lshlrev_b32 v24, 16, v11
    v_and_b32 v25, 0xffff0000, v11
    v_cvt_pk_bf16_f32 v11, v26, v27
    v_lshlrev_b32 v26, 16, v11
    v_and_b32 v27, 0xffff0000, v11
    v_cvt_pk_bf16_f32 v11, v28, v29
    v_lshlrev_b32 v28, 16, v11
    v_and_b32 v29, 0xffff0000, v11
    v_cvt_pk_bf16_f32 v11, v30, v31
    v_lshlrev_b32 v30, 16, v11
    v_and_b32 v31, 0xffff0000, v11
    v_lshlrev_b32 v13, 16, v16
    v_and_b32 v14, 0xffff0000, v16
    v_add_f32 v24, v24, v13
    v_add_f32 v25, v25, v14
    v_lshlrev_b32 v13, 16, v17
    v_and_b32 v14, 0xffff0000, v17
    v_add_f32 v26, v26, v13
    v_add_f32 v27, v27, v14
    v_lshlrev_b32 v13, 16, v18
    v_and_b32 v14, 0xffff0000, v18
    v_add_f32 v28, v28, v13
    v_add_f32 v29, v29, v14
    v_lshlrev_b32 v13, 16, v19
    v_and_b32 v14, 0xffff0000, v19
    v_add_f32 v30, v30, v13
    v_add_f32 v31, v31, v14
    v_cvt_pk_bf16_f32 v100, v24, v25
    v_cvt_pk_bf16_f32 v101, v26, v27
    v_cvt_pk_bf16_f32 v102, v28, v29
    v_cvt_pk_bf16_f32 v103, v30, v31
    buffer_store_dwordx4 v[100:103], v10, s[16:19], s50 offen sc1
    v_lshlrev_b32 v24, 16, v100
    v_and_b32 v25, 0xffff0000, v100
    v_lshlrev_b32 v26, 16, v101
    v_and_b32 v27, 0xffff0000, v101
    v_lshlrev_b32 v28, 16, v102
    v_and_b32 v29, 0xffff0000, v102
    v_lshlrev_b32 v30, 16, v103
    v_and_b32 v31, 0xffff0000, v103
    v_lshlrev_b32 v9, 3, v3
    v_mov_b32 v11, 0x7ff00000
    v_cmp_gt_u32 vcc, 16, v1
    s_nop 1
    v_cndmask_b32 v9, v11, v9, vcc
    s_lshl_b32 s51, s47, 11
    s_lshl_b32 s52, s32, 9
    s_add_u32 s51, s51, s52
    s_lshl_b32 s52, s43, 7
    s_add_u32 s51, s51, s52
    s_cmp_eq_u32 s43, 3
    s_cbranch_scc0 .noodd_k2l1_kernel_2
    ds_read_b128 v[32:35], v8 offset:0
    ds_read_b128 v[36:39], v8 offset:18432
    ds_read_b128 v[40:43], v8 offset:36864
    ds_read_b128 v[44:47], v8 offset:55296
    ds_read_b128 v[48:51], v110 offset:8192
    ds_read_b128 v[52:55], v110 offset:26624
    ds_read_b128 v[56:59], v110 offset:45056
    ds_read_b128 v[60:63], v110 offset:63488
    s_waitcnt lgkmcnt(0)
    v_add_f32 v128, v32, v36
    v_add_f32 v128, v128, v40
    v_add_f32 v128, v128, v44
    v_add_f32 v128, v128, v48
    v_add_f32 v128, v128, v52
    v_add_f32 v128, v128, v56
    v_add_f32 v128, v128, v60
    v_add_f32 v129, v33, v37
    v_add_f32 v129, v129, v41
    v_add_f32 v129, v129, v45
    v_add_f32 v129, v129, v49
    v_add_f32 v129, v129, v53
    v_add_f32 v129, v129, v57
    v_add_f32 v129, v129, v61
    v_add_f32 v130, v34, v38
    v_add_f32 v130, v130, v42
    v_add_f32 v130, v130, v46
    v_add_f32 v130, v130, v50
    v_add_f32 v130, v130, v54
    v_add_f32 v130, v130, v58
    v_add_f32 v130, v130, v62
    v_add_f32 v131, v35, v39
    v_add_f32 v131, v131, v43
    v_add_f32 v131, v131, v47
    v_add_f32 v131, v131, v51
    v_add_f32 v131, v131, v55
    v_add_f32 v131, v131, v59
    v_add_f32 v131, v131, v63
    v_cvt_pk_bf16_f32 v11, v128, v129
    v_lshlrev_b32 v128, 16, v11
    v_and_b32 v129, 0xffff0000, v11
    v_cvt_pk_bf16_f32 v11, v130, v131
    v_lshlrev_b32 v130, 16, v11
    v_and_b32 v131, 0xffff0000, v11
    v_lshlrev_b32 v13, 16, v20
    v_and_b32 v14, 0xffff0000, v20
    v_add_f32 v128, v128, v13
    v_add_f32 v129, v129, v14
    v_lshlrev_b32 v13, 16, v21
    v_and_b32 v14, 0xffff0000, v21
    v_add_f32 v130, v130, v13
    v_add_f32 v131, v131, v14
    v_cvt_pk_bf16_f32 v104, v128, v129
    v_cvt_pk_bf16_f32 v105, v130, v131
    buffer_store_dwordx2 v[104:105], v12, s[16:19], s50 offen sc1
    v_lshlrev_b32 v128, 16, v104
    v_and_b32 v129, 0xffff0000, v104
    v_lshlrev_b32 v130, 16, v105
    v_and_b32 v131, 0xffff0000, v105
    v_mov_b32 v106, 0
    v_add_f32 v106, v106, v24
    v_add_f32 v106, v106, v25
    v_add_f32 v106, v106, v26
    v_add_f32 v106, v106, v27
    v_add_f32 v106, v106, v28
    v_add_f32 v106, v106, v29
    v_add_f32 v106, v106, v30
    v_add_f32 v106, v106, v31
    v_add_f32 v106, v106, v128
    v_add_f32 v106, v106, v129
    v_add_f32 v106, v106, v130
    v_add_f32 v106, v106, v131
    v_mov_b32 v11, v106
    s_nop 1
    v_permlane16_swap_b32 v106, v11
    v_add_f32 v106, v106, v11
    v_mov_b32 v11, v106
    s_nop 1
    v_permlane32_swap_b32 v106, v11
    v_add_f32 v106, v106, v11
    v_mul_f32 v106, 0x3caaaaab, v106
    v_mov_b32 v107, 0
    v_sub_f32 v11, v24, v106
    v_fmac_f32 v107, v11, v11
    v_sub_f32 v11, v25, v106
    v_fmac_f32 v107, v11, v11
    v_sub_f32 v11, v26, v106
    v_fmac_f32 v107, v11, v11
    v_sub_f32 v11, v27, v106
    v_fmac_f32 v107, v11, v11
    v_sub_f32 v11, v28, v106
    v_fmac_f32 v107, v11, v11
    v_sub_f32 v11, v29, v106
    v_fmac_f32 v107, v11, v11
    v_sub_f32 v11, v30, v106
    v_fmac_f32 v107, v11, v11
    v_sub_f32 v11, v31, v106
    v_fmac_f32 v107, v11, v11
    v_sub_f32 v11, v128, v106
    v_fmac_f32 v107, v11, v11
    v_sub_f32 v11, v129, v106
    v_fmac_f32 v107, v11, v11
    v_sub_f32 v11, v130, v106
    v_fmac_f32 v107, v11, v11
    v_sub_f32 v11, v131, v106
    v_fmac_f32 v107, v11, v11
    v_mov_b32 v11, v107
    s_nop 1
    v_permlane16_swap_b32 v107, v11
    v_add_f32 v107, v107, v11
    v_mov_b32 v11, v107
    s_nop 1
    v_permlane32_swap_b32 v107, v11
    v_add_f32 v107, v107, v11
    buffer_store_dwordx2 v[106:107], v9, s[20:23], s51 offen sc1
    s_nop 0
    s_branch .join_k2l1_kernel_3
.noodd_k2l1_kernel_2:
    v_mov_b32 v106, 0
    v_add_f32 v106, v106, v24
    v_add_f32 v106, v106, v25
    v_add_f32 v106, v106, v26
    v_add_f32 v106, v106, v27
    v_add_f32 v106, v106, v28
    v_add_f32 v106, v106, v29
    v_add_f32 v106, v106, v30
    v_add_f32 v106, v106, v31
    v_mov_b32 v11, v106
    s_nop 1
    v_permlane16_swap_b32 v106, v11
    v_add_f32 v106, v106, v11
    v_mov_b32 v11, v106
    s_nop 1
    v_permlane32_swap_b32 v106, v11
    v_add_f32 v106, v106, v11
    v_mul_f32 v106, 0x3d000000, v106
    v_mov_b32 v107, 0
    v_sub_f32 v11, v24, v106
    v_fmac_f32 v107, v11, v11
    v_sub_f32 v11, v25, v106
    v_fmac_f32 v107, v11, v11
    v_sub_f32 v11, v26, v106
    v_fmac_f32 v107, v11, v11
    v_sub_f32 v11, v27, v106
    v_fmac_f32 v107, v11, v11
    v_sub_f32 v11, v28, v106
    v_fmac_f32 v107, v11, v11
    v_sub_f32 v11, v29, v106
    v_fmac_f32 v107, v11, v11
    v_sub_f32 v11, v30, v106
    v_fmac_f32 v107, v11, v11
    v_sub_f32 v11, v31, v106
    v_fmac_f32 v107, v11, v11
    v_mov_b32 v11, v107
    s_nop 1
    v_permlane16_swap_b32 v107, v11
    v_add_f32 v107, v107, v11
    v_mov_b32 v11, v107
    s_nop 1
    v_permlane32_swap_b32 v107, v11
    v_add_f32 v107, v107, v11
    buffer_store_dwordx2 v[106:107], v9, s[20:23], s51 offen sc1
    s_nop 0
.join_k2l1_kernel_3:
.End_k2l1_kernel_1:
    s_endpgm
.globl k3l1_kernel
.p2align 8
.type k3l1_kernel,@function
k3l1_kernel:
    s_cmp_ge_u32 s2, 256
    s_cbranch_scc1 .End_k3l1_kernel_1
    s_load_dwordx2 s[4:5], s[0:1], 88
    s_load_dwordx2 s[6:7], s[0:1], 48
    v_and_b32 v1, 63, v0
    v_lshrrev_b32 v2, 6, v0
    s_nop 0
    v_readfirstlane_b32 s3, v2
    v_and_b32 v3, 15, v1
    v_lshrrev_b32 v4, 4, v1
    v_lshlrev_b32 v5, 4, v1
    s_lshr_b32 s34, s2, 3
    s_bfe_u32 s32, s2, 0x20001
    s_lshl_b32 s32, s32, 3
    s_lshr_b32 s35, s34, 2
    s_add_u32 s32, s32, s35
    s_and_b32 s33, s2, 1
    s_lshl_b32 s33, s33, 2
    s_and_b32 s34, s34, 3
    s_add_u32 s33, s33, s34
    s_lshl_b32 s34, s33, 4
    s_lshl_b32 s35, s3, 1
    s_add_u32 s34, s34, s35
    s_waitcnt lgkmcnt(0)
    s_add_u32 s8, s4, 0x800000
    s_addc_u32 s9, s5, 0
    s_and_b32 s9, s9, 0xffff
    s_mov_b32 s10, 0x510000
    s_mov_b32 s11, 0x20000
    s_add_u32 s12, s4, 0x1f80000
    s_addc_u32 s13, s5, 0
    s_and_b32 s13, s13, 0xffff
    s_mov_b32 s14, 0x240000
    s_mov_b32 s15, 0x20000
    s_add_u32 s16, s4, 0x22c0000
    s_addc_u32 s17, s5, 0
    s_and_b32 s17, s17, 0xffff
    s_mov_b32 s18, 0x40000
    s_mov_b32 s19, 0x20000
    s_add_u32 s20, s4, 0x240000
    s_addc_u32 s21, s5, 0
    s_and_b32 s21, s21, 0xffff
    s_mov_b32 s22, 0x4800
    s_mov_b32 s23, 0x20000
    s_mov_b32 s24, s6
    s_mov_b32 s25, s7
    s_and_b32 s25, s25, 0xffff
    s_mov_b32 s26, 0x2400
    s_mov_b32 s27, 0x20000
    s_add_u32 s28, s4, 0x2a00000
    s_addc_u32 s29, s5, 0
    s_and_b32 s29, s29, 0xffff
    s_mov_b32 s30, 0x1200000
    s_mov_b32 s31, 0x20000
    v_add_u32 v2, 0x10000, v5
    v_add_u32 v0, 0x20000, v5
    s_mul_i32 s38, s34, 18432
    s_lshl_b32 s40, s3, 10
    s_mul_i32 s41, s32, 165888
    s_add_u32 s42, s41, s40
    s_min_u32 s44, s40, 1024
    s_add_u32 s39, s38, 0
    buffer_load_dwordx4 v[16:19], v5, s[12:15], s39 offen
    s_add_u32 s39, s38, 18432
    buffer_load_dwordx4 v[20:23], v5, s[12:15], s39 offen
    s_add_u32 m0, s40, 0
    s_add_u32 s45, s42, 0
    buffer_load_dwordx4 v5, s[8:11], s45 offen lds
    s_add_u32 m0, s40, 8192
    s_add_u32 s45, s42, 8192
    buffer_load_dwordx4 v5, s[8:11], s45 offen lds
    s_add_u32 s39, s38, 1024
    buffer_load_dwordx4 v[24:27], v5, s[12:15], s39 offen
    s_add_u32 s39, s38, 19456
    buffer_load_dwordx4 v[28:31], v5, s[12:15], s39 offen
    s_add_u32 m0, s40, 16384
    s_add_u32 s45, s42, 16384
    buffer_load_dwordx4 v5, s[8:11], s45 offen lds
    s_add_u32 m0, s40, 24576
    s_add_u32 s45, s42, 24576
    buffer_load_dwordx4 v5, s[8:11], s45 offen lds
    s_add_u32 s39, s38, 2048
    buffer_load_dwordx4 v[32:35], v5, s[12:15], s39 offen
    s_add_u32 s39, s38, 20480
    buffer_load_dwordx4 v[36:39], v5, s[12:15], s39 offen
    s_add_u32 m0, s40, 32768
    s_add_u32 s45, s42, 32768
    buffer_load_dwordx4 v5, s[8:11], s45 offen lds
    s_add_u32 m0, s40, 40960
    s_add_u32 s45, s42, 40960
    buffer_load_dwordx4 v5, s[8:11], s45 offen lds
    s_waitcnt vmcnt(8)
    s_barrier
    ds_read_b128 v[152:155], v5 offset:0
    ds_read_b128 v[156:159], v5 offset:1024
    ds_read_b128 v[160:163], v5 offset:2048
    ds_read_b128 v[164:167], v5 offset:3072
    ds_read_b128 v[168:171], v5 offset:4096
    ds_read_b128 v[172:175], v5 offset:5120
    ds_read_b128 v[176:179], v5 offset:6144
    ds_read_b128 v[180:183], v5 offset:7168
    ds_read_b128 v[184:187], v5 offset:8192
    s_waitcnt lgkmcnt(8)
    v_mfma_f32_16x16x32_bf16 v[80:83], v[152:155], v[16:19], 0
    v_mfma_f32_16x16x32_bf16 v[116:119], v[152:155], v[20:23], 0
    s_waitcnt lgkmcnt(7)
    v_mfma_f32_16x16x32_bf16 v[84:87], v[156:159], v[16:19], 0
    v_mfma_f32_16x16x32_bf16 v[120:123], v[156:159], v[20:23], 0
    s_waitcnt lgkmcnt(6)
    v_mfma_f32_16x16x32_bf16 v[88:91], v[160:163], v[16:19], 0
    v_mfma_f32_16x16x32_bf16 v[124:127], v[160:163], v[20:23], 0
    s_waitcnt lgkmcnt(5)
    v_mfma_f32_16x16x32_bf16 v[92:95], v[164:167], v[16:19], 0
    v_mfma_f32_16x16x32_bf16 v[128:131], v[164:167], v[20:23], 0
    s_waitcnt lgkmcnt(4)
    v_mfma_f32_16x16x32_bf16 v[96:99], v[168:171], v[16:19], 0
    v_mfma_f32_16x16x32_bf16 v[132:135], v[168:171], v[20:23], 0
    ds_read_b128 v[152:155], v5 offset:9216
    ds_read_b128 v[156:159], v5 offset:10240
    ds_read_b128 v[160:163], v5 offset:11264
    ds_read_b128 v[164:167], v5 offset:12288
    ds_read_b128 v[168:171], v5 offset:13312
    s_waitcnt lgkmcnt(8)
    v_mfma_f32_16x16x32_bf16 v[100:103], v[172:175], v[16:19], 0
    v_mfma_f32_16x16x32_bf16 v[136:139], v[172:175], v[20:23], 0
    s_waitcnt lgkmcnt(7)
    v_mfma_f32_16x16x32_bf16 v[104:107], v[176:179], v[16:19], 0
    v_mfma_f32_16x16x32_bf16 v[140:143], v[176:179], v[20:23], 0
    s_waitcnt lgkmcnt(6)
    v_mfma_f32_16x16x32_bf16 v[108:111], v[180:183], v[16:19], 0
    v_mfma_f32_16x16x32_bf16 v[144:147], v[180:183], v[20:23], 0
    s_waitcnt lgkmcnt(5)
    v_mfma_f32_16x16x32_bf16 v[112:115], v[184:187], v[16:19], 0
    v_mfma_f32_16x16x32_bf16 v[148:151], v[184:187], v[20:23], 0
    s_add_u32 s39, s38, 3072
    buffer_load_dwordx4 v[40:43], v5, s[12:15], s39 offen
    s_add_u32 s39, s38, 21504
    buffer_load_dwordx4 v[44:47], v5, s[12:15], s39 offen
    s_waitcnt vmcnt(8)
    s_waitcnt lgkmcnt(4)
    v_mfma_f32_16x16x32_bf16 v[80:83], v[152:155], v[24:27], v[80:83]
    v_mfma_f32_16x16x32_bf16 v[116:119], v[152:155], v[28:31], v[116:119]
    s_waitcnt lgkmcnt(3)
    v_mfma_f32_16x16x32_bf16 v[84:87], v[156:159], v[24:27], v[84:87]
    v_mfma_f32_16x16x32_bf16 v[120:123], v[156:159], v[28:31], v[120:123]
    s_waitcnt lgkmcnt(2)
    v_mfma_f32_16x16x32_bf16 v[88:91], v[160:163], v[24:27], v[88:91]
    v_mfma_f32_16x16x32_bf16 v[124:127], v[160:163], v[28:31], v[124:127]
    s_waitcnt lgkmcnt(1)
    v_mfma_f32_16x16x32_bf16 v[92:95], v[164:167], v[24:27], v[92:95]
    v_mfma_f32_16x16x32_bf16 v[128:131], v[164:167], v[28:31], v[128:131]
    s_waitcnt lgkmcnt(0)
    v_mfma_f32_16x16x32_bf16 v[96:99], v[168:171], v[24:27], v[96:99]
    v_mfma_f32_16x16x32_bf16 v[132:135], v[168:171], v[28:31], v[132:135]
    s_waitcnt vmcnt(6)
    s_barrier
    s_add_u32 m0, s40, 49152
    s_add_u32 s45, s42, 49152
    buffer_load_dwordx4 v5, s[8:11], s45 offen lds
    s_add_u32 m0, s40, 57344
    s_add_u32 s45, s42, 57344
    buffer_load_dwordx4 v5, s[8:11], s45 offen lds
    ds_read_b128 v[172:175], v5 offset:14336
    ds_read_b128 v[176:179], v5 offset:15360
    ds_read_b128 v[180:183], v5 offset:16384
    ds_read_b128 v[184:187], v5 offset:17408
    ds_read_b128 v[152:155], v5 offset:18432
    ds_read_b128 v[156:159], v5 offset:19456
    ds_read_b128 v[160:163], v5 offset:20480
    ds_read_b128 v[164:167], v5 offset:21504
    ds_read_b128 v[168:171], v5 offset:22528
    s_waitcnt lgkmcnt(8)
    v_mfma_f32_16x16x32_bf16 v[100:103], v[172:175], v[24:27], v[100:103]
    v_mfma_f32_16x16x32_bf16 v[136:139], v[172:175], v[28:31], v[136:139]
    s_waitcnt lgkmcnt(7)
    v_mfma_f32_16x16x32_bf16 v[104:107], v[176:179], v[24:27], v[104:107]
    v_mfma_f32_16x16x32_bf16 v[140:143], v[176:179], v[28:31], v[140:143]
    s_waitcnt lgkmcnt(6)
    v_mfma_f32_16x16x32_bf16 v[108:111], v[180:183], v[24:27], v[108:111]
    v_mfma_f32_16x16x32_bf16 v[144:147], v[180:183], v[28:31], v[144:147]
    s_waitcnt lgkmcnt(5)
    v_mfma_f32_16x16x32_bf16 v[112:115], v[184:187], v[24:27], v[112:115]
    v_mfma_f32_16x16x32_bf16 v[148:151], v[184:187], v[28:31], v[148:151]
    s_add_u32 s39, s38, 4096
    buffer_load_dwordx4 v[16:19], v5, s[12:15], s39 offen
    s_add_u32 s39, s38, 22528
    buffer_load_dwordx4 v[20:23], v5, s[12:15], s39 offen
    s_waitcnt vmcnt(8)
    ds_read_b128 v[172:175], v5 offset:23552
    ds_read_b128 v[176:179], v5 offset:24576
    ds_read_b128 v[180:183], v5 offset:25600
    ds_read_b128 v[184:187], v5 offset:26624
    s_waitcnt lgkmcnt(8)
    v_mfma_f32_16x16x32_bf16 v[80:83], v[152:155], v[32:35], v[80:83]
    v_mfma_f32_16x16x32_bf16 v[116:119], v[152:155], v[36:39], v[116:119]
    s_waitcnt lgkmcnt(7)
    v_mfma_f32_16x16x32_bf16 v[84:87], v[156:159], v[32:35], v[84:87]
    v_mfma_f32_16x16x32_bf16 v[120:123], v[156:159], v[36:39], v[120:123]
    s_waitcnt lgkmcnt(6)
    v_mfma_f32_16x16x32_bf16 v[88:91], v[160:163], v[32:35], v[88:91]
    v_mfma_f32_16x16x32_bf16 v[124:127], v[160:163], v[36:39], v[124:127]
    s_waitcnt lgkmcnt(5)
    v_mfma_f32_16x16x32_bf16 v[92:95], v[164:167], v[32:35], v[92:95]
    v_mfma_f32_16x16x32_bf16 v[128:131], v[164:167], v[36:39], v[128:131]
    s_waitcnt lgkmcnt(4)
    v_mfma_f32_16x16x32_bf16 v[96:99], v[168:171], v[32:35], v[96:99]
    v_mfma_f32_16x16x32_bf16 v[132:135], v[168:171], v[36:39], v[132:135]
    ds_read_b128 v[152:155], v5 offset:27648
    ds_read_b128 v[156:159], v5 offset:28672
    ds_read_b128 v[160:163], v5 offset:29696
    ds_read_b128 v[164:167], v5 offset:30720
    ds_read_b128 v[168:171], v5 offset:31744
    s_waitcnt lgkmcnt(8)
    v_mfma_f32_16x16x32_bf16 v[100:103], v[172:175], v[32:35], v[100:103]
    v_mfma_f32_16x16x32_bf16 v[136:139], v[172:175], v[36:39], v[136:139]
    s_waitcnt lgkmcnt(7)
    v_mfma_f32_16x16x32_bf16 v[104:107], v[176:179], v[32:35], v[104:107]
    v_mfma_f32_16x16x32_bf16 v[140:143], v[176:179], v[36:39], v[140:143]
    s_waitcnt lgkmcnt(6)
    v_mfma_f32_16x16x32_bf16 v[108:111], v[180:183], v[32:35], v[108:111]
    v_mfma_f32_16x16x32_bf16 v[144:147], v[180:183], v[36:39], v[144:147]
    s_waitcnt lgkmcnt(5)
    v_mfma_f32_16x16x32_bf16 v[112:115], v[184:187], v[32:35], v[112:115]
    v_mfma_f32_16x16x32_bf16 v[148:151], v[184:187], v[36:39], v[148:151]
    s_add_u32 s39, s38, 5120
    buffer_load_dwordx4 v[24:27], v5, s[12:15], s39 offen
    s_add_u32 s39, s38, 23552
    buffer_load_dwordx4 v[28:31], v5, s[12:15], s39 offen
    s_waitcnt vmcnt(6)
    s_waitcnt lgkmcnt(4)
    v_mfma_f32_16x16x32_bf16 v[80:83], v[152:155], v[40:43], v[80:83]
    v_mfma_f32_16x16x32_bf16 v[116:119], v[152:155], v[44:47], v[116:119]
    s_waitcnt lgkmcnt(3)
    v_mfma_f32_16x16x32_bf16 v[84:87], v[156:159], v[40:43], v[84:87]
    v_mfma_f32_16x16x32_bf16 v[120:123], v[156:159], v[44:47], v[120:123]
    s_waitcnt lgkmcnt(2)
    v_mfma_f32_16x16x32_bf16 v[88:91], v[160:163], v[40:43], v[88:91]
    v_mfma_f32_16x16x32_bf16 v[124:127], v[160:163], v[44:47], v[124:127]
    s_waitcnt lgkmcnt(1)
    v_mfma_f32_16x16x32_bf16 v[92:95], v[164:167], v[40:43], v[92:95]
    v_mfma_f32_16x16x32_bf16 v[128:131], v[164:167], v[44:47], v[128:131]
    s_waitcnt lgkmcnt(0)
    v_mfma_f32_16x16x32_bf16 v[96:99], v[168:171], v[40:43], v[96:99]
    v_mfma_f32_16x16x32_bf16 v[132:135], v[168:171], v[44:47], v[132:135]
    s_barrier
    s_add_u32 m0, s40, 65536
    s_add_u32 s45, s42, 65536
    buffer_load_dwordx4 v5, s[8:11], s45 offen lds
    s_add_u32 m0, s40, 73728
    s_add_u32 s45, s42, 73728
    buffer_load_dwordx4 v5, s[8:11], s45 offen lds
    ds_read_b128 v[172:175], v5 offset:32768
    ds_read_b128 v[176:179], v5 offset:33792
    ds_read_b128 v[180:183], v5 offset:34816
    ds_read_b128 v[184:187], v5 offset:35840
    ds_read_b128 v[152:155], v5 offset:36864
    ds_read_b128 v[156:159], v5 offset:37888
    ds_read_b128 v[160:163], v5 offset:38912
    ds_read_b128 v[164:167], v5 offset:39936
    ds_read_b128 v[168:171], v5 offset:40960
    s_waitcnt lgkmcnt(8)
    v_mfma_f32_16x16x32_bf16 v[100:103], v[172:175], v[40:43], v[100:103]
    v_mfma_f32_16x16x32_bf16 v[136:139], v[172:175], v[44:47], v[136:139]
    s_waitcnt lgkmcnt(7)
    v_mfma_f32_16x16x32_bf16 v[104:107], v[176:179], v[40:43], v[104:107]
    v_mfma_f32_16x16x32_bf16 v[140:143], v[176:179], v[44:47], v[140:143]
    s_waitcnt lgkmcnt(6)
    v_mfma_f32_16x16x32_bf16 v[108:111], v[180:183], v[40:43], v[108:111]
    v_mfma_f32_16x16x32_bf16 v[144:147], v[180:183], v[44:47], v[144:147]
    s_waitcnt lgkmcnt(5)
    v_mfma_f32_16x16x32_bf16 v[112:115], v[184:187], v[40:43], v[112:115]
    v_mfma_f32_16x16x32_bf16 v[148:151], v[184:187], v[44:47], v[148:151]
    s_add_u32 s39, s38, 6144
    buffer_load_dwordx4 v[32:35], v5, s[12:15], s39 offen
    s_add_u32 s39, s38, 24576
    buffer_load_dwordx4 v[36:39], v5, s[12:15], s39 offen
    s_waitcnt vmcnt(6)
    ds_read_b128 v[172:175], v5 offset:41984
    ds_read_b128 v[176:179], v5 offset:43008
    ds_read_b128 v[180:183], v5 offset:44032
    ds_read_b128 v[184:187], v5 offset:45056
    s_waitcnt lgkmcnt(8)
    v_mfma_f32_16x16x32_bf16 v[80:83], v[152:155], v[16:19], v[80:83]
    v_mfma_f32_16x16x32_bf16 v[116:119], v[152:155], v[20:23], v[116:119]
    s_waitcnt lgkmcnt(7)
    v_mfma_f32_16x16x32_bf16 v[84:87], v[156:159], v[16:19], v[84:87]
    v_mfma_f32_16x16x32_bf16 v[120:123], v[156:159], v[20:23], v[120:123]
    s_waitcnt lgkmcnt(6)
    v_mfma_f32_16x16x32_bf16 v[88:91], v[160:163], v[16:19], v[88:91]
    v_mfma_f32_16x16x32_bf16 v[124:127], v[160:163], v[20:23], v[124:127]
    s_waitcnt lgkmcnt(5)
    v_mfma_f32_16x16x32_bf16 v[92:95], v[164:167], v[16:19], v[92:95]
    v_mfma_f32_16x16x32_bf16 v[128:131], v[164:167], v[20:23], v[128:131]
    s_waitcnt lgkmcnt(4)
    v_mfma_f32_16x16x32_bf16 v[96:99], v[168:171], v[16:19], v[96:99]
    v_mfma_f32_16x16x32_bf16 v[132:135], v[168:171], v[20:23], v[132:135]
    s_waitcnt lgkmcnt(3)
    v_mfma_f32_16x16x32_bf16 v[100:103], v[172:175], v[16:19], v[100:103]
    v_mfma_f32_16x16x32_bf16 v[136:139], v[172:175], v[20:23], v[136:139]
    s_waitcnt lgkmcnt(2)
    v_mfma_f32_16x16x32_bf16 v[104:107], v[176:179], v[16:19], v[104:107]
    v_mfma_f32_16x16x32_bf16 v[140:143], v[176:179], v[20:23], v[140:143]
    s_waitcnt lgkmcnt(1)
    v_mfma_f32_16x16x32_bf16 v[108:111], v[180:183], v[16:19], v[108:111]
    v_mfma_f32_16x16x32_bf16 v[144:147], v[180:183], v[20:23], v[144:147]
    s_waitcnt lgkmcnt(0)
    v_mfma_f32_16x16x32_bf16 v[112:115], v[184:187], v[16:19], v[112:115]
    v_mfma_f32_16x16x32_bf16 v[148:151], v[184:187], v[20:23], v[148:151]
    s_add_u32 s39, s38, 7168
    buffer_load_dwordx4 v[40:43], v5, s[12:15], s39 offen
    s_add_u32 s39, s38, 25600
    buffer_load_dwordx4 v[44:47], v5, s[12:15], s39 offen
    s_barrier
    s_add_u32 m0, s40, 81920
    s_add_u32 s45, s42, 81920
    buffer_load_dwordx4 v5, s[8:11], s45 offen lds
    s_add_u32 m0, s40, 90112
    s_add_u32 s45, s42, 90112
    buffer_load_dwordx4 v5, s[8:11], s45 offen lds
    ds_read_b128 v[152:155], v5 offset:46080
    ds_read_b128 v[156:159], v5 offset:47104
    ds_read_b128 v[160:163], v5 offset:48128
    ds_read_b128 v[164:167], v5 offset:49152
    ds_read_b128 v[168:171], v5 offset:50176
    s_waitcnt vmcnt(8)
    ds_read_b128 v[172:175], v5 offset:51200
    ds_read_b128 v[176:179], v5 offset:52224
    ds_read_b128 v[180:183], v5 offset:53248
    ds_read_b128 v[184:187], v5 offset:54272
    s_waitcnt lgkmcnt(8)
    v_mfma_f32_16x16x32_bf16 v[80:83], v[152:155], v[24:27], v[80:83]
    v_mfma_f32_16x16x32_bf16 v[116:119], v[152:155], v[28:31], v[116:119]
    s_waitcnt lgkmcnt(7)
    v_mfma_f32_16x16x32_bf16 v[84:87], v[156:159], v[24:27], v[84:87]
    v_mfma_f32_16x16x32_bf16 v[120:123], v[156:159], v[28:31], v[120:123]
    s_waitcnt lgkmcnt(6)
    v_mfma_f32_16x16x32_bf16 v[88:91], v[160:163], v[24:27], v[88:91]
    v_mfma_f32_16x16x32_bf16 v[124:127], v[160:163], v[28:31], v[124:127]
    s_waitcnt lgkmcnt(5)
    v_mfma_f32_16x16x32_bf16 v[92:95], v[164:167], v[24:27], v[92:95]
    v_mfma_f32_16x16x32_bf16 v[128:131], v[164:167], v[28:31], v[128:131]
    s_waitcnt lgkmcnt(4)
    v_mfma_f32_16x16x32_bf16 v[96:99], v[168:171], v[24:27], v[96:99]
    v_mfma_f32_16x16x32_bf16 v[132:135], v[168:171], v[28:31], v[132:135]
    ds_read_b128 v[152:155], v5 offset:55296
    ds_read_b128 v[156:159], v5 offset:56320
    ds_read_b128 v[160:163], v5 offset:57344
    ds_read_b128 v[164:167], v5 offset:58368
    ds_read_b128 v[168:171], v5 offset:59392
    s_waitcnt lgkmcnt(8)
    v_mfma_f32_16x16x32_bf16 v[100:103], v[172:175], v[24:27], v[100:103]
    v_mfma_f32_16x16x32_bf16 v[136:139], v[172:175], v[28:31], v[136:139]
    s_waitcnt lgkmcnt(7)
    v_mfma_f32_16x16x32_bf16 v[104:107], v[176:179], v[24:27], v[104:107]
    v_mfma_f32_16x16x32_bf16 v[140:143], v[176:179], v[28:31], v[140:143]
    s_waitcnt lgkmcnt(6)
    v_mfma_f32_16x16x32_bf16 v[108:111], v[180:183], v[24:27], v[108:111]
    v_mfma_f32_16x16x32_bf16 v[144:147], v[180:183], v[28:31], v[144:147]
    s_waitcnt lgkmcnt(5)
    v_mfma_f32_16x16x32_bf16 v[112:115], v[184:187], v[24:27], v[112:115]
    v_mfma_f32_16x16x32_bf16 v[148:151], v[184:187], v[28:31], v[148:151]
    s_add_u32 s39, s38, 8192
    buffer_load_dwordx4 v[16:19], v5, s[12:15], s39 offen
    s_add_u32 s39, s38, 26624
    buffer_load_dwordx4 v[20:23], v5, s[12:15], s39 offen
    s_waitcnt vmcnt(6)
    ds_read_b128 v[172:175], v5 offset:60416
    ds_read_b128 v[176:179], v5 offset:61440
    ds_read_b128 v[180:183], v5 offset:62464
    ds_read_b128 v[184:187], v5 offset:63488
    s_waitcnt lgkmcnt(8)
    v_mfma_f32_16x16x32_bf16 v[80:83], v[152:155], v[32:35], v[80:83]
    v_mfma_f32_16x16x32_bf16 v[116:119], v[152:155], v[36:39], v[116:119]
    s_waitcnt lgkmcnt(7)
    v_mfma_f32_16x16x32_bf16 v[84:87], v[156:159], v[32:35], v[84:87]
    v_mfma_f32_16x16x32_bf16 v[120:123], v[156:159], v[36:39], v[120:123]
    s_waitcnt lgkmcnt(6)
    v_mfma_f32_16x16x32_bf16 v[88:91], v[160:163], v[32:35], v[88:91]
    v_mfma_f32_16x16x32_bf16 v[124:127], v[160:163], v[36:39], v[124:127]
    s_waitcnt lgkmcnt(5)
    v_mfma_f32_16x16x32_bf16 v[92:95], v[164:167], v[32:35], v[92:95]
    v_mfma_f32_16x16x32_bf16 v[128:131], v[164:167], v[36:39], v[128:131]
    s_waitcnt lgkmcnt(4)
    v_mfma_f32_16x16x32_bf16 v[96:99], v[168:171], v[32:35], v[96:99]
    v_mfma_f32_16x16x32_bf16 v[132:135], v[168:171], v[36:39], v[132:135]
    s_waitcnt lgkmcnt(3)
    v_mfma_f32_16x16x32_bf16 v[100:103], v[172:175], v[32:35], v[100:103]
    v_mfma_f32_16x16x32_bf16 v[136:139], v[172:175], v[36:39], v[136:139]
    s_waitcnt lgkmcnt(2)
    v_mfma_f32_16x16x32_bf16 v[104:107], v[176:179], v[32:35], v[104:107]
    v_mfma_f32_16x16x32_bf16 v[140:143], v[176:179], v[36:39], v[140:143]
    s_waitcnt lgkmcnt(1)
    v_mfma_f32_16x16x32_bf16 v[108:111], v[180:183], v[32:35], v[108:111]
    v_mfma_f32_16x16x32_bf16 v[144:147], v[180:183], v[36:39], v[144:147]
    s_waitcnt lgkmcnt(0)
    v_mfma_f32_16x16x32_bf16 v[112:115], v[184:187], v[32:35], v[112:115]
    v_mfma_f32_16x16x32_bf16 v[148:151], v[184:187], v[36:39], v[148:151]
    s_add_u32 s39, s38, 9216
    buffer_load_dwordx4 v[24:27], v5, s[12:15], s39 offen
    s_add_u32 s39, s38, 27648
    buffer_load_dwordx4 v[28:31], v5, s[12:15], s39 offen
    s_barrier
    s_add_u32 m0, s40, 98304
    s_add_u32 s45, s42, 98304
    buffer_load_dwordx4 v5, s[8:11], s45 offen lds
    s_add_u32 m0, s40, 106496
    s_add_u32 s45, s42, 106496
    buffer_load_dwordx4 v5, s[8:11], s45 offen lds
    ds_read_b128 v[152:155], v5 offset:64512
    ds_read_b128 v[156:159], v2 offset:0
    ds_read_b128 v[160:163], v2 offset:1024
    ds_read_b128 v[164:167], v2 offset:2048
    ds_read_b128 v[168:171], v2 offset:3072
    s_waitcnt vmcnt(8)
    ds_read_b128 v[172:175], v2 offset:4096
    ds_read_b128 v[176:179], v2 offset:5120
    ds_read_b128 v[180:183], v2 offset:6144
    ds_read_b128 v[184:187], v2 offset:7168
    s_waitcnt lgkmcnt(8)
    v_mfma_f32_16x16x32_bf16 v[80:83], v[152:155], v[40:43], v[80:83]
    v_mfma_f32_16x16x32_bf16 v[116:119], v[152:155], v[44:47], v[116:119]
    s_waitcnt lgkmcnt(7)
    v_mfma_f32_16x16x32_bf16 v[84:87], v[156:159], v[40:43], v[84:87]
    v_mfma_f32_16x16x32_bf16 v[120:123], v[156:159], v[44:47], v[120:123]
    s_waitcnt lgkmcnt(6)
    v_mfma_f32_16x16x32_bf16 v[88:91], v[160:163], v[40:43], v[88:91]
    v_mfma_f32_16x16x32_bf16 v[124:127], v[160:163], v[44:47], v[124:127]
    s_waitcnt lgkmcnt(5)
    v_mfma_f32_16x16x32_bf16 v[92:95], v[164:167], v[40:43], v[92:95]
    v_mfma_f32_16x16x32_bf16 v[128:131], v[164:167], v[44:47], v[128:131]
    s_waitcnt lgkmcnt(4)
    v_mfma_f32_16x16x32_bf16 v[96:99], v[168:171], v[40:43], v[96:99]
    v_mfma_f32_16x16x32_bf16 v[132:135], v[168:171], v[44:47], v[132:135]
    ds_read_b128 v[152:155], v2 offset:8192
    ds_read_b128 v[156:159], v2 offset:9216
    ds_read_b128 v[160:163], v2 offset:10240
    ds_read_b128 v[164:167], v2 offset:11264
    ds_read_b128 v[168:171], v2 offset:12288
    s_waitcnt lgkmcnt(8)
    v_mfma_f32_16x16x32_bf16 v[100:103], v[172:175], v[40:43], v[100:103]
    v_mfma_f32_16x16x32_bf16 v[136:139], v[172:175], v[44:47], v[136:139]
    s_waitcnt lgkmcnt(7)
    v_mfma_f32_16x16x32_bf16 v[104:107], v[176:179], v[40:43], v[104:107]
    v_mfma_f32_16x16x32_bf16 v[140:143], v[176:179], v[44:47], v[140:143]
    s_waitcnt lgkmcnt(6)
    v_mfma_f32_16x16x32_bf16 v[108:111], v[180:183], v[40:43], v[108:111]
    v_mfma_f32_16x16x32_bf16 v[144:147], v[180:183], v[44:47], v[144:147]
    s_waitcnt lgkmcnt(5)
    v_mfma_f32_16x16x32_bf16 v[112:115], v[184:187], v[40:43], v[112:115]
    v_mfma_f32_16x16x32_bf16 v[148:151], v[184:187], v[44:47], v[148:151]
    s_add_u32 s39, s38, 10240
    buffer_load_dwordx4 v[32:35], v5, s[12:15], s39 offen
    s_add_u32 s39, s38, 28672
    buffer_load_dwordx4 v[36:39], v5, s[12:15], s39 offen
    s_waitcnt vmcnt(6)
    s_waitcnt lgkmcnt(4)
    v_mfma_f32_16x16x32_bf16 v[80:83], v[152:155], v[16:19], v[80:83]
    v_mfma_f32_16x16x32_bf16 v[116:119], v[152:155], v[20:23], v[116:119]
    s_waitcnt lgkmcnt(3)
    v_mfma_f32_16x16x32_bf16 v[84:87], v[156:159], v[16:19], v[84:87]
    v_mfma_f32_16x16x32_bf16 v[120:123], v[156:159], v[20:23], v[120:123]
    s_waitcnt lgkmcnt(2)
    v_mfma_f32_16x16x32_bf16 v[88:91], v[160:163], v[16:19], v[88:91]
    v_mfma_f32_16x16x32_bf16 v[124:127], v[160:163], v[20:23], v[124:127]
    s_waitcnt lgkmcnt(1)
    v_mfma_f32_16x16x32_bf16 v[92:95], v[164:167], v[16:19], v[92:95]
    v_mfma_f32_16x16x32_bf16 v[128:131], v[164:167], v[20:23], v[128:131]
    s_waitcnt lgkmcnt(0)
    v_mfma_f32_16x16x32_bf16 v[96:99], v[168:171], v[16:19], v[96:99]
    v_mfma_f32_16x16x32_bf16 v[132:135], v[168:171], v[20:23], v[132:135]
    s_barrier
    s_add_u32 m0, s40, 114688
    s_add_u32 s45, s42, 114688
    buffer_load_dwordx4 v5, s[8:11], s45 offen lds
    s_add_u32 m0, s40, 122880
    s_add_u32 s45, s42, 122880
    buffer_load_dwordx4 v5, s[8:11], s45 offen lds
    ds_read_b128 v[172:175], v2 offset:13312
    ds_read_b128 v[176:179], v2 offset:14336
    ds_read_b128 v[180:183], v2 offset:15360
    ds_read_b128 v[184:187], v2 offset:16384
    ds_read_b128 v[152:155], v2 offset:17408
    ds_read_b128 v[156:159], v2 offset:18432
    ds_read_b128 v[160:163], v2 offset:19456
    ds_read_b128 v[164:167], v2 offset:20480
    ds_read_b128 v[168:171], v2 offset:21504
    s_waitcnt lgkmcnt(8)
    v_mfma_f32_16x16x32_bf16 v[100:103], v[172:175], v[16:19], v[100:103]
    v_mfma_f32_16x16x32_bf16 v[136:139], v[172:175], v[20:23], v[136:139]
    s_waitcnt lgkmcnt(7)
    v_mfma_f32_16x16x32_bf16 v[104:107], v[176:179], v[16:19], v[104:107]
    v_mfma_f32_16x16x32_bf16 v[140:143], v[176:179], v[20:23], v[140:143]
    s_waitcnt lgkmcnt(6)
    v_mfma_f32_16x16x32_bf16 v[108:111], v[180:183], v[16:19], v[108:111]
    v_mfma_f32_16x16x32_bf16 v[144:147], v[180:183], v[20:23], v[144:147]
    s_waitcnt lgkmcnt(5)
    v_mfma_f32_16x16x32_bf16 v[112:115], v[184:187], v[16:19], v[112:115]
    v_mfma_f32_16x16x32_bf16 v[148:151], v[184:187], v[20:23], v[148:151]
    s_add_u32 s39, s38, 11264
    buffer_load_dwordx4 v[40:43], v5, s[12:15], s39 offen
    s_add_u32 s39, s38, 29696
    buffer_load_dwordx4 v[44:47], v5, s[12:15], s39 offen
    s_waitcnt vmcnt(8)
    ds_read_b128 v[172:175], v2 offset:22528
    ds_read_b128 v[176:179], v2 offset:23552
    ds_read_b128 v[180:183], v2 offset:24576
    ds_read_b128 v[184:187], v2 offset:25600
    s_waitcnt lgkmcnt(8)
    v_mfma_f32_16x16x32_bf16 v[80:83], v[152:155], v[24:27], v[80:83]
    v_mfma_f32_16x16x32_bf16 v[116:119], v[152:155], v[28:31], v[116:119]
    s_waitcnt lgkmcnt(7)
    v_mfma_f32_16x16x32_bf16 v[84:87], v[156:159], v[24:27], v[84:87]
    v_mfma_f32_16x16x32_bf16 v[120:123], v[156:159], v[28:31], v[120:123]
    s_waitcnt lgkmcnt(6)
    v_mfma_f32_16x16x32_bf16 v[88:91], v[160:163], v[24:27], v[88:91]
    v_mfma_f32_16x16x32_bf16 v[124:127], v[160:163], v[28:31], v[124:127]
    s_waitcnt lgkmcnt(5)
    v_mfma_f32_16x16x32_bf16 v[92:95], v[164:167], v[24:27], v[92:95]
    v_mfma_f32_16x16x32_bf16 v[128:131], v[164:167], v[28:31], v[128:131]
    s_waitcnt lgkmcnt(4)
    v_mfma_f32_16x16x32_bf16 v[96:99], v[168:171], v[24:27], v[96:99]
    v_mfma_f32_16x16x32_bf16 v[132:135], v[168:171], v[28:31], v[132:135]
    ds_read_b128 v[152:155], v2 offset:26624
    ds_read_b128 v[156:159], v2 offset:27648
    ds_read_b128 v[160:163], v2 offset:28672
    ds_read_b128 v[164:167], v2 offset:29696
    ds_read_b128 v[168:171], v2 offset:30720
    s_waitcnt lgkmcnt(8)
    v_mfma_f32_16x16x32_bf16 v[100:103], v[172:175], v[24:27], v[100:103]
    v_mfma_f32_16x16x32_bf16 v[136:139], v[172:175], v[28:31], v[136:139]
    s_waitcnt lgkmcnt(7)
    v_mfma_f32_16x16x32_bf16 v[104:107], v[176:179], v[24:27], v[104:107]
    v_mfma_f32_16x16x32_bf16 v[140:143], v[176:179], v[28:31], v[140:143]
    s_waitcnt lgkmcnt(6)
    v_mfma_f32_16x16x32_bf16 v[108:111], v[180:183], v[24:27], v[108:111]
    v_mfma_f32_16x16x32_bf16 v[144:147], v[180:183], v[28:31], v[144:147]
    s_waitcnt lgkmcnt(5)
    v_mfma_f32_16x16x32_bf16 v[112:115], v[184:187], v[24:27], v[112:115]
    v_mfma_f32_16x16x32_bf16 v[148:151], v[184:187], v[28:31], v[148:151]
    s_add_u32 s39, s38, 12288
    buffer_load_dwordx4 v[16:19], v5, s[12:15], s39 offen
    s_add_u32 s39, s38, 30720
    buffer_load_dwordx4 v[20:23], v5, s[12:15], s39 offen
    s_waitcnt vmcnt(6)
    s_waitcnt lgkmcnt(4)
    v_mfma_f32_16x16x32_bf16 v[80:83], v[152:155], v[32:35], v[80:83]
    v_mfma_f32_16x16x32_bf16 v[116:119], v[152:155], v[36:39], v[116:119]
    s_waitcnt lgkmcnt(3)
    v_mfma_f32_16x16x32_bf16 v[84:87], v[156:159], v[32:35], v[84:87]
    v_mfma_f32_16x16x32_bf16 v[120:123], v[156:159], v[36:39], v[120:123]
    s_waitcnt lgkmcnt(2)
    v_mfma_f32_16x16x32_bf16 v[88:91], v[160:163], v[32:35], v[88:91]
    v_mfma_f32_16x16x32_bf16 v[124:127], v[160:163], v[36:39], v[124:127]
    s_waitcnt lgkmcnt(1)
    v_mfma_f32_16x16x32_bf16 v[92:95], v[164:167], v[32:35], v[92:95]
    v_mfma_f32_16x16x32_bf16 v[128:131], v[164:167], v[36:39], v[128:131]
    s_waitcnt lgkmcnt(0)
    v_mfma_f32_16x16x32_bf16 v[96:99], v[168:171], v[32:35], v[96:99]
    v_mfma_f32_16x16x32_bf16 v[132:135], v[168:171], v[36:39], v[132:135]
    s_barrier
    s_add_u32 m0, s40, 131072
    s_add_u32 s45, s42, 131072
    buffer_load_dwordx4 v5, s[8:11], s45 offen lds
    s_add_u32 m0, s40, 139264
    s_add_u32 s45, s42, 139264
    buffer_load_dwordx4 v5, s[8:11], s45 offen lds
    ds_read_b128 v[172:175], v2 offset:31744
    ds_read_b128 v[176:179], v2 offset:32768
    ds_read_b128 v[180:183], v2 offset:33792
    ds_read_b128 v[184:187], v2 offset:34816
    ds_read_b128 v[152:155], v2 offset:35840
    ds_read_b128 v[156:159], v2 offset:36864
    ds_read_b128 v[160:163], v2 offset:37888
    ds_read_b128 v[164:167], v2 offset:38912
    ds_read_b128 v[168:171], v2 offset:39936
    s_waitcnt lgkmcnt(8)
    v_mfma_f32_16x16x32_bf16 v[100:103], v[172:175], v[32:35], v[100:103]
    v_mfma_f32_16x16x32_bf16 v[136:139], v[172:175], v[36:39], v[136:139]
    s_waitcnt lgkmcnt(7)
    v_mfma_f32_16x16x32_bf16 v[104:107], v[176:179], v[32:35], v[104:107]
    v_mfma_f32_16x16x32_bf16 v[140:143], v[176:179], v[36:39], v[140:143]
    s_waitcnt lgkmcnt(6)
    v_mfma_f32_16x16x32_bf16 v[108:111], v[180:183], v[32:35], v[108:111]
    v_mfma_f32_16x16x32_bf16 v[144:147], v[180:183], v[36:39], v[144:147]
    s_waitcnt lgkmcnt(5)
    v_mfma_f32_16x16x32_bf16 v[112:115], v[184:187], v[32:35], v[112:115]
    v_mfma_f32_16x16x32_bf16 v[148:151], v[184:187], v[36:39], v[148:151]
    s_add_u32 s39, s38, 13312
    buffer_load_dwordx4 v[24:27], v5, s[12:15], s39 offen
    s_add_u32 s39, s38, 31744
    buffer_load_dwordx4 v[28:31], v5, s[12:15], s39 offen
    s_waitcnt vmcnt(6)
    ds_read_b128 v[172:175], v2 offset:40960
    ds_read_b128 v[176:179], v2 offset:41984
    ds_read_b128 v[180:183], v2 offset:43008
    ds_read_b128 v[184:187], v2 offset:44032
    s_waitcnt lgkmcnt(8)
    v_mfma_f32_16x16x32_bf16 v[80:83], v[152:155], v[40:43], v[80:83]
    v_mfma_f32_16x16x32_bf16 v[116:119], v[152:155], v[44:47], v[116:119]
    s_waitcnt lgkmcnt(7)
    v_mfma_f32_16x16x32_bf16 v[84:87], v[156:159], v[40:43], v[84:87]
    v_mfma_f32_16x16x32_bf16 v[120:123], v[156:159], v[44:47], v[120:123]
    s_waitcnt lgkmcnt(6)
    v_mfma_f32_16x16x32_bf16 v[88:91], v[160:163], v[40:43], v[88:91]
    v_mfma_f32_16x16x32_bf16 v[124:127], v[160:163], v[44:47], v[124:127]
    s_waitcnt lgkmcnt(5)
    v_mfma_f32_16x16x32_bf16 v[92:95], v[164:167], v[40:43], v[92:95]
    v_mfma_f32_16x16x32_bf16 v[128:131], v[164:167], v[44:47], v[128:131]
    s_waitcnt lgkmcnt(4)
    v_mfma_f32_16x16x32_bf16 v[96:99], v[168:171], v[40:43], v[96:99]
    v_mfma_f32_16x16x32_bf16 v[132:135], v[168:171], v[44:47], v[132:135]
    s_waitcnt lgkmcnt(3)
    v_mfma_f32_16x16x32_bf16 v[100:103], v[172:175], v[40:43], v[100:103]
    v_mfma_f32_16x16x32_bf16 v[136:139], v[172:175], v[44:47], v[136:139]
    s_waitcnt lgkmcnt(2)
    v_mfma_f32_16x16x32_bf16 v[104:107], v[176:179], v[40:43], v[104:107]
    v_mfma_f32_16x16x32_bf16 v[140:143], v[176:179], v[44:47], v[140:143]
    s_waitcnt lgkmcnt(1)
    v_mfma_f32_16x16x32_bf16 v[108:111], v[180:183], v[40:43], v[108:111]
    v_mfma_f32_16x16x32_bf16 v[144:147], v[180:183], v[44:47], v[144:147]
    s_waitcnt lgkmcnt(0)
    v_mfma_f32_16x16x32_bf16 v[112:115], v[184:187], v[40:43], v[112:115]
    v_mfma_f32_16x16x32_bf16 v[148:151], v[184:187], v[44:47], v[148:151]
    s_add_u32 s39, s38, 14336
    buffer_load_dwordx4 v[32:35], v5, s[12:15], s39 offen
    s_add_u32 s39, s38, 32768
    buffer_load_dwordx4 v[36:39], v5, s[12:15], s39 offen
    s_barrier
    s_add_u32 m0, s40, 147456
    s_add_u32 s45, s42, 147456
    buffer_load_dwordx4 v5, s[8:11], s45 offen lds
    s_add_u32 m0, s40, 155648
    s_add_u32 s45, s42, 155648
    buffer_load_dwordx4 v5, s[8:11], s45 offen lds
    s_mov_b32 m0, s44
    s_add_u32 s45, s41, s44
    s_add_u32 s45, s45, 163840
    buffer_load_dwordx4 v5, s[8:11], s45 offen lds
    ds_read_b128 v[152:155], v2 offset:45056
    ds_read_b128 v[156:159], v2 offset:46080
    ds_read_b128 v[160:163], v2 offset:47104
    ds_read_b128 v[164:167], v2 offset:48128
    ds_read_b128 v[168:171], v2 offset:49152
    s_waitcnt vmcnt(9)
    ds_read_b128 v[172:175], v2 offset:50176
    ds_read_b128 v[176:179], v2 offset:51200
    ds_read_b128 v[180:183], v2 offset:52224
    ds_read_b128 v[184:187], v2 offset:53248
    s_waitcnt lgkmcnt(8)
    v_mfma_f32_16x16x32_bf16 v[80:83], v[152:155], v[16:19], v[80:83]
    v_mfma_f32_16x16x32_bf16 v[116:119], v[152:155], v[20:23], v[116:119]
    s_waitcnt lgkmcnt(7)
    v_mfma_f32_16x16x32_bf16 v[84:87], v[156:159], v[16:19], v[84:87]
    v_mfma_f32_16x16x32_bf16 v[120:123], v[156:159], v[20:23], v[120:123]
    s_waitcnt lgkmcnt(6)
    v_mfma_f32_16x16x32_bf16 v[88:91], v[160:163], v[16:19], v[88:91]
    v_mfma_f32_16x16x32_bf16 v[124:127], v[160:163], v[20:23], v[124:127]
    s_waitcnt lgkmcnt(5)
    v_mfma_f32_16x16x32_bf16 v[92:95], v[164:167], v[16:19], v[92:95]
    v_mfma_f32_16x16x32_bf16 v[128:131], v[164:167], v[20:23], v[128:131]
    s_waitcnt lgkmcnt(4)
    v_mfma_f32_16x16x32_bf16 v[96:99], v[168:171], v[16:19], v[96:99]
    v_mfma_f32_16x16x32_bf16 v[132:135], v[168:171], v[20:23], v[132:135]
    ds_read_b128 v[152:155], v2 offset:54272
    ds_read_b128 v[156:159], v2 offset:55296
    ds_read_b128 v[160:163], v2 offset:56320
    ds_read_b128 v[164:167], v2 offset:57344
    ds_read_b128 v[168:171], v2 offset:58368
    s_waitcnt lgkmcnt(8)
    v_mfma_f32_16x16x32_bf16 v[100:103], v[172:175], v[16:19], v[100:103]
    v_mfma_f32_16x16x32_bf16 v[136:139], v[172:175], v[20:23], v[136:139]
    s_waitcnt lgkmcnt(7)
    v_mfma_f32_16x16x32_bf16 v[104:107], v[176:179], v[16:19], v[104:107]
    v_mfma_f32_16x16x32_bf16 v[140:143], v[176:179], v[20:23], v[140:143]
    s_waitcnt lgkmcnt(6)
    v_mfma_f32_16x16x32_bf16 v[108:111], v[180:183], v[16:19], v[108:111]
    v_mfma_f32_16x16x32_bf16 v[144:147], v[180:183], v[20:23], v[144:147]
    s_waitcnt lgkmcnt(5)
    v_mfma_f32_16x16x32_bf16 v[112:115], v[184:187], v[16:19], v[112:115]
    v_mfma_f32_16x16x32_bf16 v[148:151], v[184:187], v[20:23], v[148:151]
    s_add_u32 s39, s38, 15360
    buffer_load_dwordx4 v[40:43], v5, s[12:15], s39 offen
    s_add_u32 s39, s38, 33792
    buffer_load_dwordx4 v[44:47], v5, s[12:15], s39 offen
    s_waitcnt vmcnt(7)
    ds_read_b128 v[172:175], v2 offset:59392
    ds_read_b128 v[176:179], v2 offset:60416
    ds_read_b128 v[180:183], v2 offset:61440
    ds_read_b128 v[184:187], v2 offset:62464
    s_waitcnt lgkmcnt(8)
    v_mfma_f32_16x16x32_bf16 v[80:83], v[152:155], v[24:27], v[80:83]
    v_mfma_f32_16x16x32_bf16 v[116:119], v[152:155], v[28:31], v[116:119]
    s_waitcnt lgkmcnt(7)
    v_mfma_f32_16x16x32_bf16 v[84:87], v[156:159], v[24:27], v[84:87]
    v_mfma_f32_16x16x32_bf16 v[120:123], v[156:159], v[28:31], v[120:123]
    s_waitcnt lgkmcnt(6)
    v_mfma_f32_16x16x32_bf16 v[88:91], v[160:163], v[24:27], v[88:91]
    v_mfma_f32_16x16x32_bf16 v[124:127], v[160:163], v[28:31], v[124:127]
    s_waitcnt lgkmcnt(5)
    v_mfma_f32_16x16x32_bf16 v[92:95], v[164:167], v[24:27], v[92:95]
    v_mfma_f32_16x16x32_bf16 v[128:131], v[164:167], v[28:31], v[128:131]
    s_waitcnt lgkmcnt(4)
    v_mfma_f32_16x16x32_bf16 v[96:99], v[168:171], v[24:27], v[96:99]
    v_mfma_f32_16x16x32_bf16 v[132:135], v[168:171], v[28:31], v[132:135]
    s_waitcnt lgkmcnt(3)
    v_mfma_f32_16x16x32_bf16 v[100:103], v[172:175], v[24:27], v[100:103]
    v_mfma_f32_16x16x32_bf16 v[136:139], v[172:175], v[28:31], v[136:139]
    s_waitcnt lgkmcnt(2)
    v_mfma_f32_16x16x32_bf16 v[104:107], v[176:179], v[24:27], v[104:107]
    v_mfma_f32_16x16x32_bf16 v[140:143], v[176:179], v[28:31], v[140:143]
    s_waitcnt lgkmcnt(1)
    v_mfma_f32_16x16x32_bf16 v[108:111], v[180:183], v[24:27], v[108:111]
    v_mfma_f32_16x16x32_bf16 v[144:147], v[180:183], v[28:31], v[144:147]
    s_waitcnt lgkmcnt(0)
    v_mfma_f32_16x16x32_bf16 v[112:115], v[184:187], v[24:27], v[112:115]
    v_mfma_f32_16x16x32_bf16 v[148:151], v[184:187], v[28:31], v[148:151]
    s_add_u32 s39, s38, 16384
    buffer_load_dwordx4 v[16:19], v5, s[12:15], s39 offen
    s_add_u32 s39, s38, 34816
    buffer_load_dwordx4 v[20:23], v5, s[12:15], s39 offen
    v_lshlrev_b32 v7, 3, v3
    v_lshl_add_u32 v7, v4, 7, v7
    s_lshl_b32 s36, s34, 11
    s_add_u32 s37, s36, 2048
    buffer_load_dwordx2 v[192:193], v7, s[16:19], s36 offen offset:0
    buffer_load_dwordx2 v[194:195], v7, s[16:19], s36 offen offset:512
    buffer_load_dwordx2 v[196:197], v7, s[16:19], s36 offen offset:1024
    buffer_load_dwordx2 v[198:199], v7, s[16:19], s36 offen offset:1536
    buffer_load_dwordx2 v[200:201], v7, s[16:19], s37 offen offset:0
    buffer_load_dwordx2 v[202:203], v7, s[16:19], s37 offen offset:512
    buffer_load_dwordx2 v[204:205], v7, s[16:19], s37 offen offset:1024
    buffer_load_dwordx2 v[206:207], v7, s[16:19], s37 offen offset:1536
    v_lshlrev_b32 v66, 5, v4
    v_lshlrev_b32 v67, 4, v4
    v_lshlrev_b32 v68, 3, v4
    s_mul_i32 s46, s32, 576
    s_mul_i32 s47, s32, 288
    buffer_load_dwordx4 v[208:211], v66, s[20:23], s46 offen offset:0
    buffer_load_dwordx4 v[212:215], v66, s[20:23], s46 offen offset:16
    buffer_load_dwordx4 v[48:51], v67, s[24:27], s47 offen offset:0
    buffer_load_dwordx4 v[216:219], v66, s[20:23], s46 offen offset:128
    buffer_load_dwordx4 v[220:223], v66, s[20:23], s46 offen offset:144
    buffer_load_dwordx4 v[52:55], v67, s[24:27], s47 offen offset:64
    buffer_load_dwordx4 v[224:227], v66, s[20:23], s46 offen offset:256
    buffer_load_dwordx4 v[228:231], v66, s[20:23], s46 offen offset:272
    buffer_load_dwordx4 v[56:59], v67, s[24:27], s47 offen offset:128
    buffer_load_dwordx4 v[232:235], v66, s[20:23], s46 offen offset:384
    buffer_load_dwordx4 v[236:239], v66, s[20:23], s46 offen offset:400
    buffer_load_dwordx4 v[60:63], v67, s[24:27], s47 offen offset:192
    buffer_load_dwordx4 v[240:243], v67, s[20:23], s46 offen offset:512
    buffer_load_dwordx2 v[64:65], v68, s[24:27], s47 offen offset:256
    s_barrier
    ds_read_b128 v[152:155], v2 offset:63488
    ds_read_b128 v[156:159], v2 offset:64512
    ds_read_b128 v[160:163], v0 offset:0
    ds_read_b128 v[164:167], v0 offset:1024
    ds_read_b128 v[168:171], v0 offset:2048
    s_waitcnt vmcnt(29)
    ds_read_b128 v[172:175], v0 offset:3072
    ds_read_b128 v[176:179], v0 offset:4096
    ds_read_b128 v[180:183], v0 offset:5120
    ds_read_b128 v[184:187], v0 offset:6144
    s_waitcnt lgkmcnt(8)
    v_mfma_f32_16x16x32_bf16 v[80:83], v[152:155], v[32:35], v[80:83]
    v_mfma_f32_16x16x32_bf16 v[116:119], v[152:155], v[36:39], v[116:119]
    s_waitcnt lgkmcnt(7)
    v_mfma_f32_16x16x32_bf16 v[84:87], v[156:159], v[32:35], v[84:87]
    v_mfma_f32_16x16x32_bf16 v[120:123], v[156:159], v[36:39], v[120:123]
    s_waitcnt lgkmcnt(6)
    v_mfma_f32_16x16x32_bf16 v[88:91], v[160:163], v[32:35], v[88:91]
    v_mfma_f32_16x16x32_bf16 v[124:127], v[160:163], v[36:39], v[124:127]
    s_waitcnt lgkmcnt(5)
    v_mfma_f32_16x16x32_bf16 v[92:95], v[164:167], v[32:35], v[92:95]
    v_mfma_f32_16x16x32_bf16 v[128:131], v[164:167], v[36:39], v[128:131]
    s_waitcnt lgkmcnt(4)
    v_mfma_f32_16x16x32_bf16 v[96:99], v[168:171], v[32:35], v[96:99]
    v_mfma_f32_16x16x32_bf16 v[132:135], v[168:171], v[36:39], v[132:135]
    ds_read_b128 v[152:155], v0 offset:7168
    ds_read_b128 v[156:159], v0 offset:8192
    ds_read_b128 v[160:163], v0 offset:9216
    ds_read_b128 v[164:167], v0 offset:10240
    ds_read_b128 v[168:171], v0 offset:11264
    s_waitcnt lgkmcnt(8)
    v_mfma_f32_16x16x32_bf16 v[100:103], v[172:175], v[32:35], v[100:103]
    v_mfma_f32_16x16x32_bf16 v[136:139], v[172:175], v[36:39], v[136:139]
    s_waitcnt lgkmcnt(7)
    v_mfma_f32_16x16x32_bf16 v[104:107], v[176:179], v[32:35], v[104:107]
    v_mfma_f32_16x16x32_bf16 v[140:143], v[176:179], v[36:39], v[140:143]
    s_waitcnt lgkmcnt(6)
    v_mfma_f32_16x16x32_bf16 v[108:111], v[180:183], v[32:35], v[108:111]
    v_mfma_f32_16x16x32_bf16 v[144:147], v[180:183], v[36:39], v[144:147]
    s_waitcnt lgkmcnt(5)
    v_mfma_f32_16x16x32_bf16 v[112:115], v[184:187], v[32:35], v[112:115]
    v_mfma_f32_16x16x32_bf16 v[148:151], v[184:187], v[36:39], v[148:151]
    s_add_u32 s39, s38, 17408
    buffer_load_dwordx4 v[24:27], v5, s[12:15], s39 offen
    s_add_u32 s39, s38, 35840
    buffer_load_dwordx4 v[28:31], v5, s[12:15], s39 offen
    s_waitcnt vmcnt(26)
    ds_read_b128 v[172:175], v0 offset:12288
    ds_read_b128 v[176:179], v0 offset:13312
    ds_read_b128 v[180:183], v0 offset:14336
    ds_read_b128 v[184:187], v0 offset:15360
    s_waitcnt lgkmcnt(8)
    v_mfma_f32_16x16x32_bf16 v[80:83], v[152:155], v[40:43], v[80:83]
    v_mfma_f32_16x16x32_bf16 v[116:119], v[152:155], v[44:47], v[116:119]
    s_waitcnt lgkmcnt(7)
    v_mfma_f32_16x16x32_bf16 v[84:87], v[156:159], v[40:43], v[84:87]
    v_mfma_f32_16x16x32_bf16 v[120:123], v[156:159], v[44:47], v[120:123]
    s_waitcnt lgkmcnt(6)
    v_mfma_f32_16x16x32_bf16 v[88:91], v[160:163], v[40:43], v[88:91]
    v_mfma_f32_16x16x32_bf16 v[124:127], v[160:163], v[44:47], v[124:127]
    s_waitcnt lgkmcnt(5)
    v_mfma_f32_16x16x32_bf16 v[92:95], v[164:167], v[40:43], v[92:95]
    v_mfma_f32_16x16x32_bf16 v[128:131], v[164:167], v[44:47], v[128:131]
    s_waitcnt lgkmcnt(4)
    v_mfma_f32_16x16x32_bf16 v[96:99], v[168:171], v[40:43], v[96:99]
    v_mfma_f32_16x16x32_bf16 v[132:135], v[168:171], v[44:47], v[132:135]
    s_waitcnt lgkmcnt(3)
    v_mfma_f32_16x16x32_bf16 v[100:103], v[172:175], v[40:43], v[100:103]
    v_mfma_f32_16x16x32_bf16 v[136:139], v[172:175], v[44:47], v[136:139]
    s_waitcnt lgkmcnt(2)
    v_mfma_f32_16x16x32_bf16 v[104:107], v[176:179], v[40:43], v[104:107]
    v_mfma_f32_16x16x32_bf16 v[140:143], v[176:179], v[44:47], v[140:143]
    s_waitcnt lgkmcnt(1)
    v_mfma_f32_16x16x32_bf16 v[108:111], v[180:183], v[40:43], v[108:111]
    v_mfma_f32_16x16x32_bf16 v[144:147], v[180:183], v[44:47], v[144:147]
    s_waitcnt lgkmcnt(0)
    v_mfma_f32_16x16x32_bf16 v[112:115], v[184:187], v[40:43], v[112:115]
    v_mfma_f32_16x16x32_bf16 v[148:151], v[184:187], v[44:47], v[148:151]
    s_barrier
    ds_read_b128 v[152:155], v0 offset:16384
    ds_read_b128 v[156:159], v0 offset:17408
    ds_read_b128 v[160:163], v0 offset:18432
    ds_read_b128 v[164:167], v0 offset:19456
    ds_read_b128 v[168:171], v0 offset:20480
    s_waitcnt vmcnt(24)
    ds_read_b128 v[172:175], v0 offset:21504
    ds_read_b128 v[176:179], v0 offset:22528
    ds_read_b128 v[180:183], v0 offset:23552
    ds_read_b128 v[184:187], v0 offset:24576
    s_waitcnt lgkmcnt(8)
    v_mfma_f32_16x16x32_bf16 v[80:83], v[152:155], v[16:19], v[80:83]
    v_mfma_f32_16x16x32_bf16 v[116:119], v[152:155], v[20:23], v[116:119]
    s_waitcnt lgkmcnt(7)
    v_mfma_f32_16x16x32_bf16 v[84:87], v[156:159], v[16:19], v[84:87]
    v_mfma_f32_16x16x32_bf16 v[120:123], v[156:159], v[20:23], v[120:123]
    s_waitcnt lgkmcnt(6)
    v_mfma_f32_16x16x32_bf16 v[88:91], v[160:163], v[16:19], v[88:91]
    v_mfma_f32_16x16x32_bf16 v[124:127], v[160:163], v[20:23], v[124:127]
    s_waitcnt lgkmcnt(5)
    v_mfma_f32_16x16x32_bf16 v[92:95], v[164:167], v[16:19], v[92:95]
    v_mfma_f32_16x16x32_bf16 v[128:131], v[164:167], v[20:23], v[128:131]
    s_waitcnt lgkmcnt(4)
    v_mfma_f32_16x16x32_bf16 v[96:99], v[168:171], v[16:19], v[96:99]
    v_mfma_f32_16x16x32_bf16 v[132:135], v[168:171], v[20:23], v[132:135]
    ds_read_b128 v[152:155], v0 offset:25600
    ds_read_b128 v[156:159], v0 offset:26624
    ds_read_b128 v[160:163], v0 offset:27648
    ds_read_b128 v[164:167], v0 offset:28672
    ds_read_b128 v[168:171], v0 offset:29696
    s_waitcnt lgkmcnt(8)
    v_mfma_f32_16x16x32_bf16 v[100:103], v[172:175], v[16:19], v[100:103]
    v_mfma_f32_16x16x32_bf16 v[136:139], v[172:175], v[20:23], v[136:139]
    s_waitcnt lgkmcnt(7)
    v_mfma_f32_16x16x32_bf16 v[104:107], v[176:179], v[16:19], v[104:107]
    v_mfma_f32_16x16x32_bf16 v[140:143], v[176:179], v[20:23], v[140:143]
    s_waitcnt lgkmcnt(6)
    v_mfma_f32_16x16x32_bf16 v[108:111], v[180:183], v[16:19], v[108:111]
    v_mfma_f32_16x16x32_bf16 v[144:147], v[180:183], v[20:23], v[144:147]
    s_waitcnt lgkmcnt(5)
    v_mfma_f32_16x16x32_bf16 v[112:115], v[184:187], v[16:19], v[112:115]
    v_mfma_f32_16x16x32_bf16 v[148:151], v[184:187], v[20:23], v[148:151]
    s_waitcnt vmcnt(0)
    s_waitcnt lgkmcnt(4)
    v_mfma_f32_16x16x32_bf16 v[80:83], v[152:155], v[24:27], v[80:83]
    v_mfma_f32_16x16x32_bf16 v[116:119], v[152:155], v[28:31], v[116:119]
    s_waitcnt lgkmcnt(3)
    v_mfma_f32_16x16x32_bf16 v[84:87], v[156:159], v[24:27], v[84:87]
    v_mfma_f32_16x16x32_bf16 v[120:123], v[156:159], v[28:31], v[120:123]
    s_waitcnt lgkmcnt(2)
    v_mfma_f32_16x16x32_bf16 v[88:91], v[160:163], v[24:27], v[88:91]
    v_mfma_f32_16x16x32_bf16 v[124:127], v[160:163], v[28:31], v[124:127]
    s_waitcnt lgkmcnt(1)
    v_mfma_f32_16x16x32_bf16 v[92:95], v[164:167], v[24:27], v[92:95]
    v_mfma_f32_16x16x32_bf16 v[128:131], v[164:167], v[28:31], v[128:131]
    s_waitcnt lgkmcnt(0)
    v_mfma_f32_16x16x32_bf16 v[96:99], v[168:171], v[24:27], v[96:99]
    v_mfma_f32_16x16x32_bf16 v[132:135], v[168:171], v[28:31], v[132:135]
    s_barrier
    ds_read_b128 v[172:175], v0 offset:30720
    ds_read_b128 v[176:179], v0 offset:31744
    ds_read_b128 v[180:183], v5 offset:0
    ds_read_b128 v[184:187], v5 offset:1024
    s_waitcnt lgkmcnt(3)
    v_mfma_f32_16x16x32_bf16 v[100:103], v[172:175], v[24:27], v[100:103]
    v_mfma_f32_16x16x32_bf16 v[136:139], v[172:175], v[28:31], v[136:139]
    s_waitcnt lgkmcnt(2)
    v_mfma_f32_16x16x32_bf16 v[104:107], v[176:179], v[24:27], v[104:107]
    v_mfma_f32_16x16x32_bf16 v[140:143], v[176:179], v[28:31], v[140:143]
    s_waitcnt lgkmcnt(1)
    v_mfma_f32_16x16x32_bf16 v[108:111], v[180:183], v[24:27], v[108:111]
    v_mfma_f32_16x16x32_bf16 v[144:147], v[180:183], v[28:31], v[144:147]
    s_waitcnt lgkmcnt(0)
    v_mfma_f32_16x16x32_bf16 v[112:115], v[184:187], v[24:27], v[112:115]
    v_mfma_f32_16x16x32_bf16 v[148:151], v[184:187], v[28:31], v[148:151]
    v_cmp_eq_u32 vcc, 3, v4
    v_mov_b32 v14, 0x42000000
    v_mov_b32 v13, 0x42400000
    v_cndmask_b32 v14, v14, v13, vcc
    v_add_f32 v8, v192, v194
    v_add_f32 v12, v196, v198
    v_add_f32 v8, v8, v12
    v_mul_f32 v8, v8, v14
    v_mov_b32 v12, v8
    s_nop 1
    v_permlane16_swap_b32 v8, v12
    v_add_f32 v8, v8, v12
    v_mov_b32 v12, v8
    s_nop 1
    v_permlane32_swap_b32 v8, v12
    v_add_f32 v8, v8, v12
    v_mul_f32 v8, 0x3ae38e39, v8
    v_mov_b32 v13, 0
    v_sub_f32 v12, v192, v8
    v_mul_f32 v12, v12, v12
    v_fmac_f32 v13, v12, v14
    v_add_f32 v13, v13, v193
    v_sub_f32 v12, v194, v8
    v_mul_f32 v12, v12, v12
    v_fmac_f32 v13, v12, v14
    v_add_f32 v13, v13, v195
    v_sub_f32 v12, v196, v8
    v_mul_f32 v12, v12, v12
    v_fmac_f32 v13, v12, v14
    v_add_f32 v13, v13, v197
    v_sub_f32 v12, v198, v8
    v_mul_f32 v12, v12, v12
    v_fmac_f32 v13, v12, v14
    v_add_f32 v13, v13, v199
    v_mov_b32 v12, v13
    s_nop 1
    v_permlane16_swap_b32 v13, v12
    v_add_f32 v13, v13, v12
    v_mov_b32 v12, v13
    s_nop 1
    v_permlane32_swap_b32 v13, v12
    v_add_f32 v13, v13, v12
    v_mul_f32 v13, 0x3ae38e39, v13
    v_cvt_pk_bf16_f32 v12, v8, v13
    v_lshlrev_b32 v8, 16, v12
    v_and_b32 v13, 0xffff0000, v12
    v_add_f32 v13, 0x3727c5ac, v13
    v_cvt_pk_bf16_f32 v12, v13, v13
    v_lshlrev_b32 v13, 16, v12
    v_sqrt_f32 v13, v13
    s_nop 0
    v_cvt_pk_bf16_f32 v12, v13, v13
    v_lshlrev_b32 v13, 16, v12
    v_rcp_f32 v9, v13
    v_add_f32 v10, v200, v202
    v_add_f32 v12, v204, v206
    v_add_f32 v10, v10, v12
    v_mul_f32 v10, v10, v14
    v_mov_b32 v12, v10
    s_nop 1
    v_permlane16_swap_b32 v10, v12
    v_add_f32 v10, v10, v12
    v_mov_b32 v12, v10
    s_nop 1
    v_permlane32_swap_b32 v10, v12
    v_add_f32 v10, v10, v12
    v_mul_f32 v10, 0x3ae38e39, v10
    v_mov_b32 v13, 0
    v_sub_f32 v12, v200, v10
    v_mul_f32 v12, v12, v12
    v_fmac_f32 v13, v12, v14
    v_add_f32 v13, v13, v201
    v_sub_f32 v12, v202, v10
    v_mul_f32 v12, v12, v12
    v_fmac_f32 v13, v12, v14
    v_add_f32 v13, v13, v203
    v_sub_f32 v12, v204, v10
    v_mul_f32 v12, v12, v12
    v_fmac_f32 v13, v12, v14
    v_add_f32 v13, v13, v205
    v_sub_f32 v12, v206, v10
    v_mul_f32 v12, v12, v12
    v_fmac_f32 v13, v12, v14
    v_add_f32 v13, v13, v207
    v_mov_b32 v12, v13
    s_nop 1
    v_permlane16_swap_b32 v13, v12
    v_add_f32 v13, v13, v12
    v_mov_b32 v12, v13
    s_nop 1
    v_permlane32_swap_b32 v13, v12
    v_add_f32 v13, v13, v12
    v_mul_f32 v13, 0x3ae38e39, v13
    v_cvt_pk_bf16_f32 v12, v10, v13
    v_lshlrev_b32 v10, 16, v12
    v_and_b32 v13, 0xffff0000, v12
    v_add_f32 v13, 0x3727c5ac, v13
    v_cvt_pk_bf16_f32 v12, v13, v13
    v_lshlrev_b32 v13, 16, v12
    v_sqrt_f32 v13, v13
    s_nop 0
    v_cvt_pk_bf16_f32 v12, v13, v13
    v_lshlrev_b32 v13, 16, v12
    v_rcp_f32 v11, v13
    s_mul_i32 s48, s32, 18
    v_add_u32 v13, s48, v4
    v_lshrrev_b32 v14, 2, v13
    v_and_b32 v15, 3, v13
    v_lshlrev_b32 v14, 10, v14
    v_lshl_add_u32 v14, v15, 8, v14
    v_lshl_add_u32 v14, v3, 4, v14
    v_lshrrev_b32 v13, 1, v4
    v_add_u32 v13, s48, v13
    v_add_u32 v13, 16, v13
    v_lshrrev_b32 v6, 2, v13
    v_and_b32 v15, 3, v13
    v_lshlrev_b32 v6, 10, v6
    v_lshl_add_u32 v6, v15, 8, v6
    v_lshl_add_u32 v6, v3, 4, v6
    v_and_b32 v15, 1, v4
    v_lshl_add_u32 v6, v15, 3, v6
    s_mul_i32 s49, s34, 147456
    s_add_u32 s50, s49, 147456
    s_waitcnt vmcnt(0)
    v_lshlrev_b32 v152, 16, v48
    v_and_b32 v153, 0xffff0000, v48
    v_lshlrev_b32 v154, 16, v49
    v_and_b32 v155, 0xffff0000, v49
    v_lshlrev_b32 v156, 16, v50
    v_and_b32 v157, 0xffff0000, v50
    v_lshlrev_b32 v158, 16, v51
    v_and_b32 v159, 0xffff0000, v51
    v_lshlrev_b32 v160, 16, v52
    v_and_b32 v161, 0xffff0000, v52
    v_lshlrev_b32 v162, 16, v53
    v_and_b32 v163, 0xffff0000, v53
    v_lshlrev_b32 v164, 16, v54
    v_and_b32 v165, 0xffff0000, v54
    v_lshlrev_b32 v166, 16, v55
    v_and_b32 v167, 0xffff0000, v55
    v_lshlrev_b32 v168, 16, v56
    v_and_b32 v169, 0xffff0000, v56
    v_lshlrev_b32 v170, 16, v57
    v_and_b32 v171, 0xffff0000, v57
    v_lshlrev_b32 v172, 16, v58
    v_and_b32 v173, 0xffff0000, v58
    v_lshlrev_b32 v174, 16, v59
    v_and_b32 v175, 0xffff0000, v59
    v_lshlrev_b32 v176, 16, v60
    v_and_b32 v177, 0xffff0000, v60
    v_lshlrev_b32 v178, 16, v61
    v_and_b32 v179, 0xffff0000, v61
    v_lshlrev_b32 v180, 16, v62
    v_and_b32 v181, 0xffff0000, v62
    v_lshlrev_b32 v182, 16, v63
    v_and_b32 v183, 0xffff0000, v63
    v_lshlrev_b32 v184, 16, v64
    v_and_b32 v185, 0xffff0000, v64
    v_lshlrev_b32 v186, 16, v65
    v_and_b32 v187, 0xffff0000, v65
    v_sub_f32 v70, 0, v8
    v_sub_f32 v71, 0, v8
    v_mov_b32 v72, v9
    v_mov_b32 v73, v9
    v_sub_f32 v74, 0, v10
    v_sub_f32 v75, 0, v10
    v_mov_b32 v76, v11
    v_mov_b32 v77, v11
    v_pk_fma_f32 v[80:81], v[208:209], v[70:71], v[80:81]
    v_pk_mul_f32 v[80:81], v[80:81], v[72:73]
    v_cvt_pk_bf16_f32 v78, v80, v81
    v_lshlrev_b32 v80, 16, v78
    v_and_b32 v81, 0xffff0000, v78
    v_pk_add_f32 v[80:81], v[80:81], v[152:153]
    v_cvt_pk_bf16_f32 v78, v80, v81
    v_pk_max_i16 v78, v78, 0
    v_lshlrev_b32 v80, 16, v78
    v_and_b32 v81, 0xffff0000, v78
    v_pk_mul_f32 v[80:81], v[80:81], v[80:81]
    v_cvt_pk_bf16_f32 v16, v80, v81
    v_pk_fma_f32 v[82:83], v[210:211], v[70:71], v[82:83]
    v_pk_mul_f32 v[82:83], v[82:83], v[72:73]
    v_cvt_pk_bf16_f32 v79, v82, v83
    v_lshlrev_b32 v82, 16, v79
    v_and_b32 v83, 0xffff0000, v79
    v_pk_add_f32 v[82:83], v[82:83], v[154:155]
    v_cvt_pk_bf16_f32 v79, v82, v83
    v_pk_max_i16 v79, v79, 0
    v_lshlrev_b32 v82, 16, v79
    v_and_b32 v83, 0xffff0000, v79
    v_pk_mul_f32 v[82:83], v[82:83], v[82:83]
    v_cvt_pk_bf16_f32 v17, v82, v83
    v_pk_fma_f32 v[84:85], v[212:213], v[70:71], v[84:85]
    v_pk_mul_f32 v[84:85], v[84:85], v[72:73]
    v_cvt_pk_bf16_f32 v78, v84, v85
    v_lshlrev_b32 v84, 16, v78
    v_and_b32 v85, 0xffff0000, v78
    v_pk_add_f32 v[84:85], v[84:85], v[156:157]
    v_cvt_pk_bf16_f32 v78, v84, v85
    v_pk_max_i16 v78, v78, 0
    v_lshlrev_b32 v84, 16, v78
    v_and_b32 v85, 0xffff0000, v78
    v_pk_mul_f32 v[84:85], v[84:85], v[84:85]
    v_cvt_pk_bf16_f32 v18, v84, v85
    v_pk_fma_f32 v[86:87], v[214:215], v[70:71], v[86:87]
    v_pk_mul_f32 v[86:87], v[86:87], v[72:73]
    v_cvt_pk_bf16_f32 v79, v86, v87
    v_lshlrev_b32 v86, 16, v79
    v_and_b32 v87, 0xffff0000, v79
    v_pk_add_f32 v[86:87], v[86:87], v[158:159]
    v_cvt_pk_bf16_f32 v79, v86, v87
    v_pk_max_i16 v79, v79, 0
    v_lshlrev_b32 v86, 16, v79
    v_and_b32 v87, 0xffff0000, v79
    v_pk_mul_f32 v[86:87], v[86:87], v[86:87]
    v_cvt_pk_bf16_f32 v19, v86, v87
    buffer_store_dwordx4 v[16:19], v14, s[28:31], s49 offen offset:0 sc1
    v_pk_fma_f32 v[88:89], v[216:217], v[70:71], v[88:89]
    v_pk_mul_f32 v[88:89], v[88:89], v[72:73]
    v_cvt_pk_bf16_f32 v78, v88, v89
    v_lshlrev_b32 v88, 16, v78
    v_and_b32 v89, 0xffff0000, v78
    v_pk_add_f32 v[88:89], v[88:89], v[160:161]
    v_cvt_pk_bf16_f32 v78, v88, v89
    v_pk_max_i16 v78, v78, 0
    v_lshlrev_b32 v88, 16, v78
    v_and_b32 v89, 0xffff0000, v78
    v_pk_mul_f32 v[88:89], v[88:89], v[88:89]
    v_cvt_pk_bf16_f32 v20, v88, v89
    v_pk_fma_f32 v[90:91], v[218:219], v[70:71], v[90:91]
    v_pk_mul_f32 v[90:91], v[90:91], v[72:73]
    v_cvt_pk_bf16_f32 v79, v90, v91
    v_lshlrev_b32 v90, 16, v79
    v_and_b32 v91, 0xffff0000, v79
    v_pk_add_f32 v[90:91], v[90:91], v[162:163]
    v_cvt_pk_bf16_f32 v79, v90, v91
    v_pk_max_i16 v79, v79, 0
    v_lshlrev_b32 v90, 16, v79
    v_and_b32 v91, 0xffff0000, v79
    v_pk_mul_f32 v[90:91], v[90:91], v[90:91]
    v_cvt_pk_bf16_f32 v21, v90, v91
    v_pk_fma_f32 v[92:93], v[220:221], v[70:71], v[92:93]
    v_pk_mul_f32 v[92:93], v[92:93], v[72:73]
    v_cvt_pk_bf16_f32 v78, v92, v93
    v_lshlrev_b32 v92, 16, v78
    v_and_b32 v93, 0xffff0000, v78
    v_pk_add_f32 v[92:93], v[92:93], v[164:165]
    v_cvt_pk_bf16_f32 v78, v92, v93
    v_pk_max_i16 v78, v78, 0
    v_lshlrev_b32 v92, 16, v78
    v_and_b32 v93, 0xffff0000, v78
    v_pk_mul_f32 v[92:93], v[92:93], v[92:93]
    v_cvt_pk_bf16_f32 v22, v92, v93
    v_pk_fma_f32 v[94:95], v[222:223], v[70:71], v[94:95]
    v_pk_mul_f32 v[94:95], v[94:95], v[72:73]
    v_cvt_pk_bf16_f32 v79, v94, v95
    v_lshlrev_b32 v94, 16, v79
    v_and_b32 v95, 0xffff0000, v79
    v_pk_add_f32 v[94:95], v[94:95], v[166:167]
    v_cvt_pk_bf16_f32 v79, v94, v95
    v_pk_max_i16 v79, v79, 0
    v_lshlrev_b32 v94, 16, v79
    v_and_b32 v95, 0xffff0000, v79
    v_pk_mul_f32 v[94:95], v[94:95], v[94:95]
    v_cvt_pk_bf16_f32 v23, v94, v95
    buffer_store_dwordx4 v[20:23], v14, s[28:31], s49 offen offset:1024 sc1
    v_pk_fma_f32 v[96:97], v[224:225], v[70:71], v[96:97]
    v_pk_mul_f32 v[96:97], v[96:97], v[72:73]
    v_cvt_pk_bf16_f32 v78, v96, v97
    v_lshlrev_b32 v96, 16, v78
    v_and_b32 v97, 0xffff0000, v78
    v_pk_add_f32 v[96:97], v[96:97], v[168:169]
    v_cvt_pk_bf16_f32 v78, v96, v97
    v_pk_max_i16 v78, v78, 0
    v_lshlrev_b32 v96, 16, v78
    v_and_b32 v97, 0xffff0000, v78
    v_pk_mul_f32 v[96:97], v[96:97], v[96:97]
    v_cvt_pk_bf16_f32 v24, v96, v97
    v_pk_fma_f32 v[98:99], v[226:227], v[70:71], v[98:99]
    v_pk_mul_f32 v[98:99], v[98:99], v[72:73]
    v_cvt_pk_bf16_f32 v79, v98, v99
    v_lshlrev_b32 v98, 16, v79
    v_and_b32 v99, 0xffff0000, v79
    v_pk_add_f32 v[98:99], v[98:99], v[170:171]
    v_cvt_pk_bf16_f32 v79, v98, v99
    v_pk_max_i16 v79, v79, 0
    v_lshlrev_b32 v98, 16, v79
    v_and_b32 v99, 0xffff0000, v79
    v_pk_mul_f32 v[98:99], v[98:99], v[98:99]
    v_cvt_pk_bf16_f32 v25, v98, v99
    v_pk_fma_f32 v[100:101], v[228:229], v[70:71], v[100:101]
    v_pk_mul_f32 v[100:101], v[100:101], v[72:73]
    v_cvt_pk_bf16_f32 v78, v100, v101
    v_lshlrev_b32 v100, 16, v78
    v_and_b32 v101, 0xffff0000, v78
    v_pk_add_f32 v[100:101], v[100:101], v[172:173]
    v_cvt_pk_bf16_f32 v78, v100, v101
    v_pk_max_i16 v78, v78, 0
    v_lshlrev_b32 v100, 16, v78
    v_and_b32 v101, 0xffff0000, v78
    v_pk_mul_f32 v[100:101], v[100:101], v[100:101]
    v_cvt_pk_bf16_f32 v26, v100, v101
    v_pk_fma_f32 v[102:103], v[230:231], v[70:71], v[102:103]
    v_pk_mul_f32 v[102:103], v[102:103], v[72:73]
    v_cvt_pk_bf16_f32 v79, v102, v103
    v_lshlrev_b32 v102, 16, v79
    v_and_b32 v103, 0xffff0000, v79
    v_pk_add_f32 v[102:103], v[102:103], v[174:175]
    v_cvt_pk_bf16_f32 v79, v102, v103
    v_pk_max_i16 v79, v79, 0
    v_lshlrev_b32 v102, 16, v79
    v_and_b32 v103, 0xffff0000, v79
    v_pk_mul_f32 v[102:103], v[102:103], v[102:103]
    v_cvt_pk_bf16_f32 v27, v102, v103
    buffer_store_dwordx4 v[24:27], v14, s[28:31], s49 offen offset:2048 sc1
    v_pk_fma_f32 v[104:105], v[232:233], v[70:71], v[104:105]
    v_pk_mul_f32 v[104:105], v[104:105], v[72:73]
    v_cvt_pk_bf16_f32 v78, v104, v105
    v_lshlrev_b32 v104, 16, v78
    v_and_b32 v105, 0xffff0000, v78
    v_pk_add_f32 v[104:105], v[104:105], v[176:177]
    v_cvt_pk_bf16_f32 v78, v104, v105
    v_pk_max_i16 v78, v78, 0
    v_lshlrev_b32 v104, 16, v78
    v_and_b32 v105, 0xffff0000, v78
    v_pk_mul_f32 v[104:105], v[104:105], v[104:105]
    v_cvt_pk_bf16_f32 v28, v104, v105
    v_pk_fma_f32 v[106:107], v[234:235], v[70:71], v[106:107]
    v_pk_mul_f32 v[106:107], v[106:107], v[72:73]
    v_cvt_pk_bf16_f32 v79, v106, v107
    v_lshlrev_b32 v106, 16, v79
    v_and_b32 v107, 0xffff0000, v79
    v_pk_add_f32 v[106:107], v[106:107], v[178:179]
    v_cvt_pk_bf16_f32 v79, v106, v107
    v_pk_max_i16 v79, v79, 0
    v_lshlrev_b32 v106, 16, v79
    v_and_b32 v107, 0xffff0000, v79
    v_pk_mul_f32 v[106:107], v[106:107], v[106:107]
    v_cvt_pk_bf16_f32 v29, v106, v107
    v_pk_fma_f32 v[108:109], v[236:237], v[70:71], v[108:109]
    v_pk_mul_f32 v[108:109], v[108:109], v[72:73]
    v_cvt_pk_bf16_f32 v78, v108, v109
    v_lshlrev_b32 v108, 16, v78
    v_and_b32 v109, 0xffff0000, v78
    v_pk_add_f32 v[108:109], v[108:109], v[180:181]
    v_cvt_pk_bf16_f32 v78, v108, v109
    v_pk_max_i16 v78, v78, 0
    v_lshlrev_b32 v108, 16, v78
    v_and_b32 v109, 0xffff0000, v78
    v_pk_mul_f32 v[108:109], v[108:109], v[108:109]
    v_cvt_pk_bf16_f32 v30, v108, v109
    v_pk_fma_f32 v[110:111], v[238:239], v[70:71], v[110:111]
    v_pk_mul_f32 v[110:111], v[110:111], v[72:73]
    v_cvt_pk_bf16_f32 v79, v110, v111
    v_lshlrev_b32 v110, 16, v79
    v_and_b32 v111, 0xffff0000, v79
    v_pk_add_f32 v[110:111], v[110:111], v[182:183]
    v_cvt_pk_bf16_f32 v79, v110, v111
    v_pk_max_i16 v79, v79, 0
    v_lshlrev_b32 v110, 16, v79
    v_and_b32 v111, 0xffff0000, v79
    v_pk_mul_f32 v[110:111], v[110:111], v[110:111]
    v_cvt_pk_bf16_f32 v31, v110, v111
    buffer_store_dwordx4 v[28:31], v14, s[28:31], s49 offen offset:3072 sc1
    v_pk_fma_f32 v[112:113], v[240:241], v[70:71], v[112:113]
    v_pk_mul_f32 v[112:113], v[112:113], v[72:73]
    v_cvt_pk_bf16_f32 v78, v112, v113
    v_lshlrev_b32 v112, 16, v78
    v_and_b32 v113, 0xffff0000, v78
    v_pk_add_f32 v[112:113], v[112:113], v[184:185]
    v_cvt_pk_bf16_f32 v78, v112, v113
    v_pk_max_i16 v78, v78, 0
    v_lshlrev_b32 v112, 16, v78
    v_and_b32 v113, 0xffff0000, v78
    v_pk_mul_f32 v[112:113], v[112:113], v[112:113]
    v_cvt_pk_bf16_f32 v32, v112, v113
    v_pk_fma_f32 v[114:115], v[242:243], v[70:71], v[114:115]
    v_pk_mul_f32 v[114:115], v[114:115], v[72:73]
    v_cvt_pk_bf16_f32 v79, v114, v115
    v_lshlrev_b32 v114, 16, v79
    v_and_b32 v115, 0xffff0000, v79
    v_pk_add_f32 v[114:115], v[114:115], v[186:187]
    v_cvt_pk_bf16_f32 v79, v114, v115
    v_pk_max_i16 v79, v79, 0
    v_lshlrev_b32 v114, 16, v79
    v_and_b32 v115, 0xffff0000, v79
    v_pk_mul_f32 v[114:115], v[114:115], v[114:115]
    v_cvt_pk_bf16_f32 v33, v114, v115
    buffer_store_dwordx2 v[32:33], v6, s[28:31], s49 offen sc1
    v_pk_fma_f32 v[116:117], v[208:209], v[74:75], v[116:117]
    v_pk_mul_f32 v[116:117], v[116:117], v[76:77]
    v_cvt_pk_bf16_f32 v78, v116, v117
    v_lshlrev_b32 v116, 16, v78
    v_and_b32 v117, 0xffff0000, v78
    v_pk_add_f32 v[116:117], v[116:117], v[152:153]
    v_cvt_pk_bf16_f32 v78, v116, v117
    v_pk_max_i16 v78, v78, 0
    v_lshlrev_b32 v116, 16, v78
    v_and_b32 v117, 0xffff0000, v78
    v_pk_mul_f32 v[116:117], v[116:117], v[116:117]
    v_cvt_pk_bf16_f32 v34, v116, v117
    v_pk_fma_f32 v[118:119], v[210:211], v[74:75], v[118:119]
    v_pk_mul_f32 v[118:119], v[118:119], v[76:77]
    v_cvt_pk_bf16_f32 v79, v118, v119
    v_lshlrev_b32 v118, 16, v79
    v_and_b32 v119, 0xffff0000, v79
    v_pk_add_f32 v[118:119], v[118:119], v[154:155]
    v_cvt_pk_bf16_f32 v79, v118, v119
    v_pk_max_i16 v79, v79, 0
    v_lshlrev_b32 v118, 16, v79
    v_and_b32 v119, 0xffff0000, v79
    v_pk_mul_f32 v[118:119], v[118:119], v[118:119]
    v_cvt_pk_bf16_f32 v35, v118, v119
    v_pk_fma_f32 v[120:121], v[212:213], v[74:75], v[120:121]
    v_pk_mul_f32 v[120:121], v[120:121], v[76:77]
    v_cvt_pk_bf16_f32 v78, v120, v121
    v_lshlrev_b32 v120, 16, v78
    v_and_b32 v121, 0xffff0000, v78
    v_pk_add_f32 v[120:121], v[120:121], v[156:157]
    v_cvt_pk_bf16_f32 v78, v120, v121
    v_pk_max_i16 v78, v78, 0
    v_lshlrev_b32 v120, 16, v78
    v_and_b32 v121, 0xffff0000, v78
    v_pk_mul_f32 v[120:121], v[120:121], v[120:121]
    v_cvt_pk_bf16_f32 v36, v120, v121
    v_pk_fma_f32 v[122:123], v[214:215], v[74:75], v[122:123]
    v_pk_mul_f32 v[122:123], v[122:123], v[76:77]
    v_cvt_pk_bf16_f32 v79, v122, v123
    v_lshlrev_b32 v122, 16, v79
    v_and_b32 v123, 0xffff0000, v79
    v_pk_add_f32 v[122:123], v[122:123], v[158:159]
    v_cvt_pk_bf16_f32 v79, v122, v123
    v_pk_max_i16 v79, v79, 0
    v_lshlrev_b32 v122, 16, v79
    v_and_b32 v123, 0xffff0000, v79
    v_pk_mul_f32 v[122:123], v[122:123], v[122:123]
    v_cvt_pk_bf16_f32 v37, v122, v123
    buffer_store_dwordx4 v[34:37], v14, s[28:31], s50 offen offset:0 sc1
    v_pk_fma_f32 v[124:125], v[216:217], v[74:75], v[124:125]
    v_pk_mul_f32 v[124:125], v[124:125], v[76:77]
    v_cvt_pk_bf16_f32 v78, v124, v125
    v_lshlrev_b32 v124, 16, v78
    v_and_b32 v125, 0xffff0000, v78
    v_pk_add_f32 v[124:125], v[124:125], v[160:161]
    v_cvt_pk_bf16_f32 v78, v124, v125
    v_pk_max_i16 v78, v78, 0
    v_lshlrev_b32 v124, 16, v78
    v_and_b32 v125, 0xffff0000, v78
    v_pk_mul_f32 v[124:125], v[124:125], v[124:125]
    v_cvt_pk_bf16_f32 v38, v124, v125
    v_pk_fma_f32 v[126:127], v[218:219], v[74:75], v[126:127]
    v_pk_mul_f32 v[126:127], v[126:127], v[76:77]
    v_cvt_pk_bf16_f32 v79, v126, v127
    v_lshlrev_b32 v126, 16, v79
    v_and_b32 v127, 0xffff0000, v79
    v_pk_add_f32 v[126:127], v[126:127], v[162:163]
    v_cvt_pk_bf16_f32 v79, v126, v127
    v_pk_max_i16 v79, v79, 0
    v_lshlrev_b32 v126, 16, v79
    v_and_b32 v127, 0xffff0000, v79
    v_pk_mul_f32 v[126:127], v[126:127], v[126:127]
    v_cvt_pk_bf16_f32 v39, v126, v127
    v_pk_fma_f32 v[128:129], v[220:221], v[74:75], v[128:129]
    v_pk_mul_f32 v[128:129], v[128:129], v[76:77]
    v_cvt_pk_bf16_f32 v78, v128, v129
    v_lshlrev_b32 v128, 16, v78
    v_and_b32 v129, 0xffff0000, v78
    v_pk_add_f32 v[128:129], v[128:129], v[164:165]
    v_cvt_pk_bf16_f32 v78, v128, v129
    v_pk_max_i16 v78, v78, 0
    v_lshlrev_b32 v128, 16, v78
    v_and_b32 v129, 0xffff0000, v78
    v_pk_mul_f32 v[128:129], v[128:129], v[128:129]
    v_cvt_pk_bf16_f32 v40, v128, v129
    v_pk_fma_f32 v[130:131], v[222:223], v[74:75], v[130:131]
    v_pk_mul_f32 v[130:131], v[130:131], v[76:77]
    v_cvt_pk_bf16_f32 v79, v130, v131
    v_lshlrev_b32 v130, 16, v79
    v_and_b32 v131, 0xffff0000, v79
    v_pk_add_f32 v[130:131], v[130:131], v[166:167]
    v_cvt_pk_bf16_f32 v79, v130, v131
    v_pk_max_i16 v79, v79, 0
    v_lshlrev_b32 v130, 16, v79
    v_and_b32 v131, 0xffff0000, v79
    v_pk_mul_f32 v[130:131], v[130:131], v[130:131]
    v_cvt_pk_bf16_f32 v41, v130, v131
    buffer_store_dwordx4 v[38:41], v14, s[28:31], s50 offen offset:1024 sc1
    v_pk_fma_f32 v[132:133], v[224:225], v[74:75], v[132:133]
    v_pk_mul_f32 v[132:133], v[132:133], v[76:77]
    v_cvt_pk_bf16_f32 v78, v132, v133
    v_lshlrev_b32 v132, 16, v78
    v_and_b32 v133, 0xffff0000, v78
    v_pk_add_f32 v[132:133], v[132:133], v[168:169]
    v_cvt_pk_bf16_f32 v78, v132, v133
    v_pk_max_i16 v78, v78, 0
    v_lshlrev_b32 v132, 16, v78
    v_and_b32 v133, 0xffff0000, v78
    v_pk_mul_f32 v[132:133], v[132:133], v[132:133]
    v_cvt_pk_bf16_f32 v42, v132, v133
    v_pk_fma_f32 v[134:135], v[226:227], v[74:75], v[134:135]
    v_pk_mul_f32 v[134:135], v[134:135], v[76:77]
    v_cvt_pk_bf16_f32 v79, v134, v135
    v_lshlrev_b32 v134, 16, v79
    v_and_b32 v135, 0xffff0000, v79
    v_pk_add_f32 v[134:135], v[134:135], v[170:171]
    v_cvt_pk_bf16_f32 v79, v134, v135
    v_pk_max_i16 v79, v79, 0
    v_lshlrev_b32 v134, 16, v79
    v_and_b32 v135, 0xffff0000, v79
    v_pk_mul_f32 v[134:135], v[134:135], v[134:135]
    v_cvt_pk_bf16_f32 v43, v134, v135
    v_pk_fma_f32 v[136:137], v[228:229], v[74:75], v[136:137]
    v_pk_mul_f32 v[136:137], v[136:137], v[76:77]
    v_cvt_pk_bf16_f32 v78, v136, v137
    v_lshlrev_b32 v136, 16, v78
    v_and_b32 v137, 0xffff0000, v78
    v_pk_add_f32 v[136:137], v[136:137], v[172:173]
    v_cvt_pk_bf16_f32 v78, v136, v137
    v_pk_max_i16 v78, v78, 0
    v_lshlrev_b32 v136, 16, v78
    v_and_b32 v137, 0xffff0000, v78
    v_pk_mul_f32 v[136:137], v[136:137], v[136:137]
    v_cvt_pk_bf16_f32 v44, v136, v137
    v_pk_fma_f32 v[138:139], v[230:231], v[74:75], v[138:139]
    v_pk_mul_f32 v[138:139], v[138:139], v[76:77]
    v_cvt_pk_bf16_f32 v79, v138, v139
    v_lshlrev_b32 v138, 16, v79
    v_and_b32 v139, 0xffff0000, v79
    v_pk_add_f32 v[138:139], v[138:139], v[174:175]
    v_cvt_pk_bf16_f32 v79, v138, v139
    v_pk_max_i16 v79, v79, 0
    v_lshlrev_b32 v138, 16, v79
    v_and_b32 v139, 0xffff0000, v79
    v_pk_mul_f32 v[138:139], v[138:139], v[138:139]
    v_cvt_pk_bf16_f32 v45, v138, v139
    buffer_store_dwordx4 v[42:45], v14, s[28:31], s50 offen offset:2048 sc1
    v_pk_fma_f32 v[140:141], v[232:233], v[74:75], v[140:141]
    v_pk_mul_f32 v[140:141], v[140:141], v[76:77]
    v_cvt_pk_bf16_f32 v78, v140, v141
    v_lshlrev_b32 v140, 16, v78
    v_and_b32 v141, 0xffff0000, v78
    v_pk_add_f32 v[140:141], v[140:141], v[176:177]
    v_cvt_pk_bf16_f32 v78, v140, v141
    v_pk_max_i16 v78, v78, 0
    v_lshlrev_b32 v140, 16, v78
    v_and_b32 v141, 0xffff0000, v78
    v_pk_mul_f32 v[140:141], v[140:141], v[140:141]
    v_cvt_pk_bf16_f32 v46, v140, v141
    v_pk_fma_f32 v[142:143], v[234:235], v[74:75], v[142:143]
    v_pk_mul_f32 v[142:143], v[142:143], v[76:77]
    v_cvt_pk_bf16_f32 v79, v142, v143
    v_lshlrev_b32 v142, 16, v79
    v_and_b32 v143, 0xffff0000, v79
    v_pk_add_f32 v[142:143], v[142:143], v[178:179]
    v_cvt_pk_bf16_f32 v79, v142, v143
    v_pk_max_i16 v79, v79, 0
    v_lshlrev_b32 v142, 16, v79
    v_and_b32 v143, 0xffff0000, v79
    v_pk_mul_f32 v[142:143], v[142:143], v[142:143]
    v_cvt_pk_bf16_f32 v47, v142, v143
    v_pk_fma_f32 v[144:145], v[236:237], v[74:75], v[144:145]
    v_pk_mul_f32 v[144:145], v[144:145], v[76:77]
    v_cvt_pk_bf16_f32 v78, v144, v145
    v_lshlrev_b32 v144, 16, v78
    v_and_b32 v145, 0xffff0000, v78
    v_pk_add_f32 v[144:145], v[144:145], v[180:181]
    v_cvt_pk_bf16_f32 v78, v144, v145
    v_pk_max_i16 v78, v78, 0
    v_lshlrev_b32 v144, 16, v78
    v_and_b32 v145, 0xffff0000, v78
    v_pk_mul_f32 v[144:145], v[144:145], v[144:145]
    v_cvt_pk_bf16_f32 v48, v144, v145
    v_pk_fma_f32 v[146:147], v[238:239], v[74:75], v[146:147]
    v_pk_mul_f32 v[146:147], v[146:147], v[76:77]
    v_cvt_pk_bf16_f32 v79, v146, v147
    v_lshlrev_b32 v146, 16, v79
    v_and_b32 v147, 0xffff0000, v79
    v_pk_add_f32 v[146:147], v[146:147], v[182:183]
    v_cvt_pk_bf16_f32 v79, v146, v147
    v_pk_max_i16 v79, v79, 0
    v_lshlrev_b32 v146, 16, v79
    v_and_b32 v147, 0xffff0000, v79
    v_pk_mul_f32 v[146:147], v[146:147], v[146:147]
    v_cvt_pk_bf16_f32 v49, v146, v147
    buffer_store_dwordx4 v[46:49], v14, s[28:31], s50 offen offset:3072 sc1
    v_pk_fma_f32 v[148:149], v[240:241], v[74:75], v[148:149]
    v_pk_mul_f32 v[148:149], v[148:149], v[76:77]
    v_cvt_pk_bf16_f32 v78, v148, v149
    v_lshlrev_b32 v148, 16, v78
    v_and_b32 v149, 0xffff0000, v78
    v_pk_add_f32 v[148:149], v[148:149], v[184:185]
    v_cvt_pk_bf16_f32 v78, v148, v149
    v_pk_max_i16 v78, v78, 0
    v_lshlrev_b32 v148, 16, v78
    v_and_b32 v149, 0xffff0000, v78
    v_pk_mul_f32 v[148:149], v[148:149], v[148:149]
    v_cvt_pk_bf16_f32 v50, v148, v149
    v_pk_fma_f32 v[150:151], v[242:243], v[74:75], v[150:151]
    v_pk_mul_f32 v[150:151], v[150:151], v[76:77]
    v_cvt_pk_bf16_f32 v79, v150, v151
    v_lshlrev_b32 v150, 16, v79
    v_and_b32 v151, 0xffff0000, v79
    v_pk_add_f32 v[150:151], v[150:151], v[186:187]
    v_cvt_pk_bf16_f32 v79, v150, v151
    v_pk_max_i16 v79, v79, 0
    v_lshlrev_b32 v150, 16, v79
    v_and_b32 v151, 0xffff0000, v79
    v_pk_mul_f32 v[150:151], v[150:151], v[150:151]
    v_cvt_pk_bf16_f32 v51, v150, v151
    buffer_store_dwordx2 v[50:51], v6, s[28:31], s50 offen sc1
    s_nop 0
.End_k3l1_kernel_1:
    s_endpgm
.globl k4l1_kernel
.p2align 8
.type k4l1_kernel,@function
k4l1_kernel:
    s_cmp_ge_u32 s2, 256
    s_cbranch_scc1 .End_k4l1_kernel_1
    s_load_dwordx2 s[4:5], s[0:1], 88
    s_load_dwordx2 s[6:7], s[0:1], 64
    s_load_dwordx2 s[52:53], s[0:1], 72
    v_and_b32 v1, 63, v0
    v_lshrrev_b32 v2, 6, v0
    s_nop 0
    v_readfirstlane_b32 s3, v2
    v_and_b32 v3, 15, v1
    v_lshrrev_b32 v4, 4, v1
    v_lshlrev_b32 v5, 4, v1
    s_lshr_b32 s34, s2, 3
    s_bfe_u32 s32, s2, 0x20001
    s_lshl_b32 s32, s32, 3
    s_and_b32 s35, s34, 7
    s_add_u32 s32, s32, s35
    s_and_b32 s33, s2, 1
    s_lshl_b32 s33, s33, 2
    s_lshr_b32 s34, s34, 3
    s_add_u32 s33, s33, s34
    s_waitcnt lgkmcnt(0)
    s_add_u32 s8, s4, 0x1000000
    s_addc_u32 s9, s5, 0
    s_and_b32 s9, s9, 0xffff
    s_mov_b32 s10, 0x5a0000
    s_mov_b32 s11, 0x20000
    s_add_u32 s12, s4, 0x2a00000
    s_addc_u32 s13, s5, 0
    s_and_b32 s13, s13, 0xffff
    s_mov_b32 s14, 0x1200000
    s_mov_b32 s15, 0x20000
    s_add_u32 s16, s4, 0x1f80000
    s_addc_u32 s17, s5, 0
    s_and_b32 s17, s17, 0xffff
    s_mov_b32 s18, 0x240000
    s_mov_b32 s19, 0x20000
    s_mov_b32 s20, s52
    s_mov_b32 s21, s53
    s_and_b32 s21, s21, 0xffff
    s_mov_b32 s22, 0x240000
    s_mov_b32 s23, 0x20000
    s_mov_b32 s24, s6
    s_mov_b32 s25, s7
    s_and_b32 s25, s25, 0xffff
    s_mov_b32 s26, 0x480
    s_mov_b32 s27, 0x20000
    s_add_u32 s28, s4, 0x2280000
    s_addc_u32 s29, s5, 0
    s_and_b32 s29, s29, 0xffff
    s_mov_b32 s30, 0x40000
    s_mov_b32 s31, 0x20000
    s_mul_i32 s35, s32, 589824
    s_mul_i32 s36, s3, 18432
    s_add_u32 s35, s35, s36
    s_mul_i32 s37, s33, 737280
    s_mul_i32 s38, s3, 92160
    s_add_u32 s37, s37, s38
    v_mov_b32 v7, 0x7ff00000
    v_cmp_gt_u32 vcc, 8, v3
    s_nop 1
    v_cndmask_b32 v6, v7, v5, vcc
    s_add_u32 s40, s35, 0
    buffer_load_dwordx4 v[92:95], v5, s[12:15], s40 offen
    s_add_u32 s40, s35, 147456
    buffer_load_dwordx4 v[96:99], v5, s[12:15], s40 offen
    s_add_u32 s40, s35, 294912
    buffer_load_dwordx4 v[100:103], v5, s[12:15], s40 offen
    s_add_u32 s40, s35, 442368
    buffer_load_dwordx4 v[104:107], v5, s[12:15], s40 offen
    s_add_u32 s39, s37, 0
    buffer_load_dwordx4 v[108:111], v5, s[8:11], s39 offen offset:0
    buffer_load_dwordx4 v[112:115], v5, s[8:11], s39 offen offset:1024
    buffer_load_dwordx4 v[116:119], v5, s[8:11], s39 offen offset:2048
    buffer_load_dwordx4 v[120:123], v5, s[8:11], s39 offen offset:3072
    s_add_u32 s39, s39, 4096
    buffer_load_dwordx4 v[124:127], v6, s[8:11], s39 offen
    s_add_u32 s40, s35, 1024
    buffer_load_dwordx4 v[128:131], v5, s[12:15], s40 offen
    s_add_u32 s40, s35, 148480
    buffer_load_dwordx4 v[132:135], v5, s[12:15], s40 offen
    s_add_u32 s40, s35, 295936
    buffer_load_dwordx4 v[136:139], v5, s[12:15], s40 offen
    s_add_u32 s40, s35, 443392
    buffer_load_dwordx4 v[140:143], v5, s[12:15], s40 offen
    s_add_u32 s39, s37, 5120
    buffer_load_dwordx4 v[144:147], v5, s[8:11], s39 offen offset:0
    buffer_load_dwordx4 v[148:151], v5, s[8:11], s39 offen offset:1024
    buffer_load_dwordx4 v[152:155], v5, s[8:11], s39 offen offset:2048
    buffer_load_dwordx4 v[156:159], v5, s[8:11], s39 offen offset:3072
    s_add_u32 s39, s39, 4096
    buffer_load_dwordx4 v[160:163], v6, s[8:11], s39 offen
    s_add_u32 s40, s35, 2048
    buffer_load_dwordx4 v[164:167], v5, s[12:15], s40 offen
    s_add_u32 s40, s35, 149504
    buffer_load_dwordx4 v[168:171], v5, s[12:15], s40 offen
    s_add_u32 s40, s35, 296960
    buffer_load_dwordx4 v[172:175], v5, s[12:15], s40 offen
    s_add_u32 s40, s35, 444416
    buffer_load_dwordx4 v[176:179], v5, s[12:15], s40 offen
    s_add_u32 s39, s37, 10240
    buffer_load_dwordx4 v[180:183], v5, s[8:11], s39 offen offset:0
    buffer_load_dwordx4 v[184:187], v5, s[8:11], s39 offen offset:1024
    buffer_load_dwordx4 v[188:191], v5, s[8:11], s39 offen offset:2048
    buffer_load_dwordx4 v[192:195], v5, s[8:11], s39 offen offset:3072
    s_add_u32 s39, s39, 4096
    buffer_load_dwordx4 v[196:199], v6, s[8:11], s39 offen
    s_add_u32 s40, s35, 3072
    buffer_load_dwordx4 v[200:203], v5, s[12:15], s40 offen
    s_add_u32 s40, s35, 150528
    buffer_load_dwordx4 v[204:207], v5, s[12:15], s40 offen
    s_add_u32 s40, s35, 297984
    buffer_load_dwordx4 v[208:211], v5, s[12:15], s40 offen
    s_add_u32 s40, s35, 445440
    buffer_load_dwordx4 v[212:215], v5, s[12:15], s40 offen
    s_add_u32 s39, s37, 15360
    buffer_load_dwordx4 v[216:219], v5, s[8:11], s39 offen offset:0
    buffer_load_dwordx4 v[220:223], v5, s[8:11], s39 offen offset:1024
    buffer_load_dwordx4 v[224:227], v5, s[8:11], s39 offen offset:2048
    buffer_load_dwordx4 v[228:231], v5, s[8:11], s39 offen offset:3072
    s_add_u32 s39, s39, 4096
    buffer_load_dwordx4 v[232:235], v6, s[8:11], s39 offen
    s_waitcnt vmcnt(32)
    s_waitcnt vmcnt(31)
    v_mfma_f32_16x16x32_bf16 v[12:15], v[108:111], v[92:95], 0
    v_mfma_f32_16x16x32_bf16 v[32:35], v[108:111], v[96:99], 0
    v_mfma_f32_16x16x32_bf16 v[52:55], v[108:111], v[100:103], 0
    v_mfma_f32_16x16x32_bf16 v[72:75], v[108:111], v[104:107], 0
    s_waitcnt vmcnt(30)
    v_mfma_f32_16x16x32_bf16 v[16:19], v[112:115], v[92:95], 0
    v_mfma_f32_16x16x32_bf16 v[36:39], v[112:115], v[96:99], 0
    v_mfma_f32_16x16x32_bf16 v[56:59], v[112:115], v[100:103], 0
    v_mfma_f32_16x16x32_bf16 v[76:79], v[112:115], v[104:107], 0
    s_waitcnt vmcnt(29)
    v_mfma_f32_16x16x32_bf16 v[20:23], v[116:119], v[92:95], 0
    v_mfma_f32_16x16x32_bf16 v[40:43], v[116:119], v[96:99], 0
    v_mfma_f32_16x16x32_bf16 v[60:63], v[116:119], v[100:103], 0
    v_mfma_f32_16x16x32_bf16 v[80:83], v[116:119], v[104:107], 0
    s_waitcnt vmcnt(28)
    v_mfma_f32_16x16x32_bf16 v[24:27], v[120:123], v[92:95], 0
    v_mfma_f32_16x16x32_bf16 v[44:47], v[120:123], v[96:99], 0
    v_mfma_f32_16x16x32_bf16 v[64:67], v[120:123], v[100:103], 0
    v_mfma_f32_16x16x32_bf16 v[84:87], v[120:123], v[104:107], 0
    s_waitcnt vmcnt(27)
    v_mfma_f32_16x16x32_bf16 v[28:31], v[124:127], v[92:95], 0
    v_mfma_f32_16x16x32_bf16 v[48:51], v[124:127], v[96:99], 0
    v_mfma_f32_16x16x32_bf16 v[68:71], v[124:127], v[100:103], 0
    v_mfma_f32_16x16x32_bf16 v[88:91], v[124:127], v[104:107], 0
    s_add_u32 s40, s35, 4096
    buffer_load_dwordx4 v[92:95], v5, s[12:15], s40 offen
    s_add_u32 s40, s35, 151552
    buffer_load_dwordx4 v[96:99], v5, s[12:15], s40 offen
    s_add_u32 s40, s35, 299008
    buffer_load_dwordx4 v[100:103], v5, s[12:15], s40 offen
    s_add_u32 s40, s35, 446464
    buffer_load_dwordx4 v[104:107], v5, s[12:15], s40 offen
    s_add_u32 s39, s37, 20480
    buffer_load_dwordx4 v[108:111], v5, s[8:11], s39 offen offset:0
    buffer_load_dwordx4 v[112:115], v5, s[8:11], s39 offen offset:1024
    buffer_load_dwordx4 v[116:119], v5, s[8:11], s39 offen offset:2048
    buffer_load_dwordx4 v[120:123], v5, s[8:11], s39 offen offset:3072
    s_add_u32 s39, s39, 4096
    buffer_load_dwordx4 v[124:127], v6, s[8:11], s39 offen
    s_waitcnt vmcnt(32)
    s_waitcnt vmcnt(31)
    v_mfma_f32_16x16x32_bf16 v[12:15], v[144:147], v[128:131], v[12:15]
    v_mfma_f32_16x16x32_bf16 v[32:35], v[144:147], v[132:135], v[32:35]
    v_mfma_f32_16x16x32_bf16 v[52:55], v[144:147], v[136:139], v[52:55]
    v_mfma_f32_16x16x32_bf16 v[72:75], v[144:147], v[140:143], v[72:75]
    s_waitcnt vmcnt(30)
    v_mfma_f32_16x16x32_bf16 v[16:19], v[148:151], v[128:131], v[16:19]
    v_mfma_f32_16x16x32_bf16 v[36:39], v[148:151], v[132:135], v[36:39]
    v_mfma_f32_16x16x32_bf16 v[56:59], v[148:151], v[136:139], v[56:59]
    v_mfma_f32_16x16x32_bf16 v[76:79], v[148:151], v[140:143], v[76:79]
    s_waitcnt vmcnt(29)
    v_mfma_f32_16x16x32_bf16 v[20:23], v[152:155], v[128:131], v[20:23]
    v_mfma_f32_16x16x32_bf16 v[40:43], v[152:155], v[132:135], v[40:43]
    v_mfma_f32_16x16x32_bf16 v[60:63], v[152:155], v[136:139], v[60:63]
    v_mfma_f32_16x16x32_bf16 v[80:83], v[152:155], v[140:143], v[80:83]
    s_waitcnt vmcnt(28)
    v_mfma_f32_16x16x32_bf16 v[24:27], v[156:159], v[128:131], v[24:27]
    v_mfma_f32_16x16x32_bf16 v[44:47], v[156:159], v[132:135], v[44:47]
    v_mfma_f32_16x16x32_bf16 v[64:67], v[156:159], v[136:139], v[64:67]
    v_mfma_f32_16x16x32_bf16 v[84:87], v[156:159], v[140:143], v[84:87]
    s_waitcnt vmcnt(27)
    v_mfma_f32_16x16x32_bf16 v[28:31], v[160:163], v[128:131], v[28:31]
    v_mfma_f32_16x16x32_bf16 v[48:51], v[160:163], v[132:135], v[48:51]
    v_mfma_f32_16x16x32_bf16 v[68:71], v[160:163], v[136:139], v[68:71]
    v_mfma_f32_16x16x32_bf16 v[88:91], v[160:163], v[140:143], v[88:91]
    s_add_u32 s40, s35, 5120
    buffer_load_dwordx4 v[128:131], v5, s[12:15], s40 offen
    s_add_u32 s40, s35, 152576
    buffer_load_dwordx4 v[132:135], v5, s[12:15], s40 offen
    s_add_u32 s40, s35, 300032
    buffer_load_dwordx4 v[136:139], v5, s[12:15], s40 offen
    s_add_u32 s40, s35, 447488
    buffer_load_dwordx4 v[140:143], v5, s[12:15], s40 offen
    s_add_u32 s39, s37, 25600
    buffer_load_dwordx4 v[144:147], v5, s[8:11], s39 offen offset:0
    buffer_load_dwordx4 v[148:151], v5, s[8:11], s39 offen offset:1024
    buffer_load_dwordx4 v[152:155], v5, s[8:11], s39 offen offset:2048
    buffer_load_dwordx4 v[156:159], v5, s[8:11], s39 offen offset:3072
    s_add_u32 s39, s39, 4096
    buffer_load_dwordx4 v[160:163], v6, s[8:11], s39 offen
    s_waitcnt vmcnt(32)
    s_waitcnt vmcnt(31)
    v_mfma_f32_16x16x32_bf16 v[12:15], v[180:183], v[164:167], v[12:15]
    v_mfma_f32_16x16x32_bf16 v[32:35], v[180:183], v[168:171], v[32:35]
    v_mfma_f32_16x16x32_bf16 v[52:55], v[180:183], v[172:175], v[52:55]
    v_mfma_f32_16x16x32_bf16 v[72:75], v[180:183], v[176:179], v[72:75]
    s_waitcnt vmcnt(30)
    v_mfma_f32_16x16x32_bf16 v[16:19], v[184:187], v[164:167], v[16:19]
    v_mfma_f32_16x16x32_bf16 v[36:39], v[184:187], v[168:171], v[36:39]
    v_mfma_f32_16x16x32_bf16 v[56:59], v[184:187], v[172:175], v[56:59]
    v_mfma_f32_16x16x32_bf16 v[76:79], v[184:187], v[176:179], v[76:79]
    s_waitcnt vmcnt(29)
    v_mfma_f32_16x16x32_bf16 v[20:23], v[188:191], v[164:167], v[20:23]
    v_mfma_f32_16x16x32_bf16 v[40:43], v[188:191], v[168:171], v[40:43]
    v_mfma_f32_16x16x32_bf16 v[60:63], v[188:191], v[172:175], v[60:63]
    v_mfma_f32_16x16x32_bf16 v[80:83], v[188:191], v[176:179], v[80:83]
    s_waitcnt vmcnt(28)
    v_mfma_f32_16x16x32_bf16 v[24:27], v[192:195], v[164:167], v[24:27]
    v_mfma_f32_16x16x32_bf16 v[44:47], v[192:195], v[168:171], v[44:47]
    v_mfma_f32_16x16x32_bf16 v[64:67], v[192:195], v[172:175], v[64:67]
    v_mfma_f32_16x16x32_bf16 v[84:87], v[192:195], v[176:179], v[84:87]
    s_waitcnt vmcnt(27)
    v_mfma_f32_16x16x32_bf16 v[28:31], v[196:199], v[164:167], v[28:31]
    v_mfma_f32_16x16x32_bf16 v[48:51], v[196:199], v[168:171], v[48:51]
    v_mfma_f32_16x16x32_bf16 v[68:71], v[196:199], v[172:175], v[68:71]
    v_mfma_f32_16x16x32_bf16 v[88:91], v[196:199], v[176:179], v[88:91]
    s_add_u32 s40, s35, 6144
    buffer_load_dwordx4 v[164:167], v5, s[12:15], s40 offen
    s_add_u32 s40, s35, 153600
    buffer_load_dwordx4 v[168:171], v5, s[12:15], s40 offen
    s_add_u32 s40, s35, 301056
    buffer_load_dwordx4 v[172:175], v5, s[12:15], s40 offen
    s_add_u32 s40, s35, 448512
    buffer_load_dwordx4 v[176:179], v5, s[12:15], s40 offen
    s_add_u32 s39, s37, 30720
    buffer_load_dwordx4 v[180:183], v5, s[8:11], s39 offen offset:0
    buffer_load_dwordx4 v[184:187], v5, s[8:11], s39 offen offset:1024
    buffer_load_dwordx4 v[188:191], v5, s[8:11], s39 offen offset:2048
    buffer_load_dwordx4 v[192:195], v5, s[8:11], s39 offen offset:3072
    s_add_u32 s39, s39, 4096
    buffer_load_dwordx4 v[196:199], v6, s[8:11], s39 offen
    s_waitcnt vmcnt(32)
    s_waitcnt vmcnt(31)
    v_mfma_f32_16x16x32_bf16 v[12:15], v[216:219], v[200:203], v[12:15]
    v_mfma_f32_16x16x32_bf16 v[32:35], v[216:219], v[204:207], v[32:35]
    v_mfma_f32_16x16x32_bf16 v[52:55], v[216:219], v[208:211], v[52:55]
    v_mfma_f32_16x16x32_bf16 v[72:75], v[216:219], v[212:215], v[72:75]
    s_waitcnt vmcnt(30)
    v_mfma_f32_16x16x32_bf16 v[16:19], v[220:223], v[200:203], v[16:19]
    v_mfma_f32_16x16x32_bf16 v[36:39], v[220:223], v[204:207], v[36:39]
    v_mfma_f32_16x16x32_bf16 v[56:59], v[220:223], v[208:211], v[56:59]
    v_mfma_f32_16x16x32_bf16 v[76:79], v[220:223], v[212:215], v[76:79]
    s_waitcnt vmcnt(29)
    v_mfma_f32_16x16x32_bf16 v[20:23], v[224:227], v[200:203], v[20:23]
    v_mfma_f32_16x16x32_bf16 v[40:43], v[224:227], v[204:207], v[40:43]
    v_mfma_f32_16x16x32_bf16 v[60:63], v[224:227], v[208:211], v[60:63]
    v_mfma_f32_16x16x32_bf16 v[80:83], v[224:227], v[212:215], v[80:83]
    s_waitcnt vmcnt(28)
    v_mfma_f32_16x16x32_bf16 v[24:27], v[228:231], v[200:203], v[24:27]
    v_mfma_f32_16x16x32_bf16 v[44:47], v[228:231], v[204:207], v[44:47]
    v_mfma_f32_16x16x32_bf16 v[64:67], v[228:231], v[208:211], v[64:67]
    v_mfma_f32_16x16x32_bf16 v[84:87], v[228:231], v[212:215], v[84:87]
    s_waitcnt vmcnt(27)
    v_mfma_f32_16x16x32_bf16 v[28:31], v[232:235], v[200:203], v[28:31]
    v_mfma_f32_16x16x32_bf16 v[48:51], v[232:235], v[204:207], v[48:51]
    v_mfma_f32_16x16x32_bf16 v[68:71], v[232:235], v[208:211], v[68:71]
    v_mfma_f32_16x16x32_bf16 v[88:91], v[232:235], v[212:215], v[88:91]
    s_add_u32 s40, s35, 7168
    buffer_load_dwordx4 v[200:203], v5, s[12:15], s40 offen
    s_add_u32 s40, s35, 154624
    buffer_load_dwordx4 v[204:207], v5, s[12:15], s40 offen
    s_add_u32 s40, s35, 302080
    buffer_load_dwordx4 v[208:211], v5, s[12:15], s40 offen
    s_add_u32 s40, s35, 449536
    buffer_load_dwordx4 v[212:215], v5, s[12:15], s40 offen
    s_add_u32 s39, s37, 35840
    buffer_load_dwordx4 v[216:219], v5, s[8:11], s39 offen offset:0
    buffer_load_dwordx4 v[220:223], v5, s[8:11], s39 offen offset:1024
    buffer_load_dwordx4 v[224:227], v5, s[8:11], s39 offen offset:2048
    buffer_load_dwordx4 v[228:231], v5, s[8:11], s39 offen offset:3072
    s_add_u32 s39, s39, 4096
    buffer_load_dwordx4 v[232:235], v6, s[8:11], s39 offen
    s_waitcnt vmcnt(32)
    s_waitcnt vmcnt(31)
    v_mfma_f32_16x16x32_bf16 v[12:15], v[108:111], v[92:95], v[12:15]
    v_mfma_f32_16x16x32_bf16 v[32:35], v[108:111], v[96:99], v[32:35]
    v_mfma_f32_16x16x32_bf16 v[52:55], v[108:111], v[100:103], v[52:55]
    v_mfma_f32_16x16x32_bf16 v[72:75], v[108:111], v[104:107], v[72:75]
    s_waitcnt vmcnt(30)
    v_mfma_f32_16x16x32_bf16 v[16:19], v[112:115], v[92:95], v[16:19]
    v_mfma_f32_16x16x32_bf16 v[36:39], v[112:115], v[96:99], v[36:39]
    v_mfma_f32_16x16x32_bf16 v[56:59], v[112:115], v[100:103], v[56:59]
    v_mfma_f32_16x16x32_bf16 v[76:79], v[112:115], v[104:107], v[76:79]
    s_waitcnt vmcnt(29)
    v_mfma_f32_16x16x32_bf16 v[20:23], v[116:119], v[92:95], v[20:23]
    v_mfma_f32_16x16x32_bf16 v[40:43], v[116:119], v[96:99], v[40:43]
    v_mfma_f32_16x16x32_bf16 v[60:63], v[116:119], v[100:103], v[60:63]
    v_mfma_f32_16x16x32_bf16 v[80:83], v[116:119], v[104:107], v[80:83]
    s_waitcnt vmcnt(28)
    v_mfma_f32_16x16x32_bf16 v[24:27], v[120:123], v[92:95], v[24:27]
    v_mfma_f32_16x16x32_bf16 v[44:47], v[120:123], v[96:99], v[44:47]
    v_mfma_f32_16x16x32_bf16 v[64:67], v[120:123], v[100:103], v[64:67]
    v_mfma_f32_16x16x32_bf16 v[84:87], v[120:123], v[104:107], v[84:87]
    s_waitcnt vmcnt(27)
    v_mfma_f32_16x16x32_bf16 v[28:31], v[124:127], v[92:95], v[28:31]
    v_mfma_f32_16x16x32_bf16 v[48:51], v[124:127], v[96:99], v[48:51]
    v_mfma_f32_16x16x32_bf16 v[68:71], v[124:127], v[100:103], v[68:71]
    v_mfma_f32_16x16x32_bf16 v[88:91], v[124:127], v[104:107], v[88:91]
    s_add_u32 s40, s35, 8192
    buffer_load_dwordx4 v[92:95], v5, s[12:15], s40 offen
    s_add_u32 s40, s35, 155648
    buffer_load_dwordx4 v[96:99], v5, s[12:15], s40 offen
    s_add_u32 s40, s35, 303104
    buffer_load_dwordx4 v[100:103], v5, s[12:15], s40 offen
    s_add_u32 s40, s35, 450560
    buffer_load_dwordx4 v[104:107], v5, s[12:15], s40 offen
    s_add_u32 s39, s37, 40960
    buffer_load_dwordx4 v[108:111], v5, s[8:11], s39 offen offset:0
    buffer_load_dwordx4 v[112:115], v5, s[8:11], s39 offen offset:1024
    buffer_load_dwordx4 v[116:119], v5, s[8:11], s39 offen offset:2048
    buffer_load_dwordx4 v[120:123], v5, s[8:11], s39 offen offset:3072
    s_add_u32 s39, s39, 4096
    buffer_load_dwordx4 v[124:127], v6, s[8:11], s39 offen
    s_waitcnt vmcnt(32)
    s_waitcnt vmcnt(31)
    v_mfma_f32_16x16x32_bf16 v[12:15], v[144:147], v[128:131], v[12:15]
    v_mfma_f32_16x16x32_bf16 v[32:35], v[144:147], v[132:135], v[32:35]
    v_mfma_f32_16x16x32_bf16 v[52:55], v[144:147], v[136:139], v[52:55]
    v_mfma_f32_16x16x32_bf16 v[72:75], v[144:147], v[140:143], v[72:75]
    s_waitcnt vmcnt(30)
    v_mfma_f32_16x16x32_bf16 v[16:19], v[148:151], v[128:131], v[16:19]
    v_mfma_f32_16x16x32_bf16 v[36:39], v[148:151], v[132:135], v[36:39]
    v_mfma_f32_16x16x32_bf16 v[56:59], v[148:151], v[136:139], v[56:59]
    v_mfma_f32_16x16x32_bf16 v[76:79], v[148:151], v[140:143], v[76:79]
    s_waitcnt vmcnt(29)
    v_mfma_f32_16x16x32_bf16 v[20:23], v[152:155], v[128:131], v[20:23]
    v_mfma_f32_16x16x32_bf16 v[40:43], v[152:155], v[132:135], v[40:43]
    v_mfma_f32_16x16x32_bf16 v[60:63], v[152:155], v[136:139], v[60:63]
    v_mfma_f32_16x16x32_bf16 v[80:83], v[152:155], v[140:143], v[80:83]
    s_waitcnt vmcnt(28)
    v_mfma_f32_16x16x32_bf16 v[24:27], v[156:159], v[128:131], v[24:27]
    v_mfma_f32_16x16x32_bf16 v[44:47], v[156:159], v[132:135], v[44:47]
    v_mfma_f32_16x16x32_bf16 v[64:67], v[156:159], v[136:139], v[64:67]
    v_mfma_f32_16x16x32_bf16 v[84:87], v[156:159], v[140:143], v[84:87]
    s_waitcnt vmcnt(27)
    v_mfma_f32_16x16x32_bf16 v[28:31], v[160:163], v[128:131], v[28:31]
    v_mfma_f32_16x16x32_bf16 v[48:51], v[160:163], v[132:135], v[48:51]
    v_mfma_f32_16x16x32_bf16 v[68:71], v[160:163], v[136:139], v[68:71]
    v_mfma_f32_16x16x32_bf16 v[88:91], v[160:163], v[140:143], v[88:91]
    s_add_u32 s40, s35, 9216
    buffer_load_dwordx4 v[128:131], v5, s[12:15], s40 offen
    s_add_u32 s40, s35, 156672
    buffer_load_dwordx4 v[132:135], v5, s[12:15], s40 offen
    s_add_u32 s40, s35, 304128
    buffer_load_dwordx4 v[136:139], v5, s[12:15], s40 offen
    s_add_u32 s40, s35, 451584
    buffer_load_dwordx4 v[140:143], v5, s[12:15], s40 offen
    s_add_u32 s39, s37, 46080
    buffer_load_dwordx4 v[144:147], v5, s[8:11], s39 offen offset:0
    buffer_load_dwordx4 v[148:151], v5, s[8:11], s39 offen offset:1024
    buffer_load_dwordx4 v[152:155], v5, s[8:11], s39 offen offset:2048
    buffer_load_dwordx4 v[156:159], v5, s[8:11], s39 offen offset:3072
    s_add_u32 s39, s39, 4096
    buffer_load_dwordx4 v[160:163], v6, s[8:11], s39 offen
    s_waitcnt vmcnt(32)
    s_waitcnt vmcnt(31)
    v_mfma_f32_16x16x32_bf16 v[12:15], v[180:183], v[164:167], v[12:15]
    v_mfma_f32_16x16x32_bf16 v[32:35], v[180:183], v[168:171], v[32:35]
    v_mfma_f32_16x16x32_bf16 v[52:55], v[180:183], v[172:175], v[52:55]
    v_mfma_f32_16x16x32_bf16 v[72:75], v[180:183], v[176:179], v[72:75]
    s_waitcnt vmcnt(30)
    v_mfma_f32_16x16x32_bf16 v[16:19], v[184:187], v[164:167], v[16:19]
    v_mfma_f32_16x16x32_bf16 v[36:39], v[184:187], v[168:171], v[36:39]
    v_mfma_f32_16x16x32_bf16 v[56:59], v[184:187], v[172:175], v[56:59]
    v_mfma_f32_16x16x32_bf16 v[76:79], v[184:187], v[176:179], v[76:79]
    s_waitcnt vmcnt(29)
    v_mfma_f32_16x16x32_bf16 v[20:23], v[188:191], v[164:167], v[20:23]
    v_mfma_f32_16x16x32_bf16 v[40:43], v[188:191], v[168:171], v[40:43]
    v_mfma_f32_16x16x32_bf16 v[60:63], v[188:191], v[172:175], v[60:63]
    v_mfma_f32_16x16x32_bf16 v[80:83], v[188:191], v[176:179], v[80:83]
    s_waitcnt vmcnt(28)
    v_mfma_f32_16x16x32_bf16 v[24:27], v[192:195], v[164:167], v[24:27]
    v_mfma_f32_16x16x32_bf16 v[44:47], v[192:195], v[168:171], v[44:47]
    v_mfma_f32_16x16x32_bf16 v[64:67], v[192:195], v[172:175], v[64:67]
    v_mfma_f32_16x16x32_bf16 v[84:87], v[192:195], v[176:179], v[84:87]
    s_waitcnt vmcnt(27)
    v_mfma_f32_16x16x32_bf16 v[28:31], v[196:199], v[164:167], v[28:31]
    v_mfma_f32_16x16x32_bf16 v[48:51], v[196:199], v[168:171], v[48:51]
    v_mfma_f32_16x16x32_bf16 v[68:71], v[196:199], v[172:175], v[68:71]
    v_mfma_f32_16x16x32_bf16 v[88:91], v[196:199], v[176:179], v[88:91]
    s_add_u32 s40, s35, 10240
    buffer_load_dwordx4 v[164:167], v5, s[12:15], s40 offen
    s_add_u32 s40, s35, 157696
    buffer_load_dwordx4 v[168:171], v5, s[12:15], s40 offen
    s_add_u32 s40, s35, 305152
    buffer_load_dwordx4 v[172:175], v5, s[12:15], s40 offen
    s_add_u32 s40, s35, 452608
    buffer_load_dwordx4 v[176:179], v5, s[12:15], s40 offen
    s_add_u32 s39, s37, 51200
    buffer_load_dwordx4 v[180:183], v5, s[8:11], s39 offen offset:0
    buffer_load_dwordx4 v[184:187], v5, s[8:11], s39 offen offset:1024
    buffer_load_dwordx4 v[188:191], v5, s[8:11], s39 offen offset:2048
    buffer_load_dwordx4 v[192:195], v5, s[8:11], s39 offen offset:3072
    s_add_u32 s39, s39, 4096
    buffer_load_dwordx4 v[196:199], v6, s[8:11], s39 offen
    s_waitcnt vmcnt(32)
    s_waitcnt vmcnt(31)
    v_mfma_f32_16x16x32_bf16 v[12:15], v[216:219], v[200:203], v[12:15]
    v_mfma_f32_16x16x32_bf16 v[32:35], v[216:219], v[204:207], v[32:35]
    v_mfma_f32_16x16x32_bf16 v[52:55], v[216:219], v[208:211], v[52:55]
    v_mfma_f32_16x16x32_bf16 v[72:75], v[216:219], v[212:215], v[72:75]
    s_waitcnt vmcnt(30)
    v_mfma_f32_16x16x32_bf16 v[16:19], v[220:223], v[200:203], v[16:19]
    v_mfma_f32_16x16x32_bf16 v[36:39], v[220:223], v[204:207], v[36:39]
    v_mfma_f32_16x16x32_bf16 v[56:59], v[220:223], v[208:211], v[56:59]
    v_mfma_f32_16x16x32_bf16 v[76:79], v[220:223], v[212:215], v[76:79]
    s_waitcnt vmcnt(29)
    v_mfma_f32_16x16x32_bf16 v[20:23], v[224:227], v[200:203], v[20:23]
    v_mfma_f32_16x16x32_bf16 v[40:43], v[224:227], v[204:207], v[40:43]
    v_mfma_f32_16x16x32_bf16 v[60:63], v[224:227], v[208:211], v[60:63]
    v_mfma_f32_16x16x32_bf16 v[80:83], v[224:227], v[212:215], v[80:83]
    s_waitcnt vmcnt(28)
    v_mfma_f32_16x16x32_bf16 v[24:27], v[228:231], v[200:203], v[24:27]
    v_mfma_f32_16x16x32_bf16 v[44:47], v[228:231], v[204:207], v[44:47]
    v_mfma_f32_16x16x32_bf16 v[64:67], v[228:231], v[208:211], v[64:67]
    v_mfma_f32_16x16x32_bf16 v[84:87], v[228:231], v[212:215], v[84:87]
    s_waitcnt vmcnt(27)
    v_mfma_f32_16x16x32_bf16 v[28:31], v[232:235], v[200:203], v[28:31]
    v_mfma_f32_16x16x32_bf16 v[48:51], v[232:235], v[204:207], v[48:51]
    v_mfma_f32_16x16x32_bf16 v[68:71], v[232:235], v[208:211], v[68:71]
    v_mfma_f32_16x16x32_bf16 v[88:91], v[232:235], v[212:215], v[88:91]
    s_add_u32 s40, s35, 11264
    buffer_load_dwordx4 v[200:203], v5, s[12:15], s40 offen
    s_add_u32 s40, s35, 158720
    buffer_load_dwordx4 v[204:207], v5, s[12:15], s40 offen
    s_add_u32 s40, s35, 306176
    buffer_load_dwordx4 v[208:211], v5, s[12:15], s40 offen
    s_add_u32 s40, s35, 453632
    buffer_load_dwordx4 v[212:215], v5, s[12:15], s40 offen
    s_add_u32 s39, s37, 56320
    buffer_load_dwordx4 v[216:219], v5, s[8:11], s39 offen offset:0
    buffer_load_dwordx4 v[220:223], v5, s[8:11], s39 offen offset:1024
    buffer_load_dwordx4 v[224:227], v5, s[8:11], s39 offen offset:2048
    buffer_load_dwordx4 v[228:231], v5, s[8:11], s39 offen offset:3072
    s_add_u32 s39, s39, 4096
    buffer_load_dwordx4 v[232:235], v6, s[8:11], s39 offen
    s_waitcnt vmcnt(32)
    s_waitcnt vmcnt(31)
    v_mfma_f32_16x16x32_bf16 v[12:15], v[108:111], v[92:95], v[12:15]
    v_mfma_f32_16x16x32_bf16 v[32:35], v[108:111], v[96:99], v[32:35]
    v_mfma_f32_16x16x32_bf16 v[52:55], v[108:111], v[100:103], v[52:55]
    v_mfma_f32_16x16x32_bf16 v[72:75], v[108:111], v[104:107], v[72:75]
    s_waitcnt vmcnt(30)
    v_mfma_f32_16x16x32_bf16 v[16:19], v[112:115], v[92:95], v[16:19]
    v_mfma_f32_16x16x32_bf16 v[36:39], v[112:115], v[96:99], v[36:39]
    v_mfma_f32_16x16x32_bf16 v[56:59], v[112:115], v[100:103], v[56:59]
    v_mfma_f32_16x16x32_bf16 v[76:79], v[112:115], v[104:107], v[76:79]
    s_waitcnt vmcnt(29)
    v_mfma_f32_16x16x32_bf16 v[20:23], v[116:119], v[92:95], v[20:23]
    v_mfma_f32_16x16x32_bf16 v[40:43], v[116:119], v[96:99], v[40:43]
    v_mfma_f32_16x16x32_bf16 v[60:63], v[116:119], v[100:103], v[60:63]
    v_mfma_f32_16x16x32_bf16 v[80:83], v[116:119], v[104:107], v[80:83]
    s_waitcnt vmcnt(28)
    v_mfma_f32_16x16x32_bf16 v[24:27], v[120:123], v[92:95], v[24:27]
    v_mfma_f32_16x16x32_bf16 v[44:47], v[120:123], v[96:99], v[44:47]
    v_mfma_f32_16x16x32_bf16 v[64:67], v[120:123], v[100:103], v[64:67]
    v_mfma_f32_16x16x32_bf16 v[84:87], v[120:123], v[104:107], v[84:87]
    s_waitcnt vmcnt(27)
    v_mfma_f32_16x16x32_bf16 v[28:31], v[124:127], v[92:95], v[28:31]
    v_mfma_f32_16x16x32_bf16 v[48:51], v[124:127], v[96:99], v[48:51]
    v_mfma_f32_16x16x32_bf16 v[68:71], v[124:127], v[100:103], v[68:71]
    v_mfma_f32_16x16x32_bf16 v[88:91], v[124:127], v[104:107], v[88:91]
    s_add_u32 s40, s35, 12288
    buffer_load_dwordx4 v[92:95], v5, s[12:15], s40 offen
    s_add_u32 s40, s35, 159744
    buffer_load_dwordx4 v[96:99], v5, s[12:15], s40 offen
    s_add_u32 s40, s35, 307200
    buffer_load_dwordx4 v[100:103], v5, s[12:15], s40 offen
    s_add_u32 s40, s35, 454656
    buffer_load_dwordx4 v[104:107], v5, s[12:15], s40 offen
    s_add_u32 s39, s37, 61440
    buffer_load_dwordx4 v[108:111], v5, s[8:11], s39 offen offset:0
    buffer_load_dwordx4 v[112:115], v5, s[8:11], s39 offen offset:1024
    buffer_load_dwordx4 v[116:119], v5, s[8:11], s39 offen offset:2048
    buffer_load_dwordx4 v[120:123], v5, s[8:11], s39 offen offset:3072
    s_add_u32 s39, s39, 4096
    buffer_load_dwordx4 v[124:127], v6, s[8:11], s39 offen
    s_waitcnt vmcnt(32)
    s_waitcnt vmcnt(31)
    v_mfma_f32_16x16x32_bf16 v[12:15], v[144:147], v[128:131], v[12:15]
    v_mfma_f32_16x16x32_bf16 v[32:35], v[144:147], v[132:135], v[32:35]
    v_mfma_f32_16x16x32_bf16 v[52:55], v[144:147], v[136:139], v[52:55]
    v_mfma_f32_16x16x32_bf16 v[72:75], v[144:147], v[140:143], v[72:75]
    s_waitcnt vmcnt(30)
    v_mfma_f32_16x16x32_bf16 v[16:19], v[148:151], v[128:131], v[16:19]
    v_mfma_f32_16x16x32_bf16 v[36:39], v[148:151], v[132:135], v[36:39]
    v_mfma_f32_16x16x32_bf16 v[56:59], v[148:151], v[136:139], v[56:59]
    v_mfma_f32_16x16x32_bf16 v[76:79], v[148:151], v[140:143], v[76:79]
    s_waitcnt vmcnt(29)
    v_mfma_f32_16x16x32_bf16 v[20:23], v[152:155], v[128:131], v[20:23]
    v_mfma_f32_16x16x32_bf16 v[40:43], v[152:155], v[132:135], v[40:43]
    v_mfma_f32_16x16x32_bf16 v[60:63], v[152:155], v[136:139], v[60:63]
    v_mfma_f32_16x16x32_bf16 v[80:83], v[152:155], v[140:143], v[80:83]
    s_waitcnt vmcnt(28)
    v_mfma_f32_16x16x32_bf16 v[24:27], v[156:159], v[128:131], v[24:27]
    v_mfma_f32_16x16x32_bf16 v[44:47], v[156:159], v[132:135], v[44:47]
    v_mfma_f32_16x16x32_bf16 v[64:67], v[156:159], v[136:139], v[64:67]
    v_mfma_f32_16x16x32_bf16 v[84:87], v[156:159], v[140:143], v[84:87]
    s_waitcnt vmcnt(27)
    v_mfma_f32_16x16x32_bf16 v[28:31], v[160:163], v[128:131], v[28:31]
    v_mfma_f32_16x16x32_bf16 v[48:51], v[160:163], v[132:135], v[48:51]
    v_mfma_f32_16x16x32_bf16 v[68:71], v[160:163], v[136:139], v[68:71]
    v_mfma_f32_16x16x32_bf16 v[88:91], v[160:163], v[140:143], v[88:91]
    s_add_u32 s40, s35, 13312
    buffer_load_dwordx4 v[128:131], v5, s[12:15], s40 offen
    s_add_u32 s40, s35, 160768
    buffer_load_dwordx4 v[132:135], v5, s[12:15], s40 offen
    s_add_u32 s40, s35, 308224
    buffer_load_dwordx4 v[136:139], v5, s[12:15], s40 offen
    s_add_u32 s40, s35, 455680
    buffer_load_dwordx4 v[140:143], v5, s[12:15], s40 offen
    s_add_u32 s39, s37, 66560
    buffer_load_dwordx4 v[144:147], v5, s[8:11], s39 offen offset:0
    buffer_load_dwordx4 v[148:151], v5, s[8:11], s39 offen offset:1024
    buffer_load_dwordx4 v[152:155], v5, s[8:11], s39 offen offset:2048
    buffer_load_dwordx4 v[156:159], v5, s[8:11], s39 offen offset:3072
    s_add_u32 s39, s39, 4096
    buffer_load_dwordx4 v[160:163], v6, s[8:11], s39 offen
    s_waitcnt vmcnt(32)
    s_waitcnt vmcnt(31)
    v_mfma_f32_16x16x32_bf16 v[12:15], v[180:183], v[164:167], v[12:15]
    v_mfma_f32_16x16x32_bf16 v[32:35], v[180:183], v[168:171], v[32:35]
    v_mfma_f32_16x16x32_bf16 v[52:55], v[180:183], v[172:175], v[52:55]
    v_mfma_f32_16x16x32_bf16 v[72:75], v[180:183], v[176:179], v[72:75]
    s_waitcnt vmcnt(30)
    v_mfma_f32_16x16x32_bf16 v[16:19], v[184:187], v[164:167], v[16:19]
    v_mfma_f32_16x16x32_bf16 v[36:39], v[184:187], v[168:171], v[36:39]
    v_mfma_f32_16x16x32_bf16 v[56:59], v[184:187], v[172:175], v[56:59]
    v_mfma_f32_16x16x32_bf16 v[76:79], v[184:187], v[176:179], v[76:79]
    s_waitcnt vmcnt(29)
    v_mfma_f32_16x16x32_bf16 v[20:23], v[188:191], v[164:167], v[20:23]
    v_mfma_f32_16x16x32_bf16 v[40:43], v[188:191], v[168:171], v[40:43]
    v_mfma_f32_16x16x32_bf16 v[60:63], v[188:191], v[172:175], v[60:63]
    v_mfma_f32_16x16x32_bf16 v[80:83], v[188:191], v[176:179], v[80:83]
    s_waitcnt vmcnt(28)
    v_mfma_f32_16x16x32_bf16 v[24:27], v[192:195], v[164:167], v[24:27]
    v_mfma_f32_16x16x32_bf16 v[44:47], v[192:195], v[168:171], v[44:47]
    v_mfma_f32_16x16x32_bf16 v[64:67], v[192:195], v[172:175], v[64:67]
    v_mfma_f32_16x16x32_bf16 v[84:87], v[192:195], v[176:179], v[84:87]
    s_waitcnt vmcnt(27)
    v_mfma_f32_16x16x32_bf16 v[28:31], v[196:199], v[164:167], v[28:31]
    v_mfma_f32_16x16x32_bf16 v[48:51], v[196:199], v[168:171], v[48:51]
    v_mfma_f32_16x16x32_bf16 v[68:71], v[196:199], v[172:175], v[68:71]
    v_mfma_f32_16x16x32_bf16 v[88:91], v[196:199], v[176:179], v[88:91]
    s_add_u32 s40, s35, 14336
    buffer_load_dwordx4 v[164:167], v5, s[12:15], s40 offen
    s_add_u32 s40, s35, 161792
    buffer_load_dwordx4 v[168:171], v5, s[12:15], s40 offen
    s_add_u32 s40, s35, 309248
    buffer_load_dwordx4 v[172:175], v5, s[12:15], s40 offen
    s_add_u32 s40, s35, 456704
    buffer_load_dwordx4 v[176:179], v5, s[12:15], s40 offen
    s_add_u32 s39, s37, 71680
    buffer_load_dwordx4 v[180:183], v5, s[8:11], s39 offen offset:0
    buffer_load_dwordx4 v[184:187], v5, s[8:11], s39 offen offset:1024
    buffer_load_dwordx4 v[188:191], v5, s[8:11], s39 offen offset:2048
    buffer_load_dwordx4 v[192:195], v5, s[8:11], s39 offen offset:3072
    s_add_u32 s39, s39, 4096
    buffer_load_dwordx4 v[196:199], v6, s[8:11], s39 offen
    s_waitcnt vmcnt(32)
    s_waitcnt vmcnt(31)
    v_mfma_f32_16x16x32_bf16 v[12:15], v[216:219], v[200:203], v[12:15]
    v_mfma_f32_16x16x32_bf16 v[32:35], v[216:219], v[204:207], v[32:35]
    v_mfma_f32_16x16x32_bf16 v[52:55], v[216:219], v[208:211], v[52:55]
    v_mfma_f32_16x16x32_bf16 v[72:75], v[216:219], v[212:215], v[72:75]
    s_waitcnt vmcnt(30)
    v_mfma_f32_16x16x32_bf16 v[16:19], v[220:223], v[200:203], v[16:19]
    v_mfma_f32_16x16x32_bf16 v[36:39], v[220:223], v[204:207], v[36:39]
    v_mfma_f32_16x16x32_bf16 v[56:59], v[220:223], v[208:211], v[56:59]
    v_mfma_f32_16x16x32_bf16 v[76:79], v[220:223], v[212:215], v[76:79]
    s_waitcnt vmcnt(29)
    v_mfma_f32_16x16x32_bf16 v[20:23], v[224:227], v[200:203], v[20:23]
    v_mfma_f32_16x16x32_bf16 v[40:43], v[224:227], v[204:207], v[40:43]
    v_mfma_f32_16x16x32_bf16 v[60:63], v[224:227], v[208:211], v[60:63]
    v_mfma_f32_16x16x32_bf16 v[80:83], v[224:227], v[212:215], v[80:83]
    s_waitcnt vmcnt(28)
    v_mfma_f32_16x16x32_bf16 v[24:27], v[228:231], v[200:203], v[24:27]
    v_mfma_f32_16x16x32_bf16 v[44:47], v[228:231], v[204:207], v[44:47]
    v_mfma_f32_16x16x32_bf16 v[64:67], v[228:231], v[208:211], v[64:67]
    v_mfma_f32_16x16x32_bf16 v[84:87], v[228:231], v[212:215], v[84:87]
    s_waitcnt vmcnt(27)
    v_mfma_f32_16x16x32_bf16 v[28:31], v[232:235], v[200:203], v[28:31]
    v_mfma_f32_16x16x32_bf16 v[48:51], v[232:235], v[204:207], v[48:51]
    v_mfma_f32_16x16x32_bf16 v[68:71], v[232:235], v[208:211], v[68:71]
    v_mfma_f32_16x16x32_bf16 v[88:91], v[232:235], v[212:215], v[88:91]
    s_add_u32 s40, s35, 15360
    buffer_load_dwordx4 v[200:203], v5, s[12:15], s40 offen
    s_add_u32 s40, s35, 162816
    buffer_load_dwordx4 v[204:207], v5, s[12:15], s40 offen
    s_add_u32 s40, s35, 310272
    buffer_load_dwordx4 v[208:211], v5, s[12:15], s40 offen
    s_add_u32 s40, s35, 457728
    buffer_load_dwordx4 v[212:215], v5, s[12:15], s40 offen
    s_add_u32 s39, s37, 76800
    buffer_load_dwordx4 v[216:219], v5, s[8:11], s39 offen offset:0
    buffer_load_dwordx4 v[220:223], v5, s[8:11], s39 offen offset:1024
    buffer_load_dwordx4 v[224:227], v5, s[8:11], s39 offen offset:2048
    buffer_load_dwordx4 v[228:231], v5, s[8:11], s39 offen offset:3072
    s_add_u32 s39, s39, 4096
    buffer_load_dwordx4 v[232:235], v6, s[8:11], s39 offen
    s_waitcnt vmcnt(32)
    s_waitcnt vmcnt(31)
    v_mfma_f32_16x16x32_bf16 v[12:15], v[108:111], v[92:95], v[12:15]
    v_mfma_f32_16x16x32_bf16 v[32:35], v[108:111], v[96:99], v[32:35]
    v_mfma_f32_16x16x32_bf16 v[52:55], v[108:111], v[100:103], v[52:55]
    v_mfma_f32_16x16x32_bf16 v[72:75], v[108:111], v[104:107], v[72:75]
    s_waitcnt vmcnt(30)
    v_mfma_f32_16x16x32_bf16 v[16:19], v[112:115], v[92:95], v[16:19]
    v_mfma_f32_16x16x32_bf16 v[36:39], v[112:115], v[96:99], v[36:39]
    v_mfma_f32_16x16x32_bf16 v[56:59], v[112:115], v[100:103], v[56:59]
    v_mfma_f32_16x16x32_bf16 v[76:79], v[112:115], v[104:107], v[76:79]
    s_waitcnt vmcnt(29)
    v_mfma_f32_16x16x32_bf16 v[20:23], v[116:119], v[92:95], v[20:23]
    v_mfma_f32_16x16x32_bf16 v[40:43], v[116:119], v[96:99], v[40:43]
    v_mfma_f32_16x16x32_bf16 v[60:63], v[116:119], v[100:103], v[60:63]
    v_mfma_f32_16x16x32_bf16 v[80:83], v[116:119], v[104:107], v[80:83]
    s_waitcnt vmcnt(28)
    v_mfma_f32_16x16x32_bf16 v[24:27], v[120:123], v[92:95], v[24:27]
    v_mfma_f32_16x16x32_bf16 v[44:47], v[120:123], v[96:99], v[44:47]
    v_mfma_f32_16x16x32_bf16 v[64:67], v[120:123], v[100:103], v[64:67]
    v_mfma_f32_16x16x32_bf16 v[84:87], v[120:123], v[104:107], v[84:87]
    s_waitcnt vmcnt(27)
    v_mfma_f32_16x16x32_bf16 v[28:31], v[124:127], v[92:95], v[28:31]
    v_mfma_f32_16x16x32_bf16 v[48:51], v[124:127], v[96:99], v[48:51]
    v_mfma_f32_16x16x32_bf16 v[68:71], v[124:127], v[100:103], v[68:71]
    v_mfma_f32_16x16x32_bf16 v[88:91], v[124:127], v[104:107], v[88:91]
    s_add_u32 s40, s35, 16384
    buffer_load_dwordx4 v[92:95], v5, s[12:15], s40 offen
    s_add_u32 s40, s35, 163840
    buffer_load_dwordx4 v[96:99], v5, s[12:15], s40 offen
    s_add_u32 s40, s35, 311296
    buffer_load_dwordx4 v[100:103], v5, s[12:15], s40 offen
    s_add_u32 s40, s35, 458752
    buffer_load_dwordx4 v[104:107], v5, s[12:15], s40 offen
    s_add_u32 s39, s37, 81920
    buffer_load_dwordx4 v[108:111], v5, s[8:11], s39 offen offset:0
    buffer_load_dwordx4 v[112:115], v5, s[8:11], s39 offen offset:1024
    buffer_load_dwordx4 v[116:119], v5, s[8:11], s39 offen offset:2048
    buffer_load_dwordx4 v[120:123], v5, s[8:11], s39 offen offset:3072
    s_add_u32 s39, s39, 4096
    buffer_load_dwordx4 v[124:127], v6, s[8:11], s39 offen
    s_waitcnt vmcnt(32)
    s_waitcnt vmcnt(31)
    v_mfma_f32_16x16x32_bf16 v[12:15], v[144:147], v[128:131], v[12:15]
    v_mfma_f32_16x16x32_bf16 v[32:35], v[144:147], v[132:135], v[32:35]
    v_mfma_f32_16x16x32_bf16 v[52:55], v[144:147], v[136:139], v[52:55]
    v_mfma_f32_16x16x32_bf16 v[72:75], v[144:147], v[140:143], v[72:75]
    s_waitcnt vmcnt(30)
    v_mfma_f32_16x16x32_bf16 v[16:19], v[148:151], v[128:131], v[16:19]
    v_mfma_f32_16x16x32_bf16 v[36:39], v[148:151], v[132:135], v[36:39]
    v_mfma_f32_16x16x32_bf16 v[56:59], v[148:151], v[136:139], v[56:59]
    v_mfma_f32_16x16x32_bf16 v[76:79], v[148:151], v[140:143], v[76:79]
    s_waitcnt vmcnt(29)
    v_mfma_f32_16x16x32_bf16 v[20:23], v[152:155], v[128:131], v[20:23]
    v_mfma_f32_16x16x32_bf16 v[40:43], v[152:155], v[132:135], v[40:43]
    v_mfma_f32_16x16x32_bf16 v[60:63], v[152:155], v[136:139], v[60:63]
    v_mfma_f32_16x16x32_bf16 v[80:83], v[152:155], v[140:143], v[80:83]
    s_waitcnt vmcnt(28)
    v_mfma_f32_16x16x32_bf16 v[24:27], v[156:159], v[128:131], v[24:27]
    v_mfma_f32_16x16x32_bf16 v[44:47], v[156:159], v[132:135], v[44:47]
    v_mfma_f32_16x16x32_bf16 v[64:67], v[156:159], v[136:139], v[64:67]
    v_mfma_f32_16x16x32_bf16 v[84:87], v[156:159], v[140:143], v[84:87]
    s_waitcnt vmcnt(27)
    v_mfma_f32_16x16x32_bf16 v[28:31], v[160:163], v[128:131], v[28:31]
    v_mfma_f32_16x16x32_bf16 v[48:51], v[160:163], v[132:135], v[48:51]
    v_mfma_f32_16x16x32_bf16 v[68:71], v[160:163], v[136:139], v[68:71]
    v_mfma_f32_16x16x32_bf16 v[88:91], v[160:163], v[140:143], v[88:91]
    s_add_u32 s40, s35, 17408
    buffer_load_dwordx4 v[128:131], v5, s[12:15], s40 offen
    s_add_u32 s40, s35, 164864
    buffer_load_dwordx4 v[132:135], v5, s[12:15], s40 offen
    s_add_u32 s40, s35, 312320
    buffer_load_dwordx4 v[136:139], v5, s[12:15], s40 offen
    s_add_u32 s40, s35, 459776
    buffer_load_dwordx4 v[140:143], v5, s[12:15], s40 offen
    s_add_u32 s39, s37, 87040
    buffer_load_dwordx4 v[144:147], v5, s[8:11], s39 offen offset:0
    buffer_load_dwordx4 v[148:151], v5, s[8:11], s39 offen offset:1024
    buffer_load_dwordx4 v[152:155], v5, s[8:11], s39 offen offset:2048
    buffer_load_dwordx4 v[156:159], v5, s[8:11], s39 offen offset:3072
    s_add_u32 s39, s39, 4096
    buffer_load_dwordx4 v[160:163], v6, s[8:11], s39 offen
    s_waitcnt vmcnt(32)
    s_waitcnt vmcnt(31)
    v_mfma_f32_16x16x32_bf16 v[12:15], v[180:183], v[164:167], v[12:15]
    v_mfma_f32_16x16x32_bf16 v[32:35], v[180:183], v[168:171], v[32:35]
    v_mfma_f32_16x16x32_bf16 v[52:55], v[180:183], v[172:175], v[52:55]
    v_mfma_f32_16x16x32_bf16 v[72:75], v[180:183], v[176:179], v[72:75]
    s_waitcnt vmcnt(30)
    v_mfma_f32_16x16x32_bf16 v[16:19], v[184:187], v[164:167], v[16:19]
    v_mfma_f32_16x16x32_bf16 v[36:39], v[184:187], v[168:171], v[36:39]
    v_mfma_f32_16x16x32_bf16 v[56:59], v[184:187], v[172:175], v[56:59]
    v_mfma_f32_16x16x32_bf16 v[76:79], v[184:187], v[176:179], v[76:79]
    s_waitcnt vmcnt(29)
    v_mfma_f32_16x16x32_bf16 v[20:23], v[188:191], v[164:167], v[20:23]
    v_mfma_f32_16x16x32_bf16 v[40:43], v[188:191], v[168:171], v[40:43]
    v_mfma_f32_16x16x32_bf16 v[60:63], v[188:191], v[172:175], v[60:63]
    v_mfma_f32_16x16x32_bf16 v[80:83], v[188:191], v[176:179], v[80:83]
    s_waitcnt vmcnt(28)
    v_mfma_f32_16x16x32_bf16 v[24:27], v[192:195], v[164:167], v[24:27]
    v_mfma_f32_16x16x32_bf16 v[44:47], v[192:195], v[168:171], v[44:47]
    v_mfma_f32_16x16x32_bf16 v[64:67], v[192:195], v[172:175], v[64:67]
    v_mfma_f32_16x16x32_bf16 v[84:87], v[192:195], v[176:179], v[84:87]
    s_waitcnt vmcnt(27)
    v_mfma_f32_16x16x32_bf16 v[28:31], v[196:199], v[164:167], v[28:31]
    v_mfma_f32_16x16x32_bf16 v[48:51], v[196:199], v[168:171], v[48:51]
    v_mfma_f32_16x16x32_bf16 v[68:71], v[196:199], v[172:175], v[68:71]
    v_mfma_f32_16x16x32_bf16 v[88:91], v[196:199], v[176:179], v[88:91]
    s_waitcnt vmcnt(23)
    s_waitcnt vmcnt(22)
    v_mfma_f32_16x16x32_bf16 v[12:15], v[216:219], v[200:203], v[12:15]
    v_mfma_f32_16x16x32_bf16 v[32:35], v[216:219], v[204:207], v[32:35]
    v_mfma_f32_16x16x32_bf16 v[52:55], v[216:219], v[208:211], v[52:55]
    v_mfma_f32_16x16x32_bf16 v[72:75], v[216:219], v[212:215], v[72:75]
    s_waitcnt vmcnt(21)
    v_mfma_f32_16x16x32_bf16 v[16:19], v[220:223], v[200:203], v[16:19]
    v_mfma_f32_16x16x32_bf16 v[36:39], v[220:223], v[204:207], v[36:39]
    v_mfma_f32_16x16x32_bf16 v[56:59], v[220:223], v[208:211], v[56:59]
    v_mfma_f32_16x16x32_bf16 v[76:79], v[220:223], v[212:215], v[76:79]
    s_waitcnt vmcnt(20)
    v_mfma_f32_16x16x32_bf16 v[20:23], v[224:227], v[200:203], v[20:23]
    v_mfma_f32_16x16x32_bf16 v[40:43], v[224:227], v[204:207], v[40:43]
    v_mfma_f32_16x16x32_bf16 v[60:63], v[224:227], v[208:211], v[60:63]
    v_mfma_f32_16x16x32_bf16 v[80:83], v[224:227], v[212:215], v[80:83]
    s_waitcnt vmcnt(19)
    v_mfma_f32_16x16x32_bf16 v[24:27], v[228:231], v[200:203], v[24:27]
    v_mfma_f32_16x16x32_bf16 v[44:47], v[228:231], v[204:207], v[44:47]
    v_mfma_f32_16x16x32_bf16 v[64:67], v[228:231], v[208:211], v[64:67]
    v_mfma_f32_16x16x32_bf16 v[84:87], v[228:231], v[212:215], v[84:87]
    s_waitcnt vmcnt(18)
    v_mfma_f32_16x16x32_bf16 v[28:31], v[232:235], v[200:203], v[28:31]
    v_mfma_f32_16x16x32_bf16 v[48:51], v[232:235], v[204:207], v[48:51]
    v_mfma_f32_16x16x32_bf16 v[68:71], v[232:235], v[208:211], v[68:71]
    v_mfma_f32_16x16x32_bf16 v[88:91], v[232:235], v[212:215], v[88:91]
    s_waitcnt vmcnt(14)
    s_waitcnt vmcnt(13)
    v_mfma_f32_16x16x32_bf16 v[12:15], v[108:111], v[92:95], v[12:15]
    v_mfma_f32_16x16x32_bf16 v[32:35], v[108:111], v[96:99], v[32:35]
    v_mfma_f32_16x16x32_bf16 v[52:55], v[108:111], v[100:103], v[52:55]
    v_mfma_f32_16x16x32_bf16 v[72:75], v[108:111], v[104:107], v[72:75]
    s_waitcnt vmcnt(12)
    v_mfma_f32_16x16x32_bf16 v[16:19], v[112:115], v[92:95], v[16:19]
    v_mfma_f32_16x16x32_bf16 v[36:39], v[112:115], v[96:99], v[36:39]
    v_mfma_f32_16x16x32_bf16 v[56:59], v[112:115], v[100:103], v[56:59]
    v_mfma_f32_16x16x32_bf16 v[76:79], v[112:115], v[104:107], v[76:79]
    s_waitcnt vmcnt(11)
    v_mfma_f32_16x16x32_bf16 v[20:23], v[116:119], v[92:95], v[20:23]
    v_mfma_f32_16x16x32_bf16 v[40:43], v[116:119], v[96:99], v[40:43]
    v_mfma_f32_16x16x32_bf16 v[60:63], v[116:119], v[100:103], v[60:63]
    v_mfma_f32_16x16x32_bf16 v[80:83], v[116:119], v[104:107], v[80:83]
    s_waitcnt vmcnt(10)
    v_mfma_f32_16x16x32_bf16 v[24:27], v[120:123], v[92:95], v[24:27]
    v_mfma_f32_16x16x32_bf16 v[44:47], v[120:123], v[96:99], v[44:47]
    v_mfma_f32_16x16x32_bf16 v[64:67], v[120:123], v[100:103], v[64:67]
    v_mfma_f32_16x16x32_bf16 v[84:87], v[120:123], v[104:107], v[84:87]
    s_waitcnt vmcnt(9)
    v_mfma_f32_16x16x32_bf16 v[28:31], v[124:127], v[92:95], v[28:31]
    v_mfma_f32_16x16x32_bf16 v[48:51], v[124:127], v[96:99], v[48:51]
    v_mfma_f32_16x16x32_bf16 v[68:71], v[124:127], v[100:103], v[68:71]
    v_mfma_f32_16x16x32_bf16 v[88:91], v[124:127], v[104:107], v[88:91]
    s_waitcnt vmcnt(5)
    s_waitcnt vmcnt(4)
    v_mfma_f32_16x16x32_bf16 v[12:15], v[144:147], v[128:131], v[12:15]
    v_mfma_f32_16x16x32_bf16 v[32:35], v[144:147], v[132:135], v[32:35]
    v_mfma_f32_16x16x32_bf16 v[52:55], v[144:147], v[136:139], v[52:55]
    v_mfma_f32_16x16x32_bf16 v[72:75], v[144:147], v[140:143], v[72:75]
    s_waitcnt vmcnt(3)
    v_mfma_f32_16x16x32_bf16 v[16:19], v[148:151], v[128:131], v[16:19]
    v_mfma_f32_16x16x32_bf16 v[36:39], v[148:151], v[132:135], v[36:39]
    v_mfma_f32_16x16x32_bf16 v[56:59], v[148:151], v[136:139], v[56:59]
    v_mfma_f32_16x16x32_bf16 v[76:79], v[148:151], v[140:143], v[76:79]
    s_waitcnt vmcnt(2)
    v_mfma_f32_16x16x32_bf16 v[20:23], v[152:155], v[128:131], v[20:23]
    v_mfma_f32_16x16x32_bf16 v[40:43], v[152:155], v[132:135], v[40:43]
    v_mfma_f32_16x16x32_bf16 v[60:63], v[152:155], v[136:139], v[60:63]
    v_mfma_f32_16x16x32_bf16 v[80:83], v[152:155], v[140:143], v[80:83]
    s_waitcnt vmcnt(1)
    v_mfma_f32_16x16x32_bf16 v[24:27], v[156:159], v[128:131], v[24:27]
    v_mfma_f32_16x16x32_bf16 v[44:47], v[156:159], v[132:135], v[44:47]
    v_mfma_f32_16x16x32_bf16 v[64:67], v[156:159], v[136:139], v[64:67]
    v_mfma_f32_16x16x32_bf16 v[84:87], v[156:159], v[140:143], v[84:87]
    s_waitcnt vmcnt(0)
    v_mfma_f32_16x16x32_bf16 v[28:31], v[160:163], v[128:131], v[28:31]
    v_mfma_f32_16x16x32_bf16 v[48:51], v[160:163], v[132:135], v[48:51]
    v_mfma_f32_16x16x32_bf16 v[68:71], v[160:163], v[136:139], v[68:71]
    v_mfma_f32_16x16x32_bf16 v[88:91], v[160:163], v[140:143], v[88:91]
    s_and_b32 s41, s3, 7
    s_mul_i32 s41, s41, 20480
    v_add_u32 v6, s41, v5
    ds_write_b128 v6, v[12:15] offset:0
    ds_write_b128 v6, v[16:19] offset:1024
    ds_write_b128 v6, v[20:23] offset:2048
    ds_write_b128 v6, v[24:27] offset:3072
    ds_write_b128 v6, v[28:31] offset:4096
    ds_write_b128 v6, v[32:35] offset:5120
    ds_write_b128 v6, v[36:39] offset:6144
    ds_write_b128 v6, v[40:43] offset:7168
    ds_write_b128 v6, v[44:47] offset:8192
    ds_write_b128 v6, v[48:51] offset:9216
    ds_write_b128 v6, v[52:55] offset:10240
    ds_write_b128 v6, v[56:59] offset:11264
    ds_write_b128 v6, v[60:63] offset:12288
    ds_write_b128 v6, v[64:67] offset:13312
    ds_write_b128 v6, v[68:71] offset:14336
    ds_write_b128 v6, v[72:75] offset:15360
    ds_write_b128 v6, v[76:79] offset:16384
    ds_write_b128 v6, v[80:83] offset:17408
    ds_write_b128 v6, v[84:87] offset:18432
    ds_write_b128 v6, v[88:91] offset:19456
    s_lshr_b32 s42, s3, 1
    s_and_b32 s43, s3, 1
    s_mul_i32 s44, s42, 5
    s_lshl_b32 s45, s43, 1
    s_add_u32 s45, s45, s44
    s_lshl_b32 s45, s45, 10
    v_add_u32 v7, s45, v5
    s_add_u32 s46, s44, 4
    s_lshl_b32 s46, s46, 10
    v_add_u32 v8, s46, v5
    s_lshl_b32 s47, s32, 2
    s_add_u32 s47, s47, s42
    s_mul_i32 s48, s33, 9
    s_lshl_b32 s49, s43, 2
    s_add_u32 s49, s49, s48
    v_add_u32 v9, s49, v4
    v_lshrrev_b32 v10, 2, v9
    v_and_b32 v11, 3, v9
    v_lshlrev_b32 v10, 10, v10
    v_lshl_add_u32 v10, v11, 8, v10
    v_lshl_add_u32 v10, v3, 4, v10
    s_add_u32 s50, s48, 8
    s_lshr_b32 s51, s50, 2
    s_lshl_b32 s51, s51, 10
    s_and_b32 s54, s50, 3
    s_lshl_b32 s54, s54, 8
    s_add_u32 s51, s51, s54
    v_lshlrev_b32 v92, 4, v3
    v_lshl_add_u32 v92, v4, 3, v92
    v_add_u32 v92, s51, v92
    v_mov_b32 v93, 0x7ff00000
    v_cmp_gt_u32 s[56:57], 2, v4
    s_nop 1
    v_cndmask_b32 v92, v93, v92, s[56:57]
    s_mul_i32 s55, s47, 18432
    v_lshlrev_b32 v94, 4, v9
    s_lshl_b32 s58, s50, 4
    v_lshlrev_b32 v95, 3, v4
    v_add_u32 v95, s58, v95
    v_cndmask_b32 v95, v93, v95, s[56:57]
    buffer_load_dwordx4 v[96:99], v10, s[16:19], s55 offen
    buffer_load_dwordx2 v[100:101], v92, s[16:19], s55 offen
    buffer_load_dwordx4 v[102:105], v94, s[24:27], 0 offen
    buffer_load_dwordx2 v[106:107], v95, s[24:27], 0 offen
    v_mul_u32_u24 v10, 1152, v3
    v_lshl_add_u32 v10, v9, 4, v10
    v_mul_u32_u24 v92, 1152, v3
    v_lshl_add_u32 v92, v4, 3, v92
    v_add_u32 v92, s58, v92
    v_cndmask_b32 v92, v93, v92, s[56:57]
    s_mul_i32 s59, s47, 18432
    v_add_u32 v108, 0x10000, v7
    v_add_u32 v109, 0x20000, v7
    v_add_u32 v110, 0x10000, v8
    v_add_u32 v111, 0x20000, v8
    s_waitcnt lgkmcnt(0)
    s_barrier
    ds_read_b128 v[12:15], v7 offset:0
    ds_read_b128 v[16:19], v7 offset:1024
    ds_read_b128 v[20:23], v7 offset:20480
    ds_read_b128 v[24:27], v7 offset:21504
    ds_read_b128 v[28:31], v7 offset:40960
    ds_read_b128 v[32:35], v7 offset:41984
    ds_read_b128 v[36:39], v7 offset:61440
    ds_read_b128 v[40:43], v7 offset:62464
    ds_read_b128 v[44:47], v108 offset:16384
    ds_read_b128 v[48:51], v108 offset:17408
    ds_read_b128 v[52:55], v108 offset:36864
    ds_read_b128 v[56:59], v108 offset:37888
    ds_read_b128 v[60:63], v108 offset:57344
    ds_read_b128 v[64:67], v108 offset:58368
    ds_read_b128 v[68:71], v109 offset:12288
    ds_read_b128 v[72:75], v109 offset:13312
    s_waitcnt lgkmcnt(0)
    v_add_f32 v76, v12, v20
    v_add_f32 v76, v76, v28
    v_add_f32 v76, v76, v36
    v_add_f32 v76, v76, v44
    v_add_f32 v76, v76, v52
    v_add_f32 v76, v76, v60
    v_add_f32 v76, v76, v68
    v_add_f32 v77, v13, v21
    v_add_f32 v77, v77, v29
    v_add_f32 v77, v77, v37
    v_add_f32 v77, v77, v45
    v_add_f32 v77, v77, v53
    v_add_f32 v77, v77, v61
    v_add_f32 v77, v77, v69
    v_add_f32 v78, v14, v22
    v_add_f32 v78, v78, v30
    v_add_f32 v78, v78, v38
    v_add_f32 v78, v78, v46
    v_add_f32 v78, v78, v54
    v_add_f32 v78, v78, v62
    v_add_f32 v78, v78, v70
    v_add_f32 v79, v15, v23
    v_add_f32 v79, v79, v31
    v_add_f32 v79, v79, v39
    v_add_f32 v79, v79, v47
    v_add_f32 v79, v79, v55
    v_add_f32 v79, v79, v63
    v_add_f32 v79, v79, v71
    v_add_f32 v80, v16, v24
    v_add_f32 v80, v80, v32
    v_add_f32 v80, v80, v40
    v_add_f32 v80, v80, v48
    v_add_f32 v80, v80, v56
    v_add_f32 v80, v80, v64
    v_add_f32 v80, v80, v72
    v_add_f32 v81, v17, v25
    v_add_f32 v81, v81, v33
    v_add_f32 v81, v81, v41
    v_add_f32 v81, v81, v49
    v_add_f32 v81, v81, v57
    v_add_f32 v81, v81, v65
    v_add_f32 v81, v81, v73
    v_add_f32 v82, v18, v26
    v_add_f32 v82, v82, v34
    v_add_f32 v82, v82, v42
    v_add_f32 v82, v82, v50
    v_add_f32 v82, v82, v58
    v_add_f32 v82, v82, v66
    v_add_f32 v82, v82, v74
    v_add_f32 v83, v19, v27
    v_add_f32 v83, v83, v35
    v_add_f32 v83, v83, v43
    v_add_f32 v83, v83, v51
    v_add_f32 v83, v83, v59
    v_add_f32 v83, v83, v67
    v_add_f32 v83, v83, v75
    s_waitcnt vmcnt(0)
    v_cvt_pk_bf16_f32 v120, v76, v77
    v_lshlrev_b32 v76, 16, v120
    v_and_b32 v77, 0xffff0000, v120
    v_cvt_pk_bf16_f32 v120, v78, v79
    v_lshlrev_b32 v78, 16, v120
    v_and_b32 v79, 0xffff0000, v120
    v_cvt_pk_bf16_f32 v120, v80, v81
    v_lshlrev_b32 v80, 16, v120
    v_and_b32 v81, 0xffff0000, v120
    v_cvt_pk_bf16_f32 v120, v82, v83
    v_lshlrev_b32 v82, 16, v120
    v_and_b32 v83, 0xffff0000, v120
    v_lshlrev_b32 v121, 16, v102
    v_and_b32 v122, 0xffff0000, v102
    v_add_f32 v76, v76, v121
    v_add_f32 v77, v77, v122
    v_lshlrev_b32 v121, 16, v103
    v_and_b32 v122, 0xffff0000, v103
    v_add_f32 v78, v78, v121
    v_add_f32 v79, v79, v122
    v_lshlrev_b32 v121, 16, v104
    v_and_b32 v122, 0xffff0000, v104
    v_add_f32 v80, v80, v121
    v_add_f32 v81, v81, v122
    v_lshlrev_b32 v121, 16, v105
    v_and_b32 v122, 0xffff0000, v105
    v_add_f32 v82, v82, v121
    v_add_f32 v83, v83, v122
    v_cvt_pk_bf16_f32 v120, v76, v77
    v_lshlrev_b32 v76, 16, v120
    v_and_b32 v77, 0xffff0000, v120
    v_cvt_pk_bf16_f32 v120, v78, v79
    v_lshlrev_b32 v78, 16, v120
    v_and_b32 v79, 0xffff0000, v120
    v_cvt_pk_bf16_f32 v120, v80, v81
    v_lshlrev_b32 v80, 16, v120
    v_and_b32 v81, 0xffff0000, v120
    v_cvt_pk_bf16_f32 v120, v82, v83
    v_lshlrev_b32 v82, 16, v120
    v_and_b32 v83, 0xffff0000, v120
    v_lshlrev_b32 v121, 16, v96
    v_and_b32 v122, 0xffff0000, v96
    v_add_f32 v76, v76, v121
    v_add_f32 v77, v77, v122
    v_lshlrev_b32 v121, 16, v97
    v_and_b32 v122, 0xffff0000, v97
    v_add_f32 v78, v78, v121
    v_add_f32 v79, v79, v122
    v_lshlrev_b32 v121, 16, v98
    v_and_b32 v122, 0xffff0000, v98
    v_add_f32 v80, v80, v121
    v_add_f32 v81, v81, v122
    v_lshlrev_b32 v121, 16, v99
    v_and_b32 v122, 0xffff0000, v99
    v_add_f32 v82, v82, v121
    v_add_f32 v83, v83, v122
    v_cvt_pk_bf16_f32 v112, v76, v77
    v_cvt_pk_bf16_f32 v113, v78, v79
    v_cvt_pk_bf16_f32 v114, v80, v81
    v_cvt_pk_bf16_f32 v115, v82, v83
    buffer_store_dwordx4 v[112:115], v10, s[20:23], s59 offen sc1
    s_cmp_eq_u32 s43, 0
    s_nop 0
    s_cbranch_scc0 .noodd_k4l1_kernel_3
    ds_read_b128 v[12:15], v8 offset:0
    ds_read_b128 v[16:19], v8 offset:20480
    ds_read_b128 v[20:23], v8 offset:40960
    ds_read_b128 v[24:27], v8 offset:61440
    ds_read_b128 v[28:31], v110 offset:16384
    ds_read_b128 v[32:35], v110 offset:36864
    ds_read_b128 v[36:39], v110 offset:57344
    ds_read_b128 v[40:43], v111 offset:12288
    s_waitcnt lgkmcnt(0)
    v_add_f32 v84, v12, v16
    v_add_f32 v84, v84, v20
    v_add_f32 v84, v84, v24
    v_add_f32 v84, v84, v28
    v_add_f32 v84, v84, v32
    v_add_f32 v84, v84, v36
    v_add_f32 v84, v84, v40
    v_add_f32 v85, v13, v17
    v_add_f32 v85, v85, v21
    v_add_f32 v85, v85, v25
    v_add_f32 v85, v85, v29
    v_add_f32 v85, v85, v33
    v_add_f32 v85, v85, v37
    v_add_f32 v85, v85, v41
    v_add_f32 v86, v14, v18
    v_add_f32 v86, v86, v22
    v_add_f32 v86, v86, v26
    v_add_f32 v86, v86, v30
    v_add_f32 v86, v86, v34
    v_add_f32 v86, v86, v38
    v_add_f32 v86, v86, v42
    v_add_f32 v87, v15, v19
    v_add_f32 v87, v87, v23
    v_add_f32 v87, v87, v27
    v_add_f32 v87, v87, v31
    v_add_f32 v87, v87, v35
    v_add_f32 v87, v87, v39
    v_add_f32 v87, v87, v43
    v_cvt_pk_bf16_f32 v120, v84, v85
    v_lshlrev_b32 v84, 16, v120
    v_and_b32 v85, 0xffff0000, v120
    v_cvt_pk_bf16_f32 v120, v86, v87
    v_lshlrev_b32 v86, 16, v120
    v_and_b32 v87, 0xffff0000, v120
    v_lshlrev_b32 v121, 16, v106
    v_and_b32 v122, 0xffff0000, v106
    v_add_f32 v84, v84, v121
    v_add_f32 v85, v85, v122
    v_lshlrev_b32 v121, 16, v107
    v_and_b32 v122, 0xffff0000, v107
    v_add_f32 v86, v86, v121
    v_add_f32 v87, v87, v122
    v_cvt_pk_bf16_f32 v120, v84, v85
    v_lshlrev_b32 v84, 16, v120
    v_and_b32 v85, 0xffff0000, v120
    v_cvt_pk_bf16_f32 v120, v86, v87
    v_lshlrev_b32 v86, 16, v120
    v_and_b32 v87, 0xffff0000, v120
    v_lshlrev_b32 v121, 16, v100
    v_and_b32 v122, 0xffff0000, v100
    v_add_f32 v84, v84, v121
    v_add_f32 v85, v85, v122
    v_lshlrev_b32 v121, 16, v101
    v_and_b32 v122, 0xffff0000, v101
    v_add_f32 v86, v86, v121
    v_add_f32 v87, v87, v122
    v_cvt_pk_bf16_f32 v116, v84, v85
    v_cvt_pk_bf16_f32 v117, v86, v87
    buffer_store_dwordx2 v[116:117], v92, s[20:23], s59 offen sc1
    s_nop 0
    s_branch .join_k4l1_kernel_4
.noodd_k4l1_kernel_3:
    s_branch .join_k4l1_kernel_4
.join_k4l1_kernel_4:
.End_k4l1_kernel_1:
    s_endpgm
.section .rodata,"a"
.p2align 6
.amdhsa_kernel prep_kernel
  .amdhsa_next_free_vgpr 108
  .amdhsa_next_free_sgpr 64
  .amdhsa_accum_offset 108
  .amdhsa_group_segment_fixed_size 0
  .amdhsa_kernarg_size 96
  .amdhsa_user_sgpr_count 2
  .amdhsa_user_sgpr_kernarg_segment_ptr 1
  .amdhsa_system_sgpr_workgroup_id_x 1
  .amdhsa_float_denorm_mode_32 3
.end_amdhsa_kernel
.p2align 6
.amdhsa_kernel k1l0_kernel
  .amdhsa_next_free_vgpr 222
  .amdhsa_next_free_sgpr 52
  .amdhsa_accum_offset 224
  .amdhsa_group_segment_fixed_size 0
  .amdhsa_kernarg_size 96
  .amdhsa_user_sgpr_count 2
  .amdhsa_user_sgpr_kernarg_segment_ptr 1
  .amdhsa_system_sgpr_workgroup_id_x 1
  .amdhsa_float_denorm_mode_32 3
.end_amdhsa_kernel
.p2align 6
.amdhsa_kernel k2l0_kernel
  .amdhsa_next_free_vgpr 256
  .amdhsa_next_free_sgpr 58
  .amdhsa_accum_offset 256
  .amdhsa_group_segment_fixed_size 0
  .amdhsa_kernarg_size 96
  .amdhsa_user_sgpr_count 2
  .amdhsa_user_sgpr_kernarg_segment_ptr 1
  .amdhsa_system_sgpr_workgroup_id_x 1
  .amdhsa_float_denorm_mode_32 3
.end_amdhsa_kernel
.p2align 6
.amdhsa_kernel k3l0_kernel
  .amdhsa_next_free_vgpr 244
  .amdhsa_next_free_sgpr 51
  .amdhsa_accum_offset 244
  .amdhsa_group_segment_fixed_size 0
  .amdhsa_kernarg_size 96
  .amdhsa_user_sgpr_count 2
  .amdhsa_user_sgpr_kernarg_segment_ptr 1
  .amdhsa_system_sgpr_workgroup_id_x 1
  .amdhsa_float_denorm_mode_32 3
.end_amdhsa_kernel
.p2align 6
.amdhsa_kernel k4l0_kernel
  .amdhsa_next_free_vgpr 236
  .amdhsa_next_free_sgpr 62
  .amdhsa_accum_offset 236
  .amdhsa_group_segment_fixed_size 0
  .amdhsa_kernarg_size 96
  .amdhsa_user_sgpr_count 2
  .amdhsa_user_sgpr_kernarg_segment_ptr 1
  .amdhsa_system_sgpr_workgroup_id_x 1
  .amdhsa_float_denorm_mode_32 3
.end_amdhsa_kernel
.p2align 6
.amdhsa_kernel k1l1_kernel
  .amdhsa_next_free_vgpr 222
  .amdhsa_next_free_sgpr 52
  .amdhsa_accum_offset 224
  .amdhsa_group_segment_fixed_size 0
  .amdhsa_kernarg_size 96
  .amdhsa_user_sgpr_count 2
  .amdhsa_user_sgpr_kernarg_segment_ptr 1
  .amdhsa_system_sgpr_workgroup_id_x 1
  .amdhsa_float_denorm_mode_32 3
.end_amdhsa_kernel
.p2align 6
.amdhsa_kernel k2l1_kernel
  .amdhsa_next_free_vgpr 256
  .amdhsa_next_free_sgpr 58
  .amdhsa_accum_offset 256
  .amdhsa_group_segment_fixed_size 0
  .amdhsa_kernarg_size 96
  .amdhsa_user_sgpr_count 2
  .amdhsa_user_sgpr_kernarg_segment_ptr 1
  .amdhsa_system_sgpr_workgroup_id_x 1
  .amdhsa_float_denorm_mode_32 3
.end_amdhsa_kernel
.p2align 6
.amdhsa_kernel k3l1_kernel
  .amdhsa_next_free_vgpr 244
  .amdhsa_next_free_sgpr 51
  .amdhsa_accum_offset 244
  .amdhsa_group_segment_fixed_size 0
  .amdhsa_kernarg_size 96
  .amdhsa_user_sgpr_count 2
  .amdhsa_user_sgpr_kernarg_segment_ptr 1
  .amdhsa_system_sgpr_workgroup_id_x 1
  .amdhsa_float_denorm_mode_32 3
.end_amdhsa_kernel
.p2align 6
.amdhsa_kernel k4l1_kernel
  .amdhsa_next_free_vgpr 236
  .amdhsa_next_free_sgpr 60
  .amdhsa_accum_offset 236
  .amdhsa_group_segment_fixed_size 0
  .amdhsa_kernarg_size 96
  .amdhsa_user_sgpr_count 2
  .amdhsa_user_sgpr_kernarg_segment_ptr 1
  .amdhsa_system_sgpr_workgroup_id_x 1
  .amdhsa_float_denorm_mode_32 3
.end_amdhsa_kernel
```
